```python
import torch

def _softmax(x, axis=-1):
    return torch.softmax(x, dim=axis)

def _gelu(x):
    return torch.nn.functional.gelu(x, approximate='tanh')

def _silu(x):
    return torch.nn.functional.silu(x)

def _sigmoid(x):
    return torch.sigmoid(x)

def _layernorm(x, axis=-1, eps=1e-05):
    m = x.mean(dim=axis, keepdim=True)
    v = x.var(dim=axis, keepdim=True, unbiased=False)
    return (x - m) / torch.sqrt(v + eps)

def _scatter_add(tgt, idx, src, axis=0):
    return tgt.clone().index_add_(axis, idx, src)

def _segment_sum(src, seg, n):
    out = torch.zeros((n,) + src.shape[1:], dtype=src.dtype)
    return out.index_add_(0, seg, src)

def _pad(x, pw):
    flat = tuple((v for pair in reversed(pw) for v in pair))
    return torch.nn.functional.pad(x, flat)
kernel_name = 'standalone__varlen_attn_packed__ragged'

def setup_inputs():

    _w = lambda a: (lambda t: t.to(torch.bfloat16) if t.is_floating_point() else t)(torch.as_tensor(a))
    cu = torch.tensor([0, 580, 1085, 2082, 2797, 3498, 4341, 5079, 6042], dtype=torch.int64)
    T, H, D = (int(cu[-1]), 16, 128)
    return {'q': _w((lambda *s: torch.randn(*s, dtype=torch.bfloat16) * 0.8)(T, H, D)), 'k': _w((lambda *s: torch.randn(*s, dtype=torch.bfloat16) * 0.8)(T, H, D)), 'v': _w((lambda *s: torch.randn(*s, dtype=torch.bfloat16) * 0.05)(T, H, D)), 'cu': _w(cu)}

def reference(q, k, v, cu):
    T, H, D = q.shape
    out = torch.zeros_like(q)
    scale = D ** (-0.5)
    outs = []
    for i in range(len(cu) - 1):
        s, e = (int(cu[i]), int(cu[i + 1]))
        qi, ki, vi = (q[s:e].clone(), k[s:e].clone(), v[s:e].clone())
        p = _softmax(torch.einsum('qhd,khd->hqk', qi, ki) * scale, axis=-1)
        outs.append(torch.einsum('hqk,khd->qhd', p, vi))
    return torch.concatenate(outs, axis=0)
```

```asm
; @launch grid=(256,1,1) block=(256,1,1) lds=152064
.amdgcn_target "amdgcn-amd-amdhsa--gfx950"
.text
.globl standalone__varlen_attn_packed__ragged_kernel
.p2align 8
.type standalone__varlen_attn_packed__ragged_kernel,@function
standalone__varlen_attn_packed__ragged_kernel:
s_cmp_ge_u32 s2, 256
s_cbranch_scc1 L_end
s_load_dwordx4 s[16:19], s[0:1], 0
s_load_dwordx2 s[20:21], s[0:1], 16
s_getpc_b64 s[80:81]
L_pc:
s_lshr_b32 s76, s2, 3
s_lshl_b32 s77, s76, 4
s_add_u32 s77, s77, L_table-L_pc
s_add_u32 s82, s80, s77
s_addc_u32 s83, s81, 0
s_load_dwordx4 s[84:87], s[82:83], 0
s_load_dwordx2 s[12:13], s[0:1], 32
s_lshl_b32 s77, s76, 12
v_min_u32 v128, 31, v0
v_lshl_add_u32 v128, v128, 7, s77
v_min_u32 v128, L_slow-L_pc-8, v128
global_load_dword v132, v128, s[80:81]
v_lshrrev_b32 v13, 6, v0
v_bfe_u32 v14, v0, 4, 2
v_readfirstlane_b32 s72, v13
v_and_b32 v15, 15, v0
v_lshlrev_b32 v3, 13, v13
v_lshl_add_u32 v3, v14, 15, v3
v_lshl_add_u32 v3, v15, 4, v3
v_add_u32 v4, 3040, v3
s_mov_b32 s7, 0x20000
s_mov_b32 s11, 0x20000
s_mul_i32 s28, s72, 4160
s_and_b32 s76, s2, 7
s_lshl_b32 s76, s76, 9
s_mov_b32 m0, s28
s_waitcnt lgkmcnt(0)
s_add_u32 s22, s16, 128992
s_addc_u32 s23, s17, 0
s_bfe_u32 s77, s84, 0x10011
s_lshl_b32 s77, s77, 8
s_add_u32 s77, s77, s76
s_and_b32 s36, s84, 0x1fff
s_lshl_b32 s36, s36, 12
s_add_u32 s36, s36, s77
s_lshr_b32 s38, s85, 13
s_lshl_b32 s38, s38, 12
s_mov_b64 s[4:5], s[16:17]
s_mov_b64 s[8:9], s[22:23]
s_sub_u32 s10, s38, 128992
s_mov_b32 s6, s38
s_mov_b32 s27, s36
buffer_load_dwordx4 v3, s[4:7], s27 offen lds
buffer_load_dwordx4 v4, s[4:7], s27 offen offset:1056 lds
buffer_load_dwordx4 v3, s[8:11], s27 offen offset:2080 lds
buffer_load_dwordx4 v4, s[8:11], s27 offen offset:3136 lds
s_add_u32 m0, s28, 16640
s_add_u32 s27, s27, 262144
s_sub_u32 s20, s20, 2080
s_subb_u32 s21, s21, 0
s_and_b32 s37, s85, 0x1fff
s_lshl_b32 s37, s37, 12
s_add_u32 s37, s37, s77
s_bfe_u32 s39, s84, 0x3000d
s_lshr_b32 s40, s84, 20
s_sub_u32 s24, s40, 1
s_lshl_b32 s24, s24, 17
s_add_u32 s24, s24, s37
s_mov_b64 s[4:5], s[18:19]
s_mov_b64 s[8:9], s[20:21]
s_add_u32 s10, s38, 2080
buffer_load_dwordx4 v3, s[4:7], s24 offen lds
buffer_load_dwordx4 v4, s[4:7], s24 offen offset:1056 lds
buffer_load_dwordx4 v3, s[8:11], s24 offen offset:2080 lds
buffer_load_dwordx4 v4, s[8:11], s24 offen offset:3136 lds
s_add_u32 m0, s28, 33280
s_add_u32 s24, s24, -131072
buffer_load_dwordx4 v3, s[4:7], s24 offen lds
buffer_load_dwordx4 v4, s[4:7], s24 offen offset:1056 lds
buffer_load_dwordx4 v3, s[8:11], s24 offen offset:2080 lds
buffer_load_dwordx4 v4, s[8:11], s24 offen offset:3136 lds
s_add_u32 m0, s28, 49920
s_add_u32 s24, s24, -131072
v_bfe_u32 v133, v0, 2, 2
v_cmp_eq_u32 vcc, v133, v14
v_and_b32 v133, 1, v0
v_lshlrev_b32 v133, 4, v133
v_cndmask_b32 v134, 0, 1, vcc
v_lshlrev_b32 v134, v133, v134
v_bfe_u32 v133, v0, 1, 1
v_mul_u32_u24 v135, v133, v134
v_sub_u32 v134, v134, v135
v_mul_u32_u24 v133, 0x3e03, v134
v_accvgpr_write_b32 a146, v133
v_mul_u32_u24 v133, 0x3e03, v135
v_accvgpr_write_b32 a147, v133
v_mul_u32_u24 v133, 0xb9d8, v134
v_accvgpr_write_b32 a150, v133
v_mul_u32_u24 v133, 0xb9d8, v135
v_accvgpr_write_b32 a151, v133
v_accvgpr_write_b32 a144, 0
v_accvgpr_write_b32 a145, 0
v_accvgpr_write_b32 a148, 0
v_accvgpr_write_b32 a149, 0
v_accvgpr_write_b32 a152, 0
v_accvgpr_write_b32 a153, 0
s_mov_b32 s78, 2080
v_and_b32 v128, 63, v0
v_and_b32 v11, 1, v128
v_mul_u32_u24 v11, 1056, v11
v_bfe_u32 v129, v128, 3, 1
v_mad_u32_u24 v11, v129, s78, v11
v_bfe_u32 v129, v128, 1, 2
v_lshl_add_u32 v11, v129, 8, v11
v_lshl_add_u32 v11, v14, 4, v11
v_mul_u32_u24 v129, 4160, v13
v_add_u32 v11, v11, v129
v_lshrrev_b32 v5, 3, v128
v_bfe_u32 v6, v128, 3, 1
v_lshl_add_u32 v6, v13, 1, v6
v_lshl_add_u32 v6, v14, 3, v6
v_lshlrev_b32 v6, 12, v6
v_and_b32 v129, 3, v128
v_lshl_add_u32 v6, v129, 5, v6
v_bfe_u32 v129, v128, 2, 1
v_lshl_add_u32 v6, v129, 4, v6
v_lshlrev_b32 v130, 12, v13
v_add_u32 v130, 134400, v130
v_lshl_add_u32 v5, v14, 10, v130
v_lshl_add_u32 v5, v15, 3, v5
v_xor_b32 v137, 32, v5
v_bfe_u32 v129, v128, 1, 1
v_lshl_add_u32 v56, v14, 9, v130
v_mul_u32_u24 v129, 0x120, v129
v_add_u32 v56, v56, v129
v_and_b32 v129, 1, v128
v_lshl_add_u32 v56, v129, 6, v56
v_bfe_u32 v129, v128, 2, 2
v_lshl_add_u32 v56, v129, 3, v56
v_and_b32 v129, 1, v14
v_lshl_add_u32 v56, v129, 7, v56
v_xor_b32 v57, 32, v56
v_xor_b32 v58, 0x80, v56
v_xor_b32 v59, 0xa0, v56
v_lshlrev_b32 v130, 6, v13
v_add_u32 v130, 150784, v130
v_lshl_add_u32 v60, v15, 2, v130
v_lshl_add_u32 v61, v14, 4, v130
v_bfe_u32 v1, v128, 1, 2
v_mul_u32_u24 v1, 4160, v1
v_and_b32 v129, 1, v128
v_mul_u32_u24 v130, 1056, v129
v_add_u32 v1, v1, v130
v_bfe_u32 v130, v128, 3, 1
v_lshl_add_u32 v1, v130, 8, v1
v_lshl_add_u32 v1, v14, 4, v1
v_sub_u32 v7, v11, v1
v_bfe_u32 v2, v128, 3, 2
v_mul_u32_u24 v2, 4160, v2
v_bfe_u32 v130, v128, 2, 1
v_mul_u32_u24 v130, 1056, v130
v_add_u32 v2, v2, v130
v_lshrrev_b32 v130, 5, v128
v_lshl_add_u32 v2, v130, 8, v2
v_and_b32 v130, 3, v128
v_lshl_add_u32 v2, v130, 3, v2
v_add_u32 v2, 2080, v2
v_mul_u32_u24 v9, 260, v130
v_add_u32 v9, 133120, v9
v_lshlrev_b32 v8, 2, v0
v_add_u32 v8, 133120, v8
v_mov_b32 v10, 1
v_mov_b32 v0, v137
v_mov_b32 v12, 0
ds_write_b32 v8, v12
v_mov_b32 v136, 0x3f803f80
v_accvgpr_write_b32 a128, v136
v_accvgpr_write_b32 a129, v136
v_accvgpr_write_b32 a130, v136
v_accvgpr_write_b32 a131, v136
s_add_u32 s29, s28, 133120
s_mov_b32 s33, 0
s_mov_b32 s34, 16640
s_mov_b32 s35, -116480
s_mov_b32 s74, 0x3e0293ee
s_mov_b32 s15, 0x20000
s_mov_b32 s14, 0
s_mov_b32 s25, -131072
s_bfe_u32 s77, s86, 0x10011
s_lshl_b32 s77, s77, 8
s_add_u32 s77, s77, s76
s_and_b32 s41, s86, 0x1fff
s_lshl_b32 s41, s41, 12
s_add_u32 s41, s41, s77
s_lshr_b32 s43, s87, 13
s_lshl_b32 s43, s43, 12
s_and_b32 s42, s87, 0x1fff
s_lshl_b32 s42, s42, 12
s_add_u32 s42, s42, s77
s_bfe_u32 s44, s86, 0x3000d
s_lshr_b32 s45, s86, 20
s_mov_b64 s[52:53], s[16:17]
s_mov_b64 s[54:55], s[22:23]
s_mov_b32 s56, s41
s_mov_b32 s57, 262144
s_mov_b64 s[62:63], s[18:19]
s_mov_b64 s[64:65], s[20:21]
s_sub_u32 s70, s45, 1
s_lshl_b32 s66, s70, 17
s_add_u32 s66, s66, s42
s_mov_b32 s67, -131072
s_mov_b32 s58, s43
s_sub_u32 s59, s43, 128992
s_sub_u32 s60, s44, 1
s_mov_b32 s68, s43
s_add_u32 s69, s43, 2080
s_cmp_eq_u32 s44, 0
s_cmov_b64 s[58:59], 0
s_cmov_b32 s60, 0x7fffffff
s_mov_b32 s46, s36
s_mov_b32 s47, s38
s_mov_b32 s49, s40
s_lshr_b32 s77, s38, 12
s_lshr_b32 s78, s37, 12
s_sub_u32 s77, s77, s78
s_lshl_b32 s78, s40, 5
s_sub_u32 s77, s77, s78
s_add_u32 s50, s77, 32
s_bfe_u32 s73, s86, 0x4000d
s_waitcnt lgkmcnt(0)
s_bfe_u32 s77, s84, 0x4000d
s_cmp_eq_u32 s77, 11
s_cbranch_scc1 L_first11
s_cmp_eq_u32 s77, 12
s_cbranch_scc1 L_first12
s_cmp_eq_u32 s77, 13
s_cbranch_scc1 L_first13
s_branch L_first14
L_first11:
s_mov_b64 s[4:5], s[16:17]
s_mov_b64 s[8:9], s[22:23]
s_sub_u32 s10, s38, 128992
v_add_u32 v1, 16640, v1
v_add_u32 v2, 16640, v2
v_mbcnt_lo_u32_b32 v13, -1, 0
v_mbcnt_hi_u32_b32 v13, -1, v13
v_lshrrev_b32 v13, 2, v13
v_and_b32 v13, 12, v13
v_sub_u32 v13, s50, v13
v_cvt_f32_i32 v13, v13
v_mov_b32 v14, 0x7c800000
v_fmaak_f32 v16, v13, v14, 0xfc000000
v_fmaak_f32 v17, v13, v14, 0xfcc00000
v_fmaak_f32 v18, v13, v14, 0xfd200000
v_fmaak_f32 v19, v13, v14, 0xfd600000
v_min_f32 v16, 0, v16
v_min_f32 v17, 0, v17
v_min_f32 v18, 0, v18
v_min_f32 v19, 0, v19
v_mov_b32 v42, 0
v_mov_b32 v43, 0
s_mov_b32 s30, 1
s_sub_u32 s26, s40, 8
s_sub_u32 s32, s49, 5
s_waitcnt vmcnt(8)
buffer_load_dwordx4 v3, s[4:7], s27 offen lds
buffer_load_dwordx4 v4, s[4:7], s27 offen offset:1056 lds
ds_read_b128 v[192:195], v11 offset:0
ds_read_b128 v[196:199], v11 offset:64
ds_read_b128 v[200:203], v11 offset:128
ds_read_b128 v[204:207], v11 offset:192
v_add_u32 v11, 49920, v11
buffer_load_dwordx4 v3, s[8:11], s27 offen offset:2080 lds
buffer_load_dwordx4 v4, s[8:11], s27 offen offset:3136 lds
s_waitcnt lgkmcnt(3)
v_mfma_f32_16x16x32_bf16 v[64:67], a[146:149], v[192:195], 0
s_add_u32 m0, s28, 66560
s_add_u32 s27, s27, 262144
v_mfma_f32_16x16x32_bf16 v[68:71], a[144:147], v[192:195], 0
v_mfma_f32_16x16x32_bf16 v[64:67], a[150:153], v[192:195], v[64:67]
v_mfma_f32_16x16x32_bf16 v[68:71], a[148:151], v[192:195], v[68:71]
s_waitcnt lgkmcnt(2)
v_mfma_f32_16x16x32_bf16 v[72:75], a[146:149], v[196:199], 0
s_nop 4
v_cvt_pk_bf16_f32 v192, v64, v65
v_mfma_f32_16x16x32_bf16 v[76:79], a[144:147], v[196:199], 0
v_cvt_pk_bf16_f32 v193, v66, v67
v_cvt_pk_bf16_f32 v194, v68, v69
v_mfma_f32_16x16x32_bf16 v[72:75], a[150:153], v[196:199], v[72:75]
v_cvt_pk_bf16_f32 v195, v70, v71
v_mfma_f32_16x16x32_bf16 v[76:79], a[148:151], v[196:199], v[76:79]
s_waitcnt lgkmcnt(1)
v_mfma_f32_16x16x32_bf16 v[80:83], a[146:149], v[200:203], 0
s_nop 3
v_cvt_pk_bf16_f32 v196, v72, v73
v_mfma_f32_16x16x32_bf16 v[84:87], a[144:147], v[200:203], 0
v_cvt_pk_bf16_f32 v197, v74, v75
v_cvt_pk_bf16_f32 v198, v76, v77
v_mfma_f32_16x16x32_bf16 v[80:83], a[150:153], v[200:203], v[80:83]
s_waitcnt lgkmcnt(0)
s_waitcnt vmcnt(8)
s_barrier
v_mfma_f32_16x16x32_bf16 v[84:87], a[148:151], v[200:203], v[84:87]
buffer_load_dwordx4 v3, s[4:7], s27 offen lds
v_mfma_f32_16x16x32_bf16 v[88:91], a[146:149], v[204:207], 0
buffer_load_dwordx4 v4, s[4:7], s27 offen offset:1056 lds
v_mfma_f32_16x16x32_bf16 v[92:95], a[144:147], v[204:207], 0
s_mov_b64 s[4:5], s[18:19]
ds_read_b128 a[0:3], v1 offset:0
ds_read_b128 a[4:7], v1 offset:64
v_mfma_f32_16x16x32_bf16 v[88:91], a[150:153], v[204:207], v[88:91]
ds_read_b128 a[8:11], v1 offset:128
ds_read_b128 a[12:15], v1 offset:192
v_mfma_f32_16x16x32_bf16 v[92:95], a[148:151], v[204:207], v[92:95]
buffer_load_dwordx4 v3, s[8:11], s27 offen offset:2080 lds
ds_read_b128 a[16:19], v1 offset:512
ds_read_b128 a[20:23], v1 offset:576
v_cvt_pk_bf16_f32 v199, v78, v79
v_cvt_pk_bf16_f32 v200, v80, v81
ds_read_b128 a[24:27], v1 offset:640
v_cvt_pk_bf16_f32 v201, v82, v83
v_cvt_pk_bf16_f32 v202, v84, v85
v_cvt_pk_bf16_f32 v203, v86, v87
ds_read_b128 a[28:31], v1 offset:704
v_add_u32 v1, 16640, v1
v_cvt_pk_bf16_f32 v204, v88, v89
v_cvt_pk_bf16_f32 v205, v90, v91
ds_read_b64_tr_b16 a[64:65], v2 offset:0
v_cvt_pk_bf16_f32 v206, v92, v93
buffer_load_dwordx4 v4, s[8:11], s27 offen offset:3136 lds
ds_read_b64_tr_b16 a[66:67], v2 offset:512
ds_read_b64_tr_b16 a[68:69], v2 offset:32
ds_read_b64_tr_b16 a[70:71], v2 offset:544
s_add_u32 m0, s28, 83200
s_waitcnt lgkmcnt(11)
v_mfma_f32_16x16x32_bf16 v[24:27], a[0:3], v[192:195], v[16:19]
s_mov_b64 s[8:9], s[20:21]
ds_read_b64_tr_b16 a[72:73], v2 offset:64
ds_read_b64_tr_b16 a[74:75], v2 offset:576
s_waitcnt lgkmcnt(12)
v_mfma_f32_16x16x32_bf16 v[24:27], a[4:7], v[196:199], v[24:27]
s_add_u32 s10, s38, 2080
ds_read_b64_tr_b16 a[76:77], v2 offset:96
ds_read_b64_tr_b16 a[78:79], v2 offset:608
s_waitcnt lgkmcnt(13)
v_mfma_f32_16x16x32_bf16 v[24:27], a[8:11], v[200:203], v[24:27]
s_add_u32 s27, s27, 262144
ds_read_b64_tr_b16 a[80:81], v2 offset:128
ds_read_b64_tr_b16 a[82:83], v2 offset:640
ds_read_b64_tr_b16 a[84:85], v2 offset:160
v_cvt_pk_bf16_f32 v207, v94, v95
ds_read_b64_tr_b16 a[86:87], v2 offset:672
ds_read_b64_tr_b16 a[88:89], v2 offset:192
s_waitcnt lgkmcnt(15)
v_mfma_f32_16x16x32_bf16 v[24:27], a[12:15], v[204:207], v[24:27]
ds_read_b64_tr_b16 a[90:91], v2 offset:704
ds_read_b64_tr_b16 a[92:93], v2 offset:224
ds_read_b64_tr_b16 a[94:95], v2 offset:736
v_add_u32 v2, 16640, v2
s_nop 3
v_exp_f32 v24, v24
v_exp_f32 v25, v25
v_exp_f32 v26, v26
v_exp_f32 v27, v27
v_cvt_pk_bf16_f32 v40, v24, v25
v_cvt_pk_bf16_f32 v41, v26, v27
s_waitcnt lgkmcnt(0)
s_waitcnt vmcnt(8)
s_barrier
buffer_load_dwordx4 v3, s[4:7], s24 offen lds
buffer_load_dwordx4 v4, s[4:7], s24 offen offset:1056 lds
ds_read_b128 a[32:35], v1 offset:0
ds_read_b128 a[36:39], v1 offset:64
ds_read_b128 a[40:43], v1 offset:128
ds_read_b128 a[44:47], v1 offset:192
ds_read_b128 a[48:51], v1 offset:512
ds_read_b128 a[52:55], v1 offset:576
buffer_load_dwordx4 v3, s[8:11], s24 offen offset:2080 lds
ds_read_b128 a[56:59], v1 offset:640
ds_read_b128 a[60:63], v1 offset:704
v_add_u32 v1, 49920, v1
ds_read_b64_tr_b16 a[96:97], v2 offset:0
ds_read_b64_tr_b16 a[98:99], v2 offset:512
ds_read_b64_tr_b16 a[100:101], v2 offset:32
buffer_load_dwordx4 v4, s[8:11], s24 offen offset:3136 lds
s_waitcnt lgkmcnt(10)
v_mfma_f32_16x16x32_bf16 v[32:35], a[32:35], v[192:195], 0
s_add_u32 m0, s28, 99840
s_add_u32 s24, s24, -131072
ds_read_b64_tr_b16 a[102:103], v2 offset:544
s_waitcnt lgkmcnt(10)
v_mfma_f32_16x16x32_bf16 v[32:35], a[36:39], v[196:199], v[32:35]
ds_read_b64_tr_b16 a[104:105], v2 offset:64
ds_read_b64_tr_b16 a[106:107], v2 offset:576
s_waitcnt lgkmcnt(11)
v_mfma_f32_16x16x32_bf16 v[32:35], a[40:43], v[200:203], v[32:35]
ds_read_b64_tr_b16 a[108:109], v2 offset:96
ds_read_b64_tr_b16 a[110:111], v2 offset:608
s_waitcnt lgkmcnt(12)
v_mfma_f32_16x16x32_bf16 v[32:35], a[44:47], v[204:207], v[32:35]
ds_read_b64_tr_b16 a[112:113], v2 offset:128
ds_read_b64_tr_b16 a[114:115], v2 offset:640
ds_read_b64_tr_b16 a[116:117], v2 offset:160
ds_read_b64_tr_b16 a[118:119], v2 offset:672
ds_read_b64_tr_b16 a[120:121], v2 offset:192
ds_read_b64_tr_b16 a[122:123], v2 offset:704
ds_read_b64_tr_b16 a[124:125], v2 offset:224
ds_read_b64_tr_b16 a[126:127], v2 offset:736
s_waitcnt lgkmcnt(15)
v_mfma_f32_16x16x32_bf16 v[36:39], a[60:63], v[204:207], 0
v_exp_f32 v32, v32
v_mfma_f32_16x16x32_bf16 v[36:39], a[56:59], v[200:203], v[36:39]
v_exp_f32 v33, v33
v_mfma_f32_16x16x32_bf16 v[36:39], a[52:55], v[196:199], v[36:39]
v_exp_f32 v34, v34
v_mfma_f32_16x16x32_bf16 v[36:39], a[48:51], v[192:195], v[36:39]
v_exp_f32 v35, v35
v_mfma_f32_16x16x32_bf16 v[64:67], v[40:43], a[64:67], 0
v_cvt_pk_bf16_f32 v44, v32, v33
v_cvt_pk_bf16_f32 v45, v34, v35
v_mfma_f32_16x16x32_bf16 v[68:71], v[40:43], a[68:71], 0
v_add_u32 v2, 49920, v2
s_nop 1
v_exp_f32 v36, v36
v_mfma_f32_16x16x32_bf16 v[72:75], v[40:43], a[72:75], 0
v_exp_f32 v37, v37
v_mfma_f32_16x16x32_bf16 v[76:79], v[40:43], a[76:79], 0
v_exp_f32 v38, v38
v_mfma_f32_16x16x32_bf16 v[80:83], v[40:43], a[80:83], 0
v_exp_f32 v39, v39
v_mfma_f32_16x16x32_bf16 v[84:87], v[40:43], a[84:87], 0
v_cvt_pk_bf16_f32 v46, v36, v37
v_cvt_pk_bf16_f32 v47, v38, v39
v_mfma_f32_16x16x32_bf16 v[88:91], v[40:43], a[88:91], 0
v_mfma_f32_16x16x32_bf16 v[92:95], v[40:43], a[92:95], 0
v_mfma_f32_16x16x32_bf16 a[132:135], a[128:131], v[40:43], 0
s_waitcnt vmcnt(8)
buffer_load_dwordx4 v3, s[4:7], s24 offen lds
buffer_load_dwordx4 v4, s[4:7], s24 offen offset:1056 lds
ds_read_b128 v[208:211], v11 offset:0
ds_read_b128 v[212:215], v11 offset:64
ds_read_b128 v[216:219], v11 offset:128
ds_read_b128 v[220:223], v11 offset:192
v_add_u32 v11, 16640, v11
buffer_load_dwordx4 v3, s[8:11], s24 offen offset:2080 lds
buffer_load_dwordx4 v4, s[8:11], s24 offen offset:3136 lds
s_waitcnt lgkmcnt(3)
v_mfma_f32_16x16x32_bf16 v[96:99], a[146:149], v[208:211], 0
s_add_u32 m0, s28, 116480
s_add_u32 s24, s24, -131072
v_mfma_f32_16x16x32_bf16 v[100:103], a[144:147], v[208:211], 0
v_mfma_f32_16x16x32_bf16 v[96:99], a[150:153], v[208:211], v[96:99]
v_mfma_f32_16x16x32_bf16 v[100:103], a[148:151], v[208:211], v[100:103]
s_waitcnt lgkmcnt(2)
v_mfma_f32_16x16x32_bf16 v[104:107], a[146:149], v[212:215], 0
s_nop 4
v_cvt_pk_bf16_f32 v208, v96, v97
v_mfma_f32_16x16x32_bf16 v[108:111], a[144:147], v[212:215], 0
v_cvt_pk_bf16_f32 v209, v98, v99
v_cvt_pk_bf16_f32 v210, v100, v101
v_mfma_f32_16x16x32_bf16 v[104:107], a[150:153], v[212:215], v[104:107]
v_cvt_pk_bf16_f32 v211, v102, v103
v_mfma_f32_16x16x32_bf16 v[108:111], a[148:151], v[212:215], v[108:111]
s_waitcnt lgkmcnt(1)
v_mfma_f32_16x16x32_bf16 v[112:115], a[146:149], v[216:219], 0
s_nop 3
v_cvt_pk_bf16_f32 v212, v104, v105
v_mfma_f32_16x16x32_bf16 v[116:119], a[144:147], v[216:219], 0
v_cvt_pk_bf16_f32 v213, v106, v107
v_cvt_pk_bf16_f32 v214, v108, v109
v_mfma_f32_16x16x32_bf16 v[112:115], a[150:153], v[216:219], v[112:115]
v_cvt_pk_bf16_f32 v215, v110, v111
v_mfma_f32_16x16x32_bf16 v[116:119], a[148:151], v[216:219], v[116:119]
s_waitcnt lgkmcnt(0)
v_mfma_f32_16x16x32_bf16 v[120:123], a[146:149], v[220:223], 0
s_nop 3
v_cvt_pk_bf16_f32 v216, v112, v113
v_mfma_f32_16x16x32_bf16 v[124:127], a[144:147], v[220:223], 0
v_cvt_pk_bf16_f32 v217, v114, v115
v_cvt_pk_bf16_f32 v218, v116, v117
v_mfma_f32_16x16x32_bf16 v[120:123], a[150:153], v[220:223], v[120:123]
v_cvt_pk_bf16_f32 v219, v118, v119
v_mfma_f32_16x16x32_bf16 v[124:127], a[148:151], v[220:223], v[124:127]
v_mfma_f32_16x16x32_bf16 v[24:27], a[0:3], v[208:211], v[16:19]
s_nop 4
v_cvt_pk_bf16_f32 v220, v120, v121
v_mfma_f32_16x16x32_bf16 v[24:27], a[4:7], v[212:215], v[24:27]
v_cvt_pk_bf16_f32 v221, v122, v123
v_cvt_pk_bf16_f32 v222, v124, v125
v_mfma_f32_16x16x32_bf16 v[24:27], a[8:11], v[216:219], v[24:27]
v_cvt_pk_bf16_f32 v223, v126, v127
s_nop 1
v_mfma_f32_16x16x32_bf16 v[24:27], a[12:15], v[220:223], v[24:27]
v_mfma_f32_16x16x32_bf16 v[64:67], v[44:47], a[96:99], v[64:67]
v_mfma_f32_16x16x32_bf16 v[68:71], v[44:47], a[100:103], v[68:71]
s_nop 5
v_exp_f32 v24, v24
v_mfma_f32_16x16x32_bf16 v[72:75], v[44:47], a[104:107], v[72:75]
v_exp_f32 v25, v25
v_mfma_f32_16x16x32_bf16 v[76:79], v[44:47], a[108:111], v[76:79]
v_exp_f32 v26, v26
v_mfma_f32_16x16x32_bf16 v[80:83], v[44:47], a[112:115], v[80:83]
v_exp_f32 v27, v27
v_mfma_f32_16x16x32_bf16 v[84:87], v[44:47], a[116:119], v[84:87]
v_cvt_pk_bf16_f32 v40, v24, v25
v_cvt_pk_bf16_f32 v41, v26, v27
v_mfma_f32_16x16x32_bf16 v[88:91], v[44:47], a[120:123], v[88:91]
v_mfma_f32_16x16x32_bf16 v[92:95], v[44:47], a[124:127], v[92:95]
v_mfma_f32_16x16x32_bf16 a[132:135], a[128:131], v[44:47], a[132:135]
v_mfma_f32_16x16x32_bf16 v[32:35], a[32:35], v[208:211], 0
v_mfma_f32_16x16x32_bf16 v[32:35], a[36:39], v[212:215], v[32:35]
v_mfma_f32_16x16x32_bf16 v[32:35], a[40:43], v[216:219], v[32:35]
v_mfma_f32_16x16x32_bf16 v[32:35], a[44:47], v[220:223], v[32:35]
v_mfma_f32_16x16x32_bf16 v[36:39], a[60:63], v[220:223], 0
v_mfma_f32_16x16x32_bf16 v[36:39], a[56:59], v[216:219], v[36:39]
s_nop 5
v_exp_f32 v32, v32
v_mfma_f32_16x16x32_bf16 v[36:39], a[52:55], v[212:215], v[36:39]
v_exp_f32 v33, v33
v_mfma_f32_16x16x32_bf16 v[36:39], a[48:51], v[208:211], v[36:39]
v_exp_f32 v34, v34
v_mfma_f32_16x16x32_bf16 v[96:99], v[40:43], a[64:67], 0
v_exp_f32 v35, v35
v_mfma_f32_16x16x32_bf16 v[100:103], v[40:43], a[68:71], 0
v_cvt_pk_bf16_f32 v44, v32, v33
v_cvt_pk_bf16_f32 v45, v34, v35
v_mfma_f32_16x16x32_bf16 v[104:107], v[40:43], a[72:75], 0
s_nop 0
v_exp_f32 v36, v36
v_mfma_f32_16x16x32_bf16 v[108:111], v[40:43], a[76:79], 0
s_waitcnt vmcnt(8)
ds_read_b128 v[224:227], v11 offset:0
v_mfma_f32_16x16x32_bf16 v[112:115], v[40:43], a[80:83], 0
buffer_load_dwordx4 v3, s[4:7], s24 offen lds
v_mfma_f32_16x16x32_bf16 v[116:119], v[40:43], a[84:87], 0
buffer_load_dwordx4 v4, s[4:7], s24 offen offset:1056 lds
v_mfma_f32_16x16x32_bf16 v[120:123], v[40:43], a[88:91], 0
ds_read_b128 v[228:231], v11 offset:64
ds_read_b128 v[232:235], v11 offset:128
v_mfma_f32_16x16x32_bf16 v[124:127], v[40:43], a[92:95], 0
ds_read_b128 v[236:239], v11 offset:192
v_exp_f32 v37, v37
v_mfma_f32_16x16x32_bf16 a[136:139], a[128:131], v[40:43], 0
buffer_load_dwordx4 v3, s[8:11], s24 offen offset:2080 lds
v_exp_f32 v38, v38
v_exp_f32 v39, v39
v_cvt_pk_bf16_f32 v46, v36, v37
v_cvt_pk_bf16_f32 v47, v38, v39
s_waitcnt lgkmcnt(3)
v_mfma_f32_16x16x32_bf16 v[128:131], a[146:149], v[224:227], 0
v_mfma_f32_16x16x32_bf16 v[132:135], a[144:147], v[224:227], 0
buffer_load_dwordx4 v4, s[8:11], s24 offen offset:3136 lds
v_mfma_f32_16x16x32_bf16 v[128:131], a[150:153], v[224:227], v[128:131]
s_add_u32 m0, s28, 0
s_add_u32 s24, s24, -131072
v_mfma_f32_16x16x32_bf16 v[132:135], a[148:151], v[224:227], v[132:135]
s_waitcnt lgkmcnt(2)
v_mfma_f32_16x16x32_bf16 v[136:139], a[146:149], v[228:231], 0
s_nop 2
v_cvt_pk_bf16_f32 v224, v128, v129
v_mfma_f32_16x16x32_bf16 v[140:143], a[144:147], v[228:231], 0
v_cvt_pk_bf16_f32 v225, v130, v131
v_cvt_pk_bf16_f32 v226, v132, v133
v_mfma_f32_16x16x32_bf16 v[136:139], a[150:153], v[228:231], v[136:139]
v_cvt_pk_bf16_f32 v227, v134, v135
v_mfma_f32_16x16x32_bf16 v[140:143], a[148:151], v[228:231], v[140:143]
s_waitcnt lgkmcnt(1)
v_mfma_f32_16x16x32_bf16 v[144:147], a[146:149], v[232:235], 0
s_nop 3
v_cvt_pk_bf16_f32 v228, v136, v137
v_mfma_f32_16x16x32_bf16 v[148:151], a[144:147], v[232:235], 0
v_cvt_pk_bf16_f32 v229, v138, v139
v_cvt_pk_bf16_f32 v230, v140, v141
v_mfma_f32_16x16x32_bf16 v[144:147], a[150:153], v[232:235], v[144:147]
v_cvt_pk_bf16_f32 v231, v142, v143
s_waitcnt lgkmcnt(0)
s_waitcnt vmcnt(8)
s_barrier
v_mfma_f32_16x16x32_bf16 v[148:151], a[148:151], v[232:235], v[148:151]
buffer_load_dwordx4 v3, s[4:7], s24 offen lds
v_mfma_f32_16x16x32_bf16 v[152:155], a[146:149], v[236:239], 0
buffer_load_dwordx4 v4, s[4:7], s24 offen offset:1056 lds
v_mfma_f32_16x16x32_bf16 v[156:159], a[144:147], v[236:239], 0
v_cvt_pk_bf16_f32 v232, v144, v145
v_cvt_pk_bf16_f32 v233, v146, v147
v_mfma_f32_16x16x32_bf16 v[152:155], a[150:153], v[236:239], v[152:155]
s_nop 0
v_cvt_pk_bf16_f32 v234, v148, v149
v_cvt_pk_bf16_f32 v235, v150, v151
v_mfma_f32_16x16x32_bf16 v[156:159], a[148:151], v[236:239], v[156:159]
buffer_load_dwordx4 v3, s[8:11], s24 offen offset:2080 lds
v_mfma_f32_16x16x32_bf16 v[24:27], a[0:3], v[224:227], v[16:19]
ds_read_b128 a[0:3], v1 offset:0
s_nop 0
v_cvt_pk_bf16_f32 v236, v152, v153
v_mfma_f32_16x16x32_bf16 v[24:27], a[4:7], v[228:231], v[24:27]
v_cvt_pk_bf16_f32 v237, v154, v155
s_nop 0
v_cvt_pk_bf16_f32 v238, v156, v157
v_mfma_f32_16x16x32_bf16 v[24:27], a[8:11], v[232:235], v[24:27]
v_cvt_pk_bf16_f32 v239, v158, v159
ds_read_b128 a[4:7], v1 offset:64
ds_read_b128 a[8:11], v1 offset:128
v_mfma_f32_16x16x32_bf16 v[24:27], a[12:15], v[236:239], v[24:27]
buffer_load_dwordx4 v4, s[8:11], s24 offen offset:3136 lds
v_mfma_f32_16x16x32_bf16 v[96:99], v[44:47], a[96:99], v[96:99]
s_add_u32 m0, s28, 16640
ds_read_b128 a[12:15], v1 offset:192
ds_read_b128 a[16:19], v1 offset:512
v_mfma_f32_16x16x32_bf16 v[100:103], v[44:47], a[100:103], v[100:103]
s_add_u32 s24, s24, -131072
ds_read_b128 a[20:23], v1 offset:576
ds_read_b128 a[24:27], v1 offset:640
v_mfma_f32_16x16x32_bf16 v[104:107], v[44:47], a[104:107], v[104:107]
ds_read_b128 a[28:31], v1 offset:704
v_add_u32 v1, 16640, v1
v_mfma_f32_16x16x32_bf16 v[108:111], v[44:47], a[108:111], v[108:111]
v_exp_f32 v24, v24
v_mfma_f32_16x16x32_bf16 v[112:115], v[44:47], a[112:115], v[112:115]
v_exp_f32 v25, v25
v_mfma_f32_16x16x32_bf16 v[116:119], v[44:47], a[116:119], v[116:119]
v_exp_f32 v26, v26
v_mfma_f32_16x16x32_bf16 v[120:123], v[44:47], a[120:123], v[120:123]
v_exp_f32 v27, v27
v_mfma_f32_16x16x32_bf16 v[124:127], v[44:47], a[124:127], v[124:127]
v_cvt_pk_bf16_f32 v40, v24, v25
v_cvt_pk_bf16_f32 v41, v26, v27
v_mfma_f32_16x16x32_bf16 a[136:139], a[128:131], v[44:47], a[136:139]
v_mfma_f32_16x16x32_bf16 v[32:35], a[32:35], v[224:227], 0
v_mfma_f32_16x16x32_bf16 v[32:35], a[36:39], v[228:231], v[32:35]
v_mfma_f32_16x16x32_bf16 v[32:35], a[40:43], v[232:235], v[32:35]
v_mfma_f32_16x16x32_bf16 v[32:35], a[44:47], v[236:239], v[32:35]
v_mfma_f32_16x16x32_bf16 v[36:39], a[60:63], v[236:239], 0
v_mfma_f32_16x16x32_bf16 v[36:39], a[56:59], v[232:235], v[36:39]
s_nop 5
v_exp_f32 v32, v32
v_mfma_f32_16x16x32_bf16 v[36:39], a[52:55], v[228:231], v[36:39]
v_exp_f32 v33, v33
v_mfma_f32_16x16x32_bf16 v[36:39], a[48:51], v[224:227], v[36:39]
v_exp_f32 v34, v34
v_mfma_f32_16x16x32_bf16 v[128:131], v[40:43], a[64:67], 0
ds_read_b64_tr_b16 a[64:65], v2 offset:0
ds_read_b64_tr_b16 a[66:67], v2 offset:512
v_mfma_f32_16x16x32_bf16 v[132:135], v[40:43], a[68:71], 0
ds_read_b64_tr_b16 a[68:69], v2 offset:32
ds_read_b64_tr_b16 a[70:71], v2 offset:544
v_mfma_f32_16x16x32_bf16 v[136:139], v[40:43], a[72:75], 0
ds_read_b64_tr_b16 a[72:73], v2 offset:64
ds_read_b64_tr_b16 a[74:75], v2 offset:576
v_mfma_f32_16x16x32_bf16 v[140:143], v[40:43], a[76:79], 0
ds_read_b64_tr_b16 a[76:77], v2 offset:96
ds_read_b64_tr_b16 a[78:79], v2 offset:608
v_mfma_f32_16x16x32_bf16 v[144:147], v[40:43], a[80:83], 0
ds_read_b64_tr_b16 a[80:81], v2 offset:128
ds_read_b64_tr_b16 a[82:83], v2 offset:640
v_mfma_f32_16x16x32_bf16 v[148:151], v[40:43], a[84:87], 0
ds_read_b64_tr_b16 a[84:85], v2 offset:160
ds_read_b64_tr_b16 a[86:87], v2 offset:672
v_mfma_f32_16x16x32_bf16 v[152:155], v[40:43], a[88:91], 0
ds_read_b64_tr_b16 a[88:89], v2 offset:192
ds_read_b64_tr_b16 a[90:91], v2 offset:704
v_mfma_f32_16x16x32_bf16 v[156:159], v[40:43], a[92:95], 0
ds_read_b64_tr_b16 a[92:93], v2 offset:224
ds_read_b64_tr_b16 a[94:95], v2 offset:736
v_mfma_f32_16x16x32_bf16 a[140:143], a[128:131], v[40:43], 0
v_exp_f32 v35, v35
s_waitcnt lgkmcnt(15)
v_mfma_f32_16x16x32_bf16 v[24:27], a[0:3], v[192:195], 0
v_exp_f32 v36, v36
v_mfma_f32_16x16x32_bf16 v[24:27], a[4:7], v[196:199], v[24:27]
v_exp_f32 v37, v37
v_mfma_f32_16x16x32_bf16 v[24:27], a[8:11], v[200:203], v[24:27]
v_exp_f32 v38, v38
v_mfma_f32_16x16x32_bf16 v[24:27], a[12:15], v[204:207], v[24:27]
v_exp_f32 v39, v39
v_mfma_f32_16x16x32_bf16 v[28:31], a[28:31], v[204:207], 0
v_cvt_pk_bf16_f32 v44, v32, v33
v_cvt_pk_bf16_f32 v45, v34, v35
v_mfma_f32_16x16x32_bf16 v[28:31], a[24:27], v[200:203], v[28:31]
v_cvt_pk_bf16_f32 v46, v36, v37
v_cvt_pk_bf16_f32 v47, v38, v39
v_mfma_f32_16x16x32_bf16 v[28:31], a[20:23], v[196:199], v[28:31]
s_waitcnt lgkmcnt(0)
s_waitcnt vmcnt(8)
s_barrier
v_mfma_f32_16x16x32_bf16 v[28:31], a[16:19], v[192:195], v[28:31]
buffer_load_dwordx4 v3, s[4:7], s24 offen lds
v_mfma_f32_16x16x32_bf16 v[128:131], v[44:47], a[96:99], v[128:131]
buffer_load_dwordx4 v4, s[4:7], s24 offen offset:1056 lds
v_mfma_f32_16x16x32_bf16 v[132:135], v[44:47], a[100:103], v[132:135]
v_exp_f32 v24, v24
v_mfma_f32_16x16x32_bf16 v[136:139], v[44:47], a[104:107], v[136:139]
v_exp_f32 v25, v25
v_mfma_f32_16x16x32_bf16 v[140:143], v[44:47], a[108:111], v[140:143]
buffer_load_dwordx4 v3, s[8:11], s24 offen offset:2080 lds
v_mfma_f32_16x16x32_bf16 v[144:147], v[44:47], a[112:115], v[144:147]
v_exp_f32 v26, v26
v_mfma_f32_16x16x32_bf16 v[148:151], v[44:47], a[116:119], v[148:151]
v_exp_f32 v27, v27
v_mfma_f32_16x16x32_bf16 v[152:155], v[44:47], a[120:123], v[152:155]
v_exp_f32 v28, v28
v_mfma_f32_16x16x32_bf16 v[156:159], v[44:47], a[124:127], v[156:159]
buffer_load_dwordx4 v4, s[8:11], s24 offen offset:3136 lds
v_mfma_f32_16x16x32_bf16 a[140:143], a[128:131], v[44:47], a[140:143]
s_add_u32 m0, s28, 33280
v_cvt_pk_bf16_f32 v40, v24, v25
v_cvt_pk_bf16_f32 v41, v26, v27
s_add_u32 s24, s24, -131072
v_add_u32 v2, 16640, v2
L_step2_3:
v_mfma_f32_16x16x32_bf16 v[32:35], a[0:3], v[208:211], 0
buffer_load_dwordx4 v3, s[4:7], s24 offen lds
v_mfma_f32_16x16x32_bf16 v[32:35], a[4:7], v[212:215], v[32:35]
s_sub_u32 s30, s30, 1
v_exp_f32 v29, v29
v_mfma_f32_16x16x32_bf16 v[32:35], a[8:11], v[216:219], v[32:35]
s_cselect_b32 s31, s35, s34
ds_read_b128 a[32:35], v1 offset:0
v_cvt_pk_bf16_f32 v42, v28, v29
v_mfma_f32_16x16x32_bf16 v[32:35], a[12:15], v[220:223], v[32:35]
s_cselect_b32 s30, 7, s30
v_exp_f32 v30, v30
v_mfma_f32_16x16x32_bf16 v[36:39], a[28:31], v[220:223], 0
buffer_load_dwordx4 v4, s[4:7], s24 offen offset:1056 lds
v_mfma_f32_16x16x32_bf16 v[36:39], a[24:27], v[216:219], v[36:39]
s_add_u32 s33, s33, 1
v_exp_f32 v31, v31
v_mfma_f32_16x16x32_bf16 v[36:39], a[20:23], v[212:215], v[36:39]
ds_read_b128 a[36:39], v1 offset:64
v_cvt_pk_bf16_f32 v43, v30, v31
v_mfma_f32_16x16x32_bf16 v[36:39], a[16:19], v[208:211], v[36:39]
v_exp_f32 v32, v32
v_mfma_f32_16x16x32_bf16 v[64:67], v[40:43], a[64:67], v[64:67]
buffer_load_dwordx4 v3, s[8:11], s24 offen offset:2080 lds
v_mfma_f32_16x16x32_bf16 v[68:71], v[40:43], a[68:71], v[68:71]
v_exp_f32 v33, v33
v_mfma_f32_16x16x32_bf16 v[72:75], v[40:43], a[72:75], v[72:75]
ds_read_b128 a[40:43], v1 offset:128
v_cvt_pk_bf16_f32 v44, v32, v33
v_mfma_f32_16x16x32_bf16 v[76:79], v[40:43], a[76:79], v[76:79]
v_exp_f32 v34, v34
v_mfma_f32_16x16x32_bf16 v[80:83], v[40:43], a[80:83], v[80:83]
buffer_load_dwordx4 v4, s[8:11], s24 offen offset:3136 lds
v_mfma_f32_16x16x32_bf16 v[84:87], v[40:43], a[84:87], v[84:87]
s_add_u32 m0, m0, s34
v_exp_f32 v35, v35
v_mfma_f32_16x16x32_bf16 v[88:91], v[40:43], a[88:91], v[88:91]
s_cmp_eq_u32 m0, s29
ds_read_b128 a[44:47], v1 offset:192
v_cvt_pk_bf16_f32 v45, v34, v35
v_mfma_f32_16x16x32_bf16 v[92:95], v[40:43], a[92:95], v[92:95]
s_cselect_b32 m0, s28, m0
v_exp_f32 v36, v36
v_mfma_f32_16x16x32_bf16 a[132:135], a[128:131], v[40:43], a[132:135]
s_add_u32 s24, s24, s25
ds_read_b128 a[48:51], v1 offset:512
ds_read_b128 a[52:55], v1 offset:576
v_mfma_f32_16x16x32_bf16 v[24:27], a[0:3], v[224:227], 0
s_sub_u32 s26, s26, 1
ds_read_b128 a[56:59], v1 offset:640
ds_read_b128 a[60:63], v1 offset:704
v_mfma_f32_16x16x32_bf16 v[24:27], a[4:7], v[228:231], v[24:27]
v_exp_f32 v37, v37
v_mfma_f32_16x16x32_bf16 v[24:27], a[8:11], v[232:235], v[24:27]
ds_read_b64_tr_b16 a[96:97], v2 offset:0
v_cvt_pk_bf16_f32 v46, v36, v37
v_mfma_f32_16x16x32_bf16 v[24:27], a[12:15], v[236:239], v[24:27]
v_exp_f32 v38, v38
v_mfma_f32_16x16x32_bf16 v[28:31], a[28:31], v[236:239], 0
ds_read_b64_tr_b16 a[98:99], v2 offset:512
ds_read_b64_tr_b16 a[100:101], v2 offset:32
v_mfma_f32_16x16x32_bf16 v[28:31], a[24:27], v[232:235], v[28:31]
s_waitcnt vmcnt(12)
v_exp_f32 v39, v39
v_mfma_f32_16x16x32_bf16 v[28:31], a[20:23], v[228:231], v[28:31]
ds_add_u32 v8, v10
v_cvt_pk_bf16_f32 v47, v38, v39
v_mfma_f32_16x16x32_bf16 v[28:31], a[16:19], v[224:227], v[28:31]
v_exp_f32 v24, v24
v_mfma_f32_16x16x32_bf16 v[96:99], v[44:47], a[64:67], v[96:99]
ds_read_b64_tr_b16 a[102:103], v2 offset:544
ds_read_b64_tr_b16 a[104:105], v2 offset:64
v_mfma_f32_16x16x32_bf16 v[100:103], v[44:47], a[68:71], v[100:103]
v_exp_f32 v25, v25
v_mfma_f32_16x16x32_bf16 v[104:107], v[44:47], a[72:75], v[104:107]
ds_read_b64_tr_b16 a[106:107], v2 offset:576
v_cvt_pk_bf16_f32 v40, v24, v25
v_mfma_f32_16x16x32_bf16 v[108:111], v[44:47], a[76:79], v[108:111]
v_exp_f32 v26, v26
v_mfma_f32_16x16x32_bf16 v[112:115], v[44:47], a[80:83], v[112:115]
ds_read_b64_tr_b16 a[108:109], v2 offset:96
ds_read_b64_tr_b16 a[110:111], v2 offset:608
v_mfma_f32_16x16x32_bf16 v[116:119], v[44:47], a[84:87], v[116:119]
v_exp_f32 v27, v27
v_mfma_f32_16x16x32_bf16 v[120:123], v[44:47], a[88:91], v[120:123]
ds_read_b64_tr_b16 a[112:113], v2 offset:128
v_cvt_pk_bf16_f32 v41, v26, v27
v_mfma_f32_16x16x32_bf16 v[124:127], v[44:47], a[92:95], v[124:127]
v_exp_f32 v28, v28
v_mfma_f32_16x16x32_bf16 a[136:139], a[128:131], v[44:47], a[136:139]
s_waitcnt lgkmcnt(10)
ds_read_b64_tr_b16 a[114:115], v2 offset:640
ds_read_b64_tr_b16 a[116:117], v2 offset:160
v_mfma_f32_16x16x32_bf16 v[32:35], a[32:35], v[192:195], 0
ds_read_b64_tr_b16 a[118:119], v2 offset:672
ds_read_b64_tr_b16 a[120:121], v2 offset:192
v_mfma_f32_16x16x32_bf16 v[32:35], a[36:39], v[196:199], v[32:35]
v_exp_f32 v29, v29
v_mfma_f32_16x16x32_bf16 v[32:35], a[40:43], v[200:203], v[32:35]
ds_read_b64_tr_b16 a[122:123], v2 offset:704
v_cvt_pk_bf16_f32 v42, v28, v29
v_mfma_f32_16x16x32_bf16 v[32:35], a[44:47], v[204:207], v[32:35]
v_exp_f32 v30, v30
v_mfma_f32_16x16x32_bf16 v[36:39], a[60:63], v[204:207], 0
ds_read_b64_tr_b16 a[124:125], v2 offset:224
ds_read_b64_tr_b16 a[126:127], v2 offset:736
v_mfma_f32_16x16x32_bf16 v[36:39], a[56:59], v[200:203], v[36:39]
v_exp_f32 v31, v31
v_mfma_f32_16x16x32_bf16 v[36:39], a[52:55], v[196:199], v[36:39]
ds_read_b32 v11, v9
v_cvt_pk_bf16_f32 v43, v30, v31
v_mfma_f32_16x16x32_bf16 v[36:39], a[48:51], v[192:195], v[36:39]
v_exp_f32 v32, v32
v_mfma_f32_16x16x32_bf16 v[128:131], v[40:43], a[64:67], v[128:131]
v_add_u32 v1, s31, v1
v_add_u32 v2, s31, v2
v_mfma_f32_16x16x32_bf16 v[132:135], v[40:43], a[68:71], v[132:135]
v_exp_f32 v33, v33
v_mfma_f32_16x16x32_bf16 v[136:139], v[40:43], a[72:75], v[136:139]
v_cvt_pk_bf16_f32 v44, v32, v33
v_mfma_f32_16x16x32_bf16 v[140:143], v[40:43], a[76:79], v[140:143]
s_waitcnt lgkmcnt(0)
v_exp_f32 v34, v34
v_mfma_f32_16x16x32_bf16 v[144:147], v[40:43], a[80:83], v[144:147]
v_cmp_gt_u32 vcc, s33, v11
v_mfma_f32_16x16x32_bf16 v[148:151], v[40:43], a[84:87], v[148:151]
v_exp_f32 v35, v35
v_mfma_f32_16x16x32_bf16 v[152:155], v[40:43], a[88:91], v[152:155]
s_waitcnt lgkmcnt(0)
v_cvt_pk_bf16_f32 v45, v34, v35
v_mfma_f32_16x16x32_bf16 v[156:159], v[40:43], a[92:95], v[156:159]
v_exp_f32 v36, v36
v_mfma_f32_16x16x32_bf16 a[140:143], a[128:131], v[40:43], a[140:143]
s_cbranch_vccnz L_spin_9
L_spinret_10:
buffer_load_dwordx4 v3, s[4:7], s24 offen lds
buffer_load_dwordx4 v4, s[4:7], s24 offen offset:1056 lds
buffer_load_dwordx4 v3, s[8:11], s24 offen offset:2080 lds
buffer_load_dwordx4 v4, s[8:11], s24 offen offset:3136 lds
s_add_u32 m0, m0, s34
s_cmp_eq_u32 m0, s29
s_cselect_b32 m0, s28, m0
s_add_u32 s24, s24, s25
s_sub_u32 s26, s26, 1
.p2align 6
L_loop3:
v_mfma_f32_16x16x32_bf16 v[24:27], a[32:35], v[208:211], 0
buffer_load_dwordx4 v3, s[4:7], s24 offen lds
v_mfma_f32_16x16x32_bf16 v[24:27], a[36:39], v[212:215], v[24:27]
s_sub_u32 s30, s30, 1
v_exp_f32 v37, v37
v_mfma_f32_16x16x32_bf16 v[24:27], a[40:43], v[216:219], v[24:27]
s_cselect_b32 s31, s35, s34
ds_read_b128 a[0:3], v1 offset:0
v_cvt_pk_bf16_f32 v46, v36, v37
v_mfma_f32_16x16x32_bf16 v[24:27], a[44:47], v[220:223], v[24:27]
s_cselect_b32 s30, 7, s30
v_exp_f32 v38, v38
v_mfma_f32_16x16x32_bf16 v[28:31], a[60:63], v[220:223], 0
buffer_load_dwordx4 v4, s[4:7], s24 offen offset:1056 lds
v_mfma_f32_16x16x32_bf16 v[28:31], a[56:59], v[216:219], v[28:31]
s_add_u32 s33, s33, 1
v_exp_f32 v39, v39
v_mfma_f32_16x16x32_bf16 v[28:31], a[52:55], v[212:215], v[28:31]
ds_read_b128 a[4:7], v1 offset:64
v_cvt_pk_bf16_f32 v47, v38, v39
v_mfma_f32_16x16x32_bf16 v[28:31], a[48:51], v[208:211], v[28:31]
v_exp_f32 v24, v24
v_mfma_f32_16x16x32_bf16 v[64:67], v[44:47], a[96:99], v[64:67]
buffer_load_dwordx4 v3, s[8:11], s24 offen offset:2080 lds
v_mfma_f32_16x16x32_bf16 v[68:71], v[44:47], a[100:103], v[68:71]
v_exp_f32 v25, v25
v_mfma_f32_16x16x32_bf16 v[72:75], v[44:47], a[104:107], v[72:75]
ds_read_b128 a[8:11], v1 offset:128
v_cvt_pk_bf16_f32 v40, v24, v25
v_mfma_f32_16x16x32_bf16 v[76:79], v[44:47], a[108:111], v[76:79]
v_exp_f32 v26, v26
v_mfma_f32_16x16x32_bf16 v[80:83], v[44:47], a[112:115], v[80:83]
buffer_load_dwordx4 v4, s[8:11], s24 offen offset:3136 lds
v_mfma_f32_16x16x32_bf16 v[84:87], v[44:47], a[116:119], v[84:87]
s_add_u32 m0, m0, s34
v_exp_f32 v27, v27
v_mfma_f32_16x16x32_bf16 v[88:91], v[44:47], a[120:123], v[88:91]
s_cmp_eq_u32 m0, s29
ds_read_b128 a[12:15], v1 offset:192
v_cvt_pk_bf16_f32 v41, v26, v27
v_mfma_f32_16x16x32_bf16 v[92:95], v[44:47], a[124:127], v[92:95]
s_cselect_b32 m0, s28, m0
v_exp_f32 v28, v28
v_mfma_f32_16x16x32_bf16 a[132:135], a[128:131], v[44:47], a[132:135]
s_add_u32 s24, s24, s25
ds_read_b128 a[16:19], v1 offset:512
ds_read_b128 a[20:23], v1 offset:576
v_mfma_f32_16x16x32_bf16 v[32:35], a[32:35], v[224:227], 0
s_sub_u32 s26, s26, 1
ds_read_b128 a[24:27], v1 offset:640
ds_read_b128 a[28:31], v1 offset:704
v_mfma_f32_16x16x32_bf16 v[32:35], a[36:39], v[228:231], v[32:35]
s_cmov_b64 s[4:5], s[52:53]
v_exp_f32 v29, v29
v_mfma_f32_16x16x32_bf16 v[32:35], a[40:43], v[232:235], v[32:35]
s_cmov_b64 s[8:9], s[54:55]
ds_read_b64_tr_b16 a[64:65], v2 offset:0
v_cvt_pk_bf16_f32 v42, v28, v29
v_mfma_f32_16x16x32_bf16 v[32:35], a[44:47], v[236:239], v[32:35]
s_cmov_b64 s[24:25], s[56:57]
v_exp_f32 v30, v30
v_mfma_f32_16x16x32_bf16 v[36:39], a[60:63], v[236:239], 0
s_cmov_b32 s6, s58
ds_read_b64_tr_b16 a[66:67], v2 offset:512
ds_read_b64_tr_b16 a[68:69], v2 offset:32
v_mfma_f32_16x16x32_bf16 v[36:39], a[56:59], v[232:235], v[36:39]
s_waitcnt vmcnt(12)
v_exp_f32 v31, v31
v_mfma_f32_16x16x32_bf16 v[36:39], a[52:55], v[228:231], v[36:39]
s_cmov_b32 s10, s59
ds_add_u32 v8, v10
v_cvt_pk_bf16_f32 v43, v30, v31
v_mfma_f32_16x16x32_bf16 v[36:39], a[48:51], v[224:227], v[36:39]
s_cmov_b32 s26, s60
v_exp_f32 v32, v32
v_mfma_f32_16x16x32_bf16 v[96:99], v[40:43], a[96:99], v[96:99]
s_cmov_b64 s[52:53], s[62:63]
ds_read_b64_tr_b16 a[70:71], v2 offset:544
ds_read_b64_tr_b16 a[72:73], v2 offset:64
v_mfma_f32_16x16x32_bf16 v[100:103], v[40:43], a[100:103], v[100:103]
s_cmov_b64 s[54:55], s[64:65]
v_exp_f32 v33, v33
v_mfma_f32_16x16x32_bf16 v[104:107], v[40:43], a[104:107], v[104:107]
s_cmov_b64 s[56:57], s[66:67]
ds_read_b64_tr_b16 a[74:75], v2 offset:576
v_cvt_pk_bf16_f32 v44, v32, v33
v_mfma_f32_16x16x32_bf16 v[108:111], v[40:43], a[108:111], v[108:111]
s_cmov_b64 s[58:59], s[68:69]
v_exp_f32 v34, v34
v_mfma_f32_16x16x32_bf16 v[112:115], v[40:43], a[112:115], v[112:115]
s_cmov_b32 s60, s70
ds_read_b64_tr_b16 a[76:77], v2 offset:96
ds_read_b64_tr_b16 a[78:79], v2 offset:608
v_mfma_f32_16x16x32_bf16 v[116:119], v[40:43], a[116:119], v[116:119]
s_cmov_b64 s[68:69], 0
v_exp_f32 v35, v35
v_mfma_f32_16x16x32_bf16 v[120:123], v[40:43], a[120:123], v[120:123]
s_cmov_b32 s70, 0x7fffffff
ds_read_b64_tr_b16 a[80:81], v2 offset:128
v_cvt_pk_bf16_f32 v45, v34, v35
v_mfma_f32_16x16x32_bf16 v[124:127], v[40:43], a[124:127], v[124:127]
s_sub_u32 s32, s32, 1
v_exp_f32 v36, v36
v_mfma_f32_16x16x32_bf16 a[136:139], a[128:131], v[40:43], a[136:139]
s_waitcnt lgkmcnt(10)
ds_read_b64_tr_b16 a[82:83], v2 offset:640
ds_read_b64_tr_b16 a[84:85], v2 offset:160
v_mfma_f32_16x16x32_bf16 v[24:27], a[0:3], v[192:195], 0
ds_read_b64_tr_b16 a[86:87], v2 offset:672
ds_read_b64_tr_b16 a[88:89], v2 offset:192
v_mfma_f32_16x16x32_bf16 v[24:27], a[4:7], v[196:199], v[24:27]
v_exp_f32 v37, v37
v_mfma_f32_16x16x32_bf16 v[24:27], a[8:11], v[200:203], v[24:27]
ds_read_b64_tr_b16 a[90:91], v2 offset:704
v_cvt_pk_bf16_f32 v46, v36, v37
v_mfma_f32_16x16x32_bf16 v[24:27], a[12:15], v[204:207], v[24:27]
v_exp_f32 v38, v38
v_mfma_f32_16x16x32_bf16 v[28:31], a[28:31], v[204:207], 0
ds_read_b64_tr_b16 a[92:93], v2 offset:224
ds_read_b64_tr_b16 a[94:95], v2 offset:736
v_mfma_f32_16x16x32_bf16 v[28:31], a[24:27], v[200:203], v[28:31]
v_exp_f32 v39, v39
v_mfma_f32_16x16x32_bf16 v[28:31], a[20:23], v[196:199], v[28:31]
ds_read_b32 v11, v9
v_cvt_pk_bf16_f32 v47, v38, v39
v_mfma_f32_16x16x32_bf16 v[28:31], a[16:19], v[192:195], v[28:31]
v_exp_f32 v24, v24
v_mfma_f32_16x16x32_bf16 v[128:131], v[44:47], a[96:99], v[128:131]
v_add_u32 v1, s31, v1
v_add_u32 v2, s31, v2
v_mfma_f32_16x16x32_bf16 v[132:135], v[44:47], a[100:103], v[132:135]
v_exp_f32 v25, v25
v_mfma_f32_16x16x32_bf16 v[136:139], v[44:47], a[104:107], v[136:139]
v_cvt_pk_bf16_f32 v40, v24, v25
v_mfma_f32_16x16x32_bf16 v[140:143], v[44:47], a[108:111], v[140:143]
s_waitcnt lgkmcnt(0)
v_exp_f32 v26, v26
v_mfma_f32_16x16x32_bf16 v[144:147], v[44:47], a[112:115], v[144:147]
v_cmp_gt_u32 vcc, s33, v11
v_mfma_f32_16x16x32_bf16 v[148:151], v[44:47], a[116:119], v[148:151]
v_exp_f32 v27, v27
v_mfma_f32_16x16x32_bf16 v[152:155], v[44:47], a[120:123], v[152:155]
s_waitcnt lgkmcnt(0)
v_cvt_pk_bf16_f32 v41, v26, v27
v_mfma_f32_16x16x32_bf16 v[156:159], v[44:47], a[124:127], v[156:159]
v_exp_f32 v28, v28
v_mfma_f32_16x16x32_bf16 a[140:143], a[128:131], v[44:47], a[140:143]
s_cbranch_vccnz L_spin_1
L_spinret_2:
s_cbranch_scc1 L_last0_3
v_mfma_f32_16x16x32_bf16 v[32:35], a[0:3], v[208:211], 0
buffer_load_dwordx4 v3, s[4:7], s24 offen lds
v_mfma_f32_16x16x32_bf16 v[32:35], a[4:7], v[212:215], v[32:35]
s_sub_u32 s30, s30, 1
v_exp_f32 v29, v29
v_mfma_f32_16x16x32_bf16 v[32:35], a[8:11], v[216:219], v[32:35]
s_cselect_b32 s31, s35, s34
ds_read_b128 a[32:35], v1 offset:0
v_cvt_pk_bf16_f32 v42, v28, v29
v_mfma_f32_16x16x32_bf16 v[32:35], a[12:15], v[220:223], v[32:35]
s_cselect_b32 s30, 7, s30
v_exp_f32 v30, v30
v_mfma_f32_16x16x32_bf16 v[36:39], a[28:31], v[220:223], 0
buffer_load_dwordx4 v4, s[4:7], s24 offen offset:1056 lds
v_mfma_f32_16x16x32_bf16 v[36:39], a[24:27], v[216:219], v[36:39]
v_exp_f32 v31, v31
v_mfma_f32_16x16x32_bf16 v[36:39], a[20:23], v[212:215], v[36:39]
ds_read_b128 a[36:39], v1 offset:64
v_cvt_pk_bf16_f32 v43, v30, v31
v_mfma_f32_16x16x32_bf16 v[36:39], a[16:19], v[208:211], v[36:39]
v_exp_f32 v32, v32
v_mfma_f32_16x16x32_bf16 v[64:67], v[40:43], a[64:67], v[64:67]
buffer_load_dwordx4 v3, s[8:11], s24 offen offset:2080 lds
v_mfma_f32_16x16x32_bf16 v[68:71], v[40:43], a[68:71], v[68:71]
v_exp_f32 v33, v33
v_mfma_f32_16x16x32_bf16 v[72:75], v[40:43], a[72:75], v[72:75]
ds_read_b128 a[40:43], v1 offset:128
v_cvt_pk_bf16_f32 v44, v32, v33
v_mfma_f32_16x16x32_bf16 v[76:79], v[40:43], a[76:79], v[76:79]
v_exp_f32 v34, v34
v_mfma_f32_16x16x32_bf16 v[80:83], v[40:43], a[80:83], v[80:83]
buffer_load_dwordx4 v4, s[8:11], s24 offen offset:3136 lds
v_mfma_f32_16x16x32_bf16 v[84:87], v[40:43], a[84:87], v[84:87]
s_add_u32 m0, m0, s34
v_exp_f32 v35, v35
v_mfma_f32_16x16x32_bf16 v[88:91], v[40:43], a[88:91], v[88:91]
s_cmp_eq_u32 m0, s29
ds_read_b128 a[44:47], v1 offset:192
v_cvt_pk_bf16_f32 v45, v34, v35
v_mfma_f32_16x16x32_bf16 v[92:95], v[40:43], a[92:95], v[92:95]
s_cselect_b32 m0, s28, m0
v_exp_f32 v36, v36
v_mfma_f32_16x16x32_bf16 a[132:135], a[128:131], v[40:43], a[132:135]
s_add_u32 s24, s24, s25
ds_read_b128 a[48:51], v1 offset:512
ds_read_b128 a[52:55], v1 offset:576
v_mfma_f32_16x16x32_bf16 v[24:27], a[0:3], v[224:227], 0
s_sub_u32 s26, s26, 1
ds_read_b128 a[56:59], v1 offset:640
ds_read_b128 a[60:63], v1 offset:704
v_mfma_f32_16x16x32_bf16 v[24:27], a[4:7], v[228:231], v[24:27]
s_cmov_b64 s[4:5], s[52:53]
v_exp_f32 v37, v37
v_mfma_f32_16x16x32_bf16 v[24:27], a[8:11], v[232:235], v[24:27]
s_cmov_b64 s[8:9], s[54:55]
ds_read_b64_tr_b16 a[96:97], v2 offset:0
v_cvt_pk_bf16_f32 v46, v36, v37
v_mfma_f32_16x16x32_bf16 v[24:27], a[12:15], v[236:239], v[24:27]
s_cmov_b64 s[24:25], s[56:57]
v_exp_f32 v38, v38
v_mfma_f32_16x16x32_bf16 v[28:31], a[28:31], v[236:239], 0
s_cmov_b32 s6, s58
ds_read_b64_tr_b16 a[98:99], v2 offset:512
ds_read_b64_tr_b16 a[100:101], v2 offset:32
v_mfma_f32_16x16x32_bf16 v[28:31], a[24:27], v[232:235], v[28:31]
s_cmov_b32 s10, s59
v_exp_f32 v39, v39
v_mfma_f32_16x16x32_bf16 v[28:31], a[20:23], v[228:231], v[28:31]
s_cmov_b32 s26, s60
ds_read_b64_tr_b16 a[102:103], v2 offset:544
v_cvt_pk_bf16_f32 v47, v38, v39
v_mfma_f32_16x16x32_bf16 v[28:31], a[16:19], v[224:227], v[28:31]
s_cmov_b64 s[52:53], s[62:63]
v_exp_f32 v24, v24
v_mfma_f32_16x16x32_bf16 v[96:99], v[44:47], a[64:67], v[96:99]
s_cmov_b64 s[54:55], s[64:65]
ds_read_b64_tr_b16 a[104:105], v2 offset:64
ds_read_b64_tr_b16 a[106:107], v2 offset:576
v_mfma_f32_16x16x32_bf16 v[100:103], v[44:47], a[68:71], v[100:103]
s_cmov_b64 s[56:57], s[66:67]
v_exp_f32 v25, v25
v_mfma_f32_16x16x32_bf16 v[104:107], v[44:47], a[72:75], v[104:107]
s_cmov_b64 s[58:59], s[68:69]
ds_read_b64_tr_b16 a[108:109], v2 offset:96
v_cvt_pk_bf16_f32 v40, v24, v25
v_mfma_f32_16x16x32_bf16 v[108:111], v[44:47], a[76:79], v[108:111]
s_cmov_b32 s60, s70
v_exp_f32 v26, v26
v_mfma_f32_16x16x32_bf16 v[112:115], v[44:47], a[80:83], v[112:115]
s_cmov_b64 s[68:69], 0
ds_read_b64_tr_b16 a[110:111], v2 offset:608
ds_read_b64_tr_b16 a[112:113], v2 offset:128
v_mfma_f32_16x16x32_bf16 v[116:119], v[44:47], a[84:87], v[116:119]
s_cmov_b32 s70, 0x7fffffff
v_exp_f32 v27, v27
v_mfma_f32_16x16x32_bf16 v[120:123], v[44:47], a[88:91], v[120:123]
s_sub_u32 s32, s32, 1
ds_read_b64_tr_b16 a[114:115], v2 offset:640
v_cvt_pk_bf16_f32 v41, v26, v27
v_mfma_f32_16x16x32_bf16 v[124:127], v[44:47], a[92:95], v[124:127]
v_exp_f32 v28, v28
v_mfma_f32_16x16x32_bf16 a[136:139], a[128:131], v[44:47], a[136:139]
s_waitcnt lgkmcnt(10)
ds_read_b64_tr_b16 a[116:117], v2 offset:160
ds_read_b64_tr_b16 a[118:119], v2 offset:672
v_mfma_f32_16x16x32_bf16 v[32:35], a[32:35], v[192:195], 0
ds_read_b64_tr_b16 a[120:121], v2 offset:192
ds_read_b64_tr_b16 a[122:123], v2 offset:704
v_mfma_f32_16x16x32_bf16 v[32:35], a[36:39], v[196:199], v[32:35]
v_exp_f32 v29, v29
v_mfma_f32_16x16x32_bf16 v[32:35], a[40:43], v[200:203], v[32:35]
ds_read_b64_tr_b16 a[124:125], v2 offset:224
v_cvt_pk_bf16_f32 v42, v28, v29
v_mfma_f32_16x16x32_bf16 v[32:35], a[44:47], v[204:207], v[32:35]
v_exp_f32 v30, v30
v_mfma_f32_16x16x32_bf16 v[36:39], a[60:63], v[204:207], 0
ds_read_b64_tr_b16 a[126:127], v2 offset:736
v_add_u32 v1, s31, v1
v_mfma_f32_16x16x32_bf16 v[36:39], a[56:59], v[200:203], v[36:39]
v_exp_f32 v31, v31
v_mfma_f32_16x16x32_bf16 v[36:39], a[52:55], v[196:199], v[36:39]
v_cvt_pk_bf16_f32 v43, v30, v31
v_add_u32 v2, s31, v2
v_mfma_f32_16x16x32_bf16 v[36:39], a[48:51], v[192:195], v[36:39]
v_exp_f32 v32, v32
v_mfma_f32_16x16x32_bf16 v[128:131], v[40:43], a[64:67], v[128:131]
v_mfma_f32_16x16x32_bf16 v[132:135], v[40:43], a[68:71], v[132:135]
v_exp_f32 v33, v33
v_mfma_f32_16x16x32_bf16 v[136:139], v[40:43], a[72:75], v[136:139]
v_cvt_pk_bf16_f32 v44, v32, v33
v_mfma_f32_16x16x32_bf16 v[140:143], v[40:43], a[76:79], v[140:143]
v_exp_f32 v34, v34
v_mfma_f32_16x16x32_bf16 v[144:147], v[40:43], a[80:83], v[144:147]
v_mfma_f32_16x16x32_bf16 v[148:151], v[40:43], a[84:87], v[148:151]
v_exp_f32 v35, v35
v_mfma_f32_16x16x32_bf16 v[152:155], v[40:43], a[88:91], v[152:155]
s_waitcnt lgkmcnt(0)
v_cvt_pk_bf16_f32 v45, v34, v35
v_mfma_f32_16x16x32_bf16 v[156:159], v[40:43], a[92:95], v[156:159]
v_exp_f32 v36, v36
v_mfma_f32_16x16x32_bf16 a[140:143], a[128:131], v[40:43], a[140:143]
s_cbranch_scc0 L_loop3
L_last1_3:
s_cmp_eq_u32 s73, 0
s_cbranch_scc1 L_t3_1_0
s_cmp_eq_u32 s73, 4
s_cbranch_scc1 L_t3_1_4
L_t3_1_11:
v_mfma_f32_16x16x32_bf16 v[24:27], a[32:35], v[208:211], 0
s_waitcnt vmcnt(16)
buffer_load_dwordx4 v3, s[4:7], s24 offen lds
v_exp_f32 v37, v37
v_mfma_f32_16x16x32_bf16 v[24:27], a[36:39], v[212:215], v[24:27]
s_add_u32 s33, s33, 1
v_exp_f32 v39, v39
v_mfma_f32_16x16x32_bf16 v[24:27], a[40:43], v[216:219], v[24:27]
s_add_u32 s82, s46, 262144
buffer_load_dwordx4 v4, s[4:7], s24 offen offset:1056 lds
v_cvt_pk_bf16_f32 v46, v36, v37
v_mfma_f32_16x16x32_bf16 v[24:27], a[44:47], v[220:223], v[24:27]
s_mov_b32 s14, s47
v_exp_f32 v38, v38
v_mfma_f32_16x16x32_bf16 v[28:31], a[60:63], v[220:223], 0
s_add_u32 s80, s46, 0
v_cvt_pk_bf16_f32 v47, v38, v39
s_add_u32 s83, s46, 393216
v_mfma_f32_16x16x32_bf16 v[28:31], a[56:59], v[216:219], v[28:31]
s_add_u32 s81, s46, 131072
buffer_load_dwordx4 v3, s[8:11], s24 offen offset:2080 lds
v_exp_f32 v24, v24
v_mfma_f32_16x16x32_bf16 v[28:31], a[52:55], v[212:215], v[28:31]
s_sub_u32 s30, s30, 1
v_exp_f32 v25, v25
v_mfma_f32_16x16x32_bf16 v[28:31], a[48:51], v[208:211], v[28:31]
s_cselect_b32 s31, s35, s34
v_exp_f32 v27, v27
v_mfma_f32_16x16x32_bf16 a[132:135], a[128:131], v[44:47], a[132:135]
s_cselect_b32 s30, 7, s30
buffer_load_dwordx4 v4, s[8:11], s24 offen offset:3136 lds
v_exp_f32 v26, v26
v_mfma_f32_16x16x32_bf16 v[64:67], v[44:47], a[96:99], v[64:67]
s_add_u32 m0, m0, s34
v_exp_f32 v28, v28
v_mfma_f32_16x16x32_bf16 v[68:71], v[44:47], a[100:103], v[68:71]
s_add_u32 s24, s24, s25
v_exp_f32 v31, v31
v_mfma_f32_16x16x32_bf16 v[72:75], v[44:47], a[104:107], v[72:75]
s_cmp_eq_u32 m0, s29
v_exp_f32 v30, v30
v_mfma_f32_16x16x32_bf16 v[76:79], v[44:47], a[108:111], v[76:79]
s_cselect_b32 m0, s28, m0
v_exp_f32 v29, v29
v_mfma_f32_16x16x32_bf16 v[80:83], v[44:47], a[112:115], v[80:83]
s_lshr_b32 s78, s42, 12
v_cvt_pk_bf16_f32 v43, v30, v31
v_cvt_pk_bf16_f32 v41, v26, v27
v_mfma_f32_16x16x32_bf16 v[84:87], v[44:47], a[116:119], v[84:87]
s_lshr_b32 s77, s43, 12
v_cvt_pk_bf16_f32 v42, v28, v29
v_cvt_pk_bf16_f32 v40, v24, v25
v_mfma_f32_16x16x32_bf16 v[88:91], v[44:47], a[120:123], v[88:91]
s_sub_u32 s77, s77, s78
v_accvgpr_read_b32 v16, a132
v_rcp_f32 v13, v16
v_mfma_f32_16x16x32_bf16 v[92:95], v[44:47], a[124:127], v[92:95]
s_lshl_b32 s78, s45, 5
ds_write_b32 v60, v13
ds_read_b128 v[52:55], v61
v_max3_u32 v12, v12, v16, v13
v_mfma_f32_16x16x32_bf16 v[32:35], a[32:35], v[224:227], 0
s_sub_u32 s77, s77, s78
v_add_u32 v17, v1, v7
ds_read_b128 v[192:195], v17 offset:0
ds_read_b128 v[196:199], v17 offset:64
s_waitcnt vmcnt(16)
v_mfma_f32_16x16x32_bf16 v[32:35], a[36:39], v[228:231], v[32:35]
s_add_u32 s50, s77, 32
ds_read_b128 v[200:203], v17 offset:128
v_add_u32 v1, s31, v1
v_mfma_f32_16x16x32_bf16 v[32:35], a[40:43], v[232:235], v[32:35]
s_add_u32 s84, s46, 524288
ds_read_b128 v[204:207], v17 offset:192
v_add_u32 v19, v1, v7
v_mfma_f32_16x16x32_bf16 v[32:35], a[44:47], v[236:239], v[32:35]
s_add_u32 s85, s46, 655360
v_add_u32 v2, s31, v2
s_sub_u32 s30, s30, 1
v_mfma_f32_16x16x32_bf16 v[36:39], a[60:63], v[236:239], 0
s_cselect_b32 s31, s35, s34
v_add_u32 v1, s31, v1
s_cselect_b32 s30, 7, s30
v_mfma_f32_16x16x32_bf16 v[36:39], a[56:59], v[232:235], v[36:39]
s_sub_u32 s26, s26, 1
v_add_u32 v2, s31, v2
v_exp_f32 v33, v33
v_mfma_f32_16x16x32_bf16 v[36:39], a[52:55], v[228:231], v[36:39]
s_sub_u32 s30, s30, 1
v_exp_f32 v32, v32
v_mfma_f32_16x16x32_bf16 v[36:39], a[48:51], v[224:227], v[36:39]
s_cselect_b32 s31, s35, s34
v_exp_f32 v34, v34
v_mfma_f32_16x16x32_bf16 a[136:139], a[128:131], v[40:43], a[136:139]
s_cselect_b32 s30, 7, s30
s_waitcnt lgkmcnt(4)
v_pk_mul_f32 v[64:65], v[64:65], v[52:53]
v_pk_mul_f32 v[70:71], v[70:71], v[54:55]
v_pk_mul_f32 v[80:81], v[80:81], v[52:53]
v_pk_mul_f32 v[76:77], v[76:77], v[52:53]
v_pk_mul_f32 v[72:73], v[72:73], v[52:53]
v_pk_mul_f32 v[66:67], v[66:67], v[54:55]
v_pk_mul_f32 v[86:87], v[86:87], v[54:55]
v_pk_mul_f32 v[84:85], v[84:85], v[52:53]
v_pk_mul_f32 v[92:93], v[92:93], v[52:53]
v_pk_mul_f32 v[82:83], v[82:83], v[54:55]
v_pk_mul_f32 v[94:95], v[94:95], v[54:55]
v_pk_mul_f32 v[90:91], v[90:91], v[54:55]
v_pk_mul_f32 v[68:69], v[68:69], v[52:53]
v_pk_mul_f32 v[88:89], v[88:89], v[52:53]
v_pk_mul_f32 v[74:75], v[74:75], v[54:55]
v_pk_mul_f32 v[78:79], v[78:79], v[54:55]
v_mfma_f32_16x16x32_bf16 v[96:99], v[40:43], a[96:99], v[96:99]
s_sub_u32 s26, s26, 1
v_accvgpr_read_b32 v18, a136
v_rcp_f32 v13, v18
v_mfma_f32_16x16x32_bf16 v[100:103], v[40:43], a[100:103], v[100:103]
s_sub_u32 s26, s26, 1
ds_write_b32 v60, v13
ds_read_b128 v[240:243], v61
v_cvt_pk_bf16_f32 v80, v80, v84
v_mfma_f32_16x16x32_bf16 v[104:107], v[40:43], a[104:107], v[104:107]
s_mov_b32 s46, s41
v_cvt_pk_bf16_f32 v82, v82, v86
v_cvt_pk_bf16_f32 v86, v83, v87
v_mfma_f32_16x16x32_bf16 v[108:111], v[40:43], a[108:111], v[108:111]
s_sub_u32 s26, s26, 1
v_cvt_pk_bf16_f32 v66, v66, v70
v_cvt_pk_bf16_f32 v84, v81, v85
v_mfma_f32_16x16x32_bf16 v[112:115], v[40:43], a[112:115], v[112:115]
s_mov_b32 s47, s43
v_cvt_pk_bf16_f32 v70, v67, v71
v_cvt_pk_bf16_f32 v71, v75, v79
v_mfma_f32_16x16x32_bf16 v[116:119], v[40:43], a[116:119], v[116:119]
s_sub_u32 s26, s26, 1
v_cvt_pk_bf16_f32 v64, v64, v68
v_cvt_pk_bf16_f32 v68, v65, v69
v_mfma_f32_16x16x32_bf16 v[120:123], v[40:43], a[120:123], v[120:123]
s_mov_b32 s49, s45
v_cvt_pk_bf16_f32 v65, v72, v76
v_cvt_pk_bf16_f32 v67, v74, v78
v_mfma_f32_16x16x32_bf16 v[124:127], v[40:43], a[124:127], v[124:127]
s_sub_u32 s32, s49, 3
v_cvt_pk_bf16_f32 v85, v89, v93
v_cvt_pk_bf16_f32 v83, v90, v94
s_waitcnt lgkmcnt(5)
v_mfma_f32_16x16x32_bf16 v[164:167], a[144:147], v[192:195], 0
s_waitcnt vmcnt(12)
v_cvt_pk_bf16_f32 v69, v73, v77
ds_write2_b64 v0, v[68:69], v[84:85] offset0:32 offset1:48
v_cvt_pk_bf16_f32 v87, v91, v95
v_mfma_f32_16x16x32_bf16 v[160:163], a[146:149], v[192:195], 0
s_mov_b32 s73, 0
s_waitcnt lgkmcnt(1)
v_pk_mul_f32 v[102:103], v[102:103], v[242:243]
v_pk_mul_f32 v[96:97], v[96:97], v[240:241]
v_pk_mul_f32 v[114:115], v[114:115], v[242:243]
v_pk_mul_f32 v[108:109], v[108:109], v[240:241]
v_pk_mul_f32 v[120:121], v[120:121], v[240:241]
v_pk_mul_f32 v[124:125], v[124:125], v[240:241]
v_pk_mul_f32 v[98:99], v[98:99], v[242:243]
v_pk_mul_f32 v[118:119], v[118:119], v[242:243]
v_pk_mul_f32 v[122:123], v[122:123], v[242:243]
v_pk_mul_f32 v[100:101], v[100:101], v[240:241]
v_pk_mul_f32 v[106:107], v[106:107], v[242:243]
v_pk_mul_f32 v[126:127], v[126:127], v[242:243]
v_pk_mul_f32 v[112:113], v[112:113], v[240:241]
v_pk_mul_f32 v[110:111], v[110:111], v[242:243]
v_pk_mul_f32 v[116:117], v[116:117], v[240:241]
v_pk_mul_f32 v[104:105], v[104:105], v[240:241]
v_mfma_f32_16x16x32_bf16 v[172:175], a[144:147], v[196:199], 0
ds_write2_b64 v0, v[70:71], v[86:87] offset0:112 offset1:96
v_cvt_pk_bf16_f32 v81, v88, v92
v_mfma_f32_16x16x32_bf16 v[164:167], a[148:151], v[192:195], v[164:167]
ds_write2_b64 v5, v[66:67], v[82:83] offset0:80 offset1:64
v_cvt_pk_bf16_f32 v98, v98, v102
v_mfma_f32_16x16x32_bf16 v[160:163], a[150:153], v[192:195], v[160:163]
v_cvt_pk_bf16_f32 v96, v96, v100
v_cvt_pk_bf16_f32 v102, v99, v103
v_mfma_f32_16x16x32_bf16 v[168:171], a[146:149], v[196:199], 0
ds_write2_b64 v5, v[64:65], v[80:81] offset0:0 offset1:16
v_cvt_pk_bf16_f32 v114, v114, v118
v_mfma_f32_16x16x32_bf16 v[176:179], a[146:149], v[200:203], 0
v_cvt_pk_bf16_f32 v112, v112, v116
v_cvt_pk_bf16_f32 v116, v113, v117
v_mfma_f32_16x16x32_bf16 v[180:183], a[144:147], v[200:203], 0
ds_read_b64_tr_b16 v[82:83], v59 offset:0
ds_read_b64_tr_b16 v[64:65], v56 offset:0
v_cvt_pk_bf16_f32 v118, v115, v119
v_mfma_f32_16x16x32_bf16 v[168:171], a[150:153], v[196:199], v[168:171]
ds_read_b64_tr_b16 v[66:67], v57 offset:0
ds_read_b64_tr_b16 v[88:89], v58 offset:2048
ds_read_b64_tr_b16 v[74:75], v57 offset:2048
v_cvt_pk_bf16_f32 v113, v120, v124
v_mfma_f32_16x16x32_bf16 v[172:175], a[148:151], v[196:199], v[172:175]
ds_read_b64_tr_b16 v[90:91], v59 offset:2048
ds_read_b64_tr_b16 v[80:81], v58 offset:0
ds_read_b64_tr_b16 v[72:73], v56 offset:2048
v_cvt_pk_bf16_f32 v100, v97, v101
v_mfma_f32_16x16x32_bf16 v[188:191], a[144:147], v[204:207], 0
v_cvt_pk_bf16_f32 v97, v104, v108
v_cvt_pk_bf16_f32 v103, v107, v111
v_mfma_f32_16x16x32_bf16 v[180:183], a[148:151], v[200:203], v[180:183]
ds_write2_b64 v5, v[96:97], v[112:113] offset0:0 offset1:16
v_cvt_pk_bf16_f32 v99, v106, v110
v_mfma_f32_16x16x32_bf16 v[176:179], a[150:153], v[200:203], v[176:179]
v_cvt_pk_bf16_f32 v115, v122, v126
v_cvt_pk_bf16_f32 v101, v105, v109
v_mfma_f32_16x16x32_bf16 v[184:187], a[146:149], v[204:207], 0
ds_write2_b64 v5, v[98:99], v[114:115] offset0:80 offset1:64
v_cvt_pk_bf16_f32 v119, v123, v127
v_mfma_f32_16x16x32_bf16 v[184:187], a[150:153], v[204:207], v[184:187]
ds_write2_b64 v0, v[102:103], v[118:119] offset0:112 offset1:96
v_cvt_pk_bf16_f32 v117, v121, v125
v_mfma_f32_16x16x32_bf16 v[188:191], a[148:151], v[204:207], v[188:191]
s_waitcnt lgkmcnt(8)
buffer_store_dwordx4 v[64:67], v6, s[12:15], s80 offen offset:0 sc1
ds_write2_b64 v0, v[100:101], v[116:117] offset0:32 offset1:48
s_waitcnt lgkmcnt(4)
buffer_store_dwordx4 v[72:75], v6, s[12:15], s81 offen offset:0 sc1
ds_read_b64_tr_b16 v[96:97], v56 offset:0
v_exp_f32 v37, v37
ds_read_b64_tr_b16 v[98:99], v57 offset:0
ds_read_b64_tr_b16 v[106:107], v57 offset:2048
v_exp_f32 v38, v38
ds_read_b64_tr_b16 v[104:105], v56 offset:2048
ds_read_b64_tr_b16 v[112:113], v58 offset:0
buffer_store_dwordx4 v[80:83], v6, s[12:15], s80 offen offset:128 sc1
ds_read_b64_tr_b16 v[114:115], v59 offset:0
ds_read_b64_tr_b16 v[120:121], v58 offset:2048
ds_read_b64_tr_b16 v[122:123], v59 offset:2048
v_exp_f32 v36, v36
v_exp_f32 v39, v39
v_exp_f32 v35, v35
v_cvt_pk_bf16_f32 v46, v36, v37
v_cvt_pk_bf16_f32 v45, v34, v35
v_cvt_pk_bf16_f32 v47, v38, v39
v_cvt_pk_bf16_f32 v44, v32, v33
v_max3_u32 v12, v12, v18, v13
v_add_u32 v21, v1, v7
v_mfma_f32_16x16x32_bf16 a[140:143], a[128:131], v[44:47], a[140:143]
ds_read_b128 v[208:211], v19 offset:0
v_add_u32 v1, s31, v1
v_mfma_f32_16x16x32_bf16 v[128:131], v[44:47], a[96:99], v[128:131]
ds_read_b128 v[212:215], v19 offset:64
buffer_store_dwordx4 v[88:91], v6, s[12:15], s81 offen offset:128 sc1
s_waitcnt vmcnt(12)
v_mfma_f32_16x16x32_bf16 v[132:135], v[44:47], a[100:103], v[132:135]
ds_add_u32 v8, v10
s_waitcnt lgkmcnt(9)
buffer_store_dwordx4 v[96:99], v6, s[12:15], s82 offen offset:0 sc1
v_accvgpr_read_b32 v20, a140
v_mfma_f32_16x16x32_bf16 v[136:139], v[44:47], a[104:107], v[136:139]
ds_read_b128 v[216:219], v19 offset:128
v_rcp_f32 v13, v20
v_mfma_f32_16x16x32_bf16 v[140:143], v[44:47], a[108:111], v[140:143]
ds_write_b32 v60, v13
s_waitcnt lgkmcnt(9)
buffer_store_dwordx4 v[104:107], v6, s[12:15], s83 offen offset:0 sc1
ds_read_b128 v[52:55], v61
ds_read_b128 v[220:223], v19 offset:192
v_max3_u32 v12, v12, v20, v13
v_mfma_f32_16x16x32_bf16 v[144:147], v[44:47], a[112:115], v[144:147]
ds_read_b128 v[224:227], v21 offset:0
v_mbcnt_lo_u32_b32 v13, -1, 0
v_mfma_f32_16x16x32_bf16 v[148:151], v[44:47], a[116:119], v[148:151]
s_waitcnt lgkmcnt(10)
buffer_store_dwordx4 v[112:115], v6, s[12:15], s82 offen offset:128 sc1
v_mbcnt_hi_u32_b32 v13, -1, v13
v_mfma_f32_16x16x32_bf16 v[152:155], v[44:47], a[120:123], v[152:155]
ds_read_b128 v[228:231], v21 offset:64
v_lshrrev_b32 v13, 2, v13
v_mfma_f32_16x16x32_bf16 v[156:159], v[44:47], a[124:127], v[156:159]
ds_read_b128 v[232:235], v21 offset:128
v_and_b32 v13, 12, v13
s_waitcnt lgkmcnt(9)
v_mfma_f32_16x16x32_bf16 v[100:103], a[144:147], v[208:211], 0
buffer_store_dwordx4 v[120:123], v6, s[12:15], s83 offen offset:128 sc1
v_sub_u32 v13, s50, v13
v_mfma_f32_16x16x32_bf16 v[96:99], a[146:149], v[208:211], 0
ds_read_b128 v[236:239], v21 offset:192
v_cvt_f32_i32 v13, v13
v_mfma_f32_16x16x32_bf16 v[96:99], a[150:153], v[208:211], v[96:99]
v_cvt_pk_bf16_f32 v192, v160, v161
v_mov_b32 v14, 0x7c800000
s_waitcnt lgkmcnt(9)
v_mfma_f32_16x16x32_bf16 v[104:107], a[146:149], v[212:215], 0
s_waitcnt lgkmcnt(5)
v_pk_mul_f32 v[144:145], v[144:145], v[52:53]
v_pk_mul_f32 v[148:149], v[148:149], v[52:53]
v_pk_mul_f32 v[158:159], v[158:159], v[54:55]
v_pk_mul_f32 v[142:143], v[142:143], v[54:55]
v_pk_mul_f32 v[146:147], v[146:147], v[54:55]
v_pk_mul_f32 v[128:129], v[128:129], v[52:53]
v_pk_mul_f32 v[134:135], v[134:135], v[54:55]
v_pk_mul_f32 v[150:151], v[150:151], v[54:55]
v_pk_mul_f32 v[154:155], v[154:155], v[54:55]
v_pk_mul_f32 v[130:131], v[130:131], v[54:55]
v_pk_mul_f32 v[132:133], v[132:133], v[52:53]
v_pk_mul_f32 v[138:139], v[138:139], v[54:55]
v_pk_mul_f32 v[136:137], v[136:137], v[52:53]
v_pk_mul_f32 v[156:157], v[156:157], v[52:53]
v_pk_mul_f32 v[152:153], v[152:153], v[52:53]
v_pk_mul_f32 v[140:141], v[140:141], v[52:53]
v_mfma_f32_16x16x32_bf16 v[100:103], a[148:151], v[208:211], v[100:103]
v_fmaak_f32 v19, v13, v14, 0xfd600000
v_fmaak_f32 v17, v13, v14, 0xfcc00000
v_mfma_f32_16x16x32_bf16 v[108:111], a[144:147], v[212:215], 0
ds_read_b32 v11, v9
v_fmaak_f32 v18, v13, v14, 0xfd200000
v_mfma_f32_16x16x32_bf16 v[116:119], a[144:147], v[216:219], 0
v_min_f32 v17, 0, v17
v_fmaak_f32 v16, v13, v14, 0xfc000000
v_mfma_f32_16x16x32_bf16 v[108:111], a[148:151], v[212:215], v[108:111]
v_min_f32 v16, 0, v16
v_min_f32 v18, 0, v18
v_mfma_f32_16x16x32_bf16 v[112:115], a[146:149], v[216:219], 0
v_cvt_pk_bf16_f32 v193, v162, v163
v_min_f32 v19, 0, v19
v_mfma_f32_16x16x32_bf16 v[104:107], a[150:153], v[212:215], v[104:107]
v_cvt_pk_bf16_f32 v194, v164, v165
v_cvt_pk_bf16_f32 v198, v172, v173
v_mfma_f32_16x16x32_bf16 v[112:115], a[150:153], v[216:219], v[112:115]
v_cvt_pk_bf16_f32 v195, v166, v167
v_cvt_pk_bf16_f32 v199, v174, v175
s_waitcnt lgkmcnt(5)
v_mfma_f32_16x16x32_bf16 v[124:127], a[144:147], v[220:223], 0
v_cvt_pk_bf16_f32 v144, v144, v148
v_cvt_pk_bf16_f32 v197, v170, v171
v_mfma_f32_16x16x32_bf16 v[120:123], a[146:149], v[220:223], 0
v_cvt_pk_bf16_f32 v196, v168, v169
v_cvt_pk_bf16_f32 v128, v128, v132
v_mfma_f32_16x16x32_bf16 v[116:119], a[148:151], v[216:219], v[116:119]
v_cvt_pk_bf16_f32 v130, v130, v134
v_cvt_pk_bf16_f32 v134, v131, v135
v_mfma_f32_16x16x32_bf16 v[124:127], a[148:151], v[220:223], v[124:127]
v_cvt_pk_bf16_f32 v135, v139, v143
v_cvt_pk_bf16_f32 v132, v129, v133
v_mfma_f32_16x16x32_bf16 v[120:123], a[150:153], v[220:223], v[120:123]
s_waitcnt lgkmcnt(0)
v_cmp_gt_u32 vcc, s33, v11
v_cvt_pk_bf16_f32 v129, v136, v140
v_cvt_pk_bf16_f32 v202, v180, v181
v_cvt_pk_bf16_f32 v148, v145, v149
v_cvt_pk_bf16_f32 v145, v152, v156
v_cvt_pk_bf16_f32 v146, v146, v150
s_cbranch_vccnz L_spin_11
L_spinret_12:
buffer_load_dwordx4 v3, s[4:7], s24 offen lds
ds_read_b128 a[0:3], v1 offset:0
ds_read_b128 a[4:7], v1 offset:64
v_cvt_pk_bf16_f32 v150, v147, v151
ds_read_b128 a[8:11], v1 offset:128
v_cvt_pk_bf16_f32 v151, v155, v159
buffer_load_dwordx4 v4, s[4:7], s24 offen offset:1056 lds
ds_read_b128 a[12:15], v1 offset:192
v_cvt_pk_bf16_f32 v147, v154, v158
v_cvt_pk_bf16_f32 v200, v176, v177
ds_write2_b64 v5, v[128:129], v[144:145] offset0:0 offset1:16
v_cvt_pk_bf16_f32 v203, v182, v183
v_cvt_pk_bf16_f32 v201, v178, v179
v_cvt_pk_bf16_f32 v133, v137, v141
v_cvt_pk_bf16_f32 v131, v138, v142
v_mfma_f32_16x16x32_bf16 v[140:143], a[144:147], v[228:231], 0
s_add_u32 s33, s33, 1
buffer_load_dwordx4 v3, s[8:11], s24 offen offset:2080 lds
ds_write2_b64 v5, v[130:131], v[146:147] offset0:80 offset1:64
v_cvt_pk_bf16_f32 v149, v153, v157
v_mfma_f32_16x16x32_bf16 v[156:159], a[144:147], v[236:239], 0
v_cvt_pk_bf16_f32 v206, v188, v189
v_cvt_pk_bf16_f32 v204, v184, v185
v_mfma_f32_16x16x32_bf16 v[140:143], a[148:151], v[228:231], v[140:143]
buffer_load_dwordx4 v4, s[8:11], s24 offen offset:3136 lds
s_add_u32 m0, m0, s34
s_waitcnt lgkmcnt(5)
v_mfma_f32_16x16x32_bf16 v[24:27], a[0:3], v[192:195], v[16:19]
s_cmp_eq_u32 m0, s29
s_cselect_b32 m0, s28, m0
s_add_u32 s24, s24, s25
s_waitcnt lgkmcnt(4)
v_mfma_f32_16x16x32_bf16 v[24:27], a[4:7], v[196:199], v[24:27]
ds_write2_b64 v0, v[132:133], v[148:149] offset0:32 offset1:48
buffer_load_dwordx4 v3, s[4:7], s24 offen lds
ds_write2_b64 v0, v[134:135], v[150:151] offset0:112 offset1:96
s_waitcnt vmcnt(17)
s_waitcnt lgkmcnt(5)
v_mfma_f32_16x16x32_bf16 v[24:27], a[8:11], v[200:203], v[24:27]
v_cvt_pk_bf16_f32 v207, v190, v191
v_cvt_pk_bf16_f32 v205, v186, v187
v_mfma_f32_16x16x32_bf16 v[132:135], a[144:147], v[224:227], 0
ds_add_u32 v8, v10
buffer_load_dwordx4 v4, s[4:7], s24 offen offset:1056 lds
ds_read_b64_tr_b16 v[128:129], v56 offset:0
v_cvt_pk_bf16_f32 v210, v100, v101
s_waitcnt lgkmcnt(6)
v_mfma_f32_16x16x32_bf16 v[24:27], a[12:15], v[204:207], v[24:27]
ds_read_b64_tr_b16 v[130:131], v57 offset:0
v_cvt_pk_bf16_f32 v211, v102, v103
v_mfma_f32_16x16x32_bf16 v[132:135], a[148:151], v[224:227], v[132:135]
ds_read_b64_tr_b16 v[138:139], v57 offset:2048
buffer_load_dwordx4 v3, s[8:11], s24 offen offset:2080 lds
v_cvt_pk_bf16_f32 v212, v104, v105
v_mfma_f32_16x16x32_bf16 v[148:151], a[144:147], v[232:235], 0
ds_read_b64_tr_b16 v[136:137], v56 offset:2048
v_cvt_pk_bf16_f32 v208, v96, v97
v_mfma_f32_16x16x32_bf16 v[148:151], a[148:151], v[232:235], v[148:151]
ds_read_b64_tr_b16 v[146:147], v59 offset:0
v_cvt_pk_bf16_f32 v209, v98, v99
v_mfma_f32_16x16x32_bf16 v[156:159], a[148:151], v[236:239], v[156:159]
ds_read_b64_tr_b16 v[144:145], v58 offset:0
v_cvt_pk_bf16_f32 v214, v108, v109
v_mfma_f32_16x16x32_bf16 v[32:35], a[0:3], v[208:211], v[16:19]
buffer_load_dwordx4 v4, s[8:11], s24 offen offset:3136 lds
v_cvt_pk_bf16_f32 v215, v110, v111
v_cvt_pk_bf16_f32 v213, v106, v107
v_cvt_pk_bf16_f32 v217, v114, v115
v_cvt_pk_bf16_f32 v216, v112, v113
v_mfma_f32_16x16x32_bf16 v[32:35], a[4:7], v[212:215], v[32:35]
s_add_u32 m0, m0, s34
v_cvt_pk_bf16_f32 v218, v116, v117
v_cvt_pk_bf16_f32 v219, v118, v119
v_cvt_pk_bf16_f32 v220, v120, v121
v_cvt_pk_bf16_f32 v221, v122, v123
v_mfma_f32_16x16x32_bf16 v[32:35], a[8:11], v[216:219], v[32:35]
s_cmp_eq_u32 m0, s29
v_cvt_pk_bf16_f32 v223, v126, v127
v_cvt_pk_bf16_f32 v222, v124, v125
s_waitcnt lgkmcnt(4)
buffer_store_dwordx4 v[128:131], v6, s[12:15], s84 offen offset:0 sc1
v_add_u32 v2, s31, v2
v_mfma_f32_16x16x32_bf16 v[32:35], a[12:15], v[220:223], v[32:35]
s_waitcnt vmcnt(17)
ds_read_b64_tr_b16 a[66:67], v2 offset:512
ds_read_b64_tr_b16 a[64:65], v2 offset:0
ds_read_b64_tr_b16 a[68:69], v2 offset:32
ds_read_b64_tr_b16 a[70:71], v2 offset:544
ds_read_b64_tr_b16 a[74:75], v2 offset:576
ds_read_b64_tr_b16 a[72:73], v2 offset:64
s_waitcnt lgkmcnt(8)
buffer_store_dwordx4 v[136:139], v6, s[12:15], s85 offen offset:0 sc1
ds_read_b64_tr_b16 a[76:77], v2 offset:96
ds_read_b64_tr_b16 a[78:79], v2 offset:608
ds_read_b64_tr_b16 a[82:83], v2 offset:640
ds_read_b64_tr_b16 a[80:81], v2 offset:128
ds_read_b64_tr_b16 a[86:87], v2 offset:672
v_exp_f32 v24, v24
v_mfma_f32_16x16x32_bf16 v[128:131], a[146:149], v[224:227], 0
s_cselect_b32 m0, s28, m0
ds_read_b64_tr_b16 a[84:85], v2 offset:160
ds_read_b64_tr_b16 v[152:153], v58 offset:2048
ds_read_b64_tr_b16 a[90:91], v2 offset:704
v_exp_f32 v25, v25
v_mfma_f32_16x16x32_bf16 v[136:139], a[146:149], v[228:231], 0
s_sub_u32 s30, s30, 1
v_exp_f32 v27, v27
v_mfma_f32_16x16x32_bf16 v[128:131], a[150:153], v[224:227], v[128:131]
s_cselect_b32 s31, s35, s34
ds_read_b32 v11, v9
ds_add_u32 v8, v10
ds_read_b64_tr_b16 a[88:89], v2 offset:192
ds_read_b64_tr_b16 v[154:155], v59 offset:2048
ds_read_b64_tr_b16 a[92:93], v2 offset:224
v_exp_f32 v26, v26
v_mfma_f32_16x16x32_bf16 v[136:139], a[150:153], v[228:231], v[136:139]
s_cselect_b32 s30, 7, s30
ds_read_b64_tr_b16 a[94:95], v2 offset:736
v_cvt_pk_bf16_f32 v40, v24, v25
v_mov_b32 v43, 0
v_cvt_pk_bf16_f32 v41, v26, v27
v_mov_b32 v42, 0
s_waitcnt lgkmcnt(15)
buffer_store_dwordx4 v[144:147], v6, s[12:15], s84 offen offset:128 sc1
v_cvt_pk_bf16_f32 v224, v128, v129
v_mfma_f32_16x16x32_bf16 v[64:67], v[40:43], a[64:67], 0
s_add_u32 s24, s24, s25
v_cvt_pk_bf16_f32 v227, v134, v135
v_cvt_pk_bf16_f32 v225, v130, v131
v_mfma_f32_16x16x32_bf16 v[68:71], v[40:43], a[68:71], 0
ds_read_b128 a[20:23], v1 offset:576
v_cvt_pk_bf16_f32 v226, v132, v133
s_waitcnt lgkmcnt(15)
v_mfma_f32_16x16x32_bf16 v[72:75], v[40:43], a[72:75], 0
ds_read_b128 a[24:27], v1 offset:640
v_cvt_pk_bf16_f32 v229, v138, v139
s_waitcnt lgkmcnt(14)
v_mfma_f32_16x16x32_bf16 v[76:79], v[40:43], a[76:79], 0
ds_read_b128 a[28:31], v1 offset:704
v_cvt_pk_bf16_f32 v228, v136, v137
s_waitcnt lgkmcnt(13)
v_mfma_f32_16x16x32_bf16 v[80:83], v[40:43], a[80:83], 0
ds_read_b128 a[16:19], v1 offset:512
v_cvt_pk_bf16_f32 v230, v140, v141
s_waitcnt lgkmcnt(12)
v_mfma_f32_16x16x32_bf16 v[84:87], v[40:43], a[84:87], 0
buffer_load_dwordx4 v3, s[4:7], s24 offen lds
v_cvt_pk_bf16_f32 v231, v142, v143
s_waitcnt lgkmcnt(7)
v_mfma_f32_16x16x32_bf16 v[88:91], v[40:43], a[88:91], 0
v_exp_f32 v32, v32
s_waitcnt lgkmcnt(4)
v_mfma_f32_16x16x32_bf16 v[92:95], v[40:43], a[92:95], 0
buffer_store_dwordx4 v[152:155], v6, s[12:15], s85 offen offset:128 sc1
v_exp_f32 v34, v34
v_mfma_f32_16x16x32_bf16 v[144:147], a[146:149], v[232:235], 0
v_exp_f32 v33, v33
v_mfma_f32_16x16x32_bf16 a[132:135], a[128:131], v[40:43], 0
v_exp_f32 v35, v35
v_mfma_f32_16x16x32_bf16 v[144:147], a[150:153], v[232:235], v[144:147]
buffer_load_dwordx4 v4, s[4:7], s24 offen offset:1056 lds
v_cvt_pk_bf16_f32 v235, v150, v151
v_mfma_f32_16x16x32_bf16 v[152:155], a[146:149], v[236:239], 0
v_cvt_pk_bf16_f32 v234, v148, v149
v_mov_b32 v46, 0
v_mfma_f32_16x16x32_bf16 v[152:155], a[150:153], v[236:239], v[152:155]
s_nop 1
v_cvt_pk_bf16_f32 v233, v146, v147
v_cvt_pk_bf16_f32 v238, v156, v157
v_mfma_f32_16x16x32_bf16 v[24:27], a[0:3], v[224:227], v[16:19]
buffer_load_dwordx4 v3, s[8:11], s24 offen offset:2080 lds
v_cvt_pk_bf16_f32 v232, v144, v145
v_mfma_f32_16x16x32_bf16 v[24:27], a[4:7], v[228:231], v[24:27]
v_cvt_pk_bf16_f32 v239, v158, v159
v_cvt_pk_bf16_f32 v237, v154, v155
v_mfma_f32_16x16x32_bf16 v[24:27], a[8:11], v[232:235], v[24:27]
v_cvt_pk_bf16_f32 v236, v152, v153
v_mov_b32 v47, 0
v_cmp_gt_u32 vcc, s33, v11
v_mfma_f32_16x16x32_bf16 v[24:27], a[12:15], v[236:239], v[24:27]
buffer_load_dwordx4 v4, s[8:11], s24 offen offset:3136 lds
v_cvt_pk_bf16_f32 v45, v34, v35
v_cvt_pk_bf16_f32 v44, v32, v33
v_add_u32 v1, s31, v1
s_cbranch_vccnz L_spin_13
L_spinret_14:
v_mfma_f32_16x16x32_bf16 v[96:99], v[44:47], a[64:67], 0
s_add_u32 m0, m0, s34
ds_read_b128 a[32:35], v1 offset:0
ds_read_b128 a[36:39], v1 offset:64
v_exp_f32 v24, v24
v_mfma_f32_16x16x32_bf16 v[100:103], v[44:47], a[68:71], 0
s_cmp_eq_u32 m0, s29
ds_read_b128 a[40:43], v1 offset:128
ds_read_b128 a[44:47], v1 offset:192
v_exp_f32 v25, v25
v_mfma_f32_16x16x32_bf16 v[104:107], v[44:47], a[72:75], 0
s_cselect_b32 m0, s28, m0
ds_read_b128 a[60:63], v1 offset:704
v_cvt_pk_bf16_f32 v40, v24, v25
v_mfma_f32_16x16x32_bf16 v[108:111], v[44:47], a[76:79], 0
s_add_u32 s24, s24, s25
ds_read_b128 a[56:59], v1 offset:640
v_exp_f32 v26, v26
v_mfma_f32_16x16x32_bf16 v[112:115], v[44:47], a[80:83], 0
s_add_u32 s33, s33, 1
ds_read_b128 a[52:55], v1 offset:576
v_exp_f32 v27, v27
v_mfma_f32_16x16x32_bf16 v[116:119], v[44:47], a[84:87], 0
ds_read_b128 a[48:51], v1 offset:512
v_cvt_pk_bf16_f32 v41, v26, v27
v_mfma_f32_16x16x32_bf16 v[120:123], v[44:47], a[88:91], 0
ds_read_b32 v11, v9
v_add_u32 v2, s31, v2
v_mfma_f32_16x16x32_bf16 v[124:127], v[44:47], a[92:95], 0
s_sub_u32 s30, s30, 1
ds_read_b64_tr_b16 a[110:111], v2 offset:608
ds_read_b64_tr_b16 a[122:123], v2 offset:704
ds_read_b64_tr_b16 a[108:109], v2 offset:96
ds_read_b64_tr_b16 a[126:127], v2 offset:736
ds_read_b64_tr_b16 a[100:101], v2 offset:32
ds_read_b64_tr_b16 a[118:119], v2 offset:672
buffer_load_dwordx4 v3, s[4:7], s24 offen lds
ds_read_b64_tr_b16 a[116:117], v2 offset:160
ds_read_b64_tr_b16 a[98:99], v2 offset:512
ds_read_b64_tr_b16 a[114:115], v2 offset:640
s_cselect_b32 s31, s35, s34
v_mfma_f32_16x16x32_bf16 a[136:139], a[128:131], v[44:47], 0
s_cselect_b32 s30, 7, s30
ds_read_b64_tr_b16 a[106:107], v2 offset:576
ds_read_b64_tr_b16 a[96:97], v2 offset:0
ds_read_b64_tr_b16 a[104:105], v2 offset:64
v_add_u32 v1, s31, v1
s_waitcnt lgkmcnt(15)
v_mfma_f32_16x16x32_bf16 v[32:35], a[32:35], v[192:195], 0
ds_read_b64_tr_b16 a[102:103], v2 offset:544
ds_read_b64_tr_b16 a[124:125], v2 offset:224
ds_read_b64_tr_b16 a[112:113], v2 offset:128
buffer_load_dwordx4 v4, s[4:7], s24 offen offset:1056 lds
ds_read_b64_tr_b16 a[120:121], v2 offset:192
v_add_u32 v2, s31, v2
v_mfma_f32_16x16x32_bf16 v[32:35], a[36:39], v[196:199], v[32:35]
buffer_load_dwordx4 v3, s[8:11], s24 offen offset:2080 lds
v_mfma_f32_16x16x32_bf16 v[32:35], a[40:43], v[200:203], v[32:35]
s_waitcnt lgkmcnt(15)
v_cmp_gt_u32 vcc, s33, v11
v_mfma_f32_16x16x32_bf16 v[32:35], a[44:47], v[204:207], v[32:35]
v_mfma_f32_16x16x32_bf16 v[36:39], a[60:63], v[204:207], 0
v_mfma_f32_16x16x32_bf16 v[36:39], a[56:59], v[200:203], v[36:39]
buffer_load_dwordx4 v4, s[8:11], s24 offen offset:3136 lds
s_add_u32 m0, m0, s34
v_mfma_f32_16x16x32_bf16 v[36:39], a[52:55], v[196:199], v[36:39]
s_cmp_eq_u32 m0, s29
s_nop 1
v_exp_f32 v35, v35
v_mfma_f32_16x16x32_bf16 v[36:39], a[48:51], v[192:195], v[36:39]
s_cselect_b32 m0, s28, m0
v_exp_f32 v34, v34
v_mfma_f32_16x16x32_bf16 v[128:131], v[40:43], a[64:67], 0
s_add_u32 s24, s24, s25
v_exp_f32 v33, v33
v_mfma_f32_16x16x32_bf16 v[132:135], v[40:43], a[68:71], 0
v_exp_f32 v32, v32
v_mfma_f32_16x16x32_bf16 v[136:139], v[40:43], a[72:75], 0
v_exp_f32 v36, v36
v_mfma_f32_16x16x32_bf16 v[140:143], v[40:43], a[76:79], 0
v_cvt_pk_bf16_f32 v44, v32, v33
v_cvt_pk_bf16_f32 v45, v34, v35
v_mfma_f32_16x16x32_bf16 v[144:147], v[40:43], a[80:83], 0
v_mfma_f32_16x16x32_bf16 v[148:151], v[40:43], a[84:87], 0
v_mfma_f32_16x16x32_bf16 v[152:155], v[40:43], a[88:91], 0
v_mfma_f32_16x16x32_bf16 v[156:159], v[40:43], a[92:95], 0
v_mfma_f32_16x16x32_bf16 a[140:143], a[128:131], v[40:43], 0
s_waitcnt lgkmcnt(0)
s_cbranch_vccnz L_spin_15
L_spinret_16:
s_branch L_loop3
L_t3_1_4:
v_mfma_f32_16x16x32_bf16 v[24:27], a[32:35], v[208:211], 0
s_waitcnt vmcnt(16)
buffer_load_dwordx4 v3, s[4:7], s24 offen lds
buffer_load_dwordx4 v4, s[4:7], s24 offen offset:1056 lds
s_add_u32 s33, s33, 1
v_mfma_f32_16x16x32_bf16 v[24:27], a[36:39], v[212:215], v[24:27]
s_mov_b32 s14, s47
v_add_u32 v17, v1, v7
ds_read_b128 v[192:195], v17 offset:0
ds_read_b128 v[196:199], v17 offset:64
v_exp_f32 v37, v37
v_mfma_f32_16x16x32_bf16 v[24:27], a[40:43], v[216:219], v[24:27]
s_add_u32 s80, s46, 0
buffer_load_dwordx4 v3, s[8:11], s24 offen offset:2080 lds
ds_read_b128 v[200:203], v17 offset:128
ds_read_b128 v[204:207], v17 offset:192
v_exp_f32 v38, v38
v_mfma_f32_16x16x32_bf16 v[24:27], a[44:47], v[220:223], v[24:27]
s_sub_u32 s30, s30, 1
v_exp_f32 v39, v39
v_mfma_f32_16x16x32_bf16 v[28:31], a[60:63], v[220:223], 0
s_cselect_b32 s31, s35, s34
v_cvt_pk_bf16_f32 v46, v36, v37
v_cvt_pk_bf16_f32 v47, v38, v39
v_mfma_f32_16x16x32_bf16 v[28:31], a[56:59], v[216:219], v[28:31]
s_cselect_b32 s30, 7, s30
buffer_load_dwordx4 v4, s[8:11], s24 offen offset:3136 lds
s_add_u32 m0, m0, s34
v_mfma_f32_16x16x32_bf16 v[28:31], a[52:55], v[212:215], v[28:31]
s_cmp_eq_u32 m0, s29
s_cselect_b32 m0, s28, m0
s_add_u32 s24, s24, s25
v_mfma_f32_16x16x32_bf16 v[28:31], a[48:51], v[208:211], v[28:31]
s_add_u32 s81, s46, 131072
v_add_u32 v1, s31, v1
v_add_u32 v19, v1, v7
v_mfma_f32_16x16x32_bf16 a[132:135], a[128:131], v[44:47], a[132:135]
s_add_u32 s82, s46, 262144
v_exp_f32 v24, v24
v_mfma_f32_16x16x32_bf16 v[64:67], v[44:47], a[96:99], v[64:67]
s_add_u32 s83, s46, 393216
v_exp_f32 v25, v25
v_mfma_f32_16x16x32_bf16 v[68:71], v[44:47], a[100:103], v[68:71]
s_add_u32 s84, s46, 524288
v_exp_f32 v26, v26
v_mfma_f32_16x16x32_bf16 v[72:75], v[44:47], a[104:107], v[72:75]
s_add_u32 s85, s46, 655360
v_accvgpr_read_b32 v16, a132
v_rcp_f32 v13, v16
v_mfma_f32_16x16x32_bf16 v[76:79], v[44:47], a[108:111], v[76:79]
s_lshr_b32 s77, s43, 12
ds_write_b32 v60, v13
ds_read_b128 v[52:55], v61
v_exp_f32 v27, v27
v_mfma_f32_16x16x32_bf16 v[80:83], v[44:47], a[112:115], v[80:83]
s_lshr_b32 s78, s42, 12
v_exp_f32 v28, v28
v_mfma_f32_16x16x32_bf16 v[84:87], v[44:47], a[116:119], v[84:87]
s_sub_u32 s77, s77, s78
v_exp_f32 v29, v29
v_mfma_f32_16x16x32_bf16 v[88:91], v[44:47], a[120:123], v[88:91]
s_lshl_b32 s78, s45, 5
v_exp_f32 v30, v30
v_mfma_f32_16x16x32_bf16 v[92:95], v[44:47], a[124:127], v[92:95]
s_sub_u32 s77, s77, s78
v_exp_f32 v31, v31
v_mfma_f32_16x16x32_bf16 v[32:35], a[32:35], v[224:227], 0
s_add_u32 s50, s77, 32
v_cvt_pk_bf16_f32 v40, v24, v25
v_cvt_pk_bf16_f32 v41, v26, v27
v_mfma_f32_16x16x32_bf16 v[32:35], a[36:39], v[228:231], v[32:35]
s_sub_u32 s26, s26, 1
v_cvt_pk_bf16_f32 v42, v28, v29
v_cvt_pk_bf16_f32 v43, v30, v31
v_mfma_f32_16x16x32_bf16 v[32:35], a[40:43], v[232:235], v[32:35]
s_sub_u32 s26, s26, 1
s_waitcnt lgkmcnt(0)
v_pk_mul_f32 v[64:65], v[64:65], v[52:53]
v_pk_mul_f32 v[68:69], v[68:69], v[52:53]
v_pk_mul_f32 v[80:81], v[80:81], v[52:53]
v_pk_mul_f32 v[84:85], v[84:85], v[52:53]
v_pk_mul_f32 v[66:67], v[66:67], v[54:55]
v_pk_mul_f32 v[70:71], v[70:71], v[54:55]
v_pk_mul_f32 v[82:83], v[82:83], v[54:55]
v_pk_mul_f32 v[86:87], v[86:87], v[54:55]
v_pk_mul_f32 v[72:73], v[72:73], v[52:53]
v_pk_mul_f32 v[76:77], v[76:77], v[52:53]
v_pk_mul_f32 v[88:89], v[88:89], v[52:53]
v_pk_mul_f32 v[92:93], v[92:93], v[52:53]
v_pk_mul_f32 v[74:75], v[74:75], v[54:55]
v_pk_mul_f32 v[78:79], v[78:79], v[54:55]
v_pk_mul_f32 v[90:91], v[90:91], v[54:55]
v_pk_mul_f32 v[94:95], v[94:95], v[54:55]
v_mfma_f32_16x16x32_bf16 v[32:35], a[44:47], v[236:239], v[32:35]
s_waitcnt vmcnt(16)
v_cvt_pk_bf16_f32 v64, v64, v68
v_cvt_pk_bf16_f32 v80, v80, v84
v_mfma_f32_16x16x32_bf16 v[36:39], a[60:63], v[236:239], 0
s_sub_u32 s26, s26, 1
v_cvt_pk_bf16_f32 v66, v66, v70
v_cvt_pk_bf16_f32 v82, v82, v86
v_mfma_f32_16x16x32_bf16 v[36:39], a[56:59], v[232:235], v[36:39]
s_sub_u32 s26, s26, 1
v_cvt_pk_bf16_f32 v68, v65, v69
v_cvt_pk_bf16_f32 v84, v81, v85
v_mfma_f32_16x16x32_bf16 v[36:39], a[52:55], v[228:231], v[36:39]
s_sub_u32 s26, s26, 1
v_cvt_pk_bf16_f32 v70, v67, v71
v_cvt_pk_bf16_f32 v86, v83, v87
v_mfma_f32_16x16x32_bf16 v[36:39], a[48:51], v[224:227], v[36:39]
s_mov_b32 s49, s45
v_cvt_pk_bf16_f32 v65, v72, v76
v_cvt_pk_bf16_f32 v69, v73, v77
v_mfma_f32_16x16x32_bf16 a[136:139], a[128:131], v[40:43], a[136:139]
s_sub_u32 s26, s26, 1
v_cvt_pk_bf16_f32 v81, v88, v92
v_cvt_pk_bf16_f32 v85, v89, v93
v_mfma_f32_16x16x32_bf16 v[96:99], v[40:43], a[96:99], v[96:99]
s_mov_b32 s46, s41
v_cvt_pk_bf16_f32 v67, v74, v78
v_cvt_pk_bf16_f32 v71, v75, v79
v_mfma_f32_16x16x32_bf16 v[100:103], v[40:43], a[100:103], v[100:103]
s_mov_b32 s47, s43
v_cvt_pk_bf16_f32 v83, v90, v94
v_cvt_pk_bf16_f32 v87, v91, v95
v_mfma_f32_16x16x32_bf16 v[104:107], v[40:43], a[104:107], v[104:107]
s_mov_b32 s73, 0
ds_write2_b64 v5, v[64:65], v[80:81] offset0:0 offset1:16
v_max3_u32 v12, v12, v16, v13
v_mfma_f32_16x16x32_bf16 v[108:111], v[40:43], a[108:111], v[108:111]
s_sub_u32 s32, s49, 3
ds_write2_b64 v0, v[68:69], v[84:85] offset0:32 offset1:48
v_accvgpr_read_b32 v18, a136
v_mfma_f32_16x16x32_bf16 v[112:115], v[40:43], a[112:115], v[112:115]
v_rcp_f32 v13, v18
v_mfma_f32_16x16x32_bf16 v[116:119], v[40:43], a[116:119], v[116:119]
ds_write2_b64 v5, v[66:67], v[82:83] offset0:80 offset1:64
v_exp_f32 v32, v32
v_mfma_f32_16x16x32_bf16 v[120:123], v[40:43], a[120:123], v[120:123]
v_exp_f32 v33, v33
v_mfma_f32_16x16x32_bf16 v[124:127], v[40:43], a[124:127], v[124:127]
ds_write2_b64 v0, v[70:71], v[86:87] offset0:112 offset1:96
v_exp_f32 v34, v34
v_mfma_f32_16x16x32_bf16 v[160:163], a[146:149], v[192:195], 0
v_exp_f32 v35, v35
v_mfma_f32_16x16x32_bf16 v[164:167], a[144:147], v[192:195], 0
ds_read_b64_tr_b16 v[64:65], v56 offset:0
ds_read_b64_tr_b16 v[66:67], v57 offset:0
ds_read_b64_tr_b16 v[72:73], v56 offset:2048
ds_read_b64_tr_b16 v[74:75], v57 offset:2048
v_exp_f32 v36, v36
v_mfma_f32_16x16x32_bf16 v[160:163], a[150:153], v[192:195], v[160:163]
ds_read_b64_tr_b16 v[80:81], v58 offset:0
ds_read_b64_tr_b16 v[82:83], v59 offset:0
ds_read_b128 v[208:211], v19 offset:0
v_exp_f32 v37, v37
v_mfma_f32_16x16x32_bf16 v[164:167], a[148:151], v[192:195], v[164:167]
ds_read_b128 v[212:215], v19 offset:64
v_exp_f32 v38, v38
v_mfma_f32_16x16x32_bf16 v[168:171], a[146:149], v[196:199], 0
ds_read_b128 v[216:219], v19 offset:128
ds_read_b128 v[220:223], v19 offset:192
v_exp_f32 v39, v39
v_mfma_f32_16x16x32_bf16 v[172:175], a[144:147], v[196:199], 0
s_waitcnt vmcnt(12)
ds_read_b64_tr_b16 v[88:89], v58 offset:2048
ds_read_b64_tr_b16 v[90:91], v59 offset:2048
v_cvt_pk_bf16_f32 v44, v32, v33
v_mfma_f32_16x16x32_bf16 v[168:171], a[150:153], v[196:199], v[168:171]
s_waitcnt lgkmcnt(10)
buffer_store_dwordx4 v[64:67], v6, s[12:15], s80 offen offset:0 sc1
s_waitcnt lgkmcnt(8)
buffer_store_dwordx4 v[72:75], v6, s[12:15], s81 offen offset:0 sc1
ds_write_b32 v60, v13
ds_read_b128 v[240:243], v61
v_cvt_pk_bf16_f32 v45, v34, v35
v_mfma_f32_16x16x32_bf16 v[172:175], a[148:151], v[196:199], v[172:175]
s_waitcnt lgkmcnt(8)
buffer_store_dwordx4 v[80:83], v6, s[12:15], s80 offen offset:128 sc1
v_cvt_pk_bf16_f32 v46, v36, v37
v_mfma_f32_16x16x32_bf16 v[176:179], a[146:149], v[200:203], 0
v_cvt_pk_bf16_f32 v47, v38, v39
v_max3_u32 v12, v12, v18, v13
v_mfma_f32_16x16x32_bf16 v[180:183], a[144:147], v[200:203], 0
v_add_u32 v2, s31, v2
s_sub_u32 s30, s30, 1
v_mfma_f32_16x16x32_bf16 a[140:143], a[128:131], v[44:47], a[140:143]
s_cselect_b32 s31, s35, s34
s_waitcnt lgkmcnt(2)
buffer_store_dwordx4 v[88:91], v6, s[12:15], s81 offen offset:128 sc1
s_cselect_b32 s30, 7, s30
v_mfma_f32_16x16x32_bf16 v[128:131], v[44:47], a[96:99], v[128:131]
s_waitcnt lgkmcnt(0)
v_pk_mul_f32 v[96:97], v[96:97], v[240:241]
v_pk_mul_f32 v[100:101], v[100:101], v[240:241]
v_pk_mul_f32 v[112:113], v[112:113], v[240:241]
v_pk_mul_f32 v[116:117], v[116:117], v[240:241]
v_pk_mul_f32 v[98:99], v[98:99], v[242:243]
v_pk_mul_f32 v[102:103], v[102:103], v[242:243]
v_pk_mul_f32 v[114:115], v[114:115], v[242:243]
v_pk_mul_f32 v[118:119], v[118:119], v[242:243]
v_pk_mul_f32 v[104:105], v[104:105], v[240:241]
v_pk_mul_f32 v[108:109], v[108:109], v[240:241]
v_pk_mul_f32 v[120:121], v[120:121], v[240:241]
v_pk_mul_f32 v[124:125], v[124:125], v[240:241]
v_pk_mul_f32 v[106:107], v[106:107], v[242:243]
v_pk_mul_f32 v[110:111], v[110:111], v[242:243]
v_pk_mul_f32 v[122:123], v[122:123], v[242:243]
v_pk_mul_f32 v[126:127], v[126:127], v[242:243]
v_mfma_f32_16x16x32_bf16 v[132:135], v[44:47], a[100:103], v[132:135]
v_cvt_pk_bf16_f32 v96, v96, v100
v_cvt_pk_bf16_f32 v112, v112, v116
v_mfma_f32_16x16x32_bf16 v[136:139], v[44:47], a[104:107], v[136:139]
v_cvt_pk_bf16_f32 v98, v98, v102
v_cvt_pk_bf16_f32 v114, v114, v118
v_mfma_f32_16x16x32_bf16 v[140:143], v[44:47], a[108:111], v[140:143]
v_cvt_pk_bf16_f32 v100, v97, v101
v_cvt_pk_bf16_f32 v116, v113, v117
v_mfma_f32_16x16x32_bf16 v[144:147], v[44:47], a[112:115], v[144:147]
v_cvt_pk_bf16_f32 v102, v99, v103
v_cvt_pk_bf16_f32 v118, v115, v119
v_mfma_f32_16x16x32_bf16 v[148:151], v[44:47], a[116:119], v[148:151]
v_cvt_pk_bf16_f32 v97, v104, v108
v_cvt_pk_bf16_f32 v101, v105, v109
v_mfma_f32_16x16x32_bf16 v[152:155], v[44:47], a[120:123], v[152:155]
v_cvt_pk_bf16_f32 v113, v120, v124
v_cvt_pk_bf16_f32 v117, v121, v125
v_mfma_f32_16x16x32_bf16 v[156:159], v[44:47], a[124:127], v[156:159]
ds_write2_b64 v5, v[96:97], v[112:113] offset0:0 offset1:16
v_cvt_pk_bf16_f32 v99, v106, v110
v_mfma_f32_16x16x32_bf16 v[176:179], a[150:153], v[200:203], v[176:179]
ds_write2_b64 v0, v[100:101], v[116:117] offset0:32 offset1:48
v_cvt_pk_bf16_f32 v103, v107, v111
v_mfma_f32_16x16x32_bf16 v[180:183], a[148:151], v[200:203], v[180:183]
v_cvt_pk_bf16_f32 v115, v122, v126
v_cvt_pk_bf16_f32 v119, v123, v127
v_mfma_f32_16x16x32_bf16 v[184:187], a[146:149], v[204:207], 0
s_waitcnt vmcnt(12)
ds_write2_b64 v5, v[98:99], v[114:115] offset0:80 offset1:64
v_accvgpr_read_b32 v20, a140
v_mfma_f32_16x16x32_bf16 v[188:191], a[144:147], v[204:207], 0
v_rcp_f32 v13, v20
v_mfma_f32_16x16x32_bf16 v[184:187], a[150:153], v[204:207], v[184:187]
s_waitcnt vmcnt(8)
ds_add_u32 v8, v10
ds_write2_b64 v0, v[102:103], v[118:119] offset0:112 offset1:96
v_add_u32 v1, s31, v1
v_mfma_f32_16x16x32_bf16 v[188:191], a[148:151], v[204:207], v[188:191]
v_add_u32 v2, s31, v2
s_sub_u32 s30, s30, 1
v_add_u32 v21, v1, v7
ds_read_b64_tr_b16 v[96:97], v56 offset:0
s_cselect_b32 s31, s35, s34
ds_read_b64_tr_b16 v[98:99], v57 offset:0
s_cselect_b32 s30, 7, s30
ds_read_b64_tr_b16 v[104:105], v56 offset:2048
v_add_u32 v1, s31, v1
ds_read_b64_tr_b16 v[106:107], v57 offset:2048
v_add_u32 v2, s31, v2
ds_read_b64_tr_b16 v[112:113], v58 offset:0
s_sub_u32 s30, s30, 1
ds_read_b64_tr_b16 v[114:115], v59 offset:0
v_add_u32 v23, v1, v7
ds_read_b64_tr_b16 v[120:121], v58 offset:2048
s_cselect_b32 s31, s35, s34
ds_read_b64_tr_b16 v[122:123], v59 offset:2048
v_add_u32 v1, s31, v1
ds_write_b32 v60, v13
v_max3_u32 v12, v12, v20, v13
ds_read_b128 v[52:55], v61
v_mbcnt_lo_u32_b32 v13, -1, 0
v_mbcnt_hi_u32_b32 v13, -1, v13
v_lshrrev_b32 v13, 2, v13
ds_read_b128 v[224:227], v21 offset:0
v_and_b32 v13, 12, v13
v_sub_u32 v13, s50, v13
v_cvt_f32_i32 v13, v13
ds_read_b128 v[228:231], v21 offset:64
v_mov_b32 v14, 0x7c800000
v_fmaak_f32 v16, v13, v14, 0xfc000000
v_fmaak_f32 v17, v13, v14, 0xfcc00000
s_waitcnt lgkmcnt(10)
buffer_store_dwordx4 v[96:99], v6, s[12:15], s82 offen offset:0 sc1
s_waitcnt lgkmcnt(8)
buffer_store_dwordx4 v[104:107], v6, s[12:15], s83 offen offset:0 sc1
ds_read_b128 v[232:235], v21 offset:128
ds_read_b128 v[236:239], v21 offset:192
v_fmaak_f32 v18, v13, v14, 0xfd200000
v_fmaak_f32 v19, v13, v14, 0xfd600000
v_min_f32 v16, 0, v16
v_min_f32 v17, 0, v17
s_waitcnt lgkmcnt(8)
buffer_store_dwordx4 v[112:115], v6, s[12:15], s82 offen offset:128 sc1
ds_read_b32 v11, v9
s_waitcnt lgkmcnt(5)
v_pk_mul_f32 v[128:129], v[128:129], v[52:53]
v_pk_mul_f32 v[132:133], v[132:133], v[52:53]
v_pk_mul_f32 v[144:145], v[144:145], v[52:53]
v_pk_mul_f32 v[148:149], v[148:149], v[52:53]
v_pk_mul_f32 v[130:131], v[130:131], v[54:55]
v_pk_mul_f32 v[134:135], v[134:135], v[54:55]
v_pk_mul_f32 v[146:147], v[146:147], v[54:55]
v_pk_mul_f32 v[150:151], v[150:151], v[54:55]
v_cvt_pk_bf16_f32 v128, v128, v132
v_cvt_pk_bf16_f32 v144, v144, v148
buffer_store_dwordx4 v[120:123], v6, s[12:15], s83 offen offset:128 sc1
v_cvt_pk_bf16_f32 v130, v130, v134
v_cvt_pk_bf16_f32 v146, v146, v150
v_pk_mul_f32 v[136:137], v[136:137], v[52:53]
v_pk_mul_f32 v[140:141], v[140:141], v[52:53]
v_cvt_pk_bf16_f32 v132, v129, v133
v_pk_mul_f32 v[152:153], v[152:153], v[52:53]
v_pk_mul_f32 v[156:157], v[156:157], v[52:53]
v_cvt_pk_bf16_f32 v148, v145, v149
v_pk_mul_f32 v[138:139], v[138:139], v[54:55]
v_pk_mul_f32 v[142:143], v[142:143], v[54:55]
v_cvt_pk_bf16_f32 v134, v131, v135
v_pk_mul_f32 v[154:155], v[154:155], v[54:55]
v_pk_mul_f32 v[158:159], v[158:159], v[54:55]
v_cvt_pk_bf16_f32 v150, v147, v151
s_waitcnt lgkmcnt(0)
v_cmp_gt_u32 vcc, s33, v11
v_cvt_pk_bf16_f32 v129, v136, v140
v_cvt_pk_bf16_f32 v133, v137, v141
v_cvt_pk_bf16_f32 v145, v152, v156
v_cvt_pk_bf16_f32 v149, v153, v157
v_cvt_pk_bf16_f32 v131, v138, v142
s_cbranch_vccnz L_spin_17
L_spinret_18:
buffer_load_dwordx4 v3, s[4:7], s24 offen lds
v_cvt_pk_bf16_f32 v135, v139, v143
v_cvt_pk_bf16_f32 v147, v154, v158
v_cvt_pk_bf16_f32 v151, v155, v159
buffer_load_dwordx4 v4, s[4:7], s24 offen offset:1056 lds
ds_write2_b64 v5, v[128:129], v[144:145] offset0:0 offset1:16
v_min_f32 v18, 0, v18
v_min_f32 v19, 0, v19
ds_write2_b64 v0, v[132:133], v[148:149] offset0:32 offset1:48
buffer_load_dwordx4 v3, s[8:11], s24 offen offset:2080 lds
v_cvt_pk_bf16_f32 v192, v160, v161
v_cvt_pk_bf16_f32 v193, v162, v163
v_mfma_f32_16x16x32_bf16 v[160:163], a[146:149], v[208:211], 0
s_cselect_b32 s30, 7, s30
ds_write2_b64 v5, v[130:131], v[146:147] offset0:80 offset1:64
v_cvt_pk_bf16_f32 v194, v164, v165
v_mfma_f32_16x16x32_bf16 v[160:163], a[150:153], v[208:211], v[160:163]
s_add_u32 s33, s33, 1
buffer_load_dwordx4 v4, s[8:11], s24 offen offset:3136 lds
s_add_u32 m0, m0, s34
s_cmp_eq_u32 m0, s29
s_cselect_b32 m0, s28, m0
s_add_u32 s24, s24, s25
ds_write2_b64 v0, v[134:135], v[150:151] offset0:112 offset1:96
v_cvt_pk_bf16_f32 v195, v166, v167
v_mfma_f32_16x16x32_bf16 v[164:167], a[144:147], v[208:211], 0
v_cvt_pk_bf16_f32 v196, v168, v169
ds_read_b64_tr_b16 v[128:129], v56 offset:0
v_cvt_pk_bf16_f32 v197, v170, v171
v_mfma_f32_16x16x32_bf16 v[164:167], a[148:151], v[208:211], v[164:167]
ds_read_b64_tr_b16 v[130:131], v57 offset:0
ds_read_b64_tr_b16 v[136:137], v56 offset:2048
ds_read_b64_tr_b16 v[138:139], v57 offset:2048
v_cvt_pk_bf16_f32 v198, v172, v173
v_mfma_f32_16x16x32_bf16 v[168:171], a[146:149], v[212:215], 0
ds_read_b64_tr_b16 v[144:145], v58 offset:0
ds_read_b64_tr_b16 v[146:147], v59 offset:0
ds_read_b64_tr_b16 v[152:153], v58 offset:2048
v_cvt_pk_bf16_f32 v199, v174, v175
v_mfma_f32_16x16x32_bf16 v[172:175], a[144:147], v[212:215], 0
ds_read_b64_tr_b16 v[154:155], v59 offset:2048
ds_read_b128 a[0:3], v1 offset:0
v_cvt_pk_bf16_f32 v200, v176, v177
v_mfma_f32_16x16x32_bf16 v[168:171], a[150:153], v[212:215], v[168:171]
ds_read_b128 a[4:7], v1 offset:64
v_cvt_pk_bf16_f32 v201, v178, v179
v_mfma_f32_16x16x32_bf16 v[172:175], a[148:151], v[212:215], v[172:175]
ds_read_b128 a[8:11], v1 offset:128
v_cvt_pk_bf16_f32 v202, v180, v181
v_mfma_f32_16x16x32_bf16 v[176:179], a[146:149], v[216:219], 0
ds_read_b128 a[12:15], v1 offset:192
v_cvt_pk_bf16_f32 v203, v182, v183
v_mfma_f32_16x16x32_bf16 v[180:183], a[144:147], v[216:219], 0
ds_read_b128 a[28:31], v1 offset:704
v_cvt_pk_bf16_f32 v204, v184, v185
v_mfma_f32_16x16x32_bf16 v[176:179], a[150:153], v[216:219], v[176:179]
ds_read_b128 a[24:27], v1 offset:640
v_cvt_pk_bf16_f32 v205, v186, v187
v_mfma_f32_16x16x32_bf16 v[180:183], a[148:151], v[216:219], v[180:183]
s_waitcnt vmcnt(12)
ds_read_b128 a[20:23], v1 offset:576
v_cvt_pk_bf16_f32 v206, v188, v189
v_mfma_f32_16x16x32_bf16 v[184:187], a[146:149], v[220:223], 0
ds_read_b128 a[16:19], v1 offset:512
v_cvt_pk_bf16_f32 v207, v190, v191
s_waitcnt lgkmcnt(7)
v_mfma_f32_16x16x32_bf16 v[24:27], a[0:3], v[192:195], v[16:19]
ds_add_u32 v8, v10
ds_read_b128 v[240:243], v23 offset:0
v_fmaak_f32 v20, v13, v14, 0xfe840000
s_waitcnt lgkmcnt(8)
v_mfma_f32_16x16x32_bf16 v[24:27], a[4:7], v[196:199], v[24:27]
ds_read_b128 v[244:247], v23 offset:64
v_fmaak_f32 v21, v13, v14, 0xfe8c0000
s_waitcnt lgkmcnt(8)
v_mfma_f32_16x16x32_bf16 v[24:27], a[8:11], v[200:203], v[24:27]
ds_read_b128 v[248:251], v23 offset:128
v_fmaak_f32 v22, v13, v14, 0xfe940000
s_waitcnt lgkmcnt(8)
v_mfma_f32_16x16x32_bf16 v[24:27], a[12:15], v[204:207], v[24:27]
ds_read_b128 v[252:255], v23 offset:192
v_fmaak_f32 v23, v13, v14, 0xfe9c0000
v_mfma_f32_16x16x32_bf16 v[188:191], a[144:147], v[220:223], 0
v_min_f32 v20, 0, v20
v_min_f32 v21, 0, v21
v_mfma_f32_16x16x32_bf16 v[184:187], a[150:153], v[220:223], v[184:187]
v_min_f32 v22, 0, v22
v_min_f32 v23, 0, v23
v_mfma_f32_16x16x32_bf16 v[188:191], a[148:151], v[220:223], v[188:191]
v_cvt_pk_bf16_f32 v208, v160, v161
v_cvt_pk_bf16_f32 v209, v162, v163
s_waitcnt lgkmcnt(8)
v_mfma_f32_16x16x32_bf16 v[28:31], a[28:31], v[204:207], v[20:23]
v_cvt_pk_bf16_f32 v210, v164, v165
v_cvt_pk_bf16_f32 v211, v166, v167
s_waitcnt lgkmcnt(7)
v_mfma_f32_16x16x32_bf16 v[28:31], a[24:27], v[200:203], v[28:31]
v_add_u32 v2, s31, v2
ds_read_b64_tr_b16 a[64:65], v2 offset:0
ds_read_b64_tr_b16 a[66:67], v2 offset:512
v_cvt_pk_bf16_f32 v212, v168, v169
s_waitcnt lgkmcnt(8)
v_mfma_f32_16x16x32_bf16 v[28:31], a[20:23], v[196:199], v[28:31]
s_sub_u32 s30, s30, 1
v_cvt_pk_bf16_f32 v213, v170, v171
v_cvt_pk_bf16_f32 v214, v172, v173
s_waitcnt lgkmcnt(7)
v_mfma_f32_16x16x32_bf16 v[28:31], a[16:19], v[192:195], v[28:31]
s_cselect_b32 s31, s35, s34
v_cvt_pk_bf16_f32 v215, v174, v175
ds_read_b64_tr_b16 a[68:69], v2 offset:32
ds_read_b64_tr_b16 a[70:71], v2 offset:544
v_cvt_pk_bf16_f32 v216, v176, v177
v_mfma_f32_16x16x32_bf16 v[32:35], a[0:3], v[208:211], v[16:19]
s_cselect_b32 s30, 7, s30
v_cvt_pk_bf16_f32 v217, v178, v179
v_cvt_pk_bf16_f32 v218, v180, v181
v_mfma_f32_16x16x32_bf16 v[32:35], a[4:7], v[212:215], v[32:35]
ds_read_b64_tr_b16 a[72:73], v2 offset:64
v_cvt_pk_bf16_f32 v219, v182, v183
v_mfma_f32_16x16x32_bf16 v[160:163], a[146:149], v[224:227], 0
ds_read_b64_tr_b16 a[74:75], v2 offset:576
v_cvt_pk_bf16_f32 v220, v184, v185
v_mfma_f32_16x16x32_bf16 v[32:35], a[8:11], v[216:219], v[32:35]
ds_read_b64_tr_b16 a[76:77], v2 offset:96
v_cvt_pk_bf16_f32 v221, v186, v187
v_mfma_f32_16x16x32_bf16 v[164:167], a[144:147], v[224:227], 0
ds_read_b64_tr_b16 a[78:79], v2 offset:608
v_cvt_pk_bf16_f32 v222, v188, v189
v_mfma_f32_16x16x32_bf16 v[160:163], a[150:153], v[224:227], v[160:163]
ds_read_b64_tr_b16 a[80:81], v2 offset:128
v_cvt_pk_bf16_f32 v223, v190, v191
v_mfma_f32_16x16x32_bf16 v[164:167], a[148:151], v[224:227], v[164:167]
ds_read_b64_tr_b16 a[82:83], v2 offset:640
ds_read_b64_tr_b16 a[84:85], v2 offset:160
ds_read_b64_tr_b16 a[86:87], v2 offset:672
ds_read_b64_tr_b16 a[88:89], v2 offset:192
ds_read_b64_tr_b16 a[90:91], v2 offset:704
ds_read_b64_tr_b16 a[92:93], v2 offset:224
v_cvt_pk_bf16_f32 v224, v160, v161
v_mfma_f32_16x16x32_bf16 v[32:35], a[12:15], v[220:223], v[32:35]
ds_read_b64_tr_b16 a[94:95], v2 offset:736
v_cvt_pk_bf16_f32 v225, v162, v163
v_mfma_f32_16x16x32_bf16 v[36:39], a[28:31], v[220:223], v[20:23]
ds_read_b32 v11, v9
v_cvt_pk_bf16_f32 v226, v164, v165
v_mfma_f32_16x16x32_bf16 v[36:39], a[24:27], v[216:219], v[36:39]
v_exp_f32 v24, v24
v_mfma_f32_16x16x32_bf16 v[36:39], a[20:23], v[212:215], v[36:39]
v_exp_f32 v25, v25
v_mfma_f32_16x16x32_bf16 v[36:39], a[16:19], v[208:211], v[36:39]
v_exp_f32 v26, v26
v_mfma_f32_16x16x32_bf16 v[168:171], a[146:149], v[228:231], 0
v_exp_f32 v27, v27
v_mfma_f32_16x16x32_bf16 v[172:175], a[144:147], v[228:231], 0
buffer_load_dwordx4 v3, s[4:7], s24 offen lds
v_cvt_pk_bf16_f32 v40, v24, v25
v_mfma_f32_16x16x32_bf16 v[168:171], a[150:153], v[228:231], v[168:171]
v_exp_f32 v28, v28
v_mfma_f32_16x16x32_bf16 v[172:175], a[148:151], v[228:231], v[172:175]
buffer_load_dwordx4 v4, s[4:7], s24 offen offset:1056 lds
v_cvt_pk_bf16_f32 v41, v26, v27
v_mfma_f32_16x16x32_bf16 v[176:179], a[146:149], v[232:235], 0
v_exp_f32 v29, v29
v_mfma_f32_16x16x32_bf16 v[180:183], a[144:147], v[232:235], 0
buffer_load_dwordx4 v3, s[8:11], s24 offen offset:2080 lds
v_cvt_pk_bf16_f32 v42, v28, v29
v_mfma_f32_16x16x32_bf16 v[176:179], a[150:153], v[232:235], v[176:179]
v_exp_f32 v30, v30
v_mfma_f32_16x16x32_bf16 v[180:183], a[148:151], v[232:235], v[180:183]
v_exp_f32 v31, v31
v_mfma_f32_16x16x32_bf16 v[184:187], a[146:149], v[236:239], 0
buffer_load_dwordx4 v4, s[8:11], s24 offen offset:3136 lds
s_add_u32 m0, m0, s34
v_mfma_f32_16x16x32_bf16 v[188:191], a[144:147], v[236:239], 0
s_cmp_eq_u32 m0, s29
s_cselect_b32 m0, s28, m0
s_add_u32 s24, s24, s25
v_mfma_f32_16x16x32_bf16 v[184:187], a[150:153], v[236:239], v[184:187]
v_cvt_pk_bf16_f32 v43, v30, v31
v_cvt_pk_bf16_f32 v227, v166, v167
v_mfma_f32_16x16x32_bf16 v[188:191], a[148:151], v[236:239], v[188:191]
buffer_load_dwordx4 v3, s[4:7], s24 offen lds
v_cvt_pk_bf16_f32 v228, v168, v169
s_waitcnt lgkmcnt(15)
v_mfma_f32_16x16x32_bf16 v[64:67], v[40:43], a[64:67], 0
v_cvt_pk_bf16_f32 v229, v170, v171
v_cvt_pk_bf16_f32 v230, v172, v173
s_waitcnt lgkmcnt(13)
v_mfma_f32_16x16x32_bf16 v[68:71], v[40:43], a[68:71], 0
v_cvt_pk_bf16_f32 v231, v174, v175
v_cvt_pk_bf16_f32 v232, v176, v177
s_waitcnt lgkmcnt(11)
v_mfma_f32_16x16x32_bf16 v[72:75], v[40:43], a[72:75], 0
v_cvt_pk_bf16_f32 v233, v178, v179
v_cvt_pk_bf16_f32 v234, v180, v181
s_waitcnt lgkmcnt(9)
v_mfma_f32_16x16x32_bf16 v[76:79], v[40:43], a[76:79], 0
buffer_load_dwordx4 v4, s[4:7], s24 offen offset:1056 lds
v_cvt_pk_bf16_f32 v235, v182, v183
s_waitcnt lgkmcnt(7)
v_mfma_f32_16x16x32_bf16 v[80:83], v[40:43], a[80:83], 0
v_cvt_pk_bf16_f32 v236, v184, v185
v_cvt_pk_bf16_f32 v237, v186, v187
s_waitcnt lgkmcnt(5)
v_mfma_f32_16x16x32_bf16 v[84:87], v[40:43], a[84:87], 0
v_cvt_pk_bf16_f32 v238, v188, v189
v_cvt_pk_bf16_f32 v239, v190, v191
s_waitcnt lgkmcnt(3)
v_mfma_f32_16x16x32_bf16 v[88:91], v[40:43], a[88:91], 0
buffer_load_dwordx4 v3, s[8:11], s24 offen offset:2080 lds
v_exp_f32 v32, v32
s_waitcnt lgkmcnt(1)
v_mfma_f32_16x16x32_bf16 v[92:95], v[40:43], a[92:95], 0
v_exp_f32 v33, v33
v_mfma_f32_16x16x32_bf16 a[132:135], a[128:131], v[40:43], 0
v_exp_f32 v34, v34
v_mfma_f32_16x16x32_bf16 v[24:27], a[0:3], v[224:227], v[16:19]
v_exp_f32 v35, v35
v_mfma_f32_16x16x32_bf16 v[24:27], a[4:7], v[228:231], v[24:27]
buffer_load_dwordx4 v4, s[8:11], s24 offen offset:3136 lds
s_add_u32 m0, m0, s34
v_mfma_f32_16x16x32_bf16 v[24:27], a[8:11], v[232:235], v[24:27]
s_cmp_eq_u32 m0, s29
s_cselect_b32 m0, s28, m0
s_add_u32 s24, s24, s25
v_mfma_f32_16x16x32_bf16 v[24:27], a[12:15], v[236:239], v[24:27]
v_exp_f32 v36, v36
v_mfma_f32_16x16x32_bf16 v[28:31], a[28:31], v[236:239], v[20:23]
buffer_load_dwordx4 v3, s[4:7], s24 offen lds
v_exp_f32 v37, v37
v_mfma_f32_16x16x32_bf16 v[28:31], a[24:27], v[232:235], v[28:31]
v_exp_f32 v38, v38
v_mfma_f32_16x16x32_bf16 v[28:31], a[20:23], v[228:231], v[28:31]
v_exp_f32 v39, v39
v_mfma_f32_16x16x32_bf16 v[28:31], a[16:19], v[224:227], v[28:31]
buffer_load_dwordx4 v4, s[4:7], s24 offen offset:1056 lds
v_cvt_pk_bf16_f32 v44, v32, v33
v_mfma_f32_16x16x32_bf16 v[160:163], a[146:149], v[240:243], 0
v_cvt_pk_bf16_f32 v45, v34, v35
v_cvt_pk_bf16_f32 v46, v36, v37
v_mfma_f32_16x16x32_bf16 v[164:167], a[144:147], v[240:243], 0
v_cvt_pk_bf16_f32 v47, v38, v39
v_mov_b32 v48, v32
v_mfma_f32_16x16x32_bf16 v[160:163], a[150:153], v[240:243], v[160:163]
v_mov_b32 v49, v33
v_add_f32 v48, v48, v34
v_mfma_f32_16x16x32_bf16 v[96:99], v[44:47], a[64:67], 0
buffer_load_dwordx4 v3, s[8:11], s24 offen offset:2080 lds
v_add_f32 v49, v49, v35
v_mfma_f32_16x16x32_bf16 v[100:103], v[44:47], a[68:71], 0
v_add_f32 v48, v48, v36
v_add_f32 v49, v49, v37
v_mfma_f32_16x16x32_bf16 v[104:107], v[44:47], a[72:75], 0
v_add_f32 v48, v48, v38
v_add_f32 v49, v49, v39
v_mfma_f32_16x16x32_bf16 v[108:111], v[44:47], a[76:79], 0
buffer_store_dwordx4 v[128:131], v6, s[12:15], s84 offen offset:0 sc1
v_exp_f32 v24, v24
v_mfma_f32_16x16x32_bf16 v[112:115], v[44:47], a[80:83], 0
v_exp_f32 v25, v25
v_mfma_f32_16x16x32_bf16 v[164:167], a[148:151], v[240:243], v[164:167]
v_cvt_pk_bf16_f32 v240, v160, v161
v_cvt_pk_bf16_f32 v241, v162, v163
v_mfma_f32_16x16x32_bf16 v[168:171], a[146:149], v[244:247], 0
buffer_load_dwordx4 v4, s[8:11], s24 offen offset:3136 lds
s_add_u32 m0, m0, s34
v_mfma_f32_16x16x32_bf16 v[172:175], a[144:147], v[244:247], 0
s_cmp_eq_u32 m0, s29
s_cselect_b32 m0, s28, m0
s_add_u32 s24, s24, s25
v_mfma_f32_16x16x32_bf16 v[116:119], v[44:47], a[84:87], 0
v_cvt_pk_bf16_f32 v242, v164, v165
v_cvt_pk_bf16_f32 v243, v166, v167
v_mfma_f32_16x16x32_bf16 v[168:171], a[150:153], v[244:247], v[168:171]
v_exp_f32 v26, v26
v_mfma_f32_16x16x32_bf16 v[172:175], a[148:151], v[244:247], v[172:175]
buffer_store_dwordx4 v[136:139], v6, s[12:15], s85 offen offset:0 sc1
s_nop 4
v_cvt_pk_bf16_f32 v244, v168, v169
v_mfma_f32_16x16x32_bf16 v[176:179], a[146:149], v[248:251], 0
s_waitcnt vmcnt(14)
ds_add_u32 v8, v10
v_cvt_pk_bf16_f32 v245, v170, v171
v_mfma_f32_16x16x32_bf16 v[180:183], a[144:147], v[248:251], 0
buffer_store_dwordx4 v[144:147], v6, s[12:15], s84 offen offset:128 sc1
v_cvt_pk_bf16_f32 v246, v172, v173
v_mfma_f32_16x16x32_bf16 v[120:123], v[44:47], a[88:91], 0
v_cvt_pk_bf16_f32 v247, v174, v175
s_waitcnt lgkmcnt(1)
v_cmp_gt_u32 vcc, s33, v11
v_mfma_f32_16x16x32_bf16 v[176:179], a[150:153], v[248:251], v[176:179]
v_exp_f32 v27, v27
v_mfma_f32_16x16x32_bf16 v[180:183], a[148:151], v[248:251], v[180:183]
s_cbranch_vccnz L_spin_19
L_spinret_20:
buffer_store_dwordx4 v[152:155], v6, s[12:15], s85 offen offset:128 sc1
s_nop 3
v_cvt_pk_bf16_f32 v248, v176, v177
v_mfma_f32_16x16x32_bf16 v[184:187], a[146:149], v[252:255], 0
s_add_u32 s33, s33, 1
v_cvt_pk_bf16_f32 v249, v178, v179
v_cvt_pk_bf16_f32 v250, v180, v181
v_mfma_f32_16x16x32_bf16 v[188:191], a[144:147], v[252:255], 0
v_cvt_pk_bf16_f32 v251, v182, v183
v_cvt_pk_bf16_f32 v40, v24, v25
v_mfma_f32_16x16x32_bf16 v[124:127], v[44:47], a[92:95], 0
v_exp_f32 v28, v28
v_mfma_f32_16x16x32_bf16 v[184:187], a[150:153], v[252:255], v[184:187]
buffer_load_dwordx4 v3, s[4:7], s24 offen lds
v_cvt_pk_bf16_f32 v41, v26, v27
v_mfma_f32_16x16x32_bf16 v[188:191], a[148:151], v[252:255], v[188:191]
v_exp_f32 v29, v29
v_mfma_f32_16x16x32_bf16 v[32:35], a[0:3], v[240:243], v[16:19]
s_nop 2
v_cvt_pk_bf16_f32 v252, v184, v185
v_cvt_pk_bf16_f32 v253, v186, v187
v_mfma_f32_16x16x32_bf16 v[32:35], a[4:7], v[244:247], v[32:35]
buffer_load_dwordx4 v4, s[4:7], s24 offen offset:1056 lds
v_cvt_pk_bf16_f32 v254, v188, v189
v_mfma_f32_16x16x32_bf16 v[32:35], a[8:11], v[248:251], v[32:35]
v_cvt_pk_bf16_f32 v255, v190, v191
v_exp_f32 v30, v30
s_nop 0
v_mfma_f32_16x16x32_bf16 v[32:35], a[12:15], v[252:255], v[32:35]
v_exp_f32 v31, v31
v_mfma_f32_16x16x32_bf16 v[36:39], a[28:31], v[252:255], v[20:23]
buffer_load_dwordx4 v3, s[8:11], s24 offen offset:2080 lds
v_cvt_pk_bf16_f32 v42, v28, v29
v_mfma_f32_16x16x32_bf16 v[36:39], a[24:27], v[248:251], v[36:39]
v_cvt_pk_bf16_f32 v43, v30, v31
v_add_u32 v1, s31, v1
v_mfma_f32_16x16x32_bf16 v[36:39], a[20:23], v[244:247], v[36:39]
ds_read_b128 a[32:35], v1 offset:0
ds_read_b128 a[36:39], v1 offset:64
v_add_u32 v2, s31, v2
v_mfma_f32_16x16x32_bf16 v[36:39], a[16:19], v[240:243], v[36:39]
s_sub_u32 s30, s30, 1
ds_read_b128 a[40:43], v1 offset:128
s_cselect_b32 s31, s35, s34
v_mfma_f32_16x16x32_bf16 v[128:131], v[40:43], a[64:67], 0
s_cselect_b32 s30, 7, s30
ds_read_b128 a[44:47], v1 offset:192
buffer_load_dwordx4 v4, s[8:11], s24 offen offset:3136 lds
ds_read_b128 a[60:63], v1 offset:704
s_add_u32 m0, m0, s34
v_mfma_f32_16x16x32_bf16 v[132:135], v[40:43], a[68:71], 0
s_cmp_eq_u32 m0, s29
ds_read_b128 a[56:59], v1 offset:640
s_cselect_b32 m0, s28, m0
v_mfma_f32_16x16x32_bf16 v[136:139], v[40:43], a[72:75], 0
s_add_u32 s24, s24, s25
ds_read_b128 a[52:55], v1 offset:576
v_exp_f32 v32, v32
v_mfma_f32_16x16x32_bf16 v[140:143], v[40:43], a[76:79], 0
ds_read_b128 a[48:51], v1 offset:512
ds_read_b64_tr_b16 a[96:97], v2 offset:0
v_mov_b32 v50, v32
v_mfma_f32_16x16x32_bf16 v[144:147], v[40:43], a[80:83], 0
ds_read_b64_tr_b16 a[98:99], v2 offset:512
ds_read_b64_tr_b16 a[100:101], v2 offset:32
ds_read_b64_tr_b16 a[102:103], v2 offset:544
v_add_u32 v1, s31, v1
v_mfma_f32_16x16x32_bf16 v[148:151], v[40:43], a[84:87], 0
ds_read_b32 v11, v9
ds_read_b64_tr_b16 a[104:105], v2 offset:64
ds_read_b64_tr_b16 a[106:107], v2 offset:576
v_exp_f32 v33, v33
v_mfma_f32_16x16x32_bf16 v[152:155], v[40:43], a[88:91], 0
ds_read_b64_tr_b16 a[108:109], v2 offset:96
ds_read_b64_tr_b16 a[110:111], v2 offset:608
ds_read_b64_tr_b16 a[112:113], v2 offset:128
ds_read_b64_tr_b16 a[114:115], v2 offset:640
v_cvt_pk_bf16_f32 v44, v32, v33
v_mfma_f32_16x16x32_bf16 v[156:159], v[40:43], a[92:95], 0
ds_read_b64_tr_b16 a[116:117], v2 offset:160
ds_read_b64_tr_b16 a[118:119], v2 offset:672
ds_read_b64_tr_b16 a[120:121], v2 offset:192
v_mov_b32 v51, v33
v_mfma_f32_16x16x32_bf16 a[136:139], a[128:131], v[40:43], 0
ds_read_b64_tr_b16 a[122:123], v2 offset:704
ds_read_b64_tr_b16 a[124:125], v2 offset:224
ds_read_b64_tr_b16 a[126:127], v2 offset:736
v_add_u32 v2, s31, v2
s_waitcnt lgkmcnt(15)
v_mfma_f32_16x16x32_bf16 v[24:27], a[32:35], v[192:195], 0
v_exp_f32 v34, v34
v_mfma_f32_16x16x32_bf16 v[24:27], a[36:39], v[196:199], v[24:27]
v_exp_f32 v35, v35
v_mfma_f32_16x16x32_bf16 v[24:27], a[40:43], v[200:203], v[24:27]
v_exp_f32 v36, v36
v_mfma_f32_16x16x32_bf16 v[24:27], a[44:47], v[204:207], v[24:27]
v_exp_f32 v37, v37
v_mfma_f32_16x16x32_bf16 v[28:31], a[60:63], v[204:207], 0
v_exp_f32 v38, v38
v_mfma_f32_16x16x32_bf16 v[28:31], a[56:59], v[200:203], v[28:31]
v_exp_f32 v39, v39
v_mfma_f32_16x16x32_bf16 v[28:31], a[52:55], v[196:199], v[28:31]
v_cvt_pk_bf16_f32 v45, v34, v35
v_cvt_pk_bf16_f32 v46, v36, v37
v_mfma_f32_16x16x32_bf16 v[28:31], a[48:51], v[192:195], v[28:31]
v_cvt_pk_bf16_f32 v47, v38, v39
s_waitcnt lgkmcnt(12)
v_cmp_gt_u32 vcc, s33, v11
v_add_f32 v50, v50, v34
v_mfma_f32_16x16x32_bf16 v[160:163], v[44:47], a[64:67], 0
v_exp_f32 v24, v24
v_mfma_f32_16x16x32_bf16 v[164:167], v[44:47], a[68:71], 0
v_exp_f32 v25, v25
v_mfma_f32_16x16x32_bf16 v[168:171], v[44:47], a[72:75], 0
v_exp_f32 v26, v26
v_mfma_f32_16x16x32_bf16 v[172:175], v[44:47], a[76:79], 0
v_exp_f32 v27, v27
v_mfma_f32_16x16x32_bf16 v[176:179], v[44:47], a[80:83], 0
v_add_f32 v51, v51, v35
v_add_f32 v50, v50, v36
v_mfma_f32_16x16x32_bf16 v[180:183], v[44:47], a[84:87], 0
v_add_f32 v51, v51, v37
v_exp_f32 v28, v28
v_mfma_f32_16x16x32_bf16 v[184:187], v[44:47], a[88:91], 0
v_add_f32 v50, v50, v38
v_add_f32 v51, v51, v39
v_mfma_f32_16x16x32_bf16 v[188:191], v[44:47], a[92:95], 0
v_cvt_pk_bf16_f32 v40, v24, v25
v_cvt_pk_bf16_f32 v41, v26, v27
s_waitcnt lgkmcnt(0)
s_cbranch_vccnz L_spin_21
L_spinret_22:
s_branch L_loop4
L_t3_1_0:
v_mfma_f32_16x16x32_bf16 v[24:27], a[32:35], v[208:211], 0
s_mov_b32 s14, s47
v_exp_f32 v37, v37
v_mfma_f32_16x16x32_bf16 v[24:27], a[36:39], v[212:215], v[24:27]
s_add_u32 s80, s46, 0
v_exp_f32 v38, v38
v_mfma_f32_16x16x32_bf16 v[24:27], a[40:43], v[216:219], v[24:27]
s_add_u32 s81, s46, 131072
v_exp_f32 v39, v39
v_mfma_f32_16x16x32_bf16 v[24:27], a[44:47], v[220:223], v[24:27]
s_add_u32 s82, s46, 262144
v_cvt_pk_bf16_f32 v46, v36, v37
v_cvt_pk_bf16_f32 v47, v38, v39
v_mfma_f32_16x16x32_bf16 v[28:31], a[60:63], v[220:223], 0
s_add_u32 s83, s46, 393216
s_add_u32 s84, s46, 524288
s_add_u32 s85, s46, 655360
v_mfma_f32_16x16x32_bf16 v[28:31], a[56:59], v[216:219], v[28:31]
v_exp_f32 v24, v24
v_mfma_f32_16x16x32_bf16 v[28:31], a[52:55], v[212:215], v[28:31]
v_exp_f32 v25, v25
v_mfma_f32_16x16x32_bf16 v[28:31], a[48:51], v[208:211], v[28:31]
v_exp_f32 v26, v26
v_mfma_f32_16x16x32_bf16 a[132:135], a[128:131], v[44:47], a[132:135]
v_exp_f32 v27, v27
v_mfma_f32_16x16x32_bf16 v[64:67], v[44:47], a[96:99], v[64:67]
v_cvt_pk_bf16_f32 v40, v24, v25
s_nop 2
v_exp_f32 v28, v28
v_mfma_f32_16x16x32_bf16 v[68:71], v[44:47], a[100:103], v[68:71]
v_accvgpr_read_b32 v16, a132
v_rcp_f32 v13, v16
v_mfma_f32_16x16x32_bf16 v[72:75], v[44:47], a[104:107], v[72:75]
ds_write_b32 v60, v13
v_mfma_f32_16x16x32_bf16 v[76:79], v[44:47], a[108:111], v[76:79]
ds_read_b128 v[52:55], v61
v_exp_f32 v29, v29
v_mfma_f32_16x16x32_bf16 v[80:83], v[44:47], a[112:115], v[80:83]
v_exp_f32 v30, v30
v_mfma_f32_16x16x32_bf16 v[84:87], v[44:47], a[116:119], v[84:87]
v_exp_f32 v31, v31
v_mfma_f32_16x16x32_bf16 v[88:91], v[44:47], a[120:123], v[88:91]
v_cvt_pk_bf16_f32 v41, v26, v27
v_cvt_pk_bf16_f32 v42, v28, v29
v_mfma_f32_16x16x32_bf16 v[92:95], v[44:47], a[124:127], v[92:95]
v_cvt_pk_bf16_f32 v43, v30, v31
v_max3_u32 v12, v12, v16, v13
v_mfma_f32_16x16x32_bf16 v[32:35], a[32:35], v[224:227], 0
v_mfma_f32_16x16x32_bf16 v[32:35], a[36:39], v[228:231], v[32:35]
v_mfma_f32_16x16x32_bf16 v[32:35], a[40:43], v[232:235], v[32:35]
s_waitcnt lgkmcnt(0)
v_pk_mul_f32 v[64:65], v[64:65], v[52:53]
v_pk_mul_f32 v[68:69], v[68:69], v[52:53]
v_pk_mul_f32 v[80:81], v[80:81], v[52:53]
v_pk_mul_f32 v[84:85], v[84:85], v[52:53]
v_pk_mul_f32 v[66:67], v[66:67], v[54:55]
v_pk_mul_f32 v[70:71], v[70:71], v[54:55]
v_pk_mul_f32 v[82:83], v[82:83], v[54:55]
v_pk_mul_f32 v[86:87], v[86:87], v[54:55]
v_pk_mul_f32 v[72:73], v[72:73], v[52:53]
v_pk_mul_f32 v[76:77], v[76:77], v[52:53]
v_pk_mul_f32 v[88:89], v[88:89], v[52:53]
v_pk_mul_f32 v[92:93], v[92:93], v[52:53]
v_pk_mul_f32 v[74:75], v[74:75], v[54:55]
v_pk_mul_f32 v[78:79], v[78:79], v[54:55]
v_pk_mul_f32 v[90:91], v[90:91], v[54:55]
v_pk_mul_f32 v[94:95], v[94:95], v[54:55]
v_mfma_f32_16x16x32_bf16 v[32:35], a[44:47], v[236:239], v[32:35]
v_cvt_pk_bf16_f32 v64, v64, v68
v_cvt_pk_bf16_f32 v80, v80, v84
v_mfma_f32_16x16x32_bf16 v[36:39], a[60:63], v[236:239], 0
v_cvt_pk_bf16_f32 v66, v66, v70
v_cvt_pk_bf16_f32 v82, v82, v86
v_mfma_f32_16x16x32_bf16 v[36:39], a[56:59], v[232:235], v[36:39]
v_cvt_pk_bf16_f32 v68, v65, v69
v_cvt_pk_bf16_f32 v84, v81, v85
v_mfma_f32_16x16x32_bf16 v[36:39], a[52:55], v[228:231], v[36:39]
v_cvt_pk_bf16_f32 v70, v67, v71
v_cvt_pk_bf16_f32 v86, v83, v87
v_mfma_f32_16x16x32_bf16 v[36:39], a[48:51], v[224:227], v[36:39]
v_cvt_pk_bf16_f32 v65, v72, v76
v_cvt_pk_bf16_f32 v69, v73, v77
v_mfma_f32_16x16x32_bf16 a[136:139], a[128:131], v[40:43], a[136:139]
v_cvt_pk_bf16_f32 v81, v88, v92
v_cvt_pk_bf16_f32 v85, v89, v93
v_mfma_f32_16x16x32_bf16 v[96:99], v[40:43], a[96:99], v[96:99]
ds_write2_b64 v5, v[64:65], v[80:81] offset0:0 offset1:16
v_mfma_f32_16x16x32_bf16 v[100:103], v[40:43], a[100:103], v[100:103]
ds_write2_b64 v0, v[68:69], v[84:85] offset0:32 offset1:48
v_mfma_f32_16x16x32_bf16 v[104:107], v[40:43], a[104:107], v[104:107]
v_cvt_pk_bf16_f32 v67, v74, v78
v_cvt_pk_bf16_f32 v71, v75, v79
v_mfma_f32_16x16x32_bf16 v[108:111], v[40:43], a[108:111], v[108:111]
v_cvt_pk_bf16_f32 v83, v90, v94
v_cvt_pk_bf16_f32 v87, v91, v95
v_mfma_f32_16x16x32_bf16 v[112:115], v[40:43], a[112:115], v[112:115]
ds_write2_b64 v5, v[66:67], v[82:83] offset0:80 offset1:64
v_mfma_f32_16x16x32_bf16 v[116:119], v[40:43], a[116:119], v[116:119]
ds_write2_b64 v0, v[70:71], v[86:87] offset0:112 offset1:96
v_mfma_f32_16x16x32_bf16 v[120:123], v[40:43], a[120:123], v[120:123]
v_accvgpr_read_b32 v18, a136
v_rcp_f32 v13, v18
v_mfma_f32_16x16x32_bf16 v[124:127], v[40:43], a[124:127], v[124:127]
ds_read_b64_tr_b16 v[64:65], v56 offset:0
ds_read_b64_tr_b16 v[66:67], v57 offset:0
ds_read_b64_tr_b16 v[72:73], v56 offset:2048
ds_read_b64_tr_b16 v[74:75], v57 offset:2048
v_exp_f32 v32, v32
ds_write_b32 v60, v13
ds_read_b128 v[192:195], v61
v_exp_f32 v33, v33
v_exp_f32 v34, v34
ds_read_b64_tr_b16 v[80:81], v58 offset:0
ds_read_b64_tr_b16 v[82:83], v59 offset:0
v_exp_f32 v35, v35
ds_read_b64_tr_b16 v[88:89], v58 offset:2048
ds_read_b64_tr_b16 v[90:91], v59 offset:2048
v_exp_f32 v36, v36
v_exp_f32 v37, v37
v_exp_f32 v38, v38
v_exp_f32 v39, v39
v_cvt_pk_bf16_f32 v44, v32, v33
v_cvt_pk_bf16_f32 v45, v34, v35
v_cvt_pk_bf16_f32 v46, v36, v37
s_waitcnt lgkmcnt(8)
buffer_store_dwordx4 v[64:67], v6, s[12:15], s80 offen offset:0 sc1
s_waitcnt lgkmcnt(6)
buffer_store_dwordx4 v[72:75], v6, s[12:15], s81 offen offset:0 sc1
s_waitcnt lgkmcnt(4)
v_pk_mul_f32 v[96:97], v[96:97], v[192:193]
v_pk_mul_f32 v[100:101], v[100:101], v[192:193]
v_pk_mul_f32 v[112:113], v[112:113], v[192:193]
v_pk_mul_f32 v[116:117], v[116:117], v[192:193]
v_pk_mul_f32 v[98:99], v[98:99], v[194:195]
v_pk_mul_f32 v[102:103], v[102:103], v[194:195]
v_pk_mul_f32 v[114:115], v[114:115], v[194:195]
v_pk_mul_f32 v[118:119], v[118:119], v[194:195]
v_cvt_pk_bf16_f32 v96, v96, v100
v_cvt_pk_bf16_f32 v112, v112, v116
v_cvt_pk_bf16_f32 v98, v98, v102
v_cvt_pk_bf16_f32 v114, v114, v118
v_pk_mul_f32 v[104:105], v[104:105], v[192:193]
v_pk_mul_f32 v[108:109], v[108:109], v[192:193]
v_cvt_pk_bf16_f32 v100, v97, v101
v_pk_mul_f32 v[120:121], v[120:121], v[192:193]
v_pk_mul_f32 v[124:125], v[124:125], v[192:193]
v_cvt_pk_bf16_f32 v116, v113, v117
v_pk_mul_f32 v[106:107], v[106:107], v[194:195]
v_pk_mul_f32 v[110:111], v[110:111], v[194:195]
v_cvt_pk_bf16_f32 v102, v99, v103
v_pk_mul_f32 v[122:123], v[122:123], v[194:195]
v_pk_mul_f32 v[126:127], v[126:127], v[194:195]
v_cvt_pk_bf16_f32 v118, v115, v119
v_cvt_pk_bf16_f32 v97, v104, v108
v_cvt_pk_bf16_f32 v101, v105, v109
v_cvt_pk_bf16_f32 v113, v120, v124
v_cvt_pk_bf16_f32 v117, v121, v125
v_cvt_pk_bf16_f32 v99, v106, v110
v_cvt_pk_bf16_f32 v103, v107, v111
v_cvt_pk_bf16_f32 v115, v122, v126
v_cvt_pk_bf16_f32 v119, v123, v127
ds_write2_b64 v5, v[96:97], v[112:113] offset0:0 offset1:16
ds_write2_b64 v0, v[100:101], v[116:117] offset0:32 offset1:48
s_waitcnt lgkmcnt(4)
buffer_store_dwordx4 v[80:83], v6, s[12:15], s80 offen offset:128 sc1
ds_write2_b64 v5, v[98:99], v[114:115] offset0:80 offset1:64
v_cvt_pk_bf16_f32 v47, v38, v39
v_max3_u32 v12, v12, v18, v13
s_waitcnt lgkmcnt(3)
buffer_store_dwordx4 v[88:91], v6, s[12:15], s81 offen offset:128 sc1
v_mfma_f32_16x16x32_bf16 a[140:143], a[128:131], v[44:47], a[140:143]
ds_write2_b64 v0, v[102:103], v[118:119] offset0:112 offset1:96
v_mfma_f32_16x16x32_bf16 v[128:131], v[44:47], a[96:99], v[128:131]
ds_read_b64_tr_b16 v[96:97], v56 offset:0
ds_read_b64_tr_b16 v[98:99], v57 offset:0
v_mfma_f32_16x16x32_bf16 v[132:135], v[44:47], a[100:103], v[132:135]
ds_read_b64_tr_b16 v[104:105], v56 offset:2048
s_nop 1
v_accvgpr_read_b32 v20, a140
v_mfma_f32_16x16x32_bf16 v[136:139], v[44:47], a[104:107], v[136:139]
ds_read_b64_tr_b16 v[106:107], v57 offset:2048
v_rcp_f32 v13, v20
v_mfma_f32_16x16x32_bf16 v[140:143], v[44:47], a[108:111], v[140:143]
ds_write_b32 v60, v13
v_mfma_f32_16x16x32_bf16 v[144:147], v[44:47], a[112:115], v[144:147]
ds_read_b128 v[52:55], v61
ds_read_b64_tr_b16 v[112:113], v58 offset:0
v_mfma_f32_16x16x32_bf16 v[148:151], v[44:47], a[116:119], v[148:151]
ds_read_b64_tr_b16 v[114:115], v59 offset:0
ds_read_b64_tr_b16 v[120:121], v58 offset:2048
v_mfma_f32_16x16x32_bf16 v[152:155], v[44:47], a[120:123], v[152:155]
ds_read_b64_tr_b16 v[122:123], v59 offset:2048
v_max3_u32 v12, v12, v20, v13
v_mfma_f32_16x16x32_bf16 v[156:159], v[44:47], a[124:127], v[156:159]
s_waitcnt lgkmcnt(8)
buffer_store_dwordx4 v[96:99], v6, s[12:15], s82 offen offset:0 sc1
s_waitcnt lgkmcnt(6)
buffer_store_dwordx4 v[104:107], v6, s[12:15], s83 offen offset:0 sc1
s_waitcnt lgkmcnt(4)
v_pk_mul_f32 v[128:129], v[128:129], v[52:53]
v_pk_mul_f32 v[132:133], v[132:133], v[52:53]
v_pk_mul_f32 v[144:145], v[144:145], v[52:53]
v_pk_mul_f32 v[148:149], v[148:149], v[52:53]
v_pk_mul_f32 v[130:131], v[130:131], v[54:55]
v_pk_mul_f32 v[134:135], v[134:135], v[54:55]
v_pk_mul_f32 v[146:147], v[146:147], v[54:55]
v_pk_mul_f32 v[150:151], v[150:151], v[54:55]
v_cvt_pk_bf16_f32 v128, v128, v132
v_cvt_pk_bf16_f32 v144, v144, v148
v_cvt_pk_bf16_f32 v130, v130, v134
v_cvt_pk_bf16_f32 v146, v146, v150
v_pk_mul_f32 v[136:137], v[136:137], v[52:53]
v_pk_mul_f32 v[140:141], v[140:141], v[52:53]
v_cvt_pk_bf16_f32 v132, v129, v133
v_pk_mul_f32 v[152:153], v[152:153], v[52:53]
v_pk_mul_f32 v[156:157], v[156:157], v[52:53]
v_cvt_pk_bf16_f32 v148, v145, v149
v_pk_mul_f32 v[138:139], v[138:139], v[54:55]
v_pk_mul_f32 v[142:143], v[142:143], v[54:55]
v_cvt_pk_bf16_f32 v134, v131, v135
v_pk_mul_f32 v[154:155], v[154:155], v[54:55]
v_pk_mul_f32 v[158:159], v[158:159], v[54:55]
v_cvt_pk_bf16_f32 v150, v147, v151
v_cvt_pk_bf16_f32 v129, v136, v140
v_cvt_pk_bf16_f32 v133, v137, v141
v_cvt_pk_bf16_f32 v145, v152, v156
v_cvt_pk_bf16_f32 v149, v153, v157
v_cvt_pk_bf16_f32 v131, v138, v142
v_cvt_pk_bf16_f32 v135, v139, v143
v_cvt_pk_bf16_f32 v147, v154, v158
v_cvt_pk_bf16_f32 v151, v155, v159
ds_write2_b64 v5, v[128:129], v[144:145] offset0:0 offset1:16
ds_write2_b64 v0, v[132:133], v[148:149] offset0:32 offset1:48
s_waitcnt lgkmcnt(4)
buffer_store_dwordx4 v[112:115], v6, s[12:15], s82 offen offset:128 sc1
ds_write2_b64 v5, v[130:131], v[146:147] offset0:80 offset1:64
s_waitcnt lgkmcnt(3)
buffer_store_dwordx4 v[120:123], v6, s[12:15], s83 offen offset:128 sc1
ds_write2_b64 v0, v[134:135], v[150:151] offset0:112 offset1:96
ds_read_b64_tr_b16 v[128:129], v56 offset:0
ds_read_b64_tr_b16 v[130:131], v57 offset:0
ds_read_b64_tr_b16 v[136:137], v56 offset:2048
ds_read_b64_tr_b16 v[138:139], v57 offset:2048
ds_read_b64_tr_b16 v[144:145], v58 offset:0
ds_read_b64_tr_b16 v[146:147], v59 offset:0
ds_read_b64_tr_b16 v[152:153], v58 offset:2048
ds_read_b64_tr_b16 v[154:155], v59 offset:2048
s_waitcnt lgkmcnt(6)
buffer_store_dwordx4 v[128:131], v6, s[12:15], s84 offen offset:0 sc1
s_waitcnt lgkmcnt(4)
buffer_store_dwordx4 v[136:139], v6, s[12:15], s85 offen offset:0 sc1
s_waitcnt lgkmcnt(2)
buffer_store_dwordx4 v[144:147], v6, s[12:15], s84 offen offset:128 sc1
s_waitcnt lgkmcnt(0)
buffer_store_dwordx4 v[152:155], v6, s[12:15], s85 offen offset:128 sc1
s_waitcnt vmcnt(12)
s_branch L_fin
L_last0_3:
s_cmp_eq_u32 s73, 0
s_cbranch_scc1 L_t3_0_0
s_cmp_eq_u32 s73, 3
s_cbranch_scc1 L_t3_0_3
s_cmp_eq_u32 s73, 4
s_cbranch_scc1 L_t3_0_4
s_cmp_eq_u32 s73, 11
s_cbranch_scc1 L_t3_0_11
L_t3_0_12:
v_mfma_f32_16x16x32_bf16 v[32:35], a[0:3], v[208:211], 0
s_waitcnt vmcnt(16)
buffer_load_dwordx4 v3, s[4:7], s24 offen lds
v_mfma_f32_16x16x32_bf16 v[32:35], a[4:7], v[212:215], v[32:35]
s_add_u32 s33, s33, 1
buffer_load_dwordx4 v4, s[4:7], s24 offen offset:1056 lds
v_mfma_f32_16x16x32_bf16 v[32:35], a[8:11], v[216:219], v[32:35]
s_mov_b32 s14, s47
buffer_load_dwordx4 v3, s[8:11], s24 offen offset:2080 lds
v_mfma_f32_16x16x32_bf16 v[32:35], a[12:15], v[220:223], v[32:35]
s_add_u32 s80, s46, 0
v_exp_f32 v29, v29
v_mfma_f32_16x16x32_bf16 v[36:39], a[28:31], v[220:223], 0
s_add_u32 s81, s46, 131072
buffer_load_dwordx4 v4, s[8:11], s24 offen offset:3136 lds
v_mfma_f32_16x16x32_bf16 v[36:39], a[24:27], v[216:219], v[36:39]
s_add_u32 m0, m0, s34
v_exp_f32 v30, v30
v_mfma_f32_16x16x32_bf16 v[36:39], a[20:23], v[212:215], v[36:39]
s_cmp_eq_u32 m0, s29
v_exp_f32 v31, v31
v_mfma_f32_16x16x32_bf16 v[36:39], a[16:19], v[208:211], v[36:39]
s_cselect_b32 m0, s28, m0
v_cvt_pk_bf16_f32 v42, v28, v29
v_cvt_pk_bf16_f32 v43, v30, v31
s_add_u32 s24, s24, s25
v_exp_f32 v32, v32
v_mfma_f32_16x16x32_bf16 a[132:135], a[128:131], v[40:43], a[132:135]
s_add_u32 s82, s46, 262144
v_exp_f32 v33, v33
v_mfma_f32_16x16x32_bf16 v[64:67], v[40:43], a[64:67], v[64:67]
s_sub_u32 s30, s30, 1
v_exp_f32 v34, v34
v_mfma_f32_16x16x32_bf16 v[68:71], v[40:43], a[68:71], v[68:71]
s_cselect_b32 s31, s35, s34
v_exp_f32 v35, v35
v_mfma_f32_16x16x32_bf16 v[72:75], v[40:43], a[72:75], v[72:75]
s_cselect_b32 s30, 7, s30
v_accvgpr_read_b32 v16, a132
v_rcp_f32 v13, v16
v_mfma_f32_16x16x32_bf16 v[76:79], v[40:43], a[76:79], v[76:79]
s_add_u32 s83, s46, 393216
ds_write_b32 v60, v13
v_mfma_f32_16x16x32_bf16 v[80:83], v[40:43], a[80:83], v[80:83]
s_lshr_b32 s77, s43, 12
ds_read_b128 v[52:55], v61
v_exp_f32 v36, v36
v_mfma_f32_16x16x32_bf16 v[84:87], v[40:43], a[84:87], v[84:87]
s_lshr_b32 s78, s42, 12
v_exp_f32 v37, v37
v_mfma_f32_16x16x32_bf16 v[88:91], v[40:43], a[88:91], v[88:91]
s_sub_u32 s77, s77, s78
v_exp_f32 v38, v38
v_mfma_f32_16x16x32_bf16 v[92:95], v[40:43], a[92:95], v[92:95]
s_lshl_b32 s78, s45, 5
v_exp_f32 v39, v39
v_mfma_f32_16x16x32_bf16 v[24:27], a[0:3], v[224:227], 0
s_sub_u32 s77, s77, s78
v_cvt_pk_bf16_f32 v44, v32, v33
v_cvt_pk_bf16_f32 v45, v34, v35
v_mfma_f32_16x16x32_bf16 v[24:27], a[4:7], v[228:231], v[24:27]
s_add_u32 s50, s77, 32
v_cvt_pk_bf16_f32 v46, v36, v37
v_cvt_pk_bf16_f32 v47, v38, v39
v_mfma_f32_16x16x32_bf16 v[24:27], a[8:11], v[232:235], v[24:27]
s_add_u32 s84, s46, 524288
v_max3_u32 v12, v12, v16, v13
v_add_u32 v17, v1, v7
v_mfma_f32_16x16x32_bf16 v[24:27], a[12:15], v[236:239], v[24:27]
s_add_u32 s85, s46, 655360
s_waitcnt vmcnt(16)
ds_read_b128 v[192:195], v17 offset:0
v_mfma_f32_16x16x32_bf16 v[28:31], a[28:31], v[236:239], 0
s_sub_u32 s26, s26, 1
ds_read_b128 v[196:199], v17 offset:64
ds_read_b128 v[200:203], v17 offset:128
v_mfma_f32_16x16x32_bf16 v[28:31], a[24:27], v[232:235], v[28:31]
s_sub_u32 s26, s26, 1
ds_read_b128 v[204:207], v17 offset:192
v_exp_f32 v24, v24
s_waitcnt lgkmcnt(4)
v_pk_mul_f32 v[64:65], v[64:65], v[52:53]
v_pk_mul_f32 v[68:69], v[68:69], v[52:53]
v_pk_mul_f32 v[80:81], v[80:81], v[52:53]
v_pk_mul_f32 v[84:85], v[84:85], v[52:53]
v_pk_mul_f32 v[66:67], v[66:67], v[54:55]
v_pk_mul_f32 v[70:71], v[70:71], v[54:55]
v_pk_mul_f32 v[82:83], v[82:83], v[54:55]
v_pk_mul_f32 v[86:87], v[86:87], v[54:55]
v_pk_mul_f32 v[72:73], v[72:73], v[52:53]
v_pk_mul_f32 v[76:77], v[76:77], v[52:53]
v_pk_mul_f32 v[88:89], v[88:89], v[52:53]
v_pk_mul_f32 v[92:93], v[92:93], v[52:53]
v_pk_mul_f32 v[74:75], v[74:75], v[54:55]
v_pk_mul_f32 v[78:79], v[78:79], v[54:55]
v_pk_mul_f32 v[90:91], v[90:91], v[54:55]
v_pk_mul_f32 v[94:95], v[94:95], v[54:55]
v_mfma_f32_16x16x32_bf16 v[28:31], a[20:23], v[228:231], v[28:31]
s_sub_u32 s26, s26, 1
v_cvt_pk_bf16_f32 v64, v64, v68
v_cvt_pk_bf16_f32 v80, v80, v84
v_mfma_f32_16x16x32_bf16 v[28:31], a[16:19], v[224:227], v[28:31]
s_sub_u32 s26, s26, 1
v_cvt_pk_bf16_f32 v66, v66, v70
v_cvt_pk_bf16_f32 v82, v82, v86
v_mfma_f32_16x16x32_bf16 a[136:139], a[128:131], v[44:47], a[136:139]
s_sub_u32 s26, s26, 1
v_cvt_pk_bf16_f32 v68, v65, v69
v_cvt_pk_bf16_f32 v84, v81, v85
v_mfma_f32_16x16x32_bf16 v[96:99], v[44:47], a[64:67], v[96:99]
s_mov_b32 s49, s45
v_cvt_pk_bf16_f32 v70, v67, v71
v_cvt_pk_bf16_f32 v86, v83, v87
v_mfma_f32_16x16x32_bf16 v[100:103], v[44:47], a[68:71], v[100:103]
s_sub_u32 s26, s26, 1
v_cvt_pk_bf16_f32 v65, v72, v76
v_cvt_pk_bf16_f32 v69, v73, v77
v_mfma_f32_16x16x32_bf16 v[104:107], v[44:47], a[72:75], v[104:107]
s_mov_b32 s46, s41
v_cvt_pk_bf16_f32 v81, v88, v92
v_cvt_pk_bf16_f32 v85, v89, v93
v_mfma_f32_16x16x32_bf16 v[108:111], v[44:47], a[76:79], v[108:111]
s_mov_b32 s47, s43
v_cvt_pk_bf16_f32 v67, v74, v78
v_cvt_pk_bf16_f32 v71, v75, v79
v_mfma_f32_16x16x32_bf16 v[112:115], v[44:47], a[80:83], v[112:115]
s_mov_b32 s73, 0
v_cvt_pk_bf16_f32 v83, v90, v94
v_cvt_pk_bf16_f32 v87, v91, v95
v_mfma_f32_16x16x32_bf16 v[116:119], v[44:47], a[84:87], v[116:119]
s_sub_u32 s32, s49, 3
ds_write2_b64 v5, v[64:65], v[80:81] offset0:0 offset1:16
v_mfma_f32_16x16x32_bf16 v[120:123], v[44:47], a[88:91], v[120:123]
ds_write2_b64 v0, v[68:69], v[84:85] offset0:32 offset1:48
v_mfma_f32_16x16x32_bf16 v[124:127], v[44:47], a[92:95], v[124:127]
ds_write2_b64 v5, v[66:67], v[82:83] offset0:80 offset1:64
s_waitcnt lgkmcnt(6)
v_mfma_f32_16x16x32_bf16 v[160:163], a[146:149], v[192:195], 0
v_accvgpr_read_b32 v18, a136
v_rcp_f32 v13, v18
v_mfma_f32_16x16x32_bf16 v[164:167], a[144:147], v[192:195], 0
s_waitcnt vmcnt(12)
ds_write2_b64 v0, v[70:71], v[86:87] offset0:112 offset1:96
v_mfma_f32_16x16x32_bf16 v[160:163], a[150:153], v[192:195], v[160:163]
v_exp_f32 v25, v25
v_mfma_f32_16x16x32_bf16 v[164:167], a[148:151], v[192:195], v[164:167]
v_exp_f32 v26, v26
s_waitcnt lgkmcnt(6)
v_mfma_f32_16x16x32_bf16 v[168:171], a[146:149], v[196:199], 0
ds_read_b64_tr_b16 v[64:65], v56 offset:0
ds_read_b64_tr_b16 v[66:67], v57 offset:0
v_mfma_f32_16x16x32_bf16 v[172:175], a[144:147], v[196:199], 0
ds_read_b64_tr_b16 v[72:73], v56 offset:2048
ds_read_b64_tr_b16 v[74:75], v57 offset:2048
v_mfma_f32_16x16x32_bf16 v[168:171], a[150:153], v[196:199], v[168:171]
ds_read_b64_tr_b16 v[80:81], v58 offset:0
ds_read_b64_tr_b16 v[82:83], v59 offset:0
v_mfma_f32_16x16x32_bf16 v[172:175], a[148:151], v[196:199], v[172:175]
ds_read_b64_tr_b16 v[88:89], v58 offset:2048
ds_read_b64_tr_b16 v[90:91], v59 offset:2048
s_waitcnt lgkmcnt(13)
v_mfma_f32_16x16x32_bf16 v[176:179], a[146:149], v[200:203], 0
ds_write_b32 v60, v13
v_mfma_f32_16x16x32_bf16 v[180:183], a[144:147], v[200:203], 0
ds_read_b128 v[240:243], v61
v_exp_f32 v27, v27
v_mfma_f32_16x16x32_bf16 v[176:179], a[150:153], v[200:203], v[176:179]
v_exp_f32 v28, v28
v_mfma_f32_16x16x32_bf16 v[180:183], a[148:151], v[200:203], v[180:183]
v_exp_f32 v29, v29
s_waitcnt lgkmcnt(14)
v_mfma_f32_16x16x32_bf16 v[184:187], a[146:149], v[204:207], 0
v_exp_f32 v30, v30
v_mfma_f32_16x16x32_bf16 v[188:191], a[144:147], v[204:207], 0
v_exp_f32 v31, v31
v_mfma_f32_16x16x32_bf16 v[184:187], a[150:153], v[204:207], v[184:187]
s_waitcnt lgkmcnt(8)
buffer_store_dwordx4 v[64:67], v6, s[12:15], s80 offen offset:0 sc1
v_mfma_f32_16x16x32_bf16 v[188:191], a[148:151], v[204:207], v[188:191]
s_waitcnt lgkmcnt(6)
buffer_store_dwordx4 v[72:75], v6, s[12:15], s81 offen offset:0 sc1
s_waitcnt lgkmcnt(4)
buffer_store_dwordx4 v[80:83], v6, s[12:15], s80 offen offset:128 sc1
s_waitcnt lgkmcnt(2)
buffer_store_dwordx4 v[88:91], v6, s[12:15], s81 offen offset:128 sc1
s_waitcnt vmcnt(12)
s_waitcnt lgkmcnt(0)
v_pk_mul_f32 v[96:97], v[96:97], v[240:241]
v_pk_mul_f32 v[100:101], v[100:101], v[240:241]
v_pk_mul_f32 v[112:113], v[112:113], v[240:241]
v_pk_mul_f32 v[116:117], v[116:117], v[240:241]
v_pk_mul_f32 v[98:99], v[98:99], v[242:243]
v_pk_mul_f32 v[102:103], v[102:103], v[242:243]
v_pk_mul_f32 v[114:115], v[114:115], v[242:243]
v_pk_mul_f32 v[118:119], v[118:119], v[242:243]
v_cvt_pk_bf16_f32 v96, v96, v100
v_cvt_pk_bf16_f32 v112, v112, v116
v_cvt_pk_bf16_f32 v98, v98, v102
v_cvt_pk_bf16_f32 v114, v114, v118
v_pk_mul_f32 v[104:105], v[104:105], v[240:241]
v_pk_mul_f32 v[108:109], v[108:109], v[240:241]
v_cvt_pk_bf16_f32 v100, v97, v101
v_pk_mul_f32 v[120:121], v[120:121], v[240:241]
v_pk_mul_f32 v[124:125], v[124:125], v[240:241]
v_cvt_pk_bf16_f32 v116, v113, v117
v_pk_mul_f32 v[106:107], v[106:107], v[242:243]
v_pk_mul_f32 v[110:111], v[110:111], v[242:243]
v_cvt_pk_bf16_f32 v102, v99, v103
v_pk_mul_f32 v[122:123], v[122:123], v[242:243]
v_pk_mul_f32 v[126:127], v[126:127], v[242:243]
v_cvt_pk_bf16_f32 v118, v115, v119
v_cvt_pk_bf16_f32 v97, v104, v108
v_cvt_pk_bf16_f32 v101, v105, v109
v_cvt_pk_bf16_f32 v113, v120, v124
v_cvt_pk_bf16_f32 v117, v121, v125
v_cvt_pk_bf16_f32 v99, v106, v110
v_cvt_pk_bf16_f32 v103, v107, v111
v_cvt_pk_bf16_f32 v115, v122, v126
v_cvt_pk_bf16_f32 v119, v123, v127
ds_write2_b64 v5, v[96:97], v[112:113] offset0:0 offset1:16
ds_write2_b64 v0, v[100:101], v[116:117] offset0:32 offset1:48
v_cvt_pk_bf16_f32 v40, v24, v25
v_cvt_pk_bf16_f32 v41, v26, v27
v_cvt_pk_bf16_f32 v42, v28, v29
v_cvt_pk_bf16_f32 v43, v30, v31
ds_write2_b64 v5, v[98:99], v[114:115] offset0:80 offset1:64
s_nop 0
v_mfma_f32_16x16x32_bf16 a[140:143], a[128:131], v[40:43], a[140:143]
v_add_u32 v1, s31, v1
v_add_u32 v2, s31, v2
v_mfma_f32_16x16x32_bf16 v[128:131], v[40:43], a[64:67], v[128:131]
s_sub_u32 s30, s30, 1
v_add_u32 v19, v1, v7
ds_write2_b64 v0, v[102:103], v[118:119] offset0:112 offset1:96
v_mfma_f32_16x16x32_bf16 v[132:135], v[40:43], a[68:71], v[132:135]
s_cselect_b32 s31, s35, s34
s_cselect_b32 s30, 7, s30
v_add_u32 v1, s31, v1
v_mfma_f32_16x16x32_bf16 v[136:139], v[40:43], a[72:75], v[136:139]
v_add_u32 v2, s31, v2
ds_read_b64_tr_b16 v[96:97], v56 offset:0
v_mfma_f32_16x16x32_bf16 v[140:143], v[40:43], a[76:79], v[140:143]
s_sub_u32 s30, s30, 1
ds_read_b64_tr_b16 v[98:99], v57 offset:0
ds_read_b64_tr_b16 v[104:105], v56 offset:2048
v_mfma_f32_16x16x32_bf16 v[144:147], v[40:43], a[80:83], v[144:147]
s_cselect_b32 s31, s35, s34
ds_read_b64_tr_b16 v[106:107], v57 offset:2048
ds_read_b64_tr_b16 v[112:113], v58 offset:0
v_mfma_f32_16x16x32_bf16 v[148:151], v[40:43], a[84:87], v[148:151]
s_cselect_b32 s30, 7, s30
s_waitcnt vmcnt(8)
ds_add_u32 v8, v10
v_mfma_f32_16x16x32_bf16 v[152:155], v[40:43], a[88:91], v[152:155]
ds_read_b64_tr_b16 v[114:115], v59 offset:0
v_add_u32 v21, v1, v7
v_mfma_f32_16x16x32_bf16 v[156:159], v[40:43], a[92:95], v[156:159]
ds_read_b128 v[208:211], v19 offset:0
v_add_u32 v1, s31, v1
v_add_u32 v2, s31, v2
s_sub_u32 s30, s30, 1
v_add_u32 v23, v1, v7
s_cselect_b32 s31, s35, s34
v_add_u32 v1, s31, v1
v_max3_u32 v12, v12, v18, v13
v_accvgpr_read_b32 v20, a140
v_rcp_f32 v13, v20
ds_read_b128 v[212:215], v19 offset:64
ds_write_b32 v60, v13
ds_read_b128 v[216:219], v19 offset:128
ds_read_b128 v[52:55], v61
ds_read_b64_tr_b16 v[120:121], v58 offset:2048
v_max3_u32 v12, v12, v20, v13
ds_read_b64_tr_b16 v[122:123], v59 offset:2048
v_mbcnt_lo_u32_b32 v13, -1, 0
ds_read_b128 v[220:223], v19 offset:192
v_mbcnt_hi_u32_b32 v13, -1, v13
v_lshrrev_b32 v13, 2, v13
s_waitcnt lgkmcnt(13)
buffer_store_dwordx4 v[96:99], v6, s[12:15], s82 offen offset:0 sc1
s_waitcnt lgkmcnt(11)
buffer_store_dwordx4 v[104:107], v6, s[12:15], s83 offen offset:0 sc1
s_waitcnt lgkmcnt(8)
buffer_store_dwordx4 v[112:115], v6, s[12:15], s82 offen offset:128 sc1
v_and_b32 v13, 12, v13
v_sub_u32 v13, s50, v13
v_cvt_f32_i32 v13, v13
v_mov_b32 v14, 0x7c800000
v_fmaak_f32 v16, v13, v14, 0xfc000000
v_fmaak_f32 v17, v13, v14, 0xfcc00000
v_fmaak_f32 v18, v13, v14, 0xfd200000
v_fmaak_f32 v19, v13, v14, 0xfd600000
v_min_f32 v16, 0, v16
v_min_f32 v17, 0, v17
v_min_f32 v18, 0, v18
v_min_f32 v19, 0, v19
v_cvt_pk_bf16_f32 v192, v160, v161
v_cvt_pk_bf16_f32 v193, v162, v163
s_waitcnt lgkmcnt(3)
v_pk_mul_f32 v[128:129], v[128:129], v[52:53]
v_pk_mul_f32 v[132:133], v[132:133], v[52:53]
v_pk_mul_f32 v[144:145], v[144:145], v[52:53]
v_pk_mul_f32 v[148:149], v[148:149], v[52:53]
v_pk_mul_f32 v[130:131], v[130:131], v[54:55]
v_pk_mul_f32 v[134:135], v[134:135], v[54:55]
v_pk_mul_f32 v[146:147], v[146:147], v[54:55]
v_pk_mul_f32 v[150:151], v[150:151], v[54:55]
v_pk_mul_f32 v[136:137], v[136:137], v[52:53]
v_pk_mul_f32 v[140:141], v[140:141], v[52:53]
v_pk_mul_f32 v[152:153], v[152:153], v[52:53]
v_pk_mul_f32 v[156:157], v[156:157], v[52:53]
v_pk_mul_f32 v[138:139], v[138:139], v[54:55]
v_pk_mul_f32 v[142:143], v[142:143], v[54:55]
v_pk_mul_f32 v[154:155], v[154:155], v[54:55]
v_pk_mul_f32 v[158:159], v[158:159], v[54:55]
v_mfma_f32_16x16x32_bf16 v[160:163], a[146:149], v[208:211], 0
s_cselect_b32 s30, 7, s30
v_cvt_pk_bf16_f32 v194, v164, v165
v_cvt_pk_bf16_f32 v195, v166, v167
v_mfma_f32_16x16x32_bf16 v[164:167], a[144:147], v[208:211], 0
ds_read_b32 v11, v9
v_add_u32 v2, s31, v2
v_mfma_f32_16x16x32_bf16 v[160:163], a[150:153], v[208:211], v[160:163]
s_sub_u32 s30, s30, 1
v_cvt_pk_bf16_f32 v196, v168, v169
v_cvt_pk_bf16_f32 v197, v170, v171
v_mfma_f32_16x16x32_bf16 v[164:167], a[148:151], v[208:211], v[164:167]
s_cselect_b32 s31, s35, s34
v_cvt_pk_bf16_f32 v198, v172, v173
v_cvt_pk_bf16_f32 v199, v174, v175
v_mfma_f32_16x16x32_bf16 v[168:171], a[146:149], v[212:215], 0
s_cselect_b32 s30, 7, s30
v_cvt_pk_bf16_f32 v200, v176, v177
v_cvt_pk_bf16_f32 v201, v178, v179
v_mfma_f32_16x16x32_bf16 v[172:175], a[144:147], v[212:215], 0
s_waitcnt lgkmcnt(2)
buffer_store_dwordx4 v[120:123], v6, s[12:15], s83 offen offset:128 sc1
v_mfma_f32_16x16x32_bf16 v[168:171], a[150:153], v[212:215], v[168:171]
ds_read_b128 v[224:227], v21 offset:0
v_cvt_pk_bf16_f32 v202, v180, v181
v_mfma_f32_16x16x32_bf16 v[172:175], a[148:151], v[212:215], v[172:175]
ds_read_b128 v[228:231], v21 offset:64
v_cvt_pk_bf16_f32 v203, v182, v183
v_mfma_f32_16x16x32_bf16 v[176:179], a[146:149], v[216:219], 0
v_cvt_pk_bf16_f32 v128, v128, v132
v_cvt_pk_bf16_f32 v144, v144, v148
v_mfma_f32_16x16x32_bf16 v[180:183], a[144:147], v[216:219], 0
v_cvt_pk_bf16_f32 v130, v130, v134
v_cvt_pk_bf16_f32 v146, v146, v150
v_mfma_f32_16x16x32_bf16 v[176:179], a[150:153], v[216:219], v[176:179]
s_waitcnt lgkmcnt(2)
v_cmp_gt_u32 vcc, s33, v11
v_cvt_pk_bf16_f32 v132, v129, v133
v_mfma_f32_16x16x32_bf16 v[180:183], a[148:151], v[216:219], v[180:183]
v_cvt_pk_bf16_f32 v148, v145, v149
v_cvt_pk_bf16_f32 v134, v131, v135
s_cbranch_vccnz L_spin_23
L_spinret_24:
buffer_load_dwordx4 v3, s[4:7], s24 offen lds
buffer_load_dwordx4 v4, s[4:7], s24 offen offset:1056 lds
buffer_load_dwordx4 v3, s[8:11], s24 offen offset:2080 lds
ds_read_b128 a[0:3], v1 offset:0
ds_read_b128 a[4:7], v1 offset:64
ds_read_b128 a[8:11], v1 offset:128
ds_read_b128 a[12:15], v1 offset:192
v_cvt_pk_bf16_f32 v150, v147, v151
v_cvt_pk_bf16_f32 v204, v184, v185
ds_read_b64_tr_b16 a[64:65], v2 offset:0
v_cvt_pk_bf16_f32 v205, v186, v187
v_mfma_f32_16x16x32_bf16 v[184:187], a[146:149], v[220:223], 0
s_add_u32 s33, s33, 1
buffer_load_dwordx4 v4, s[8:11], s24 offen offset:3136 lds
v_mfma_f32_16x16x32_bf16 v[184:187], a[150:153], v[220:223], v[184:187]
s_add_u32 m0, m0, s34
s_cmp_eq_u32 m0, s29
s_cselect_b32 m0, s28, m0
s_add_u32 s24, s24, s25
ds_read_b64_tr_b16 a[66:67], v2 offset:512
ds_read_b64_tr_b16 a[68:69], v2 offset:32
ds_read_b64_tr_b16 a[70:71], v2 offset:544
ds_read_b64_tr_b16 a[72:73], v2 offset:64
ds_read_b64_tr_b16 a[74:75], v2 offset:576
v_cvt_pk_bf16_f32 v206, v188, v189
v_cvt_pk_bf16_f32 v207, v190, v191
v_mfma_f32_16x16x32_bf16 v[188:191], a[144:147], v[220:223], 0
buffer_load_dwordx4 v3, s[4:7], s24 offen lds
v_mfma_f32_16x16x32_bf16 v[188:191], a[148:151], v[220:223], v[188:191]
ds_read_b64_tr_b16 a[76:77], v2 offset:96
v_cvt_pk_bf16_f32 v129, v136, v140
v_cvt_pk_bf16_f32 v133, v137, v141
v_cvt_pk_bf16_f32 v145, v152, v156
v_cvt_pk_bf16_f32 v149, v153, v157
v_cvt_pk_bf16_f32 v131, v138, v142
v_cvt_pk_bf16_f32 v135, v139, v143
v_cvt_pk_bf16_f32 v147, v154, v158
v_cvt_pk_bf16_f32 v151, v155, v159
ds_write2_b64 v5, v[128:129], v[144:145] offset0:0 offset1:16
s_waitcnt lgkmcnt(11)
v_mfma_f32_16x16x32_bf16 v[24:27], a[0:3], v[192:195], v[16:19]
buffer_load_dwordx4 v4, s[4:7], s24 offen offset:1056 lds
s_waitcnt lgkmcnt(10)
v_mfma_f32_16x16x32_bf16 v[24:27], a[4:7], v[196:199], v[24:27]
ds_write2_b64 v0, v[132:133], v[148:149] offset0:32 offset1:48
s_waitcnt lgkmcnt(10)
v_mfma_f32_16x16x32_bf16 v[24:27], a[8:11], v[200:203], v[24:27]
s_waitcnt vmcnt(14)
ds_add_u32 v8, v10
s_waitcnt lgkmcnt(10)
v_mfma_f32_16x16x32_bf16 v[24:27], a[12:15], v[204:207], v[24:27]
buffer_load_dwordx4 v3, s[8:11], s24 offen offset:2080 lds
ds_write2_b64 v5, v[130:131], v[146:147] offset0:80 offset1:64
ds_write2_b64 v0, v[134:135], v[150:151] offset0:112 offset1:96
buffer_load_dwordx4 v4, s[8:11], s24 offen offset:3136 lds
s_add_u32 m0, m0, s34
s_cmp_eq_u32 m0, s29
s_cselect_b32 m0, s28, m0
s_add_u32 s24, s24, s25
v_cvt_pk_bf16_f32 v208, v160, v161
ds_read_b64_tr_b16 a[78:79], v2 offset:608
v_cvt_pk_bf16_f32 v209, v162, v163
v_mfma_f32_16x16x32_bf16 v[160:163], a[146:149], v[224:227], 0
ds_read_b64_tr_b16 a[80:81], v2 offset:128
v_cvt_pk_bf16_f32 v210, v164, v165
v_mfma_f32_16x16x32_bf16 v[160:163], a[150:153], v[224:227], v[160:163]
buffer_load_dwordx4 v3, s[4:7], s24 offen lds
v_cvt_pk_bf16_f32 v211, v166, v167
v_mfma_f32_16x16x32_bf16 v[164:167], a[144:147], v[224:227], 0
ds_read_b64_tr_b16 a[82:83], v2 offset:640
ds_read_b64_tr_b16 v[128:129], v56 offset:0
v_mfma_f32_16x16x32_bf16 v[32:35], a[0:3], v[208:211], v[16:19]
ds_read_b64_tr_b16 v[130:131], v57 offset:0
v_cvt_pk_bf16_f32 v212, v168, v169
v_mfma_f32_16x16x32_bf16 v[164:167], a[148:151], v[224:227], v[164:167]
ds_read_b64_tr_b16 a[84:85], v2 offset:160
buffer_load_dwordx4 v4, s[4:7], s24 offen offset:1056 lds
v_cvt_pk_bf16_f32 v213, v170, v171
v_mfma_f32_16x16x32_bf16 v[168:171], a[146:149], v[228:231], 0
ds_read_b64_tr_b16 a[86:87], v2 offset:672
v_cvt_pk_bf16_f32 v214, v172, v173
v_mfma_f32_16x16x32_bf16 v[168:171], a[150:153], v[228:231], v[168:171]
ds_read_b64_tr_b16 a[88:89], v2 offset:192
v_cvt_pk_bf16_f32 v215, v174, v175
v_mfma_f32_16x16x32_bf16 v[172:175], a[144:147], v[228:231], 0
ds_read_b64_tr_b16 a[90:91], v2 offset:704
v_cvt_pk_bf16_f32 v216, v176, v177
v_mfma_f32_16x16x32_bf16 v[32:35], a[4:7], v[212:215], v[32:35]
buffer_load_dwordx4 v3, s[8:11], s24 offen offset:2080 lds
v_mfma_f32_16x16x32_bf16 v[172:175], a[148:151], v[228:231], v[172:175]
ds_read_b64_tr_b16 a[92:93], v2 offset:224
v_cvt_pk_bf16_f32 v217, v178, v179
v_cvt_pk_bf16_f32 v218, v180, v181
v_cvt_pk_bf16_f32 v219, v182, v183
v_cvt_pk_bf16_f32 v220, v184, v185
v_cvt_pk_bf16_f32 v221, v186, v187
v_mfma_f32_16x16x32_bf16 v[32:35], a[8:11], v[216:219], v[32:35]
ds_read_b64_tr_b16 a[94:95], v2 offset:736
v_cvt_pk_bf16_f32 v222, v188, v189
v_cvt_pk_bf16_f32 v223, v190, v191
buffer_load_dwordx4 v4, s[8:11], s24 offen offset:3136 lds
s_nop 0
v_mfma_f32_16x16x32_bf16 v[32:35], a[12:15], v[220:223], v[32:35]
s_add_u32 m0, m0, s34
v_exp_f32 v24, v24
v_exp_f32 v25, v25
v_exp_f32 v26, v26
v_exp_f32 v27, v27
v_mov_b32 v42, 0
v_mov_b32 v43, 0
v_cvt_pk_bf16_f32 v40, v24, v25
v_cvt_pk_bf16_f32 v41, v26, v27
ds_read_b64_tr_b16 v[136:137], v56 offset:2048
ds_read_b64_tr_b16 v[138:139], v57 offset:2048
s_waitcnt lgkmcnt(15)
v_mfma_f32_16x16x32_bf16 v[64:67], v[40:43], a[64:67], 0
s_cmp_eq_u32 m0, s29
ds_read_b64_tr_b16 v[144:145], v58 offset:0
ds_read_b64_tr_b16 v[146:147], v59 offset:0
v_mfma_f32_16x16x32_bf16 v[68:71], v[40:43], a[68:71], 0
s_cselect_b32 m0, s28, m0
v_cvt_pk_bf16_f32 v224, v160, v161
v_cvt_pk_bf16_f32 v225, v162, v163
v_mfma_f32_16x16x32_bf16 v[72:75], v[40:43], a[72:75], 0
s_add_u32 s24, s24, s25
v_cvt_pk_bf16_f32 v226, v164, v165
v_cvt_pk_bf16_f32 v227, v166, v167
s_waitcnt lgkmcnt(14)
v_mfma_f32_16x16x32_bf16 v[76:79], v[40:43], a[76:79], 0
ds_read_b128 v[232:235], v21 offset:128
v_cvt_pk_bf16_f32 v228, v168, v169
s_waitcnt lgkmcnt(13)
v_mfma_f32_16x16x32_bf16 v[80:83], v[40:43], a[80:83], 0
ds_read_b32 v11, v9
v_cvt_pk_bf16_f32 v229, v170, v171
s_waitcnt lgkmcnt(10)
v_mfma_f32_16x16x32_bf16 v[84:87], v[40:43], a[84:87], 0
ds_read_b128 v[236:239], v21 offset:192
v_cvt_pk_bf16_f32 v230, v172, v173
s_waitcnt lgkmcnt(9)
v_mfma_f32_16x16x32_bf16 v[88:91], v[40:43], a[88:91], 0
ds_read_b64_tr_b16 v[152:153], v58 offset:2048
v_cvt_pk_bf16_f32 v231, v174, v175
s_waitcnt lgkmcnt(8)
v_mfma_f32_16x16x32_bf16 v[92:95], v[40:43], a[92:95], 0
ds_read_b64_tr_b16 v[154:155], v59 offset:2048
ds_read_b128 v[240:243], v23 offset:0
v_mfma_f32_16x16x32_bf16 a[132:135], a[128:131], v[40:43], 0
ds_read_b128 v[244:247], v23 offset:64
ds_read_b128 v[248:251], v23 offset:128
v_mfma_f32_16x16x32_bf16 v[24:27], a[0:3], v[224:227], v[16:19]
ds_read_b128 v[252:255], v23 offset:192
v_mov_b32 v46, 0
v_mfma_f32_16x16x32_bf16 v[24:27], a[4:7], v[228:231], v[24:27]
buffer_store_dwordx4 v[128:131], v6, s[12:15], s84 offen offset:0 sc1
v_exp_f32 v32, v32
v_exp_f32 v33, v33
v_mov_b32 v47, 0
s_waitcnt lgkmcnt(11)
buffer_store_dwordx4 v[136:139], v6, s[12:15], s85 offen offset:0 sc1
s_waitcnt lgkmcnt(8)
v_mfma_f32_16x16x32_bf16 v[176:179], a[146:149], v[232:235], 0
v_exp_f32 v34, v34
v_mfma_f32_16x16x32_bf16 v[180:183], a[144:147], v[232:235], 0
v_exp_f32 v35, v35
v_mfma_f32_16x16x32_bf16 v[176:179], a[150:153], v[232:235], v[176:179]
v_cvt_pk_bf16_f32 v44, v32, v33
v_cvt_pk_bf16_f32 v45, v34, v35
v_mfma_f32_16x16x32_bf16 v[180:183], a[148:151], v[232:235], v[180:183]
ds_read_b128 a[16:19], v1 offset:512
v_mov_b32 v48, v32
s_waitcnt lgkmcnt(7)
v_mfma_f32_16x16x32_bf16 v[184:187], a[146:149], v[236:239], 0
ds_read_b128 a[20:23], v1 offset:576
v_cvt_pk_bf16_f32 v232, v176, v177
v_mfma_f32_16x16x32_bf16 v[188:191], a[144:147], v[236:239], 0
v_cvt_pk_bf16_f32 v233, v178, v179
v_cvt_pk_bf16_f32 v234, v180, v181
v_mfma_f32_16x16x32_bf16 v[184:187], a[150:153], v[236:239], v[184:187]
v_cvt_pk_bf16_f32 v235, v182, v183
v_mov_b32 v49, v33
v_mfma_f32_16x16x32_bf16 v[188:191], a[148:151], v[236:239], v[188:191]
ds_read_b128 a[24:27], v1 offset:640
v_add_f32 v48, v48, v34
v_mfma_f32_16x16x32_bf16 v[24:27], a[8:11], v[232:235], v[24:27]
ds_read_b128 a[28:31], v1 offset:704
s_nop 0
v_cvt_pk_bf16_f32 v236, v184, v185
s_waitcnt lgkmcnt(7)
v_mfma_f32_16x16x32_bf16 v[160:163], a[146:149], v[240:243], 0
v_cvt_pk_bf16_f32 v237, v186, v187
v_cvt_pk_bf16_f32 v238, v188, v189
v_mfma_f32_16x16x32_bf16 v[164:167], a[144:147], v[240:243], 0
v_cvt_pk_bf16_f32 v239, v190, v191
v_add_f32 v49, v49, v35
v_mfma_f32_16x16x32_bf16 v[160:163], a[150:153], v[240:243], v[160:163]
v_cmp_gt_u32 vcc, s33, v11
v_add_u32 v1, s31, v1
v_mfma_f32_16x16x32_bf16 v[24:27], a[12:15], v[236:239], v[24:27]
buffer_load_dwordx4 v3, s[4:7], s24 offen lds
v_mfma_f32_16x16x32_bf16 v[96:99], v[44:47], a[64:67], 0
s_cbranch_vccnz L_spin_25
L_spinret_26:
ds_read_b128 a[32:35], v1 offset:0
ds_read_b128 a[36:39], v1 offset:64
v_mfma_f32_16x16x32_bf16 v[100:103], v[44:47], a[68:71], 0
s_add_u32 s33, s33, 1
ds_read_b128 a[40:43], v1 offset:128
ds_read_b128 a[44:47], v1 offset:192
v_mfma_f32_16x16x32_bf16 v[104:107], v[44:47], a[72:75], 0
v_exp_f32 v24, v24
v_mfma_f32_16x16x32_bf16 v[108:111], v[44:47], a[76:79], 0
v_exp_f32 v25, v25
v_mfma_f32_16x16x32_bf16 v[112:115], v[44:47], a[80:83], 0
v_exp_f32 v26, v26
v_mfma_f32_16x16x32_bf16 v[164:167], a[148:151], v[240:243], v[164:167]
v_cvt_pk_bf16_f32 v240, v160, v161
v_cvt_pk_bf16_f32 v241, v162, v163
s_waitcnt lgkmcnt(10)
v_mfma_f32_16x16x32_bf16 v[168:171], a[146:149], v[244:247], 0
v_exp_f32 v27, v27
v_mfma_f32_16x16x32_bf16 v[172:175], a[144:147], v[244:247], 0
ds_read_b128 a[60:63], v1 offset:704
s_nop 0
v_cvt_pk_bf16_f32 v242, v164, v165
v_mfma_f32_16x16x32_bf16 v[116:119], v[44:47], a[84:87], 0
v_cvt_pk_bf16_f32 v243, v166, v167
v_cvt_pk_bf16_f32 v40, v24, v25
v_mfma_f32_16x16x32_bf16 v[168:171], a[150:153], v[244:247], v[168:171]
v_cvt_pk_bf16_f32 v41, v26, v27
ds_read_b128 a[56:59], v1 offset:640
v_mfma_f32_16x16x32_bf16 v[172:175], a[148:151], v[244:247], v[172:175]
ds_read_b128 a[52:55], v1 offset:576
ds_read_b128 a[48:51], v1 offset:512
s_waitcnt lgkmcnt(13)
v_mfma_f32_16x16x32_bf16 v[176:179], a[146:149], v[248:251], 0
buffer_load_dwordx4 v4, s[4:7], s24 offen offset:1056 lds
v_mfma_f32_16x16x32_bf16 v[180:183], a[144:147], v[248:251], 0
v_cvt_pk_bf16_f32 v244, v168, v169
v_cvt_pk_bf16_f32 v245, v170, v171
v_mfma_f32_16x16x32_bf16 v[120:123], v[44:47], a[88:91], 0
v_cvt_pk_bf16_f32 v246, v172, v173
v_cvt_pk_bf16_f32 v247, v174, v175
v_mfma_f32_16x16x32_bf16 v[176:179], a[150:153], v[248:251], v[176:179]
buffer_load_dwordx4 v3, s[8:11], s24 offen offset:2080 lds
v_mfma_f32_16x16x32_bf16 v[180:183], a[148:151], v[248:251], v[180:183]
buffer_load_dwordx4 v4, s[8:11], s24 offen offset:3136 lds
s_waitcnt lgkmcnt(12)
v_mfma_f32_16x16x32_bf16 v[184:187], a[146:149], v[252:255], 0
s_add_u32 m0, m0, s34
v_add_u32 v2, s31, v2
s_nop 0
v_cvt_pk_bf16_f32 v248, v176, v177
v_mfma_f32_16x16x32_bf16 v[188:191], a[144:147], v[252:255], 0
s_cmp_eq_u32 m0, s29
v_cvt_pk_bf16_f32 v249, v178, v179
v_cvt_pk_bf16_f32 v250, v180, v181
v_mfma_f32_16x16x32_bf16 v[124:127], v[44:47], a[92:95], 0
s_cselect_b32 m0, s28, m0
v_cvt_pk_bf16_f32 v251, v182, v183
ds_read_b64_tr_b16 a[96:97], v2 offset:0
v_mfma_f32_16x16x32_bf16 v[184:187], a[150:153], v[252:255], v[184:187]
s_add_u32 s24, s24, s25
ds_read_b64_tr_b16 a[98:99], v2 offset:512
ds_read_b64_tr_b16 a[100:101], v2 offset:32
v_mfma_f32_16x16x32_bf16 v[188:191], a[148:151], v[252:255], v[188:191]
s_sub_u32 s30, s30, 1
ds_read_b64_tr_b16 a[102:103], v2 offset:544
ds_read_b64_tr_b16 a[104:105], v2 offset:64
v_mfma_f32_16x16x32_bf16 v[32:35], a[0:3], v[240:243], v[16:19]
s_cselect_b32 s31, s35, s34
ds_read_b64_tr_b16 a[106:107], v2 offset:576
v_cvt_pk_bf16_f32 v252, v184, v185
v_mfma_f32_16x16x32_bf16 v[32:35], a[4:7], v[244:247], v[32:35]
s_cselect_b32 s30, 7, s30
v_cvt_pk_bf16_f32 v253, v186, v187
v_cvt_pk_bf16_f32 v254, v188, v189
v_mfma_f32_16x16x32_bf16 v[32:35], a[8:11], v[248:251], v[32:35]
buffer_store_dwordx4 v[144:147], v6, s[12:15], s84 offen offset:128 sc1
buffer_store_dwordx4 v[152:155], v6, s[12:15], s85 offen offset:128 sc1
v_cvt_pk_bf16_f32 v255, v190, v191
ds_read_b64_tr_b16 a[108:109], v2 offset:96
ds_read_b64_tr_b16 a[110:111], v2 offset:608
v_mfma_f32_16x16x32_bf16 v[32:35], a[12:15], v[252:255], v[32:35]
ds_read_b64_tr_b16 a[112:113], v2 offset:128
ds_read_b64_tr_b16 a[114:115], v2 offset:640
v_mfma_f32_16x16x32_bf16 v[128:131], v[40:43], a[64:67], 0
ds_read_b64_tr_b16 a[116:117], v2 offset:160
s_waitcnt vmcnt(16)
v_mfma_f32_16x16x32_bf16 v[132:135], v[40:43], a[68:71], 0
ds_add_u32 v8, v10
v_mfma_f32_16x16x32_bf16 v[136:139], v[40:43], a[72:75], 0
ds_read_b64_tr_b16 a[118:119], v2 offset:672
ds_read_b64_tr_b16 a[120:121], v2 offset:192
v_mfma_f32_16x16x32_bf16 v[140:143], v[40:43], a[76:79], 0
ds_read_b64_tr_b16 a[122:123], v2 offset:704
ds_read_b64_tr_b16 a[124:125], v2 offset:224
v_mfma_f32_16x16x32_bf16 v[144:147], v[40:43], a[80:83], 0
ds_read_b64_tr_b16 a[126:127], v2 offset:736
v_add_u32 v1, s31, v1
v_mfma_f32_16x16x32_bf16 v[148:151], v[40:43], a[84:87], 0
buffer_load_dwordx4 v3, s[4:7], s24 offen lds
v_mfma_f32_16x16x32_bf16 v[152:155], v[40:43], a[88:91], 0
v_exp_f32 v32, v32
v_mfma_f32_16x16x32_bf16 v[156:159], v[40:43], a[92:95], 0
v_exp_f32 v33, v33
v_mfma_f32_16x16x32_bf16 a[136:139], a[128:131], v[40:43], 0
v_exp_f32 v34, v34
s_waitcnt lgkmcnt(15)
v_mfma_f32_16x16x32_bf16 v[24:27], a[32:35], v[192:195], 0
v_exp_f32 v35, v35
v_mfma_f32_16x16x32_bf16 v[24:27], a[36:39], v[196:199], v[24:27]
buffer_load_dwordx4 v4, s[4:7], s24 offen offset:1056 lds
v_mfma_f32_16x16x32_bf16 v[24:27], a[40:43], v[200:203], v[24:27]
buffer_load_dwordx4 v3, s[8:11], s24 offen offset:2080 lds
v_mfma_f32_16x16x32_bf16 v[24:27], a[44:47], v[204:207], v[24:27]
v_cvt_pk_bf16_f32 v44, v32, v33
v_cvt_pk_bf16_f32 v45, v34, v35
v_mfma_f32_16x16x32_bf16 v[28:31], a[60:63], v[204:207], 0
buffer_load_dwordx4 v4, s[8:11], s24 offen offset:3136 lds
v_mfma_f32_16x16x32_bf16 v[28:31], a[56:59], v[200:203], v[28:31]
s_add_u32 m0, m0, s34
s_cmp_eq_u32 m0, s29
v_mov_b32 v50, v32
v_mfma_f32_16x16x32_bf16 v[28:31], a[52:55], v[196:199], v[28:31]
s_cselect_b32 m0, s28, m0
v_exp_f32 v24, v24
v_mfma_f32_16x16x32_bf16 v[28:31], a[48:51], v[192:195], v[28:31]
s_add_u32 s24, s24, s25
v_exp_f32 v25, v25
v_mfma_f32_16x16x32_bf16 v[160:163], v[44:47], a[64:67], 0
v_exp_f32 v26, v26
v_mfma_f32_16x16x32_bf16 v[164:167], v[44:47], a[68:71], 0
v_exp_f32 v27, v27
v_mfma_f32_16x16x32_bf16 v[168:171], v[44:47], a[72:75], 0
v_mov_b32 v51, v33
v_add_f32 v50, v50, v34
v_mfma_f32_16x16x32_bf16 v[172:175], v[44:47], a[76:79], 0
v_exp_f32 v28, v28
v_mfma_f32_16x16x32_bf16 v[176:179], v[44:47], a[80:83], 0
v_add_f32 v51, v51, v35
v_add_u32 v2, s31, v2
v_mfma_f32_16x16x32_bf16 v[180:183], v[44:47], a[84:87], 0
v_cvt_pk_bf16_f32 v40, v24, v25
v_cvt_pk_bf16_f32 v41, v26, v27
v_mfma_f32_16x16x32_bf16 v[184:187], v[44:47], a[88:91], 0
ds_read_b32 v11, v9
v_mfma_f32_16x16x32_bf16 v[188:191], v[44:47], a[92:95], 0
s_waitcnt lgkmcnt(0)
v_cmp_gt_u32 vcc, s33, v11
s_cbranch_vccnz L_spin_27
L_spinret_28:
s_branch L_loop4
L_t3_0_11:
v_mfma_f32_16x16x32_bf16 v[32:35], a[0:3], v[208:211], 0
s_waitcnt vmcnt(16)
buffer_load_dwordx4 v3, s[4:7], s24 offen lds
v_mfma_f32_16x16x32_bf16 v[32:35], a[4:7], v[212:215], v[32:35]
s_add_u32 s33, s33, 1
v_exp_f32 v29, v29
v_mfma_f32_16x16x32_bf16 v[32:35], a[8:11], v[216:219], v[32:35]
s_mov_b32 s14, s47
buffer_load_dwordx4 v4, s[4:7], s24 offen offset:1056 lds
v_mfma_f32_16x16x32_bf16 v[32:35], a[12:15], v[220:223], v[32:35]
s_add_u32 s82, s46, 262144
v_exp_f32 v30, v30
v_mfma_f32_16x16x32_bf16 v[36:39], a[28:31], v[220:223], 0
s_add_u32 s80, s46, 0
v_exp_f32 v31, v31
v_mfma_f32_16x16x32_bf16 v[36:39], a[24:27], v[216:219], v[36:39]
s_add_u32 s83, s46, 393216
v_cvt_pk_bf16_f32 v42, v28, v29
v_cvt_pk_bf16_f32 v43, v30, v31
v_mfma_f32_16x16x32_bf16 v[36:39], a[20:23], v[212:215], v[36:39]
s_add_u32 s81, s46, 131072
buffer_load_dwordx4 v3, s[8:11], s24 offen offset:2080 lds
v_mfma_f32_16x16x32_bf16 v[36:39], a[16:19], v[208:211], v[36:39]
s_sub_u32 s30, s30, 1
v_exp_f32 v32, v32
v_mfma_f32_16x16x32_bf16 a[132:135], a[128:131], v[40:43], a[132:135]
s_cselect_b32 s31, s35, s34
v_exp_f32 v33, v33
v_mfma_f32_16x16x32_bf16 v[64:67], v[40:43], a[64:67], v[64:67]
s_cselect_b32 s30, 7, s30
v_exp_f32 v34, v34
v_mfma_f32_16x16x32_bf16 v[68:71], v[40:43], a[68:71], v[68:71]
s_lshr_b32 s77, s43, 12
buffer_load_dwordx4 v4, s[8:11], s24 offen offset:3136 lds
v_mfma_f32_16x16x32_bf16 v[72:75], v[40:43], a[72:75], v[72:75]
s_add_u32 m0, m0, s34
v_accvgpr_read_b32 v16, a132
v_rcp_f32 v13, v16
v_mfma_f32_16x16x32_bf16 v[76:79], v[40:43], a[76:79], v[76:79]
s_cmp_eq_u32 m0, s29
ds_write_b32 v60, v13
v_mfma_f32_16x16x32_bf16 v[80:83], v[40:43], a[80:83], v[80:83]
s_cselect_b32 m0, s28, m0
v_exp_f32 v35, v35
v_mfma_f32_16x16x32_bf16 v[84:87], v[40:43], a[84:87], v[84:87]
s_add_u32 s24, s24, s25
v_exp_f32 v36, v36
v_mfma_f32_16x16x32_bf16 v[88:91], v[40:43], a[88:91], v[88:91]
s_lshr_b32 s78, s42, 12
v_exp_f32 v37, v37
v_mfma_f32_16x16x32_bf16 v[92:95], v[40:43], a[92:95], v[92:95]
s_sub_u32 s77, s77, s78
v_exp_f32 v38, v38
v_mfma_f32_16x16x32_bf16 v[24:27], a[0:3], v[224:227], 0
s_lshl_b32 s78, s45, 5
v_exp_f32 v39, v39
v_mfma_f32_16x16x32_bf16 v[24:27], a[4:7], v[228:231], v[24:27]
s_sub_u32 s77, s77, s78
v_cvt_pk_bf16_f32 v44, v32, v33
v_cvt_pk_bf16_f32 v45, v34, v35
v_mfma_f32_16x16x32_bf16 v[24:27], a[8:11], v[232:235], v[24:27]
s_add_u32 s50, s77, 32
v_cvt_pk_bf16_f32 v46, v36, v37
v_cvt_pk_bf16_f32 v47, v38, v39
v_mfma_f32_16x16x32_bf16 v[24:27], a[12:15], v[236:239], v[24:27]
s_add_u32 s84, s46, 524288
v_max3_u32 v12, v12, v16, v13
ds_read_b128 v[52:55], v61
v_mfma_f32_16x16x32_bf16 v[28:31], a[28:31], v[236:239], 0
s_add_u32 s85, s46, 655360
v_add_u32 v17, v1, v7
ds_read_b128 v[192:195], v17 offset:0
v_mfma_f32_16x16x32_bf16 v[28:31], a[24:27], v[232:235], v[28:31]
s_sub_u32 s26, s26, 1
ds_read_b128 v[196:199], v17 offset:64
v_exp_f32 v24, v24
v_mfma_f32_16x16x32_bf16 v[28:31], a[20:23], v[228:231], v[28:31]
s_sub_u32 s26, s26, 1
v_exp_f32 v25, v25
v_mfma_f32_16x16x32_bf16 v[28:31], a[16:19], v[224:227], v[28:31]
s_sub_u32 s26, s26, 1
v_exp_f32 v26, v26
v_mfma_f32_16x16x32_bf16 a[136:139], a[128:131], v[44:47], a[136:139]
s_sub_u32 s26, s26, 1
v_exp_f32 v27, v27
v_mfma_f32_16x16x32_bf16 v[96:99], v[44:47], a[64:67], v[96:99]
s_mov_b32 s49, s45
v_cvt_pk_bf16_f32 v40, v24, v25
v_exp_f32 v28, v28
v_mfma_f32_16x16x32_bf16 v[100:103], v[44:47], a[68:71], v[100:103]
s_sub_u32 s26, s26, 1
s_waitcnt lgkmcnt(2)
v_pk_mul_f32 v[64:65], v[64:65], v[52:53]
v_pk_mul_f32 v[68:69], v[68:69], v[52:53]
v_pk_mul_f32 v[80:81], v[80:81], v[52:53]
v_pk_mul_f32 v[84:85], v[84:85], v[52:53]
v_pk_mul_f32 v[66:67], v[66:67], v[54:55]
v_pk_mul_f32 v[70:71], v[70:71], v[54:55]
v_pk_mul_f32 v[82:83], v[82:83], v[54:55]
v_pk_mul_f32 v[86:87], v[86:87], v[54:55]
v_pk_mul_f32 v[72:73], v[72:73], v[52:53]
v_pk_mul_f32 v[76:77], v[76:77], v[52:53]
v_pk_mul_f32 v[88:89], v[88:89], v[52:53]
v_pk_mul_f32 v[92:93], v[92:93], v[52:53]
v_pk_mul_f32 v[74:75], v[74:75], v[54:55]
v_pk_mul_f32 v[78:79], v[78:79], v[54:55]
v_pk_mul_f32 v[90:91], v[90:91], v[54:55]
v_pk_mul_f32 v[94:95], v[94:95], v[54:55]
v_mfma_f32_16x16x32_bf16 v[104:107], v[44:47], a[72:75], v[104:107]
s_mov_b32 s46, s41
v_accvgpr_read_b32 v18, a136
v_rcp_f32 v13, v18
v_mfma_f32_16x16x32_bf16 v[108:111], v[44:47], a[76:79], v[108:111]
s_mov_b32 s47, s43
ds_write_b32 v60, v13
v_mfma_f32_16x16x32_bf16 v[112:115], v[44:47], a[80:83], v[112:115]
s_mov_b32 s73, 0
ds_read_b128 v[240:243], v61
v_cvt_pk_bf16_f32 v64, v64, v68
v_mfma_f32_16x16x32_bf16 v[116:119], v[44:47], a[84:87], v[116:119]
s_waitcnt vmcnt(16)
v_cvt_pk_bf16_f32 v80, v80, v84
v_cvt_pk_bf16_f32 v66, v66, v70
v_mfma_f32_16x16x32_bf16 v[120:123], v[44:47], a[88:91], v[120:123]
s_sub_u32 s32, s49, 3
v_cvt_pk_bf16_f32 v82, v82, v86
v_cvt_pk_bf16_f32 v68, v65, v69
v_mfma_f32_16x16x32_bf16 v[124:127], v[44:47], a[92:95], v[124:127]
ds_read_b128 v[200:203], v17 offset:128
v_cvt_pk_bf16_f32 v84, v81, v85
s_waitcnt lgkmcnt(4)
v_mfma_f32_16x16x32_bf16 v[160:163], a[146:149], v[192:195], 0
ds_read_b128 v[204:207], v17 offset:192
v_cvt_pk_bf16_f32 v70, v67, v71
v_mfma_f32_16x16x32_bf16 v[164:167], a[144:147], v[192:195], 0
v_cvt_pk_bf16_f32 v86, v83, v87
v_cvt_pk_bf16_f32 v65, v72, v76
v_mfma_f32_16x16x32_bf16 v[160:163], a[150:153], v[192:195], v[160:163]
v_cvt_pk_bf16_f32 v69, v73, v77
v_cvt_pk_bf16_f32 v81, v88, v92
v_mfma_f32_16x16x32_bf16 v[164:167], a[148:151], v[192:195], v[164:167]
s_waitcnt lgkmcnt(2)
v_pk_mul_f32 v[96:97], v[96:97], v[240:241]
v_pk_mul_f32 v[100:101], v[100:101], v[240:241]
v_pk_mul_f32 v[112:113], v[112:113], v[240:241]
v_pk_mul_f32 v[116:117], v[116:117], v[240:241]
v_pk_mul_f32 v[98:99], v[98:99], v[242:243]
v_pk_mul_f32 v[102:103], v[102:103], v[242:243]
v_pk_mul_f32 v[114:115], v[114:115], v[242:243]
v_pk_mul_f32 v[118:119], v[118:119], v[242:243]
v_pk_mul_f32 v[104:105], v[104:105], v[240:241]
v_pk_mul_f32 v[108:109], v[108:109], v[240:241]
v_pk_mul_f32 v[120:121], v[120:121], v[240:241]
v_pk_mul_f32 v[124:125], v[124:125], v[240:241]
v_pk_mul_f32 v[106:107], v[106:107], v[242:243]
v_pk_mul_f32 v[110:111], v[110:111], v[242:243]
v_pk_mul_f32 v[122:123], v[122:123], v[242:243]
v_pk_mul_f32 v[126:127], v[126:127], v[242:243]
v_mfma_f32_16x16x32_bf16 v[168:171], a[146:149], v[196:199], 0
ds_write2_b64 v5, v[64:65], v[80:81] offset0:0 offset1:16
v_mfma_f32_16x16x32_bf16 v[172:175], a[144:147], v[196:199], 0
v_cvt_pk_bf16_f32 v85, v89, v93
v_cvt_pk_bf16_f32 v67, v74, v78
v_mfma_f32_16x16x32_bf16 v[168:171], a[150:153], v[196:199], v[168:171]
ds_write2_b64 v0, v[68:69], v[84:85] offset0:32 offset1:48
v_mfma_f32_16x16x32_bf16 v[172:175], a[148:151], v[196:199], v[172:175]
v_cvt_pk_bf16_f32 v71, v75, v79
v_cvt_pk_bf16_f32 v83, v90, v94
s_waitcnt lgkmcnt(3)
v_mfma_f32_16x16x32_bf16 v[176:179], a[146:149], v[200:203], 0
ds_write2_b64 v5, v[66:67], v[82:83] offset0:80 offset1:64
v_mfma_f32_16x16x32_bf16 v[180:183], a[144:147], v[200:203], 0
v_cvt_pk_bf16_f32 v87, v91, v95
v_cvt_pk_bf16_f32 v96, v96, v100
v_mfma_f32_16x16x32_bf16 v[176:179], a[150:153], v[200:203], v[176:179]
ds_write2_b64 v0, v[70:71], v[86:87] offset0:112 offset1:96
v_mfma_f32_16x16x32_bf16 v[180:183], a[148:151], v[200:203], v[180:183]
v_cvt_pk_bf16_f32 v112, v112, v116
v_cvt_pk_bf16_f32 v98, v98, v102
s_waitcnt lgkmcnt(4)
v_mfma_f32_16x16x32_bf16 v[184:187], a[146:149], v[204:207], 0
ds_read_b64_tr_b16 v[64:65], v56 offset:0
v_cvt_pk_bf16_f32 v114, v114, v118
v_mfma_f32_16x16x32_bf16 v[188:191], a[144:147], v[204:207], 0
ds_read_b64_tr_b16 v[66:67], v57 offset:0
v_cvt_pk_bf16_f32 v100, v97, v101
v_mfma_f32_16x16x32_bf16 v[184:187], a[150:153], v[204:207], v[184:187]
ds_read_b64_tr_b16 v[72:73], v56 offset:2048
v_cvt_pk_bf16_f32 v116, v113, v117
v_mfma_f32_16x16x32_bf16 v[188:191], a[148:151], v[204:207], v[188:191]
ds_read_b64_tr_b16 v[74:75], v57 offset:2048
v_cvt_pk_bf16_f32 v102, v99, v103
v_cvt_pk_bf16_f32 v118, v115, v119
ds_read_b64_tr_b16 v[80:81], v58 offset:0
ds_read_b64_tr_b16 v[82:83], v59 offset:0
ds_read_b64_tr_b16 v[88:89], v58 offset:2048
ds_read_b64_tr_b16 v[90:91], v59 offset:2048
v_cvt_pk_bf16_f32 v97, v104, v108
v_cvt_pk_bf16_f32 v101, v105, v109
v_cvt_pk_bf16_f32 v113, v120, v124
v_cvt_pk_bf16_f32 v117, v121, v125
v_cvt_pk_bf16_f32 v99, v106, v110
v_cvt_pk_bf16_f32 v103, v107, v111
v_cvt_pk_bf16_f32 v115, v122, v126
v_cvt_pk_bf16_f32 v119, v123, v127
ds_write2_b64 v5, v[96:97], v[112:113] offset0:0 offset1:16
v_exp_f32 v29, v29
ds_write2_b64 v0, v[100:101], v[116:117] offset0:32 offset1:48
v_exp_f32 v30, v30
v_exp_f32 v31, v31
s_waitcnt lgkmcnt(8)
buffer_store_dwordx4 v[64:67], v6, s[12:15], s80 offen offset:0 sc1
ds_write2_b64 v5, v[98:99], v[114:115] offset0:80 offset1:64
s_waitcnt vmcnt(13)
v_cvt_pk_bf16_f32 v41, v26, v27
v_cvt_pk_bf16_f32 v42, v28, v29
v_cvt_pk_bf16_f32 v43, v30, v31
v_max3_u32 v12, v12, v18, v13
ds_write2_b64 v0, v[102:103], v[118:119] offset0:112 offset1:96
v_mfma_f32_16x16x32_bf16 a[140:143], a[128:131], v[40:43], a[140:143]
s_waitcnt lgkmcnt(8)
buffer_store_dwordx4 v[72:75], v6, s[12:15], s81 offen offset:0 sc1
v_mfma_f32_16x16x32_bf16 v[128:131], v[40:43], a[64:67], v[128:131]
ds_read_b64_tr_b16 v[96:97], v56 offset:0
ds_read_b64_tr_b16 v[98:99], v57 offset:0
v_mfma_f32_16x16x32_bf16 v[132:135], v[40:43], a[68:71], v[132:135]
ds_read_b64_tr_b16 v[104:105], v56 offset:2048
ds_read_b64_tr_b16 v[106:107], v57 offset:2048
v_mfma_f32_16x16x32_bf16 v[136:139], v[40:43], a[72:75], v[136:139]
ds_read_b64_tr_b16 v[112:113], v58 offset:0
ds_read_b64_tr_b16 v[114:115], v59 offset:0
v_mfma_f32_16x16x32_bf16 v[140:143], v[40:43], a[76:79], v[140:143]
ds_read_b64_tr_b16 v[120:121], v58 offset:2048
ds_read_b64_tr_b16 v[122:123], v59 offset:2048
v_mfma_f32_16x16x32_bf16 v[144:147], v[40:43], a[80:83], v[144:147]
s_waitcnt lgkmcnt(14)
buffer_store_dwordx4 v[80:83], v6, s[12:15], s80 offen offset:128 sc1
v_mfma_f32_16x16x32_bf16 v[148:151], v[40:43], a[84:87], v[148:151]
v_accvgpr_read_b32 v20, a140
v_rcp_f32 v13, v20
v_mfma_f32_16x16x32_bf16 v[152:155], v[40:43], a[88:91], v[152:155]
ds_write_b32 v60, v13
v_mfma_f32_16x16x32_bf16 v[156:159], v[40:43], a[92:95], v[156:159]
s_waitcnt lgkmcnt(7)
buffer_store_dwordx4 v[96:99], v6, s[12:15], s82 offen offset:0 sc1
v_add_u32 v1, s31, v1
v_add_u32 v2, s31, v2
s_sub_u32 s30, s30, 1
s_waitcnt lgkmcnt(5)
buffer_store_dwordx4 v[104:107], v6, s[12:15], s83 offen offset:0 sc1
v_add_u32 v19, v1, v7
s_cselect_b32 s31, s35, s34
s_cselect_b32 s30, 7, s30
v_add_u32 v1, s31, v1
v_add_u32 v2, s31, v2
s_sub_u32 s30, s30, 1
v_add_u32 v21, v1, v7
s_cselect_b32 s31, s35, s34
ds_read_b128 v[208:211], v19 offset:0
v_add_u32 v1, s31, v1
ds_read_b128 v[52:55], v61
s_waitcnt lgkmcnt(5)
buffer_store_dwordx4 v[112:115], v6, s[12:15], s82 offen offset:128 sc1
ds_read_b128 v[212:215], v19 offset:64
ds_read_b128 v[216:219], v19 offset:128
v_max3_u32 v12, v12, v20, v13
ds_read_b128 v[220:223], v19 offset:192
v_mbcnt_lo_u32_b32 v13, -1, 0
v_mbcnt_hi_u32_b32 v13, -1, v13
s_waitcnt vmcnt(14)
ds_add_u32 v8, v10
v_lshrrev_b32 v13, 2, v13
v_and_b32 v13, 12, v13
s_waitcnt lgkmcnt(7)
buffer_store_dwordx4 v[120:123], v6, s[12:15], s83 offen offset:128 sc1
v_sub_u32 v13, s50, v13
v_cvt_f32_i32 v13, v13
v_mov_b32 v14, 0x7c800000
v_fmaak_f32 v16, v13, v14, 0xfc000000
v_fmaak_f32 v17, v13, v14, 0xfcc00000
v_fmaak_f32 v18, v13, v14, 0xfd200000
s_waitcnt lgkmcnt(5)
v_mfma_f32_16x16x32_bf16 v[96:99], a[146:149], v[208:211], 0
s_cselect_b32 s30, 7, s30
s_waitcnt lgkmcnt(4)
v_pk_mul_f32 v[128:129], v[128:129], v[52:53]
v_pk_mul_f32 v[132:133], v[132:133], v[52:53]
v_pk_mul_f32 v[144:145], v[144:145], v[52:53]
v_pk_mul_f32 v[148:149], v[148:149], v[52:53]
v_pk_mul_f32 v[130:131], v[130:131], v[54:55]
v_pk_mul_f32 v[134:135], v[134:135], v[54:55]
v_pk_mul_f32 v[146:147], v[146:147], v[54:55]
v_pk_mul_f32 v[150:151], v[150:151], v[54:55]
v_pk_mul_f32 v[136:137], v[136:137], v[52:53]
v_pk_mul_f32 v[140:141], v[140:141], v[52:53]
v_pk_mul_f32 v[152:153], v[152:153], v[52:53]
v_pk_mul_f32 v[156:157], v[156:157], v[52:53]
v_pk_mul_f32 v[138:139], v[138:139], v[54:55]
v_pk_mul_f32 v[142:143], v[142:143], v[54:55]
v_pk_mul_f32 v[154:155], v[154:155], v[54:55]
v_pk_mul_f32 v[158:159], v[158:159], v[54:55]
v_mfma_f32_16x16x32_bf16 v[100:103], a[144:147], v[208:211], 0
buffer_store_dwordx4 v[88:91], v6, s[12:15], s81 offen offset:128 sc1
v_mfma_f32_16x16x32_bf16 v[96:99], a[150:153], v[208:211], v[96:99]
ds_read_b128 v[224:227], v21 offset:0
v_fmaak_f32 v19, v13, v14, 0xfd600000
v_mfma_f32_16x16x32_bf16 v[100:103], a[148:151], v[208:211], v[100:103]
ds_read_b128 v[228:231], v21 offset:64
v_min_f32 v16, 0, v16
s_waitcnt lgkmcnt(5)
v_mfma_f32_16x16x32_bf16 v[104:107], a[146:149], v[212:215], 0
ds_read_b128 v[232:235], v21 offset:128
v_min_f32 v17, 0, v17
v_mfma_f32_16x16x32_bf16 v[108:111], a[144:147], v[212:215], 0
ds_read_b128 v[236:239], v21 offset:192
v_min_f32 v18, 0, v18
v_mfma_f32_16x16x32_bf16 v[104:107], a[150:153], v[212:215], v[104:107]
v_min_f32 v19, 0, v19
v_cvt_pk_bf16_f32 v192, v160, v161
v_mfma_f32_16x16x32_bf16 v[108:111], a[148:151], v[212:215], v[108:111]
v_cvt_pk_bf16_f32 v193, v162, v163
v_cvt_pk_bf16_f32 v194, v164, v165
s_waitcnt lgkmcnt(6)
v_mfma_f32_16x16x32_bf16 v[112:115], a[146:149], v[216:219], 0
v_cvt_pk_bf16_f32 v195, v166, v167
v_cvt_pk_bf16_f32 v196, v168, v169
v_mfma_f32_16x16x32_bf16 v[116:119], a[144:147], v[216:219], 0
v_cvt_pk_bf16_f32 v197, v170, v171
v_cvt_pk_bf16_f32 v198, v172, v173
v_mfma_f32_16x16x32_bf16 v[112:115], a[150:153], v[216:219], v[112:115]
v_cvt_pk_bf16_f32 v199, v174, v175
v_cvt_pk_bf16_f32 v128, v128, v132
v_mfma_f32_16x16x32_bf16 v[116:119], a[148:151], v[216:219], v[116:119]
v_cvt_pk_bf16_f32 v144, v144, v148
v_cvt_pk_bf16_f32 v130, v130, v134
s_waitcnt lgkmcnt(5)
v_mfma_f32_16x16x32_bf16 v[120:123], a[146:149], v[220:223], 0
v_cvt_pk_bf16_f32 v146, v146, v150
v_cvt_pk_bf16_f32 v132, v129, v133
v_mfma_f32_16x16x32_bf16 v[124:127], a[144:147], v[220:223], 0
ds_read_b32 v11, v9
v_cvt_pk_bf16_f32 v148, v145, v149
v_mfma_f32_16x16x32_bf16 v[120:123], a[150:153], v[220:223], v[120:123]
v_cvt_pk_bf16_f32 v134, v131, v135
v_cvt_pk_bf16_f32 v150, v147, v151
v_mfma_f32_16x16x32_bf16 v[124:127], a[148:151], v[220:223], v[124:127]
v_cvt_pk_bf16_f32 v129, v136, v140
v_cvt_pk_bf16_f32 v133, v137, v141
v_cvt_pk_bf16_f32 v145, v152, v156
v_cvt_pk_bf16_f32 v149, v153, v157
v_cvt_pk_bf16_f32 v131, v138, v142
v_cvt_pk_bf16_f32 v135, v139, v143
s_waitcnt lgkmcnt(3)
v_mfma_f32_16x16x32_bf16 v[140:143], a[144:147], v[228:231], 0
ds_write2_b64 v5, v[128:129], v[144:145] offset0:0 offset1:16
v_mfma_f32_16x16x32_bf16 v[140:143], a[148:151], v[228:231], v[140:143]
ds_write2_b64 v0, v[132:133], v[148:149] offset0:32 offset1:48
s_waitcnt lgkmcnt(2)
v_cmp_gt_u32 vcc, s33, v11
v_cvt_pk_bf16_f32 v147, v154, v158
v_cvt_pk_bf16_f32 v151, v155, v159
v_mfma_f32_16x16x32_bf16 v[156:159], a[144:147], v[236:239], 0
v_cvt_pk_bf16_f32 v200, v176, v177
s_cbranch_vccnz L_spin_29
L_spinret_30:
v_mfma_f32_16x16x32_bf16 v[156:159], a[148:151], v[236:239], v[156:159]
s_add_u32 s33, s33, 1
buffer_load_dwordx4 v3, s[4:7], s24 offen lds
ds_read_b128 a[0:3], v1 offset:0
ds_read_b128 a[4:7], v1 offset:64
v_cvt_pk_bf16_f32 v201, v178, v179
ds_read_b128 a[8:11], v1 offset:128
v_cvt_pk_bf16_f32 v202, v180, v181
buffer_load_dwordx4 v4, s[4:7], s24 offen offset:1056 lds
ds_read_b128 a[12:15], v1 offset:192
v_cvt_pk_bf16_f32 v203, v182, v183
v_cvt_pk_bf16_f32 v204, v184, v185
ds_write2_b64 v5, v[130:131], v[146:147] offset0:80 offset1:64
v_cvt_pk_bf16_f32 v205, v186, v187
v_cvt_pk_bf16_f32 v206, v188, v189
v_cvt_pk_bf16_f32 v207, v190, v191
v_cvt_pk_bf16_f32 v208, v96, v97
buffer_load_dwordx4 v3, s[8:11], s24 offen offset:2080 lds
ds_write2_b64 v0, v[134:135], v[150:151] offset0:112 offset1:96
s_waitcnt lgkmcnt(5)
v_mfma_f32_16x16x32_bf16 v[24:27], a[0:3], v[192:195], v[16:19]
s_waitcnt vmcnt(15)
v_cvt_pk_bf16_f32 v209, v98, v99
v_cvt_pk_bf16_f32 v210, v100, v101
s_waitcnt lgkmcnt(4)
v_mfma_f32_16x16x32_bf16 v[24:27], a[4:7], v[196:199], v[24:27]
v_cvt_pk_bf16_f32 v211, v102, v103
ds_add_u32 v8, v10
s_waitcnt lgkmcnt(4)
v_mfma_f32_16x16x32_bf16 v[24:27], a[8:11], v[200:203], v[24:27]
buffer_load_dwordx4 v4, s[8:11], s24 offen offset:3136 lds
s_waitcnt lgkmcnt(3)
v_mfma_f32_16x16x32_bf16 v[24:27], a[12:15], v[204:207], v[24:27]
s_add_u32 m0, m0, s34
s_cmp_eq_u32 m0, s29
s_cselect_b32 m0, s28, m0
v_mfma_f32_16x16x32_bf16 v[32:35], a[0:3], v[208:211], v[16:19]
s_add_u32 s24, s24, s25
ds_read_b64_tr_b16 v[128:129], v56 offset:0
ds_read_b64_tr_b16 v[130:131], v57 offset:0
v_mfma_f32_16x16x32_bf16 v[132:135], a[144:147], v[224:227], 0
buffer_load_dwordx4 v3, s[4:7], s24 offen lds
v_mfma_f32_16x16x32_bf16 v[132:135], a[148:151], v[224:227], v[132:135]
ds_read_b64_tr_b16 v[136:137], v56 offset:2048
v_cvt_pk_bf16_f32 v212, v104, v105
v_mfma_f32_16x16x32_bf16 v[148:151], a[144:147], v[232:235], 0
ds_read_b64_tr_b16 v[138:139], v57 offset:2048
v_cvt_pk_bf16_f32 v213, v106, v107
v_mfma_f32_16x16x32_bf16 v[148:151], a[148:151], v[232:235], v[148:151]
ds_read_b64_tr_b16 v[144:145], v58 offset:0
v_cvt_pk_bf16_f32 v214, v108, v109
buffer_load_dwordx4 v4, s[4:7], s24 offen offset:1056 lds
v_cvt_pk_bf16_f32 v215, v110, v111
v_cvt_pk_bf16_f32 v216, v112, v113
v_cvt_pk_bf16_f32 v217, v114, v115
v_mfma_f32_16x16x32_bf16 v[32:35], a[4:7], v[212:215], v[32:35]
ds_read_b64_tr_b16 v[146:147], v59 offset:0
v_cvt_pk_bf16_f32 v218, v116, v117
v_cvt_pk_bf16_f32 v219, v118, v119
v_cvt_pk_bf16_f32 v220, v120, v121
v_cvt_pk_bf16_f32 v221, v122, v123
v_mfma_f32_16x16x32_bf16 v[32:35], a[8:11], v[216:219], v[32:35]
ds_read_b64_tr_b16 v[152:153], v58 offset:2048
buffer_load_dwordx4 v3, s[8:11], s24 offen offset:2080 lds
v_cvt_pk_bf16_f32 v222, v124, v125
v_cvt_pk_bf16_f32 v223, v126, v127
v_add_u32 v2, s31, v2
ds_read_b64_tr_b16 a[64:65], v2 offset:0
v_mfma_f32_16x16x32_bf16 v[32:35], a[12:15], v[220:223], v[32:35]
s_waitcnt vmcnt(15)
ds_read_b64_tr_b16 a[66:67], v2 offset:512
ds_read_b64_tr_b16 a[68:69], v2 offset:32
ds_read_b64_tr_b16 a[70:71], v2 offset:544
ds_read_b64_tr_b16 a[72:73], v2 offset:64
ds_read_b64_tr_b16 a[74:75], v2 offset:576
ds_read_b64_tr_b16 a[76:77], v2 offset:96
v_exp_f32 v24, v24
buffer_load_dwordx4 v4, s[8:11], s24 offen offset:3136 lds
ds_read_b64_tr_b16 a[78:79], v2 offset:608
ds_read_b64_tr_b16 a[80:81], v2 offset:128
ds_read_b64_tr_b16 a[82:83], v2 offset:640
ds_read_b64_tr_b16 a[84:85], v2 offset:160
ds_read_b64_tr_b16 a[86:87], v2 offset:672
v_exp_f32 v25, v25
ds_read_b64_tr_b16 a[88:89], v2 offset:192
ds_read_b64_tr_b16 a[90:91], v2 offset:704
v_exp_f32 v26, v26
ds_read_b64_tr_b16 v[154:155], v59 offset:2048
s_waitcnt lgkmcnt(15)
buffer_store_dwordx4 v[128:131], v6, s[12:15], s84 offen offset:0 sc1
s_nop 1
v_mfma_f32_16x16x32_bf16 v[128:131], a[146:149], v[224:227], 0
s_sub_u32 s30, s30, 1
v_exp_f32 v27, v27
v_mfma_f32_16x16x32_bf16 v[128:131], a[150:153], v[224:227], v[128:131]
s_cselect_b32 s31, s35, s34
ds_read_b32 v11, v9
ds_add_u32 v8, v10
ds_read_b64_tr_b16 a[92:93], v2 offset:224
ds_read_b64_tr_b16 a[94:95], v2 offset:736
buffer_store_dwordx4 v[136:139], v6, s[12:15], s85 offen offset:0 sc1
s_nop 1
v_mfma_f32_16x16x32_bf16 v[136:139], a[146:149], v[228:231], 0
s_cselect_b32 s30, 7, s30
v_mov_b32 v42, 0
v_mov_b32 v43, 0
v_mfma_f32_16x16x32_bf16 v[136:139], a[150:153], v[228:231], v[136:139]
s_add_u32 m0, m0, s34
v_cvt_pk_bf16_f32 v40, v24, v25
v_cvt_pk_bf16_f32 v41, v26, v27
v_cvt_pk_bf16_f32 v224, v128, v129
v_cvt_pk_bf16_f32 v225, v130, v131
s_waitcnt lgkmcnt(15)
v_mfma_f32_16x16x32_bf16 v[64:67], v[40:43], a[64:67], 0
s_cmp_eq_u32 m0, s29
buffer_store_dwordx4 v[144:147], v6, s[12:15], s84 offen offset:128 sc1
v_mfma_f32_16x16x32_bf16 v[68:71], v[40:43], a[68:71], 0
s_cselect_b32 m0, s28, m0
v_cvt_pk_bf16_f32 v226, v132, v133
v_cvt_pk_bf16_f32 v227, v134, v135
s_waitcnt lgkmcnt(13)
v_mfma_f32_16x16x32_bf16 v[72:75], v[40:43], a[72:75], 0
s_add_u32 s24, s24, s25
v_cvt_pk_bf16_f32 v228, v136, v137
v_cvt_pk_bf16_f32 v229, v138, v139
s_waitcnt lgkmcnt(11)
v_mfma_f32_16x16x32_bf16 v[76:79], v[40:43], a[76:79], 0
s_waitcnt lgkmcnt(4)
buffer_store_dwordx4 v[152:155], v6, s[12:15], s85 offen offset:128 sc1
v_mfma_f32_16x16x32_bf16 v[80:83], v[40:43], a[80:83], 0
ds_read_b128 a[16:19], v1 offset:512
v_cvt_pk_bf16_f32 v230, v140, v141
v_mfma_f32_16x16x32_bf16 v[84:87], v[40:43], a[84:87], 0
ds_read_b128 a[20:23], v1 offset:576
v_cvt_pk_bf16_f32 v231, v142, v143
v_mfma_f32_16x16x32_bf16 v[88:91], v[40:43], a[88:91], 0
ds_read_b128 a[24:27], v1 offset:640
v_exp_f32 v32, v32
v_mfma_f32_16x16x32_bf16 v[144:147], a[146:149], v[232:235], 0
ds_read_b128 a[28:31], v1 offset:704
v_exp_f32 v33, v33
s_waitcnt lgkmcnt(4)
v_mfma_f32_16x16x32_bf16 v[92:95], v[40:43], a[92:95], 0
buffer_load_dwordx4 v3, s[4:7], s24 offen lds
v_mfma_f32_16x16x32_bf16 v[144:147], a[150:153], v[232:235], v[144:147]
v_cvt_pk_bf16_f32 v234, v148, v149
v_cvt_pk_bf16_f32 v235, v150, v151
v_mfma_f32_16x16x32_bf16 v[152:155], a[146:149], v[236:239], 0
buffer_load_dwordx4 v4, s[4:7], s24 offen offset:1056 lds
v_mfma_f32_16x16x32_bf16 a[132:135], a[128:131], v[40:43], 0
s_nop 2
v_cvt_pk_bf16_f32 v232, v144, v145
v_cvt_pk_bf16_f32 v233, v146, v147
v_mfma_f32_16x16x32_bf16 v[152:155], a[150:153], v[236:239], v[152:155]
v_cvt_pk_bf16_f32 v238, v156, v157
v_cvt_pk_bf16_f32 v239, v158, v159
v_mfma_f32_16x16x32_bf16 v[24:27], a[0:3], v[224:227], v[16:19]
v_exp_f32 v34, v34
v_mfma_f32_16x16x32_bf16 v[24:27], a[4:7], v[228:231], v[24:27]
buffer_load_dwordx4 v3, s[8:11], s24 offen offset:2080 lds
v_mfma_f32_16x16x32_bf16 v[24:27], a[8:11], v[232:235], v[24:27]
s_nop 0
v_cvt_pk_bf16_f32 v236, v152, v153
v_cvt_pk_bf16_f32 v237, v154, v155
v_exp_f32 v35, v35
s_nop 0
v_mfma_f32_16x16x32_bf16 v[24:27], a[12:15], v[236:239], v[24:27]
v_cmp_gt_u32 vcc, s33, v11
v_mov_b32 v46, 0
v_mov_b32 v47, 0
v_cvt_pk_bf16_f32 v44, v32, v33
v_cvt_pk_bf16_f32 v45, v34, v35
v_add_u32 v1, s31, v1
s_cbranch_vccnz L_spin_31
L_spinret_32:
v_mfma_f32_16x16x32_bf16 v[96:99], v[44:47], a[64:67], 0
s_add_u32 s33, s33, 1
ds_read_b128 a[32:35], v1 offset:0
ds_read_b128 a[36:39], v1 offset:64
v_mfma_f32_16x16x32_bf16 v[100:103], v[44:47], a[68:71], 0
ds_read_b128 a[40:43], v1 offset:128
v_exp_f32 v24, v24
v_mfma_f32_16x16x32_bf16 v[104:107], v[44:47], a[72:75], 0
ds_read_b128 a[44:47], v1 offset:192
v_exp_f32 v25, v25
v_mfma_f32_16x16x32_bf16 v[108:111], v[44:47], a[76:79], 0
ds_read_b128 a[60:63], v1 offset:704
ds_read_b128 a[56:59], v1 offset:640
v_mfma_f32_16x16x32_bf16 v[112:115], v[44:47], a[80:83], 0
buffer_load_dwordx4 v4, s[8:11], s24 offen offset:3136 lds
v_mfma_f32_16x16x32_bf16 v[116:119], v[44:47], a[84:87], 0
s_add_u32 m0, m0, s34
ds_read_b128 a[52:55], v1 offset:576
ds_read_b128 a[48:51], v1 offset:512
v_mfma_f32_16x16x32_bf16 v[120:123], v[44:47], a[88:91], 0
s_cmp_eq_u32 m0, s29
ds_read_b32 v11, v9
v_exp_f32 v26, v26
v_mfma_f32_16x16x32_bf16 v[124:127], v[44:47], a[92:95], 0
s_cselect_b32 m0, s28, m0
v_exp_f32 v27, v27
v_mfma_f32_16x16x32_bf16 a[136:139], a[128:131], v[44:47], 0
s_add_u32 s24, s24, s25
v_cvt_pk_bf16_f32 v40, v24, v25
v_cvt_pk_bf16_f32 v41, v26, v27
s_waitcnt lgkmcnt(8)
v_mfma_f32_16x16x32_bf16 v[32:35], a[32:35], v[192:195], 0
buffer_load_dwordx4 v3, s[4:7], s24 offen lds
s_waitcnt lgkmcnt(7)
v_mfma_f32_16x16x32_bf16 v[32:35], a[36:39], v[196:199], v[32:35]
v_add_u32 v2, s31, v2
ds_read_b64_tr_b16 a[96:97], v2 offset:0
s_waitcnt lgkmcnt(7)
v_mfma_f32_16x16x32_bf16 v[32:35], a[40:43], v[200:203], v[32:35]
s_sub_u32 s30, s30, 1
ds_read_b64_tr_b16 a[98:99], v2 offset:512
ds_read_b64_tr_b16 a[100:101], v2 offset:32
s_waitcnt lgkmcnt(8)
v_mfma_f32_16x16x32_bf16 v[32:35], a[44:47], v[204:207], v[32:35]
s_cselect_b32 s31, s35, s34
ds_read_b64_tr_b16 a[102:103], v2 offset:544
ds_read_b64_tr_b16 a[104:105], v2 offset:64
s_waitcnt lgkmcnt(9)
v_mfma_f32_16x16x32_bf16 v[36:39], a[60:63], v[204:207], 0
s_cselect_b32 s30, 7, s30
ds_read_b64_tr_b16 a[106:107], v2 offset:576
ds_read_b64_tr_b16 a[108:109], v2 offset:96
s_waitcnt lgkmcnt(10)
v_mfma_f32_16x16x32_bf16 v[36:39], a[56:59], v[200:203], v[36:39]
ds_read_b64_tr_b16 a[110:111], v2 offset:608
ds_read_b64_tr_b16 a[112:113], v2 offset:128
s_waitcnt lgkmcnt(11)
v_mfma_f32_16x16x32_bf16 v[36:39], a[52:55], v[196:199], v[36:39]
ds_read_b64_tr_b16 a[114:115], v2 offset:640
ds_read_b64_tr_b16 a[116:117], v2 offset:160
s_waitcnt lgkmcnt(12)
v_mfma_f32_16x16x32_bf16 v[36:39], a[48:51], v[192:195], v[36:39]
ds_read_b64_tr_b16 a[118:119], v2 offset:672
ds_read_b64_tr_b16 a[120:121], v2 offset:192
v_mfma_f32_16x16x32_bf16 v[128:131], v[40:43], a[64:67], 0
ds_read_b64_tr_b16 a[122:123], v2 offset:704
ds_read_b64_tr_b16 a[124:125], v2 offset:224
v_mfma_f32_16x16x32_bf16 v[132:135], v[40:43], a[68:71], 0
ds_read_b64_tr_b16 a[126:127], v2 offset:736
buffer_load_dwordx4 v4, s[4:7], s24 offen offset:1056 lds
v_mfma_f32_16x16x32_bf16 v[136:139], v[40:43], a[72:75], 0
s_waitcnt lgkmcnt(15)
v_cmp_gt_u32 vcc, s33, v11
v_exp_f32 v32, v32
v_mfma_f32_16x16x32_bf16 v[140:143], v[40:43], a[76:79], 0
buffer_load_dwordx4 v3, s[8:11], s24 offen offset:2080 lds
v_mfma_f32_16x16x32_bf16 v[144:147], v[40:43], a[80:83], 0
v_exp_f32 v33, v33
v_mfma_f32_16x16x32_bf16 v[148:151], v[40:43], a[84:87], 0
v_exp_f32 v34, v34
v_mfma_f32_16x16x32_bf16 v[152:155], v[40:43], a[88:91], 0
v_exp_f32 v35, v35
v_mfma_f32_16x16x32_bf16 v[156:159], v[40:43], a[92:95], 0
buffer_load_dwordx4 v4, s[8:11], s24 offen offset:3136 lds
v_mfma_f32_16x16x32_bf16 a[140:143], a[128:131], v[40:43], 0
s_add_u32 m0, m0, s34
s_cmp_eq_u32 m0, s29
v_exp_f32 v36, v36
s_cselect_b32 m0, s28, m0
s_add_u32 s24, s24, s25
v_add_u32 v1, s31, v1
v_add_u32 v2, s31, v2
v_cvt_pk_bf16_f32 v44, v32, v33
v_cvt_pk_bf16_f32 v45, v34, v35
s_waitcnt lgkmcnt(0)
s_cbranch_vccnz L_spin_33
L_spinret_34:
s_branch L_loop3
L_t3_0_4:
v_mfma_f32_16x16x32_bf16 v[32:35], a[0:3], v[208:211], 0
s_waitcnt vmcnt(16)
buffer_load_dwordx4 v3, s[4:7], s24 offen lds
buffer_load_dwordx4 v4, s[4:7], s24 offen offset:1056 lds
buffer_load_dwordx4 v3, s[8:11], s24 offen offset:2080 lds
s_add_u32 s33, s33, 1
v_mfma_f32_16x16x32_bf16 v[32:35], a[4:7], v[212:215], v[32:35]
s_mov_b32 s14, s47
v_add_u32 v17, v1, v7
ds_read_b128 v[192:195], v17 offset:0
ds_read_b128 v[196:199], v17 offset:64
ds_read_b128 v[200:203], v17 offset:128
ds_read_b128 v[204:207], v17 offset:192
v_exp_f32 v29, v29
v_mfma_f32_16x16x32_bf16 v[32:35], a[8:11], v[216:219], v[32:35]
s_add_u32 s80, s46, 0
buffer_load_dwordx4 v4, s[8:11], s24 offen offset:3136 lds
s_add_u32 m0, m0, s34
v_mfma_f32_16x16x32_bf16 v[32:35], a[12:15], v[220:223], v[32:35]
s_cmp_eq_u32 m0, s29
s_cselect_b32 m0, s28, m0
s_add_u32 s24, s24, s25
v_mfma_f32_16x16x32_bf16 v[36:39], a[28:31], v[220:223], 0
s_add_u32 s81, s46, 131072
v_exp_f32 v30, v30
v_mfma_f32_16x16x32_bf16 v[36:39], a[24:27], v[216:219], v[36:39]
s_add_u32 s82, s46, 262144
v_exp_f32 v31, v31
v_mfma_f32_16x16x32_bf16 v[36:39], a[20:23], v[212:215], v[36:39]
s_sub_u32 s30, s30, 1
v_cvt_pk_bf16_f32 v42, v28, v29
v_cvt_pk_bf16_f32 v43, v30, v31
v_mfma_f32_16x16x32_bf16 v[36:39], a[16:19], v[208:211], v[36:39]
s_cselect_b32 s31, s35, s34
v_exp_f32 v32, v32
v_mfma_f32_16x16x32_bf16 a[132:135], a[128:131], v[40:43], a[132:135]
s_cselect_b32 s30, 7, s30
v_exp_f32 v33, v33
v_mfma_f32_16x16x32_bf16 v[64:67], v[40:43], a[64:67], v[64:67]
s_add_u32 s83, s46, 393216
v_exp_f32 v34, v34
v_mfma_f32_16x16x32_bf16 v[68:71], v[40:43], a[68:71], v[68:71]
s_add_u32 s84, s46, 524288
v_exp_f32 v35, v35
v_mfma_f32_16x16x32_bf16 v[72:75], v[40:43], a[72:75], v[72:75]
s_add_u32 s85, s46, 655360
v_accvgpr_read_b32 v16, a132
v_rcp_f32 v13, v16
v_mfma_f32_16x16x32_bf16 v[76:79], v[40:43], a[76:79], v[76:79]
s_lshr_b32 s77, s43, 12
ds_write_b32 v60, v13
ds_read_b128 v[52:55], v61
v_exp_f32 v36, v36
v_mfma_f32_16x16x32_bf16 v[80:83], v[40:43], a[80:83], v[80:83]
s_lshr_b32 s78, s42, 12
v_exp_f32 v37, v37
v_mfma_f32_16x16x32_bf16 v[84:87], v[40:43], a[84:87], v[84:87]
s_sub_u32 s77, s77, s78
v_exp_f32 v38, v38
v_mfma_f32_16x16x32_bf16 v[88:91], v[40:43], a[88:91], v[88:91]
s_lshl_b32 s78, s45, 5
v_exp_f32 v39, v39
v_mfma_f32_16x16x32_bf16 v[92:95], v[40:43], a[92:95], v[92:95]
s_sub_u32 s77, s77, s78
v_cvt_pk_bf16_f32 v44, v32, v33
v_cvt_pk_bf16_f32 v45, v34, v35
v_mfma_f32_16x16x32_bf16 v[24:27], a[0:3], v[224:227], 0
s_add_u32 s50, s77, 32
v_cvt_pk_bf16_f32 v46, v36, v37
v_cvt_pk_bf16_f32 v47, v38, v39
v_mfma_f32_16x16x32_bf16 v[24:27], a[4:7], v[228:231], v[24:27]
s_sub_u32 s26, s26, 1
v_max3_u32 v12, v12, v16, v13
v_add_u32 v1, s31, v1
v_mfma_f32_16x16x32_bf16 v[24:27], a[8:11], v[232:235], v[24:27]
s_sub_u32 s26, s26, 1
v_add_u32 v19, v1, v7
v_add_u32 v2, s31, v2
v_mfma_f32_16x16x32_bf16 v[24:27], a[12:15], v[236:239], v[24:27]
s_sub_u32 s30, s30, 1
s_cselect_b32 s31, s35, s34
s_cselect_b32 s30, 7, s30
v_mfma_f32_16x16x32_bf16 v[28:31], a[28:31], v[236:239], 0
s_sub_u32 s26, s26, 1
v_add_u32 v1, s31, v1
v_add_u32 v2, s31, v2
v_mfma_f32_16x16x32_bf16 v[28:31], a[24:27], v[232:235], v[28:31]
s_sub_u32 s30, s30, 1
s_waitcnt lgkmcnt(0)
v_pk_mul_f32 v[64:65], v[64:65], v[52:53]
v_pk_mul_f32 v[68:69], v[68:69], v[52:53]
v_pk_mul_f32 v[80:81], v[80:81], v[52:53]
v_pk_mul_f32 v[84:85], v[84:85], v[52:53]
v_pk_mul_f32 v[66:67], v[66:67], v[54:55]
v_pk_mul_f32 v[70:71], v[70:71], v[54:55]
v_pk_mul_f32 v[82:83], v[82:83], v[54:55]
v_pk_mul_f32 v[86:87], v[86:87], v[54:55]
v_pk_mul_f32 v[72:73], v[72:73], v[52:53]
v_pk_mul_f32 v[76:77], v[76:77], v[52:53]
v_pk_mul_f32 v[88:89], v[88:89], v[52:53]
v_pk_mul_f32 v[92:93], v[92:93], v[52:53]
v_pk_mul_f32 v[74:75], v[74:75], v[54:55]
v_pk_mul_f32 v[78:79], v[78:79], v[54:55]
v_pk_mul_f32 v[90:91], v[90:91], v[54:55]
v_pk_mul_f32 v[94:95], v[94:95], v[54:55]
v_mfma_f32_16x16x32_bf16 v[28:31], a[20:23], v[228:231], v[28:31]
s_waitcnt vmcnt(16)
v_cvt_pk_bf16_f32 v64, v64, v68
v_cvt_pk_bf16_f32 v80, v80, v84
v_mfma_f32_16x16x32_bf16 v[28:31], a[16:19], v[224:227], v[28:31]
s_cselect_b32 s31, s35, s34
v_cvt_pk_bf16_f32 v66, v66, v70
v_cvt_pk_bf16_f32 v82, v82, v86
v_mfma_f32_16x16x32_bf16 a[136:139], a[128:131], v[44:47], a[136:139]
s_cselect_b32 s30, 7, s30
v_cvt_pk_bf16_f32 v68, v65, v69
v_cvt_pk_bf16_f32 v84, v81, v85
v_mfma_f32_16x16x32_bf16 v[96:99], v[44:47], a[64:67], v[96:99]
s_sub_u32 s26, s26, 1
v_cvt_pk_bf16_f32 v70, v67, v71
v_cvt_pk_bf16_f32 v86, v83, v87
v_mfma_f32_16x16x32_bf16 v[100:103], v[44:47], a[68:71], v[100:103]
s_sub_u32 s26, s26, 1
v_cvt_pk_bf16_f32 v65, v72, v76
v_cvt_pk_bf16_f32 v69, v73, v77
v_mfma_f32_16x16x32_bf16 v[104:107], v[44:47], a[72:75], v[104:107]
s_mov_b32 s49, s45
v_cvt_pk_bf16_f32 v81, v88, v92
v_cvt_pk_bf16_f32 v85, v89, v93
v_mfma_f32_16x16x32_bf16 v[108:111], v[44:47], a[76:79], v[108:111]
s_sub_u32 s26, s26, 1
v_cvt_pk_bf16_f32 v67, v74, v78
v_cvt_pk_bf16_f32 v71, v75, v79
v_mfma_f32_16x16x32_bf16 v[112:115], v[44:47], a[80:83], v[112:115]
s_mov_b32 s46, s41
v_cvt_pk_bf16_f32 v83, v90, v94
v_cvt_pk_bf16_f32 v87, v91, v95
v_mfma_f32_16x16x32_bf16 v[116:119], v[44:47], a[84:87], v[116:119]
s_mov_b32 s47, s43
ds_write2_b64 v5, v[64:65], v[80:81] offset0:0 offset1:16
ds_write2_b64 v0, v[68:69], v[84:85] offset0:32 offset1:48
v_accvgpr_read_b32 v18, a136
v_mfma_f32_16x16x32_bf16 v[120:123], v[44:47], a[88:91], v[120:123]
s_mov_b32 s73, 0
v_rcp_f32 v13, v18
v_mfma_f32_16x16x32_bf16 v[124:127], v[44:47], a[92:95], v[124:127]
s_sub_u32 s32, s49, 3
ds_write2_b64 v5, v[66:67], v[82:83] offset0:80 offset1:64
v_exp_f32 v24, v24
v_mfma_f32_16x16x32_bf16 v[76:79], a[144:147], v[196:199], 0
ds_write2_b64 v0, v[70:71], v[86:87] offset0:112 offset1:96
v_exp_f32 v25, v25
v_mfma_f32_16x16x32_bf16 v[68:71], a[144:147], v[192:195], 0
v_exp_f32 v26, v26
v_mfma_f32_16x16x32_bf16 v[68:71], a[148:151], v[192:195], v[68:71]
ds_read_b64_tr_b16 v[64:65], v56 offset:0
ds_read_b64_tr_b16 v[66:67], v57 offset:0
v_exp_f32 v27, v27
v_mfma_f32_16x16x32_bf16 v[76:79], a[148:151], v[196:199], v[76:79]
ds_read_b64_tr_b16 v[72:73], v56 offset:2048
ds_read_b64_tr_b16 v[74:75], v57 offset:2048
ds_read_b64_tr_b16 v[80:81], v58 offset:0
ds_read_b64_tr_b16 v[82:83], v59 offset:0
v_exp_f32 v28, v28
v_mfma_f32_16x16x32_bf16 v[84:87], a[144:147], v[200:203], 0
ds_write_b32 v60, v13
ds_read_b128 v[240:243], v61
v_exp_f32 v29, v29
v_mfma_f32_16x16x32_bf16 v[84:87], a[148:151], v[200:203], v[84:87]
ds_read_b64_tr_b16 v[88:89], v58 offset:2048
ds_read_b64_tr_b16 v[90:91], v59 offset:2048
s_waitcnt vmcnt(12)
v_mfma_f32_16x16x32_bf16 v[92:95], a[144:147], v[204:207], 0
ds_read_b128 v[208:211], v19 offset:0
ds_read_b128 v[212:215], v19 offset:64
v_exp_f32 v30, v30
v_mfma_f32_16x16x32_bf16 v[92:95], a[148:151], v[204:207], v[92:95]
ds_read_b128 v[216:219], v19 offset:128
v_exp_f32 v31, v31
ds_read_b128 v[220:223], v19 offset:192
v_cvt_pk_bf16_f32 v40, v24, v25
v_cvt_pk_bf16_f32 v41, v26, v27
v_cvt_pk_bf16_f32 v42, v28, v29
v_cvt_pk_bf16_f32 v43, v30, v31
v_max3_u32 v12, v12, v18, v13
v_add_u32 v21, v1, v7
v_mfma_f32_16x16x32_bf16 a[140:143], a[128:131], v[40:43], a[140:143]
s_waitcnt lgkmcnt(12)
buffer_store_dwordx4 v[64:67], v6, s[12:15], s80 offen offset:0 sc1
s_waitcnt lgkmcnt(10)
buffer_store_dwordx4 v[72:75], v6, s[12:15], s81 offen offset:0 sc1
s_waitcnt lgkmcnt(8)
buffer_store_dwordx4 v[80:83], v6, s[12:15], s80 offen offset:128 sc1
s_waitcnt lgkmcnt(6)
v_pk_mul_f32 v[96:97], v[96:97], v[240:241]
v_pk_mul_f32 v[100:101], v[100:101], v[240:241]
v_pk_mul_f32 v[112:113], v[112:113], v[240:241]
v_pk_mul_f32 v[116:117], v[116:117], v[240:241]
v_pk_mul_f32 v[98:99], v[98:99], v[242:243]
v_pk_mul_f32 v[102:103], v[102:103], v[242:243]
v_pk_mul_f32 v[114:115], v[114:115], v[242:243]
v_pk_mul_f32 v[118:119], v[118:119], v[242:243]
v_pk_mul_f32 v[104:105], v[104:105], v[240:241]
v_pk_mul_f32 v[108:109], v[108:109], v[240:241]
v_pk_mul_f32 v[120:121], v[120:121], v[240:241]
v_pk_mul_f32 v[124:125], v[124:125], v[240:241]
v_pk_mul_f32 v[106:107], v[106:107], v[242:243]
v_pk_mul_f32 v[110:111], v[110:111], v[242:243]
v_pk_mul_f32 v[122:123], v[122:123], v[242:243]
v_pk_mul_f32 v[126:127], v[126:127], v[242:243]
v_mfma_f32_16x16x32_bf16 v[128:131], v[40:43], a[64:67], v[128:131]
s_waitcnt lgkmcnt(4)
buffer_store_dwordx4 v[88:91], v6, s[12:15], s81 offen offset:128 sc1
v_cvt_pk_bf16_f32 v96, v96, v100
v_mfma_f32_16x16x32_bf16 v[132:135], v[40:43], a[68:71], v[132:135]
v_cvt_pk_bf16_f32 v112, v112, v116
v_cvt_pk_bf16_f32 v98, v98, v102
v_mfma_f32_16x16x32_bf16 v[136:139], v[40:43], a[72:75], v[136:139]
v_cvt_pk_bf16_f32 v114, v114, v118
v_cvt_pk_bf16_f32 v100, v97, v101
v_mfma_f32_16x16x32_bf16 v[140:143], v[40:43], a[76:79], v[140:143]
v_cvt_pk_bf16_f32 v116, v113, v117
v_cvt_pk_bf16_f32 v102, v99, v103
v_mfma_f32_16x16x32_bf16 v[144:147], v[40:43], a[80:83], v[144:147]
v_cvt_pk_bf16_f32 v118, v115, v119
v_cvt_pk_bf16_f32 v97, v104, v108
v_mfma_f32_16x16x32_bf16 v[148:151], v[40:43], a[84:87], v[148:151]
v_cvt_pk_bf16_f32 v101, v105, v109
v_cvt_pk_bf16_f32 v113, v120, v124
v_mfma_f32_16x16x32_bf16 v[152:155], v[40:43], a[88:91], v[152:155]
ds_write2_b64 v5, v[96:97], v[112:113] offset0:0 offset1:16
v_cvt_pk_bf16_f32 v117, v121, v125
v_mfma_f32_16x16x32_bf16 v[156:159], v[40:43], a[92:95], v[156:159]
ds_write2_b64 v0, v[100:101], v[116:117] offset0:32 offset1:48
v_cvt_pk_bf16_f32 v99, v106, v110
v_mfma_f32_16x16x32_bf16 v[64:67], a[146:149], v[192:195], 0
v_cvt_pk_bf16_f32 v103, v107, v111
v_cvt_pk_bf16_f32 v115, v122, v126
v_mfma_f32_16x16x32_bf16 v[64:67], a[150:153], v[192:195], v[64:67]
ds_write2_b64 v5, v[98:99], v[114:115] offset0:80 offset1:64
s_waitcnt vmcnt(12)
v_mfma_f32_16x16x32_bf16 v[72:75], a[146:149], v[196:199], 0
v_cvt_pk_bf16_f32 v119, v123, v127
ds_write2_b64 v0, v[102:103], v[118:119] offset0:112 offset1:96
v_accvgpr_read_b32 v20, a140
v_mfma_f32_16x16x32_bf16 v[72:75], a[150:153], v[196:199], v[72:75]
v_rcp_f32 v13, v20
v_mfma_f32_16x16x32_bf16 v[80:83], a[146:149], v[200:203], 0
ds_read_b64_tr_b16 v[96:97], v56 offset:0
ds_read_b64_tr_b16 v[98:99], v57 offset:0
ds_read_b64_tr_b16 v[104:105], v56 offset:2048
ds_read_b64_tr_b16 v[106:107], v57 offset:2048
v_add_u32 v1, s31, v1
v_mfma_f32_16x16x32_bf16 v[80:83], a[150:153], v[200:203], v[80:83]
ds_read_b64_tr_b16 v[112:113], v58 offset:0
ds_read_b64_tr_b16 v[114:115], v59 offset:0
ds_read_b64_tr_b16 v[120:121], v58 offset:2048
v_add_u32 v2, s31, v2
v_mfma_f32_16x16x32_bf16 v[88:91], a[146:149], v[204:207], 0
s_sub_u32 s30, s30, 1
ds_read_b64_tr_b16 v[122:123], v59 offset:2048
ds_write_b32 v60, v13
ds_read_b128 v[52:55], v61
v_add_u32 v23, v1, v7
v_mfma_f32_16x16x32_bf16 v[88:91], a[150:153], v[204:207], v[88:91]
s_cselect_b32 s31, s35, s34
v_add_u32 v1, s31, v1
ds_read_b128 v[224:227], v21 offset:0
v_max3_u32 v12, v12, v20, v13
s_waitcnt lgkmcnt(15)
v_mfma_f32_16x16x32_bf16 v[100:103], a[144:147], v[208:211], 0
s_cselect_b32 s30, 7, s30
ds_read_b128 v[228:231], v21 offset:64
v_mbcnt_lo_u32_b32 v13, -1, 0
v_mfma_f32_16x16x32_bf16 v[100:103], a[148:151], v[208:211], v[100:103]
s_waitcnt vmcnt(8)
ds_add_u32 v8, v10
ds_read_b128 v[232:235], v21 offset:128
v_mbcnt_hi_u32_b32 v13, -1, v13
v_mfma_f32_16x16x32_bf16 v[108:111], a[144:147], v[212:215], 0
ds_read_b128 v[236:239], v21 offset:192
v_lshrrev_b32 v13, 2, v13
v_mfma_f32_16x16x32_bf16 v[108:111], a[148:151], v[212:215], v[108:111]
ds_read_b128 v[240:243], v23 offset:0
s_waitcnt lgkmcnt(14)
buffer_store_dwordx4 v[96:99], v6, s[12:15], s82 offen offset:0 sc1
s_waitcnt lgkmcnt(12)
buffer_store_dwordx4 v[104:107], v6, s[12:15], s83 offen offset:0 sc1
s_waitcnt lgkmcnt(10)
buffer_store_dwordx4 v[112:115], v6, s[12:15], s82 offen offset:128 sc1
s_waitcnt lgkmcnt(6)
v_pk_mul_f32 v[128:129], v[128:129], v[52:53]
v_pk_mul_f32 v[132:133], v[132:133], v[52:53]
v_pk_mul_f32 v[144:145], v[144:145], v[52:53]
v_pk_mul_f32 v[148:149], v[148:149], v[52:53]
v_pk_mul_f32 v[130:131], v[130:131], v[54:55]
v_pk_mul_f32 v[134:135], v[134:135], v[54:55]
v_pk_mul_f32 v[146:147], v[146:147], v[54:55]
v_pk_mul_f32 v[150:151], v[150:151], v[54:55]
v_pk_mul_f32 v[136:137], v[136:137], v[52:53]
v_pk_mul_f32 v[140:141], v[140:141], v[52:53]
v_pk_mul_f32 v[152:153], v[152:153], v[52:53]
v_pk_mul_f32 v[156:157], v[156:157], v[52:53]
v_pk_mul_f32 v[138:139], v[138:139], v[54:55]
v_pk_mul_f32 v[142:143], v[142:143], v[54:55]
v_pk_mul_f32 v[154:155], v[154:155], v[54:55]
v_pk_mul_f32 v[158:159], v[158:159], v[54:55]
v_mfma_f32_16x16x32_bf16 v[96:99], a[146:149], v[208:211], 0
buffer_store_dwordx4 v[120:123], v6, s[12:15], s83 offen offset:128 sc1
v_cvt_pk_bf16_f32 v128, v128, v132
v_mfma_f32_16x16x32_bf16 v[96:99], a[150:153], v[208:211], v[96:99]
v_cvt_pk_bf16_f32 v144, v144, v148
v_cvt_pk_bf16_f32 v130, v130, v134
v_mfma_f32_16x16x32_bf16 v[104:107], a[146:149], v[212:215], 0
v_cvt_pk_bf16_f32 v146, v146, v150
v_cvt_pk_bf16_f32 v132, v129, v133
v_mfma_f32_16x16x32_bf16 v[104:107], a[150:153], v[212:215], v[104:107]
ds_read_b32 v11, v9
v_cvt_pk_bf16_f32 v148, v145, v149
v_mfma_f32_16x16x32_bf16 v[112:115], a[146:149], v[216:219], 0
v_cvt_pk_bf16_f32 v134, v131, v135
v_cvt_pk_bf16_f32 v150, v147, v151
v_mfma_f32_16x16x32_bf16 v[116:119], a[144:147], v[216:219], 0
v_cvt_pk_bf16_f32 v129, v136, v140
v_cvt_pk_bf16_f32 v133, v137, v141
v_mfma_f32_16x16x32_bf16 v[112:115], a[150:153], v[216:219], v[112:115]
v_cvt_pk_bf16_f32 v145, v152, v156
v_cvt_pk_bf16_f32 v149, v153, v157
v_mfma_f32_16x16x32_bf16 v[116:119], a[148:151], v[216:219], v[116:119]
ds_write2_b64 v5, v[128:129], v[144:145] offset0:0 offset1:16
v_cvt_pk_bf16_f32 v131, v138, v142
v_mfma_f32_16x16x32_bf16 v[120:123], a[146:149], v[220:223], 0
ds_write2_b64 v0, v[132:133], v[148:149] offset0:32 offset1:48
v_cvt_pk_bf16_f32 v135, v139, v143
v_mfma_f32_16x16x32_bf16 v[124:127], a[144:147], v[220:223], 0
v_cvt_pk_bf16_f32 v147, v154, v158
v_cvt_pk_bf16_f32 v151, v155, v159
v_mfma_f32_16x16x32_bf16 v[120:123], a[150:153], v[220:223], v[120:123]
ds_write2_b64 v5, v[130:131], v[146:147] offset0:80 offset1:64
s_waitcnt lgkmcnt(3)
v_cmp_gt_u32 vcc, s33, v11
v_mfma_f32_16x16x32_bf16 v[124:127], a[148:151], v[220:223], v[124:127]
ds_write2_b64 v0, v[134:135], v[150:151] offset0:112 offset1:96
s_cbranch_vccnz L_spin_35
L_spinret_36:
v_mfma_f32_16x16x32_bf16 v[132:135], a[144:147], v[224:227], 0
s_add_u32 s33, s33, 1
buffer_load_dwordx4 v3, s[4:7], s24 offen lds
buffer_load_dwordx4 v4, s[4:7], s24 offen offset:1056 lds
buffer_load_dwordx4 v3, s[8:11], s24 offen offset:2080 lds
ds_read_b64_tr_b16 v[128:129], v56 offset:0
ds_read_b64_tr_b16 v[130:131], v57 offset:0
ds_read_b64_tr_b16 v[136:137], v56 offset:2048
ds_read_b64_tr_b16 v[138:139], v57 offset:2048
ds_read_b64_tr_b16 v[144:145], v58 offset:0
v_and_b32 v13, 12, v13
v_mfma_f32_16x16x32_bf16 v[132:135], a[148:151], v[224:227], v[132:135]
ds_read_b64_tr_b16 v[146:147], v59 offset:0
ds_read_b64_tr_b16 v[152:153], v58 offset:2048
buffer_load_dwordx4 v4, s[8:11], s24 offen offset:3136 lds
s_add_u32 m0, m0, s34
v_mfma_f32_16x16x32_bf16 v[140:143], a[144:147], v[228:231], 0
s_cmp_eq_u32 m0, s29
s_cselect_b32 m0, s28, m0
s_add_u32 s24, s24, s25
v_mfma_f32_16x16x32_bf16 v[140:143], a[148:151], v[228:231], v[140:143]
ds_read_b64_tr_b16 v[154:155], v59 offset:2048
ds_read_b128 a[0:3], v1 offset:0
ds_read_b128 a[4:7], v1 offset:64
ds_read_b128 a[8:11], v1 offset:128
v_sub_u32 v13, s50, v13
v_mfma_f32_16x16x32_bf16 v[148:151], a[144:147], v[232:235], 0
buffer_load_dwordx4 v3, s[4:7], s24 offen lds
ds_read_b128 a[12:15], v1 offset:192
ds_read_b128 a[28:31], v1 offset:704
v_cvt_f32_i32 v13, v13
v_mfma_f32_16x16x32_bf16 v[148:151], a[148:151], v[232:235], v[148:151]
ds_read_b128 a[24:27], v1 offset:640
v_mov_b32 v14, 0x7c800000
v_mfma_f32_16x16x32_bf16 v[156:159], a[144:147], v[236:239], 0
s_waitcnt vmcnt(13)
ds_read_b128 a[20:23], v1 offset:576
v_fmaak_f32 v16, v13, v14, 0xfc000000
v_mfma_f32_16x16x32_bf16 v[156:159], a[148:151], v[236:239], v[156:159]
ds_read_b128 a[16:19], v1 offset:512
buffer_load_dwordx4 v4, s[4:7], s24 offen offset:1056 lds
v_fmaak_f32 v17, v13, v14, 0xfcc00000
v_mfma_f32_16x16x32_bf16 v[160:163], a[146:149], v[240:243], 0
ds_add_u32 v8, v10
v_fmaak_f32 v18, v13, v14, 0xfd200000
v_mfma_f32_16x16x32_bf16 v[164:167], a[144:147], v[240:243], 0
ds_read_b128 v[244:247], v23 offset:64
v_fmaak_f32 v19, v13, v14, 0xfd600000
v_mfma_f32_16x16x32_bf16 v[160:163], a[150:153], v[240:243], v[160:163]
ds_read_b128 v[248:251], v23 offset:128
v_min_f32 v16, 0, v16
v_mfma_f32_16x16x32_bf16 v[164:167], a[148:151], v[240:243], v[164:167]
buffer_load_dwordx4 v3, s[8:11], s24 offen offset:2080 lds
v_min_f32 v17, 0, v17
v_min_f32 v18, 0, v18
v_min_f32 v19, 0, v19
v_cvt_pk_bf16_f32 v192, v64, v65
v_cvt_pk_bf16_f32 v193, v66, v67
v_cvt_pk_bf16_f32 v194, v68, v69
v_cvt_pk_bf16_f32 v195, v70, v71
v_cvt_pk_bf16_f32 v196, v72, v73
v_cvt_pk_bf16_f32 v197, v74, v75
s_waitcnt lgkmcnt(10)
v_mfma_f32_16x16x32_bf16 v[24:27], a[0:3], v[192:195], v[16:19]
ds_read_b128 v[252:255], v23 offset:192
buffer_load_dwordx4 v4, s[8:11], s24 offen offset:3136 lds
s_add_u32 m0, m0, s34
s_cmp_eq_u32 m0, s29
s_cselect_b32 m0, s28, m0
s_add_u32 s24, s24, s25
v_cvt_pk_bf16_f32 v198, v76, v77
v_cvt_pk_bf16_f32 v199, v78, v79
v_cvt_pk_bf16_f32 v200, v80, v81
v_cvt_pk_bf16_f32 v201, v82, v83
s_waitcnt lgkmcnt(10)
v_mfma_f32_16x16x32_bf16 v[24:27], a[4:7], v[196:199], v[24:27]
v_cvt_pk_bf16_f32 v202, v84, v85
v_cvt_pk_bf16_f32 v203, v86, v87
v_cvt_pk_bf16_f32 v204, v88, v89
v_cvt_pk_bf16_f32 v205, v90, v91
s_waitcnt lgkmcnt(9)
v_mfma_f32_16x16x32_bf16 v[24:27], a[8:11], v[200:203], v[24:27]
buffer_load_dwordx4 v3, s[4:7], s24 offen lds
v_cvt_pk_bf16_f32 v206, v92, v93
s_waitcnt lgkmcnt(2)
v_mfma_f32_16x16x32_bf16 v[168:171], a[146:149], v[244:247], 0
v_cvt_pk_bf16_f32 v207, v94, v95
v_fmaak_f32 v20, v13, v14, 0xfe840000
v_mfma_f32_16x16x32_bf16 v[172:175], a[144:147], v[244:247], 0
v_fmaak_f32 v21, v13, v14, 0xfe8c0000
v_fmaak_f32 v22, v13, v14, 0xfe940000
v_mfma_f32_16x16x32_bf16 v[24:27], a[12:15], v[204:207], v[24:27]
v_fmaak_f32 v23, v13, v14, 0xfe9c0000
buffer_load_dwordx4 v4, s[4:7], s24 offen offset:1056 lds
v_min_f32 v20, 0, v20
v_mfma_f32_16x16x32_bf16 v[168:171], a[150:153], v[244:247], v[168:171]
v_min_f32 v21, 0, v21
v_min_f32 v22, 0, v22
v_mfma_f32_16x16x32_bf16 v[172:175], a[148:151], v[244:247], v[172:175]
v_min_f32 v23, 0, v23
v_cvt_pk_bf16_f32 v208, v96, v97
s_waitcnt lgkmcnt(1)
v_mfma_f32_16x16x32_bf16 v[176:179], a[146:149], v[248:251], 0
v_cvt_pk_bf16_f32 v209, v98, v99
v_cvt_pk_bf16_f32 v210, v100, v101
v_mfma_f32_16x16x32_bf16 v[28:31], a[28:31], v[204:207], v[20:23]
buffer_load_dwordx4 v3, s[8:11], s24 offen offset:2080 lds
v_cvt_pk_bf16_f32 v211, v102, v103
v_mfma_f32_16x16x32_bf16 v[28:31], a[24:27], v[200:203], v[28:31]
v_add_u32 v2, s31, v2
ds_read_b64_tr_b16 a[64:65], v2 offset:0
ds_read_b64_tr_b16 a[66:67], v2 offset:512
v_cvt_pk_bf16_f32 v212, v104, v105
v_mfma_f32_16x16x32_bf16 v[28:31], a[20:23], v[196:199], v[28:31]
s_sub_u32 s30, s30, 1
v_cvt_pk_bf16_f32 v213, v106, v107
v_cvt_pk_bf16_f32 v214, v108, v109
v_mfma_f32_16x16x32_bf16 v[28:31], a[16:19], v[192:195], v[28:31]
s_cselect_b32 s31, s35, s34
buffer_load_dwordx4 v4, s[8:11], s24 offen offset:3136 lds
v_cvt_pk_bf16_f32 v215, v110, v111
v_mfma_f32_16x16x32_bf16 v[32:35], a[0:3], v[208:211], v[16:19]
s_cselect_b32 s30, 7, s30
s_add_u32 m0, m0, s34
s_cmp_eq_u32 m0, s29
v_mfma_f32_16x16x32_bf16 v[32:35], a[4:7], v[212:215], v[32:35]
s_cselect_b32 m0, s28, m0
s_add_u32 s24, s24, s25
ds_read_b64_tr_b16 a[68:69], v2 offset:32
ds_read_b64_tr_b16 a[70:71], v2 offset:544
v_cvt_pk_bf16_f32 v216, v112, v113
v_mfma_f32_16x16x32_bf16 v[180:183], a[144:147], v[248:251], 0
ds_read_b64_tr_b16 a[72:73], v2 offset:64
buffer_load_dwordx4 v3, s[4:7], s24 offen lds
v_cvt_pk_bf16_f32 v217, v114, v115
v_mfma_f32_16x16x32_bf16 v[176:179], a[150:153], v[248:251], v[176:179]
ds_read_b64_tr_b16 a[74:75], v2 offset:576
v_cvt_pk_bf16_f32 v218, v116, v117
v_mfma_f32_16x16x32_bf16 v[180:183], a[148:151], v[248:251], v[180:183]
ds_read_b64_tr_b16 a[76:77], v2 offset:96
v_cvt_pk_bf16_f32 v219, v118, v119
s_waitcnt lgkmcnt(7)
v_mfma_f32_16x16x32_bf16 v[184:187], a[146:149], v[252:255], 0
ds_read_b64_tr_b16 a[78:79], v2 offset:608
v_cvt_pk_bf16_f32 v220, v120, v121
v_mfma_f32_16x16x32_bf16 v[32:35], a[8:11], v[216:219], v[32:35]
buffer_load_dwordx4 v4, s[4:7], s24 offen offset:1056 lds
v_cvt_pk_bf16_f32 v221, v122, v123
v_mfma_f32_16x16x32_bf16 v[188:191], a[144:147], v[252:255], 0
ds_read_b64_tr_b16 a[80:81], v2 offset:128
v_cvt_pk_bf16_f32 v222, v124, v125
v_mfma_f32_16x16x32_bf16 v[184:187], a[150:153], v[252:255], v[184:187]
ds_read_b64_tr_b16 a[82:83], v2 offset:640
v_cvt_pk_bf16_f32 v223, v126, v127
v_mfma_f32_16x16x32_bf16 v[188:191], a[148:151], v[252:255], v[188:191]
ds_read_b64_tr_b16 a[84:85], v2 offset:160
ds_read_b64_tr_b16 a[86:87], v2 offset:672
buffer_store_dwordx4 v[128:131], v6, s[12:15], s84 offen offset:0 sc1
ds_read_b64_tr_b16 a[88:89], v2 offset:192
ds_read_b64_tr_b16 a[90:91], v2 offset:704
v_exp_f32 v24, v24
v_mfma_f32_16x16x32_bf16 v[32:35], a[12:15], v[220:223], v[32:35]
ds_read_b64_tr_b16 a[92:93], v2 offset:224
v_exp_f32 v25, v25
v_mfma_f32_16x16x32_bf16 v[36:39], a[28:31], v[220:223], v[20:23]
buffer_store_dwordx4 v[136:139], v6, s[12:15], s85 offen offset:0 sc1
v_exp_f32 v26, v26
v_mfma_f32_16x16x32_bf16 v[36:39], a[24:27], v[216:219], v[36:39]
ds_read_b64_tr_b16 a[94:95], v2 offset:736
v_exp_f32 v27, v27
v_mfma_f32_16x16x32_bf16 v[36:39], a[20:23], v[212:215], v[36:39]
buffer_store_dwordx4 v[144:147], v6, s[12:15], s84 offen offset:128 sc1
v_exp_f32 v28, v28
v_mfma_f32_16x16x32_bf16 v[36:39], a[16:19], v[208:211], v[36:39]
ds_read_b32 v11, v9
v_exp_f32 v29, v29
v_mfma_f32_16x16x32_bf16 v[128:131], a[146:149], v[224:227], 0
buffer_store_dwordx4 v[152:155], v6, s[12:15], s85 offen offset:128 sc1
v_exp_f32 v30, v30
v_mfma_f32_16x16x32_bf16 v[128:131], a[150:153], v[224:227], v[128:131]
v_exp_f32 v31, v31
v_mfma_f32_16x16x32_bf16 v[136:139], a[146:149], v[228:231], 0
v_cvt_pk_bf16_f32 v40, v24, v25
buffer_load_dwordx4 v3, s[8:11], s24 offen offset:2080 lds
v_cvt_pk_bf16_f32 v41, v26, v27
v_mfma_f32_16x16x32_bf16 v[136:139], a[150:153], v[228:231], v[136:139]
v_cvt_pk_bf16_f32 v42, v28, v29
v_cvt_pk_bf16_f32 v43, v30, v31
v_mfma_f32_16x16x32_bf16 v[144:147], a[146:149], v[232:235], 0
v_cvt_pk_bf16_f32 v224, v128, v129
v_cvt_pk_bf16_f32 v225, v130, v131
s_waitcnt lgkmcnt(15)
v_mfma_f32_16x16x32_bf16 v[64:67], v[40:43], a[64:67], 0
v_cvt_pk_bf16_f32 v226, v132, v133
v_cvt_pk_bf16_f32 v227, v134, v135
s_waitcnt lgkmcnt(13)
v_mfma_f32_16x16x32_bf16 v[68:71], v[40:43], a[68:71], 0
buffer_load_dwordx4 v4, s[8:11], s24 offen offset:3136 lds
s_add_u32 m0, m0, s34
s_waitcnt lgkmcnt(11)
v_mfma_f32_16x16x32_bf16 v[72:75], v[40:43], a[72:75], 0
s_cmp_eq_u32 m0, s29
s_cselect_b32 m0, s28, m0
s_add_u32 s24, s24, s25
s_waitcnt lgkmcnt(9)
v_mfma_f32_16x16x32_bf16 v[76:79], v[40:43], a[76:79], 0
v_cvt_pk_bf16_f32 v228, v136, v137
v_cvt_pk_bf16_f32 v229, v138, v139
s_waitcnt lgkmcnt(7)
v_mfma_f32_16x16x32_bf16 v[80:83], v[40:43], a[80:83], 0
v_cvt_pk_bf16_f32 v230, v140, v141
v_cvt_pk_bf16_f32 v231, v142, v143
s_waitcnt lgkmcnt(5)
v_mfma_f32_16x16x32_bf16 v[84:87], v[40:43], a[84:87], 0
buffer_load_dwordx4 v3, s[4:7], s24 offen lds
v_exp_f32 v32, v32
s_waitcnt lgkmcnt(3)
v_mfma_f32_16x16x32_bf16 v[88:91], v[40:43], a[88:91], 0
v_exp_f32 v33, v33
s_waitcnt lgkmcnt(1)
v_mfma_f32_16x16x32_bf16 v[92:95], v[40:43], a[92:95], 0
v_exp_f32 v34, v34
v_mfma_f32_16x16x32_bf16 v[144:147], a[150:153], v[232:235], v[144:147]
buffer_load_dwordx4 v4, s[4:7], s24 offen offset:1056 lds
v_cvt_pk_bf16_f32 v234, v148, v149
v_mfma_f32_16x16x32_bf16 v[152:155], a[146:149], v[236:239], 0
v_cvt_pk_bf16_f32 v235, v150, v151
v_exp_f32 v35, v35
v_mfma_f32_16x16x32_bf16 a[132:135], a[128:131], v[40:43], 0
s_nop 1
v_cvt_pk_bf16_f32 v232, v144, v145
v_cvt_pk_bf16_f32 v233, v146, v147
v_mfma_f32_16x16x32_bf16 v[152:155], a[150:153], v[236:239], v[152:155]
v_cvt_pk_bf16_f32 v238, v156, v157
v_cvt_pk_bf16_f32 v239, v158, v159
v_mfma_f32_16x16x32_bf16 v[24:27], a[0:3], v[224:227], v[16:19]
buffer_load_dwordx4 v3, s[8:11], s24 offen offset:2080 lds
v_exp_f32 v36, v36
v_mfma_f32_16x16x32_bf16 v[24:27], a[4:7], v[228:231], v[24:27]
s_nop 1
v_cvt_pk_bf16_f32 v236, v152, v153
v_cvt_pk_bf16_f32 v237, v154, v155
v_mfma_f32_16x16x32_bf16 v[24:27], a[8:11], v[232:235], v[24:27]
v_exp_f32 v37, v37
v_mfma_f32_16x16x32_bf16 v[24:27], a[12:15], v[236:239], v[24:27]
v_exp_f32 v38, v38
v_mfma_f32_16x16x32_bf16 v[28:31], a[28:31], v[236:239], v[20:23]
v_exp_f32 v39, v39
v_mfma_f32_16x16x32_bf16 v[28:31], a[24:27], v[232:235], v[28:31]
v_cvt_pk_bf16_f32 v44, v32, v33
v_cvt_pk_bf16_f32 v45, v34, v35
v_mfma_f32_16x16x32_bf16 v[28:31], a[20:23], v[228:231], v[28:31]
v_cvt_pk_bf16_f32 v46, v36, v37
v_cvt_pk_bf16_f32 v47, v38, v39
v_mfma_f32_16x16x32_bf16 v[28:31], a[16:19], v[224:227], v[28:31]
buffer_load_dwordx4 v4, s[8:11], s24 offen offset:3136 lds
v_cvt_pk_bf16_f32 v240, v160, v161
v_mfma_f32_16x16x32_bf16 v[96:99], v[44:47], a[64:67], 0
s_add_u32 m0, m0, s34
v_cvt_pk_bf16_f32 v241, v162, v163
v_cvt_pk_bf16_f32 v242, v164, v165
v_mfma_f32_16x16x32_bf16 v[100:103], v[44:47], a[68:71], 0
s_cmp_eq_u32 m0, s29
v_cvt_pk_bf16_f32 v243, v166, v167
v_mov_b32 v48, v32
v_mfma_f32_16x16x32_bf16 v[104:107], v[44:47], a[72:75], 0
s_cselect_b32 m0, s28, m0
v_mov_b32 v49, v33
v_add_f32 v48, v48, v34
v_mfma_f32_16x16x32_bf16 v[108:111], v[44:47], a[76:79], 0
s_add_u32 s24, s24, s25
v_add_f32 v49, v49, v35
v_cvt_pk_bf16_f32 v244, v168, v169
v_mfma_f32_16x16x32_bf16 v[112:115], v[44:47], a[80:83], 0
v_cvt_pk_bf16_f32 v245, v170, v171
v_cvt_pk_bf16_f32 v246, v172, v173
v_mfma_f32_16x16x32_bf16 v[116:119], v[44:47], a[84:87], 0
v_cvt_pk_bf16_f32 v247, v174, v175
v_cvt_pk_bf16_f32 v248, v176, v177
v_mfma_f32_16x16x32_bf16 v[120:123], v[44:47], a[88:91], 0
v_cvt_pk_bf16_f32 v249, v178, v179
v_cvt_pk_bf16_f32 v250, v180, v181
v_mfma_f32_16x16x32_bf16 v[124:127], v[44:47], a[92:95], 0
v_cvt_pk_bf16_f32 v251, v182, v183
v_cvt_pk_bf16_f32 v252, v184, v185
v_mfma_f32_16x16x32_bf16 v[32:35], a[0:3], v[240:243], v[16:19]
v_cvt_pk_bf16_f32 v253, v186, v187
v_cvt_pk_bf16_f32 v254, v188, v189
v_mfma_f32_16x16x32_bf16 v[32:35], a[4:7], v[244:247], v[32:35]
s_waitcnt vmcnt(20)
ds_add_u32 v8, v10
v_cvt_pk_bf16_f32 v255, v190, v191
v_mfma_f32_16x16x32_bf16 v[32:35], a[8:11], v[248:251], v[32:35]
v_add_f32 v48, v48, v36
v_add_f32 v49, v49, v37
v_mfma_f32_16x16x32_bf16 v[32:35], a[12:15], v[252:255], v[32:35]
v_add_f32 v48, v48, v38
v_add_f32 v49, v49, v39
v_mfma_f32_16x16x32_bf16 v[36:39], a[28:31], v[252:255], v[20:23]
v_exp_f32 v24, v24
v_mfma_f32_16x16x32_bf16 v[36:39], a[24:27], v[248:251], v[36:39]
v_exp_f32 v25, v25
v_mfma_f32_16x16x32_bf16 v[36:39], a[20:23], v[244:247], v[36:39]
v_exp_f32 v26, v26
v_mfma_f32_16x16x32_bf16 v[36:39], a[16:19], v[240:243], v[36:39]
v_exp_f32 v27, v27
v_exp_f32 v28, v28
v_exp_f32 v29, v29
v_exp_f32 v30, v30
v_exp_f32 v31, v31
s_waitcnt lgkmcnt(1)
v_cmp_gt_u32 vcc, s33, v11
v_cvt_pk_bf16_f32 v40, v24, v25
v_cvt_pk_bf16_f32 v41, v26, v27
v_cvt_pk_bf16_f32 v42, v28, v29
v_cvt_pk_bf16_f32 v43, v30, v31
v_add_u32 v1, s31, v1
s_cbranch_vccnz L_spin_37
L_spinret_38:
v_mfma_f32_16x16x32_bf16 v[128:131], v[40:43], a[64:67], 0
s_add_u32 s33, s33, 1
ds_read_b128 a[32:35], v1 offset:0
ds_read_b128 a[36:39], v1 offset:64
ds_read_b128 a[40:43], v1 offset:128
ds_read_b128 a[44:47], v1 offset:192
v_exp_f32 v32, v32
v_mfma_f32_16x16x32_bf16 v[132:135], v[40:43], a[68:71], 0
ds_read_b128 a[60:63], v1 offset:704
v_exp_f32 v33, v33
v_mfma_f32_16x16x32_bf16 v[136:139], v[40:43], a[72:75], 0
ds_read_b128 a[56:59], v1 offset:640
ds_read_b128 a[52:55], v1 offset:576
v_exp_f32 v34, v34
v_mfma_f32_16x16x32_bf16 v[140:143], v[40:43], a[76:79], 0
ds_read_b128 a[48:51], v1 offset:512
v_exp_f32 v35, v35
v_mfma_f32_16x16x32_bf16 v[144:147], v[40:43], a[80:83], 0
v_exp_f32 v36, v36
v_mfma_f32_16x16x32_bf16 v[148:151], v[40:43], a[84:87], 0
ds_read_b32 v11, v9
v_exp_f32 v37, v37
v_mfma_f32_16x16x32_bf16 v[152:155], v[40:43], a[88:91], 0
v_exp_f32 v38, v38
v_mfma_f32_16x16x32_bf16 v[156:159], v[40:43], a[92:95], 0
v_exp_f32 v39, v39
v_mfma_f32_16x16x32_bf16 a[136:139], a[128:131], v[40:43], 0
v_add_u32 v2, s31, v2
ds_read_b64_tr_b16 a[96:97], v2 offset:0
ds_read_b64_tr_b16 a[98:99], v2 offset:512
ds_read_b64_tr_b16 a[100:101], v2 offset:32
ds_read_b64_tr_b16 a[102:103], v2 offset:544
ds_read_b64_tr_b16 a[104:105], v2 offset:64
ds_read_b64_tr_b16 a[106:107], v2 offset:576
ds_read_b64_tr_b16 a[108:109], v2 offset:96
ds_read_b64_tr_b16 a[110:111], v2 offset:608
ds_read_b64_tr_b16 a[112:113], v2 offset:128
ds_read_b64_tr_b16 a[114:115], v2 offset:640
ds_read_b64_tr_b16 a[116:117], v2 offset:160
v_cvt_pk_bf16_f32 v44, v32, v33
s_waitcnt lgkmcnt(15)
v_mfma_f32_16x16x32_bf16 v[24:27], a[32:35], v[192:195], 0
s_sub_u32 s30, s30, 1
ds_read_b64_tr_b16 a[118:119], v2 offset:672
ds_read_b64_tr_b16 a[120:121], v2 offset:192
ds_read_b64_tr_b16 a[122:123], v2 offset:704
v_cvt_pk_bf16_f32 v45, v34, v35
v_mfma_f32_16x16x32_bf16 v[24:27], a[36:39], v[196:199], v[24:27]
s_cselect_b32 s31, s35, s34
ds_read_b64_tr_b16 a[124:125], v2 offset:224
ds_read_b64_tr_b16 a[126:127], v2 offset:736
v_cvt_pk_bf16_f32 v46, v36, v37
v_mfma_f32_16x16x32_bf16 v[24:27], a[40:43], v[200:203], v[24:27]
s_cselect_b32 s30, 7, s30
v_cvt_pk_bf16_f32 v47, v38, v39
s_waitcnt lgkmcnt(15)
v_cmp_gt_u32 vcc, s33, v11
v_mfma_f32_16x16x32_bf16 v[24:27], a[44:47], v[204:207], v[24:27]
v_mov_b32 v50, v32
v_mov_b32 v51, v33
v_mfma_f32_16x16x32_bf16 v[28:31], a[60:63], v[204:207], 0
v_add_f32 v50, v50, v34
v_add_f32 v51, v51, v35
v_mfma_f32_16x16x32_bf16 v[28:31], a[56:59], v[200:203], v[28:31]
v_add_f32 v50, v50, v36
s_nop 0
v_exp_f32 v24, v24
v_mfma_f32_16x16x32_bf16 v[28:31], a[52:55], v[196:199], v[28:31]
v_exp_f32 v25, v25
v_mfma_f32_16x16x32_bf16 v[28:31], a[48:51], v[192:195], v[28:31]
v_exp_f32 v26, v26
v_mfma_f32_16x16x32_bf16 v[160:163], v[44:47], a[64:67], 0
v_exp_f32 v27, v27
v_mfma_f32_16x16x32_bf16 v[164:167], v[44:47], a[68:71], 0
v_add_f32 v51, v51, v37
s_nop 2
v_exp_f32 v28, v28
v_mfma_f32_16x16x32_bf16 v[168:171], v[44:47], a[72:75], 0
v_add_f32 v50, v50, v38
v_add_f32 v51, v51, v39
v_mfma_f32_16x16x32_bf16 v[172:175], v[44:47], a[76:79], 0
s_waitcnt lgkmcnt(0)
s_cbranch_vccnz L_spin_39
L_spinret_40:
v_add_u32 v1, s31, v1
v_add_u32 v2, s31, v2
v_mfma_f32_16x16x32_bf16 v[176:179], v[44:47], a[80:83], 0
v_cvt_pk_bf16_f32 v40, v24, v25
v_cvt_pk_bf16_f32 v41, v26, v27
v_mfma_f32_16x16x32_bf16 v[180:183], v[44:47], a[84:87], 0
v_mfma_f32_16x16x32_bf16 v[184:187], v[44:47], a[88:91], 0
v_mfma_f32_16x16x32_bf16 v[188:191], v[44:47], a[92:95], 0
s_branch L_loop4
L_t3_0_3:
v_mfma_f32_16x16x32_bf16 v[32:35], a[0:3], v[208:211], 0
s_waitcnt vmcnt(16)
buffer_load_dwordx4 v3, s[4:7], s24 offen lds
buffer_load_dwordx4 v4, s[4:7], s24 offen offset:1056 lds
s_add_u32 s33, s33, 1
v_mfma_f32_16x16x32_bf16 v[32:35], a[4:7], v[212:215], v[32:35]
s_sub_u32 s30, s30, 1
v_add_u32 v17, v1, v7
ds_read_b128 v[192:195], v17 offset:0
ds_read_b128 v[196:199], v17 offset:64
s_cselect_b32 s31, s35, s34
v_mfma_f32_16x16x32_bf16 v[32:35], a[8:11], v[216:219], v[32:35]
s_mov_b32 s14, s47
ds_read_b128 v[200:203], v17 offset:128
v_add_u32 v1, s31, v1
v_mfma_f32_16x16x32_bf16 v[32:35], a[12:15], v[220:223], v[32:35]
s_cselect_b32 s30, 7, s30
buffer_load_dwordx4 v3, s[8:11], s24 offen offset:2080 lds
ds_read_b128 v[204:207], v17 offset:192
v_add_u32 v19, v1, v7
v_mfma_f32_16x16x32_bf16 v[36:39], a[28:31], v[220:223], 0
s_add_u32 s80, s46, 0
v_exp_f32 v29, v29
v_mfma_f32_16x16x32_bf16 v[36:39], a[24:27], v[216:219], v[36:39]
s_add_u32 s81, s46, 131072
v_exp_f32 v30, v30
v_mfma_f32_16x16x32_bf16 v[36:39], a[20:23], v[212:215], v[36:39]
s_add_u32 s82, s46, 262144
v_exp_f32 v31, v31
v_mfma_f32_16x16x32_bf16 v[36:39], a[16:19], v[208:211], v[36:39]
s_add_u32 s83, s46, 393216
buffer_load_dwordx4 v4, s[8:11], s24 offen offset:3136 lds
s_add_u32 m0, m0, s34
s_waitcnt lgkmcnt(3)
v_mfma_f32_16x16x32_bf16 v[160:163], a[146:149], v[192:195], 0
s_cmp_eq_u32 m0, s29
s_cselect_b32 m0, s28, m0
s_add_u32 s24, s24, s25
v_mfma_f32_16x16x32_bf16 v[164:167], a[144:147], v[192:195], 0
s_add_u32 s84, s46, 524288
v_cvt_pk_bf16_f32 v42, v28, v29
v_cvt_pk_bf16_f32 v43, v30, v31
v_mfma_f32_16x16x32_bf16 v[160:163], a[150:153], v[192:195], v[160:163]
s_add_u32 s85, s46, 655360
v_exp_f32 v32, v32
v_mfma_f32_16x16x32_bf16 a[132:135], a[128:131], v[40:43], a[132:135]
s_lshr_b32 s77, s43, 12
v_exp_f32 v33, v33
v_mfma_f32_16x16x32_bf16 v[64:67], v[40:43], a[64:67], v[64:67]
s_lshr_b32 s78, s42, 12
v_exp_f32 v34, v34
v_mfma_f32_16x16x32_bf16 v[68:71], v[40:43], a[68:71], v[68:71]
s_sub_u32 s77, s77, s78
v_exp_f32 v35, v35
v_mfma_f32_16x16x32_bf16 v[72:75], v[40:43], a[72:75], v[72:75]
s_lshl_b32 s78, s45, 5
v_accvgpr_read_b32 v16, a132
v_rcp_f32 v13, v16
v_mfma_f32_16x16x32_bf16 v[76:79], v[40:43], a[76:79], v[76:79]
s_sub_u32 s77, s77, s78
ds_write_b32 v60, v13
ds_read_b128 v[52:55], v61
v_exp_f32 v36, v36
v_mfma_f32_16x16x32_bf16 v[80:83], v[40:43], a[80:83], v[80:83]
s_add_u32 s50, s77, 32
v_exp_f32 v37, v37
v_mfma_f32_16x16x32_bf16 v[84:87], v[40:43], a[84:87], v[84:87]
s_sub_u32 s26, s26, 1
v_exp_f32 v38, v38
v_mfma_f32_16x16x32_bf16 v[88:91], v[40:43], a[88:91], v[88:91]
s_sub_u32 s26, s26, 1
v_exp_f32 v39, v39
v_mfma_f32_16x16x32_bf16 v[92:95], v[40:43], a[92:95], v[92:95]
s_waitcnt vmcnt(16)
ds_read_b128 v[208:211], v19 offset:0
ds_read_b128 v[212:215], v19 offset:64
v_cvt_pk_bf16_f32 v44, v32, v33
v_mfma_f32_16x16x32_bf16 v[24:27], a[0:3], v[224:227], 0
s_sub_u32 s26, s26, 1
ds_read_b128 v[216:219], v19 offset:128
v_cvt_pk_bf16_f32 v45, v34, v35
v_mfma_f32_16x16x32_bf16 v[24:27], a[4:7], v[228:231], v[24:27]
s_sub_u32 s26, s26, 1
ds_read_b128 v[220:223], v19 offset:192
v_cvt_pk_bf16_f32 v46, v36, v37
v_mfma_f32_16x16x32_bf16 v[24:27], a[8:11], v[232:235], v[24:27]
s_mov_b32 s49, s45
s_waitcnt lgkmcnt(4)
v_pk_mul_f32 v[64:65], v[64:65], v[52:53]
v_pk_mul_f32 v[68:69], v[68:69], v[52:53]
v_pk_mul_f32 v[80:81], v[80:81], v[52:53]
v_pk_mul_f32 v[84:85], v[84:85], v[52:53]
v_pk_mul_f32 v[66:67], v[66:67], v[54:55]
v_pk_mul_f32 v[70:71], v[70:71], v[54:55]
v_pk_mul_f32 v[82:83], v[82:83], v[54:55]
v_pk_mul_f32 v[86:87], v[86:87], v[54:55]
v_pk_mul_f32 v[72:73], v[72:73], v[52:53]
v_pk_mul_f32 v[76:77], v[76:77], v[52:53]
v_pk_mul_f32 v[88:89], v[88:89], v[52:53]
v_pk_mul_f32 v[92:93], v[92:93], v[52:53]
v_pk_mul_f32 v[74:75], v[74:75], v[54:55]
v_pk_mul_f32 v[78:79], v[78:79], v[54:55]
v_pk_mul_f32 v[90:91], v[90:91], v[54:55]
v_pk_mul_f32 v[94:95], v[94:95], v[54:55]
v_mfma_f32_16x16x32_bf16 v[24:27], a[12:15], v[236:239], v[24:27]
s_sub_u32 s26, s26, 1
v_cvt_pk_bf16_f32 v64, v64, v68
v_cvt_pk_bf16_f32 v80, v80, v84
v_mfma_f32_16x16x32_bf16 v[28:31], a[28:31], v[236:239], 0
s_mov_b32 s46, s41
v_cvt_pk_bf16_f32 v66, v66, v70
v_cvt_pk_bf16_f32 v82, v82, v86
v_mfma_f32_16x16x32_bf16 v[28:31], a[24:27], v[232:235], v[28:31]
s_mov_b32 s47, s43
v_cvt_pk_bf16_f32 v68, v65, v69
v_cvt_pk_bf16_f32 v84, v81, v85
v_mfma_f32_16x16x32_bf16 v[28:31], a[20:23], v[228:231], v[28:31]
s_mov_b32 s73, 0
v_cvt_pk_bf16_f32 v70, v67, v71
v_cvt_pk_bf16_f32 v86, v83, v87
v_mfma_f32_16x16x32_bf16 v[28:31], a[16:19], v[224:227], v[28:31]
s_sub_u32 s32, s49, 3
v_cvt_pk_bf16_f32 v65, v72, v76
v_cvt_pk_bf16_f32 v69, v73, v77
v_mfma_f32_16x16x32_bf16 v[164:167], a[148:151], v[192:195], v[164:167]
v_cvt_pk_bf16_f32 v81, v88, v92
v_cvt_pk_bf16_f32 v85, v89, v93
v_mfma_f32_16x16x32_bf16 v[168:171], a[146:149], v[196:199], 0
ds_write2_b64 v5, v[64:65], v[80:81] offset0:0 offset1:16
v_cvt_pk_bf16_f32 v67, v74, v78
v_mfma_f32_16x16x32_bf16 v[172:175], a[144:147], v[196:199], 0
ds_write2_b64 v0, v[68:69], v[84:85] offset0:32 offset1:48
v_cvt_pk_bf16_f32 v71, v75, v79
v_mfma_f32_16x16x32_bf16 v[168:171], a[150:153], v[196:199], v[168:171]
v_cvt_pk_bf16_f32 v83, v90, v94
v_cvt_pk_bf16_f32 v87, v91, v95
v_mfma_f32_16x16x32_bf16 v[172:175], a[148:151], v[196:199], v[172:175]
ds_write2_b64 v5, v[66:67], v[82:83] offset0:80 offset1:64
s_waitcnt vmcnt(12)
v_mfma_f32_16x16x32_bf16 v[176:179], a[146:149], v[200:203], 0
v_cvt_pk_bf16_f32 v47, v38, v39
v_max3_u32 v12, v12, v16, v13
v_mfma_f32_16x16x32_bf16 v[180:183], a[144:147], v[200:203], 0
ds_write2_b64 v0, v[70:71], v[86:87] offset0:112 offset1:96
v_exp_f32 v24, v24
v_mfma_f32_16x16x32_bf16 a[136:139], a[128:131], v[44:47], a[136:139]
v_exp_f32 v25, v25
v_mfma_f32_16x16x32_bf16 v[96:99], v[44:47], a[64:67], v[96:99]
ds_read_b64_tr_b16 v[64:65], v56 offset:0
ds_read_b64_tr_b16 v[66:67], v57 offset:0
ds_read_b64_tr_b16 v[72:73], v56 offset:2048
v_exp_f32 v26, v26
v_mfma_f32_16x16x32_bf16 v[100:103], v[44:47], a[68:71], v[100:103]
ds_read_b64_tr_b16 v[74:75], v57 offset:2048
ds_read_b64_tr_b16 v[80:81], v58 offset:0
ds_read_b64_tr_b16 v[82:83], v59 offset:0
ds_read_b64_tr_b16 v[88:89], v58 offset:2048
v_accvgpr_read_b32 v18, a136
v_mfma_f32_16x16x32_bf16 v[104:107], v[44:47], a[72:75], v[104:107]
ds_read_b64_tr_b16 v[90:91], v59 offset:2048
v_rcp_f32 v13, v18
v_mfma_f32_16x16x32_bf16 v[108:111], v[44:47], a[76:79], v[108:111]
ds_write_b32 v60, v13
ds_read_b128 v[240:243], v61
v_exp_f32 v27, v27
v_mfma_f32_16x16x32_bf16 v[112:115], v[44:47], a[80:83], v[112:115]
v_exp_f32 v28, v28
v_mfma_f32_16x16x32_bf16 v[116:119], v[44:47], a[84:87], v[116:119]
s_waitcnt lgkmcnt(8)
buffer_store_dwordx4 v[64:67], v6, s[12:15], s80 offen offset:0 sc1
s_waitcnt lgkmcnt(6)
buffer_store_dwordx4 v[72:75], v6, s[12:15], s81 offen offset:0 sc1
v_exp_f32 v29, v29
v_mfma_f32_16x16x32_bf16 v[120:123], v[44:47], a[88:91], v[120:123]
s_waitcnt lgkmcnt(4)
buffer_store_dwordx4 v[80:83], v6, s[12:15], s80 offen offset:128 sc1
v_exp_f32 v30, v30
v_mfma_f32_16x16x32_bf16 v[124:127], v[44:47], a[92:95], v[124:127]
v_exp_f32 v31, v31
v_mfma_f32_16x16x32_bf16 v[176:179], a[150:153], v[200:203], v[176:179]
v_cvt_pk_bf16_f32 v40, v24, v25
s_waitcnt lgkmcnt(2)
buffer_store_dwordx4 v[88:91], v6, s[12:15], s81 offen offset:128 sc1
s_waitcnt lgkmcnt(0)
v_pk_mul_f32 v[96:97], v[96:97], v[240:241]
v_pk_mul_f32 v[100:101], v[100:101], v[240:241]
v_pk_mul_f32 v[112:113], v[112:113], v[240:241]
v_pk_mul_f32 v[116:117], v[116:117], v[240:241]
v_pk_mul_f32 v[98:99], v[98:99], v[242:243]
v_pk_mul_f32 v[102:103], v[102:103], v[242:243]
v_pk_mul_f32 v[114:115], v[114:115], v[242:243]
v_pk_mul_f32 v[118:119], v[118:119], v[242:243]
v_pk_mul_f32 v[104:105], v[104:105], v[240:241]
v_pk_mul_f32 v[108:109], v[108:109], v[240:241]
v_pk_mul_f32 v[120:121], v[120:121], v[240:241]
v_pk_mul_f32 v[124:125], v[124:125], v[240:241]
v_pk_mul_f32 v[106:107], v[106:107], v[242:243]
v_pk_mul_f32 v[110:111], v[110:111], v[242:243]
v_pk_mul_f32 v[122:123], v[122:123], v[242:243]
v_pk_mul_f32 v[126:127], v[126:127], v[242:243]
v_mfma_f32_16x16x32_bf16 v[180:183], a[148:151], v[200:203], v[180:183]
v_cvt_pk_bf16_f32 v96, v96, v100
v_cvt_pk_bf16_f32 v112, v112, v116
v_mfma_f32_16x16x32_bf16 v[184:187], a[146:149], v[204:207], 0
v_cvt_pk_bf16_f32 v98, v98, v102
v_cvt_pk_bf16_f32 v114, v114, v118
v_mfma_f32_16x16x32_bf16 v[188:191], a[144:147], v[204:207], 0
v_cvt_pk_bf16_f32 v100, v97, v101
v_cvt_pk_bf16_f32 v116, v113, v117
v_mfma_f32_16x16x32_bf16 v[184:187], a[150:153], v[204:207], v[184:187]
v_cvt_pk_bf16_f32 v102, v99, v103
v_cvt_pk_bf16_f32 v118, v115, v119
v_mfma_f32_16x16x32_bf16 v[188:191], a[148:151], v[204:207], v[188:191]
v_cvt_pk_bf16_f32 v97, v104, v108
v_cvt_pk_bf16_f32 v101, v105, v109
v_cvt_pk_bf16_f32 v113, v120, v124
v_cvt_pk_bf16_f32 v117, v121, v125
v_cvt_pk_bf16_f32 v99, v106, v110
v_cvt_pk_bf16_f32 v103, v107, v111
v_cvt_pk_bf16_f32 v115, v122, v126
v_cvt_pk_bf16_f32 v119, v123, v127
ds_write2_b64 v5, v[96:97], v[112:113] offset0:0 offset1:16
v_cvt_pk_bf16_f32 v41, v26, v27
v_cvt_pk_bf16_f32 v42, v28, v29
ds_write2_b64 v0, v[100:101], v[116:117] offset0:32 offset1:48
v_cvt_pk_bf16_f32 v43, v30, v31
v_max3_u32 v12, v12, v18, v13
v_add_u32 v2, s31, v2
v_mfma_f32_16x16x32_bf16 a[140:143], a[128:131], v[40:43], a[140:143]
s_sub_u32 s30, s30, 1
s_cselect_b32 s31, s35, s34
s_cselect_b32 s30, 7, s30
v_mfma_f32_16x16x32_bf16 v[128:131], v[40:43], a[64:67], v[128:131]
ds_write2_b64 v5, v[98:99], v[114:115] offset0:80 offset1:64
s_nop 2
v_accvgpr_read_b32 v20, a140
v_mfma_f32_16x16x32_bf16 v[132:135], v[40:43], a[68:71], v[132:135]
v_rcp_f32 v13, v20
v_mfma_f32_16x16x32_bf16 v[136:139], v[40:43], a[72:75], v[136:139]
ds_write2_b64 v0, v[102:103], v[118:119] offset0:112 offset1:96
s_waitcnt vmcnt(12)
v_mfma_f32_16x16x32_bf16 v[140:143], v[40:43], a[76:79], v[140:143]
v_add_u32 v1, s31, v1
v_add_u32 v2, s31, v2
v_mfma_f32_16x16x32_bf16 v[144:147], v[40:43], a[80:83], v[144:147]
s_sub_u32 s30, s30, 1
ds_add_u32 v8, v10
ds_read_b64_tr_b16 v[96:97], v56 offset:0
ds_read_b64_tr_b16 v[98:99], v57 offset:0
v_add_u32 v21, v1, v7
v_mfma_f32_16x16x32_bf16 v[148:151], v[40:43], a[84:87], v[148:151]
s_cselect_b32 s31, s35, s34
ds_read_b64_tr_b16 v[104:105], v56 offset:2048
ds_read_b64_tr_b16 v[106:107], v57 offset:2048
ds_read_b64_tr_b16 v[112:113], v58 offset:0
v_add_u32 v1, s31, v1
v_mfma_f32_16x16x32_bf16 v[152:155], v[40:43], a[88:91], v[152:155]
s_cselect_b32 s30, 7, s30
ds_read_b64_tr_b16 v[114:115], v59 offset:0
ds_read_b64_tr_b16 v[120:121], v58 offset:2048
ds_read_b64_tr_b16 v[122:123], v59 offset:2048
v_max3_u32 v12, v12, v20, v13
v_mfma_f32_16x16x32_bf16 v[156:159], v[40:43], a[92:95], v[156:159]
ds_write_b32 v60, v13
ds_read_b128 v[52:55], v61
v_mbcnt_lo_u32_b32 v13, -1, 0
v_mbcnt_hi_u32_b32 v13, -1, v13
v_lshrrev_b32 v13, 2, v13
v_and_b32 v13, 12, v13
v_sub_u32 v13, s50, v13
v_cvt_f32_i32 v13, v13
v_mov_b32 v14, 0x7c800000
v_fmaak_f32 v16, v13, v14, 0xfc000000
v_fmaak_f32 v17, v13, v14, 0xfcc00000
v_fmaak_f32 v18, v13, v14, 0xfd200000
s_waitcnt lgkmcnt(8)
buffer_store_dwordx4 v[96:99], v6, s[12:15], s82 offen offset:0 sc1
s_waitcnt lgkmcnt(6)
buffer_store_dwordx4 v[104:107], v6, s[12:15], s83 offen offset:0 sc1
v_fmaak_f32 v19, v13, v14, 0xfd600000
v_min_f32 v16, 0, v16
v_min_f32 v17, 0, v17
s_waitcnt lgkmcnt(4)
buffer_store_dwordx4 v[112:115], v6, s[12:15], s82 offen offset:128 sc1
s_waitcnt lgkmcnt(0)
v_pk_mul_f32 v[128:129], v[128:129], v[52:53]
v_pk_mul_f32 v[132:133], v[132:133], v[52:53]
v_pk_mul_f32 v[144:145], v[144:145], v[52:53]
v_pk_mul_f32 v[148:149], v[148:149], v[52:53]
v_pk_mul_f32 v[130:131], v[130:131], v[54:55]
v_pk_mul_f32 v[134:135], v[134:135], v[54:55]
v_pk_mul_f32 v[146:147], v[146:147], v[54:55]
v_pk_mul_f32 v[150:151], v[150:151], v[54:55]
v_cvt_pk_bf16_f32 v128, v128, v132
v_cvt_pk_bf16_f32 v144, v144, v148
buffer_store_dwordx4 v[120:123], v6, s[12:15], s83 offen offset:128 sc1
v_cvt_pk_bf16_f32 v130, v130, v134
v_cvt_pk_bf16_f32 v146, v146, v150
v_pk_mul_f32 v[136:137], v[136:137], v[52:53]
v_pk_mul_f32 v[140:141], v[140:141], v[52:53]
v_cvt_pk_bf16_f32 v132, v129, v133
v_pk_mul_f32 v[152:153], v[152:153], v[52:53]
v_pk_mul_f32 v[156:157], v[156:157], v[52:53]
v_cvt_pk_bf16_f32 v148, v145, v149
v_pk_mul_f32 v[138:139], v[138:139], v[54:55]
v_pk_mul_f32 v[142:143], v[142:143], v[54:55]
v_cvt_pk_bf16_f32 v134, v131, v135
v_pk_mul_f32 v[154:155], v[154:155], v[54:55]
v_pk_mul_f32 v[158:159], v[158:159], v[54:55]
v_cvt_pk_bf16_f32 v150, v147, v151
v_cvt_pk_bf16_f32 v129, v136, v140
v_cvt_pk_bf16_f32 v133, v137, v141
ds_read_b32 v11, v9
v_cvt_pk_bf16_f32 v145, v152, v156
v_cvt_pk_bf16_f32 v149, v153, v157
v_cvt_pk_bf16_f32 v131, v138, v142
v_cvt_pk_bf16_f32 v135, v139, v143
v_cvt_pk_bf16_f32 v147, v154, v158
v_cvt_pk_bf16_f32 v151, v155, v159
ds_write2_b64 v5, v[128:129], v[144:145] offset0:0 offset1:16
v_min_f32 v18, 0, v18
v_min_f32 v19, 0, v19
ds_write2_b64 v0, v[132:133], v[148:149] offset0:32 offset1:48
v_cvt_pk_bf16_f32 v192, v160, v161
v_cvt_pk_bf16_f32 v193, v162, v163
v_mfma_f32_16x16x32_bf16 v[160:163], a[146:149], v[208:211], 0
v_cvt_pk_bf16_f32 v194, v164, v165
v_cvt_pk_bf16_f32 v195, v166, v167
v_mfma_f32_16x16x32_bf16 v[164:167], a[144:147], v[208:211], 0
ds_write2_b64 v5, v[130:131], v[146:147] offset0:80 offset1:64
s_waitcnt lgkmcnt(3)
v_cmp_gt_u32 vcc, s33, v11
v_mfma_f32_16x16x32_bf16 v[160:163], a[150:153], v[208:211], v[160:163]
v_cvt_pk_bf16_f32 v196, v168, v169
v_cvt_pk_bf16_f32 v197, v170, v171
v_mfma_f32_16x16x32_bf16 v[164:167], a[148:151], v[208:211], v[164:167]
s_cbranch_vccnz L_spin_41
L_spinret_42:
buffer_load_dwordx4 v3, s[4:7], s24 offen lds
buffer_load_dwordx4 v4, s[4:7], s24 offen offset:1056 lds
ds_write2_b64 v0, v[134:135], v[150:151] offset0:112 offset1:96
v_cvt_pk_bf16_f32 v198, v172, v173
v_mfma_f32_16x16x32_bf16 v[168:171], a[146:149], v[212:215], 0
s_add_u32 s33, s33, 1
ds_read_b64_tr_b16 v[128:129], v56 offset:0
ds_read_b64_tr_b16 v[130:131], v57 offset:0
v_cvt_pk_bf16_f32 v199, v174, v175
v_mfma_f32_16x16x32_bf16 v[172:175], a[144:147], v[212:215], 0
buffer_load_dwordx4 v3, s[8:11], s24 offen offset:2080 lds
ds_read_b64_tr_b16 v[136:137], v56 offset:2048
ds_read_b64_tr_b16 v[138:139], v57 offset:2048
ds_read_b64_tr_b16 v[144:145], v58 offset:0
ds_read_b64_tr_b16 v[146:147], v59 offset:0
ds_read_b128 a[0:3], v1 offset:0
v_cvt_pk_bf16_f32 v200, v176, v177
v_mfma_f32_16x16x32_bf16 v[168:171], a[150:153], v[212:215], v[168:171]
ds_read_b128 a[4:7], v1 offset:64
v_cvt_pk_bf16_f32 v201, v178, v179
v_mfma_f32_16x16x32_bf16 v[172:175], a[148:151], v[212:215], v[172:175]
buffer_load_dwordx4 v4, s[8:11], s24 offen offset:3136 lds
s_add_u32 m0, m0, s34
v_mfma_f32_16x16x32_bf16 v[176:179], a[146:149], v[216:219], 0
s_cmp_eq_u32 m0, s29
s_cselect_b32 m0, s28, m0
s_add_u32 s24, s24, s25
v_mfma_f32_16x16x32_bf16 v[176:179], a[150:153], v[216:219], v[176:179]
ds_read_b128 a[8:11], v1 offset:128
ds_read_b128 a[12:15], v1 offset:192
v_cvt_pk_bf16_f32 v202, v180, v181
ds_read_b64_tr_b16 v[152:153], v58 offset:2048
v_cvt_pk_bf16_f32 v203, v182, v183
v_mfma_f32_16x16x32_bf16 v[180:183], a[144:147], v[216:219], 0
buffer_load_dwordx4 v3, s[4:7], s24 offen lds
ds_read_b64_tr_b16 v[154:155], v59 offset:2048
ds_read_b128 a[28:31], v1 offset:704
ds_read_b128 a[24:27], v1 offset:640
v_cvt_pk_bf16_f32 v204, v184, v185
s_waitcnt lgkmcnt(7)
v_mfma_f32_16x16x32_bf16 v[24:27], a[0:3], v[192:195], v[16:19]
ds_read_b128 a[20:23], v1 offset:576
v_cvt_pk_bf16_f32 v205, v186, v187
s_waitcnt lgkmcnt(7)
v_mfma_f32_16x16x32_bf16 v[24:27], a[4:7], v[196:199], v[24:27]
ds_read_b128 a[16:19], v1 offset:512
v_cvt_pk_bf16_f32 v206, v188, v189
v_mfma_f32_16x16x32_bf16 v[180:183], a[148:151], v[216:219], v[180:183]
s_waitcnt vmcnt(17)
buffer_load_dwordx4 v4, s[4:7], s24 offen offset:1056 lds
ds_add_u32 v8, v10
v_cvt_pk_bf16_f32 v207, v190, v191
v_mfma_f32_16x16x32_bf16 v[184:187], a[146:149], v[220:223], 0
ds_read_b128 v[224:227], v21 offset:0
ds_read_b128 v[228:231], v21 offset:64
v_fmaak_f32 v20, v13, v14, 0xfe840000
s_waitcnt lgkmcnt(10)
v_mfma_f32_16x16x32_bf16 v[24:27], a[8:11], v[200:203], v[24:27]
ds_read_b128 v[232:235], v21 offset:128
v_fmaak_f32 v22, v13, v14, 0xfe940000
s_waitcnt lgkmcnt(10)
v_mfma_f32_16x16x32_bf16 v[24:27], a[12:15], v[204:207], v[24:27]
buffer_load_dwordx4 v3, s[8:11], s24 offen offset:2080 lds
ds_read_b128 v[236:239], v21 offset:192
v_fmaak_f32 v21, v13, v14, 0xfe8c0000
v_mfma_f32_16x16x32_bf16 v[188:191], a[144:147], v[220:223], 0
v_fmaak_f32 v23, v13, v14, 0xfe9c0000
v_min_f32 v20, 0, v20
v_mfma_f32_16x16x32_bf16 v[184:187], a[150:153], v[220:223], v[184:187]
v_min_f32 v21, 0, v21
v_min_f32 v22, 0, v22
v_mfma_f32_16x16x32_bf16 v[188:191], a[148:151], v[220:223], v[188:191]
v_min_f32 v23, 0, v23
v_cvt_pk_bf16_f32 v208, v160, v161
buffer_load_dwordx4 v4, s[8:11], s24 offen offset:3136 lds
s_add_u32 m0, m0, s34
s_waitcnt lgkmcnt(8)
v_mfma_f32_16x16x32_bf16 v[28:31], a[28:31], v[204:207], v[20:23]
s_cmp_eq_u32 m0, s29
s_cselect_b32 m0, s28, m0
s_add_u32 s24, s24, s25
s_waitcnt lgkmcnt(7)
v_mfma_f32_16x16x32_bf16 v[28:31], a[24:27], v[200:203], v[28:31]
v_cvt_pk_bf16_f32 v209, v162, v163
v_cvt_pk_bf16_f32 v210, v164, v165
s_waitcnt lgkmcnt(6)
v_mfma_f32_16x16x32_bf16 v[28:31], a[20:23], v[196:199], v[28:31]
v_cvt_pk_bf16_f32 v211, v166, v167
v_add_u32 v2, s31, v2
s_waitcnt lgkmcnt(5)
v_mfma_f32_16x16x32_bf16 v[28:31], a[16:19], v[192:195], v[28:31]
s_sub_u32 s30, s30, 1
buffer_load_dwordx4 v3, s[4:7], s24 offen lds
ds_read_b64_tr_b16 a[64:65], v2 offset:0
ds_read_b64_tr_b16 a[66:67], v2 offset:512
v_cvt_pk_bf16_f32 v212, v168, v169
v_mfma_f32_16x16x32_bf16 v[32:35], a[0:3], v[208:211], v[16:19]
s_cselect_b32 s31, s35, s34
v_cvt_pk_bf16_f32 v213, v170, v171
v_cvt_pk_bf16_f32 v214, v172, v173
s_waitcnt lgkmcnt(5)
v_mfma_f32_16x16x32_bf16 v[160:163], a[146:149], v[224:227], 0
s_cselect_b32 s30, 7, s30
v_cvt_pk_bf16_f32 v215, v174, v175
ds_read_b64_tr_b16 a[68:69], v2 offset:32
ds_read_b64_tr_b16 a[70:71], v2 offset:544
v_cvt_pk_bf16_f32 v216, v176, v177
v_mfma_f32_16x16x32_bf16 v[32:35], a[4:7], v[212:215], v[32:35]
buffer_load_dwordx4 v4, s[4:7], s24 offen offset:1056 lds
v_cvt_pk_bf16_f32 v217, v178, v179
v_mfma_f32_16x16x32_bf16 v[164:167], a[144:147], v[224:227], 0
ds_read_b64_tr_b16 a[72:73], v2 offset:64
v_cvt_pk_bf16_f32 v218, v180, v181
v_mfma_f32_16x16x32_bf16 v[160:163], a[150:153], v[224:227], v[160:163]
ds_read_b64_tr_b16 a[74:75], v2 offset:576
v_cvt_pk_bf16_f32 v219, v182, v183
v_mfma_f32_16x16x32_bf16 v[164:167], a[148:151], v[224:227], v[164:167]
ds_read_b64_tr_b16 a[76:77], v2 offset:96
buffer_load_dwordx4 v3, s[8:11], s24 offen offset:2080 lds
v_cvt_pk_bf16_f32 v220, v184, v185
v_mfma_f32_16x16x32_bf16 v[32:35], a[8:11], v[216:219], v[32:35]
ds_read_b64_tr_b16 a[78:79], v2 offset:608
v_cvt_pk_bf16_f32 v221, v186, v187
s_waitcnt lgkmcnt(10)
v_mfma_f32_16x16x32_bf16 v[168:171], a[146:149], v[228:231], 0
ds_read_b64_tr_b16 a[80:81], v2 offset:128
v_cvt_pk_bf16_f32 v222, v188, v189
v_mfma_f32_16x16x32_bf16 v[172:175], a[144:147], v[228:231], 0
ds_read_b32 v11, v9
v_cvt_pk_bf16_f32 v223, v190, v191
v_mfma_f32_16x16x32_bf16 v[168:171], a[150:153], v[228:231], v[168:171]
buffer_load_dwordx4 v4, s[8:11], s24 offen offset:3136 lds
s_add_u32 m0, m0, s34
v_mfma_f32_16x16x32_bf16 v[32:35], a[12:15], v[220:223], v[32:35]
s_cmp_eq_u32 m0, s29
s_cselect_b32 m0, s28, m0
s_add_u32 s24, s24, s25
v_mfma_f32_16x16x32_bf16 v[36:39], a[28:31], v[220:223], v[20:23]
ds_read_b64_tr_b16 a[82:83], v2 offset:640
v_exp_f32 v24, v24
v_mfma_f32_16x16x32_bf16 v[36:39], a[24:27], v[216:219], v[36:39]
ds_read_b64_tr_b16 a[84:85], v2 offset:160
buffer_load_dwordx4 v3, s[4:7], s24 offen lds
v_exp_f32 v25, v25
v_mfma_f32_16x16x32_bf16 v[36:39], a[20:23], v[212:215], v[36:39]
ds_read_b64_tr_b16 a[86:87], v2 offset:672
v_exp_f32 v26, v26
v_mfma_f32_16x16x32_bf16 v[36:39], a[16:19], v[208:211], v[36:39]
ds_read_b64_tr_b16 a[88:89], v2 offset:192
v_exp_f32 v27, v27
v_mfma_f32_16x16x32_bf16 v[172:175], a[148:151], v[228:231], v[172:175]
buffer_load_dwordx4 v4, s[4:7], s24 offen offset:1056 lds
v_exp_f32 v28, v28
s_waitcnt lgkmcnt(15)
v_mfma_f32_16x16x32_bf16 v[176:179], a[146:149], v[232:235], 0
ds_read_b64_tr_b16 a[90:91], v2 offset:704
v_exp_f32 v29, v29
v_mfma_f32_16x16x32_bf16 v[180:183], a[144:147], v[232:235], 0
ds_read_b64_tr_b16 a[92:93], v2 offset:224
v_exp_f32 v30, v30
v_mfma_f32_16x16x32_bf16 v[176:179], a[150:153], v[232:235], v[176:179]
buffer_load_dwordx4 v3, s[8:11], s24 offen offset:2080 lds
v_exp_f32 v31, v31
v_mfma_f32_16x16x32_bf16 v[180:183], a[148:151], v[232:235], v[180:183]
ds_read_b64_tr_b16 a[94:95], v2 offset:736
v_cvt_pk_bf16_f32 v40, v24, v25
s_waitcnt lgkmcnt(15)
v_mfma_f32_16x16x32_bf16 v[184:187], a[146:149], v[236:239], 0
v_cvt_pk_bf16_f32 v41, v26, v27
v_cvt_pk_bf16_f32 v42, v28, v29
v_mfma_f32_16x16x32_bf16 v[188:191], a[144:147], v[236:239], 0
v_cvt_pk_bf16_f32 v43, v30, v31
v_cvt_pk_bf16_f32 v224, v160, v161
v_mfma_f32_16x16x32_bf16 v[184:187], a[150:153], v[236:239], v[184:187]
buffer_store_dwordx4 v[128:131], v6, s[12:15], s84 offen offset:0 sc1
v_cvt_pk_bf16_f32 v225, v162, v163
v_mfma_f32_16x16x32_bf16 v[64:67], v[40:43], a[64:67], 0
v_cvt_pk_bf16_f32 v226, v164, v165
v_cvt_pk_bf16_f32 v227, v166, v167
s_waitcnt lgkmcnt(13)
v_mfma_f32_16x16x32_bf16 v[68:71], v[40:43], a[68:71], 0
v_cvt_pk_bf16_f32 v228, v168, v169
buffer_store_dwordx4 v[136:139], v6, s[12:15], s85 offen offset:0 sc1
v_cvt_pk_bf16_f32 v229, v170, v171
s_waitcnt lgkmcnt(11)
v_mfma_f32_16x16x32_bf16 v[72:75], v[40:43], a[72:75], 0
v_cvt_pk_bf16_f32 v230, v172, v173
v_cvt_pk_bf16_f32 v231, v174, v175
s_waitcnt lgkmcnt(9)
v_mfma_f32_16x16x32_bf16 v[76:79], v[40:43], a[76:79], 0
s_waitcnt vmcnt(25)
ds_add_u32 v8, v10
v_cvt_pk_bf16_f32 v232, v176, v177
s_waitcnt lgkmcnt(7)
v_mfma_f32_16x16x32_bf16 v[80:83], v[40:43], a[80:83], 0
buffer_load_dwordx4 v4, s[8:11], s24 offen offset:3136 lds
v_cvt_pk_bf16_f32 v233, v178, v179
s_waitcnt lgkmcnt(5)
v_mfma_f32_16x16x32_bf16 v[84:87], v[40:43], a[84:87], 0
s_add_u32 m0, m0, s34
v_cvt_pk_bf16_f32 v234, v180, v181
v_cvt_pk_bf16_f32 v235, v182, v183
s_waitcnt lgkmcnt(3)
v_mfma_f32_16x16x32_bf16 v[88:91], v[40:43], a[88:91], 0
s_cmp_eq_u32 m0, s29
v_exp_f32 v32, v32
s_waitcnt lgkmcnt(1)
v_mfma_f32_16x16x32_bf16 v[92:95], v[40:43], a[92:95], 0
s_cselect_b32 m0, s28, m0
v_exp_f32 v33, v33
v_mfma_f32_16x16x32_bf16 a[132:135], a[128:131], v[40:43], 0
s_add_u32 s24, s24, s25
v_exp_f32 v34, v34
v_mfma_f32_16x16x32_bf16 v[188:191], a[148:151], v[236:239], v[188:191]
v_cvt_pk_bf16_f32 v236, v184, v185
v_cvt_pk_bf16_f32 v237, v186, v187
v_mfma_f32_16x16x32_bf16 v[24:27], a[0:3], v[224:227], v[16:19]
v_exp_f32 v35, v35
v_mfma_f32_16x16x32_bf16 v[24:27], a[4:7], v[228:231], v[24:27]
v_exp_f32 v36, v36
v_mfma_f32_16x16x32_bf16 v[24:27], a[8:11], v[232:235], v[24:27]
buffer_store_dwordx4 v[144:147], v6, s[12:15], s84 offen offset:128 sc1
buffer_store_dwordx4 v[152:155], v6, s[12:15], s85 offen offset:128 sc1
v_cvt_pk_bf16_f32 v238, v188, v189
v_cvt_pk_bf16_f32 v239, v190, v191
v_exp_f32 v37, v37
s_nop 0
v_mfma_f32_16x16x32_bf16 v[24:27], a[12:15], v[236:239], v[24:27]
v_exp_f32 v38, v38
v_mfma_f32_16x16x32_bf16 v[28:31], a[28:31], v[236:239], v[20:23]
v_exp_f32 v39, v39
v_mfma_f32_16x16x32_bf16 v[28:31], a[24:27], v[232:235], v[28:31]
v_cmp_gt_u32 vcc, s33, v11
v_cvt_pk_bf16_f32 v44, v32, v33
v_mfma_f32_16x16x32_bf16 v[28:31], a[20:23], v[228:231], v[28:31]
v_cvt_pk_bf16_f32 v45, v34, v35
v_cvt_pk_bf16_f32 v46, v36, v37
v_mfma_f32_16x16x32_bf16 v[28:31], a[16:19], v[224:227], v[28:31]
s_cbranch_vccnz L_spin_43
L_spinret_44:
v_cvt_pk_bf16_f32 v47, v38, v39
v_add_u32 v1, s31, v1
ds_read_b128 a[32:35], v1 offset:0
ds_read_b128 a[36:39], v1 offset:64
v_add_u32 v2, s31, v2
v_mfma_f32_16x16x32_bf16 v[96:99], v[44:47], a[64:67], 0
s_add_u32 s33, s33, 1
ds_read_b128 a[40:43], v1 offset:128
s_sub_u32 s30, s30, 1
v_mfma_f32_16x16x32_bf16 v[100:103], v[44:47], a[68:71], 0
s_cselect_b32 s31, s35, s34
ds_read_b128 a[44:47], v1 offset:192
s_cselect_b32 s30, 7, s30
v_mfma_f32_16x16x32_bf16 v[104:107], v[44:47], a[72:75], 0
ds_read_b128 a[60:63], v1 offset:704
v_exp_f32 v24, v24
v_mfma_f32_16x16x32_bf16 v[108:111], v[44:47], a[76:79], 0
ds_read_b128 a[56:59], v1 offset:640
ds_read_b128 a[52:55], v1 offset:576
v_exp_f32 v25, v25
v_mfma_f32_16x16x32_bf16 v[112:115], v[44:47], a[80:83], 0
ds_read_b128 a[48:51], v1 offset:512
v_cvt_pk_bf16_f32 v40, v24, v25
v_mfma_f32_16x16x32_bf16 v[116:119], v[44:47], a[84:87], 0
ds_read_b64_tr_b16 a[96:97], v2 offset:0
ds_read_b64_tr_b16 a[98:99], v2 offset:512
v_add_u32 v1, s31, v1
v_mfma_f32_16x16x32_bf16 v[120:123], v[44:47], a[88:91], 0
ds_read_b32 v11, v9
ds_read_b64_tr_b16 a[100:101], v2 offset:32
ds_read_b64_tr_b16 a[102:103], v2 offset:544
v_exp_f32 v26, v26
v_mfma_f32_16x16x32_bf16 v[124:127], v[44:47], a[92:95], 0
ds_read_b64_tr_b16 a[104:105], v2 offset:64
ds_read_b64_tr_b16 a[106:107], v2 offset:576
ds_read_b64_tr_b16 a[108:109], v2 offset:96
ds_read_b64_tr_b16 a[110:111], v2 offset:608
v_exp_f32 v27, v27
v_mfma_f32_16x16x32_bf16 a[136:139], a[128:131], v[44:47], 0
ds_read_b64_tr_b16 a[112:113], v2 offset:128
v_cvt_pk_bf16_f32 v41, v26, v27
s_waitcnt lgkmcnt(15)
v_mfma_f32_16x16x32_bf16 v[32:35], a[32:35], v[192:195], 0
ds_read_b64_tr_b16 a[114:115], v2 offset:640
ds_read_b64_tr_b16 a[116:117], v2 offset:160
ds_read_b64_tr_b16 a[118:119], v2 offset:672
ds_read_b64_tr_b16 a[120:121], v2 offset:192
ds_read_b64_tr_b16 a[122:123], v2 offset:704
ds_read_b64_tr_b16 a[124:125], v2 offset:224
v_exp_f32 v28, v28
v_mfma_f32_16x16x32_bf16 v[32:35], a[36:39], v[196:199], v[32:35]
ds_read_b64_tr_b16 a[126:127], v2 offset:736
s_waitcnt lgkmcnt(14)
v_cmp_gt_u32 vcc, s33, v11
v_mfma_f32_16x16x32_bf16 v[32:35], a[40:43], v[200:203], v[32:35]
v_exp_f32 v29, v29
v_mfma_f32_16x16x32_bf16 v[32:35], a[44:47], v[204:207], v[32:35]
v_exp_f32 v30, v30
v_mfma_f32_16x16x32_bf16 v[36:39], a[60:63], v[204:207], 0
v_exp_f32 v31, v31
v_mfma_f32_16x16x32_bf16 v[36:39], a[56:59], v[200:203], v[36:39]
v_cvt_pk_bf16_f32 v42, v28, v29
v_cvt_pk_bf16_f32 v43, v30, v31
v_mfma_f32_16x16x32_bf16 v[36:39], a[52:55], v[196:199], v[36:39]
s_nop 0
v_exp_f32 v32, v32
v_mfma_f32_16x16x32_bf16 v[36:39], a[48:51], v[192:195], v[36:39]
v_exp_f32 v33, v33
v_mfma_f32_16x16x32_bf16 v[128:131], v[40:43], a[64:67], 0
v_exp_f32 v34, v34
v_mfma_f32_16x16x32_bf16 v[132:135], v[40:43], a[68:71], 0
s_waitcnt lgkmcnt(0)
s_cbranch_vccnz L_spin_45
L_spinret_46:
v_exp_f32 v35, v35
v_mfma_f32_16x16x32_bf16 v[136:139], v[40:43], a[72:75], 0
v_exp_f32 v36, v36
v_mfma_f32_16x16x32_bf16 v[140:143], v[40:43], a[76:79], 0
v_add_u32 v2, s31, v2
v_cvt_pk_bf16_f32 v44, v32, v33
v_mfma_f32_16x16x32_bf16 v[144:147], v[40:43], a[80:83], 0
v_cvt_pk_bf16_f32 v45, v34, v35
v_mfma_f32_16x16x32_bf16 v[148:151], v[40:43], a[84:87], 0
v_mfma_f32_16x16x32_bf16 v[152:155], v[40:43], a[88:91], 0
v_mfma_f32_16x16x32_bf16 v[156:159], v[40:43], a[92:95], 0
v_mfma_f32_16x16x32_bf16 a[140:143], a[128:131], v[40:43], 0
s_branch L_loop3
L_t3_0_0:
v_mfma_f32_16x16x32_bf16 v[32:35], a[0:3], v[208:211], 0
s_add_u32 s80, s46, 0
v_exp_f32 v31, v31
v_mfma_f32_16x16x32_bf16 v[32:35], a[4:7], v[212:215], v[32:35]
s_mov_b32 s14, s47
v_exp_f32 v30, v30
v_mfma_f32_16x16x32_bf16 v[32:35], a[8:11], v[216:219], v[32:35]
s_add_u32 s81, s46, 131072
v_exp_f32 v29, v29
v_mfma_f32_16x16x32_bf16 v[32:35], a[12:15], v[220:223], v[32:35]
s_add_u32 s82, s46, 262144
v_cvt_pk_bf16_f32 v42, v28, v29
v_cvt_pk_bf16_f32 v43, v30, v31
v_mfma_f32_16x16x32_bf16 v[36:39], a[28:31], v[220:223], 0
s_add_u32 s83, s46, 393216
s_add_u32 s84, s46, 524288
s_add_u32 s85, s46, 655360
v_mfma_f32_16x16x32_bf16 v[36:39], a[24:27], v[216:219], v[36:39]
v_exp_f32 v33, v33
v_mfma_f32_16x16x32_bf16 v[36:39], a[20:23], v[212:215], v[36:39]
v_exp_f32 v32, v32
v_mfma_f32_16x16x32_bf16 v[36:39], a[16:19], v[208:211], v[36:39]
v_exp_f32 v35, v35
v_mfma_f32_16x16x32_bf16 a[132:135], a[128:131], v[40:43], a[132:135]
v_exp_f32 v34, v34
v_mfma_f32_16x16x32_bf16 v[64:67], v[40:43], a[64:67], v[64:67]
v_cvt_pk_bf16_f32 v44, v32, v33
s_nop 2
v_exp_f32 v37, v37
v_mfma_f32_16x16x32_bf16 v[68:71], v[40:43], a[68:71], v[68:71]
v_accvgpr_read_b32 v16, a132
v_rcp_f32 v13, v16
v_mfma_f32_16x16x32_bf16 v[72:75], v[40:43], a[72:75], v[72:75]
ds_write_b32 v60, v13
v_mfma_f32_16x16x32_bf16 v[76:79], v[40:43], a[76:79], v[76:79]
ds_read_b128 v[52:55], v61
v_exp_f32 v39, v39
v_mfma_f32_16x16x32_bf16 v[80:83], v[40:43], a[80:83], v[80:83]
v_exp_f32 v36, v36
v_mfma_f32_16x16x32_bf16 v[84:87], v[40:43], a[84:87], v[84:87]
v_exp_f32 v38, v38
v_mfma_f32_16x16x32_bf16 v[88:91], v[40:43], a[88:91], v[88:91]
v_cvt_pk_bf16_f32 v47, v38, v39
v_cvt_pk_bf16_f32 v45, v34, v35
v_mfma_f32_16x16x32_bf16 v[92:95], v[40:43], a[92:95], v[92:95]
v_cvt_pk_bf16_f32 v46, v36, v37
v_max3_u32 v12, v12, v16, v13
v_mfma_f32_16x16x32_bf16 v[24:27], a[0:3], v[224:227], 0
v_mfma_f32_16x16x32_bf16 v[24:27], a[4:7], v[228:231], v[24:27]
s_waitcnt lgkmcnt(0)
v_pk_mul_f32 v[64:65], v[64:65], v[52:53]
v_pk_mul_f32 v[84:85], v[84:85], v[52:53]
v_pk_mul_f32 v[66:67], v[66:67], v[54:55]
v_pk_mul_f32 v[68:69], v[68:69], v[52:53]
v_pk_mul_f32 v[92:93], v[92:93], v[52:53]
v_pk_mul_f32 v[72:73], v[72:73], v[52:53]
v_pk_mul_f32 v[80:81], v[80:81], v[52:53]
v_pk_mul_f32 v[78:79], v[78:79], v[54:55]
v_pk_mul_f32 v[86:87], v[86:87], v[54:55]
v_pk_mul_f32 v[90:91], v[90:91], v[54:55]
v_pk_mul_f32 v[82:83], v[82:83], v[54:55]
v_pk_mul_f32 v[70:71], v[70:71], v[54:55]
v_pk_mul_f32 v[94:95], v[94:95], v[54:55]
v_pk_mul_f32 v[76:77], v[76:77], v[52:53]
v_pk_mul_f32 v[88:89], v[88:89], v[52:53]
v_pk_mul_f32 v[74:75], v[74:75], v[54:55]
v_mfma_f32_16x16x32_bf16 v[24:27], a[8:11], v[232:235], v[24:27]
v_cvt_pk_bf16_f32 v64, v64, v68
v_cvt_pk_bf16_f32 v66, v66, v70
v_mfma_f32_16x16x32_bf16 v[24:27], a[12:15], v[236:239], v[24:27]
v_cvt_pk_bf16_f32 v82, v82, v86
v_cvt_pk_bf16_f32 v86, v83, v87
v_mfma_f32_16x16x32_bf16 v[28:31], a[28:31], v[236:239], 0
v_cvt_pk_bf16_f32 v68, v65, v69
v_cvt_pk_bf16_f32 v65, v72, v76
v_mfma_f32_16x16x32_bf16 v[28:31], a[24:27], v[232:235], v[28:31]
v_cvt_pk_bf16_f32 v83, v90, v94
v_cvt_pk_bf16_f32 v80, v80, v84
v_mfma_f32_16x16x32_bf16 v[28:31], a[20:23], v[228:231], v[28:31]
v_cvt_pk_bf16_f32 v84, v81, v85
v_cvt_pk_bf16_f32 v81, v88, v92
v_mfma_f32_16x16x32_bf16 v[28:31], a[16:19], v[224:227], v[28:31]
ds_write2_b64 v5, v[64:65], v[80:81] offset0:0 offset1:16
v_mfma_f32_16x16x32_bf16 a[136:139], a[128:131], v[44:47], a[136:139]
v_cvt_pk_bf16_f32 v87, v91, v95
v_cvt_pk_bf16_f32 v70, v67, v71
v_mfma_f32_16x16x32_bf16 v[96:99], v[44:47], a[64:67], v[96:99]
v_cvt_pk_bf16_f32 v71, v75, v79
v_cvt_pk_bf16_f32 v69, v73, v77
v_mfma_f32_16x16x32_bf16 v[100:103], v[44:47], a[68:71], v[100:103]
ds_write2_b64 v0, v[70:71], v[86:87] offset0:112 offset1:96
v_mfma_f32_16x16x32_bf16 v[104:107], v[44:47], a[72:75], v[104:107]
v_cvt_pk_bf16_f32 v67, v74, v78
ds_write2_b64 v5, v[66:67], v[82:83] offset0:80 offset1:64
v_mfma_f32_16x16x32_bf16 v[108:111], v[44:47], a[76:79], v[108:111]
v_cvt_pk_bf16_f32 v85, v89, v93
v_accvgpr_read_b32 v18, a136
v_mfma_f32_16x16x32_bf16 v[112:115], v[44:47], a[80:83], v[112:115]
ds_write2_b64 v0, v[68:69], v[84:85] offset0:32 offset1:48
v_mfma_f32_16x16x32_bf16 v[116:119], v[44:47], a[84:87], v[116:119]
v_rcp_f32 v13, v18
v_mfma_f32_16x16x32_bf16 v[120:123], v[44:47], a[88:91], v[120:123]
v_exp_f32 v30, v30
v_mfma_f32_16x16x32_bf16 v[124:127], v[44:47], a[92:95], v[124:127]
ds_read_b64_tr_b16 v[64:65], v56 offset:0
ds_read_b64_tr_b16 v[66:67], v57 offset:0
ds_write_b32 v60, v13
ds_read_b64_tr_b16 v[74:75], v57 offset:2048
v_exp_f32 v28, v28
ds_read_b64_tr_b16 v[72:73], v56 offset:2048
ds_read_b128 v[192:195], v61
v_exp_f32 v26, v26
v_exp_f32 v24, v24
ds_read_b64_tr_b16 v[80:81], v58 offset:0
ds_read_b64_tr_b16 v[82:83], v59 offset:0
v_exp_f32 v31, v31
ds_read_b64_tr_b16 v[90:91], v59 offset:2048
ds_read_b64_tr_b16 v[88:89], v58 offset:2048
v_exp_f32 v25, v25
v_exp_f32 v29, v29
v_exp_f32 v27, v27
s_waitcnt lgkmcnt(8)
buffer_store_dwordx4 v[64:67], v6, s[12:15], s80 offen offset:0 sc1
v_cvt_pk_bf16_f32 v42, v28, v29
v_cvt_pk_bf16_f32 v43, v30, v31
s_waitcnt lgkmcnt(5)
buffer_store_dwordx4 v[72:75], v6, s[12:15], s81 offen offset:0 sc1
s_waitcnt lgkmcnt(4)
v_pk_mul_f32 v[118:119], v[118:119], v[194:195]
v_pk_mul_f32 v[100:101], v[100:101], v[192:193]
v_pk_mul_f32 v[102:103], v[102:103], v[194:195]
v_pk_mul_f32 v[110:111], v[110:111], v[194:195]
v_pk_mul_f32 v[96:97], v[96:97], v[192:193]
v_pk_mul_f32 v[108:109], v[108:109], v[192:193]
v_pk_mul_f32 v[98:99], v[98:99], v[194:195]
v_pk_mul_f32 v[112:113], v[112:113], v[192:193]
v_pk_mul_f32 v[106:107], v[106:107], v[194:195]
v_pk_mul_f32 v[114:115], v[114:115], v[194:195]
v_cvt_pk_bf16_f32 v114, v114, v118
v_pk_mul_f32 v[116:117], v[116:117], v[192:193]
v_cvt_pk_bf16_f32 v112, v112, v116
v_cvt_pk_bf16_f32 v116, v113, v117
v_pk_mul_f32 v[122:123], v[122:123], v[194:195]
v_pk_mul_f32 v[124:125], v[124:125], v[192:193]
v_pk_mul_f32 v[104:105], v[104:105], v[192:193]
v_cvt_pk_bf16_f32 v96, v96, v100
v_cvt_pk_bf16_f32 v100, v97, v101
v_cvt_pk_bf16_f32 v97, v104, v108
v_cvt_pk_bf16_f32 v98, v98, v102
v_cvt_pk_bf16_f32 v102, v99, v103
v_cvt_pk_bf16_f32 v103, v107, v111
v_cvt_pk_bf16_f32 v118, v115, v119
v_pk_mul_f32 v[120:121], v[120:121], v[192:193]
v_cvt_pk_bf16_f32 v117, v121, v125
v_pk_mul_f32 v[126:127], v[126:127], v[194:195]
v_cvt_pk_bf16_f32 v115, v122, v126
v_cvt_pk_bf16_f32 v101, v105, v109
ds_write2_b64 v0, v[100:101], v[116:117] offset0:32 offset1:48
v_cvt_pk_bf16_f32 v99, v106, v110
v_cvt_pk_bf16_f32 v113, v120, v124
ds_write2_b64 v5, v[98:99], v[114:115] offset0:80 offset1:64
v_cvt_pk_bf16_f32 v119, v123, v127
s_waitcnt lgkmcnt(4)
buffer_store_dwordx4 v[80:83], v6, s[12:15], s80 offen offset:128 sc1
v_cvt_pk_bf16_f32 v40, v24, v25
ds_write2_b64 v5, v[96:97], v[112:113] offset0:0 offset1:16
v_cvt_pk_bf16_f32 v41, v26, v27
v_max3_u32 v12, v12, v18, v13
s_waitcnt lgkmcnt(3)
buffer_store_dwordx4 v[88:91], v6, s[12:15], s81 offen offset:128 sc1
v_mfma_f32_16x16x32_bf16 a[140:143], a[128:131], v[40:43], a[140:143]
ds_write2_b64 v0, v[102:103], v[118:119] offset0:112 offset1:96
v_mfma_f32_16x16x32_bf16 v[128:131], v[40:43], a[64:67], v[128:131]
s_nop 5
v_accvgpr_read_b32 v20, a140
v_mfma_f32_16x16x32_bf16 v[132:135], v[40:43], a[68:71], v[132:135]
ds_read_b64_tr_b16 v[98:99], v57 offset:0
ds_read_b64_tr_b16 v[96:97], v56 offset:0
v_mfma_f32_16x16x32_bf16 v[136:139], v[40:43], a[72:75], v[136:139]
ds_read_b64_tr_b16 v[104:105], v56 offset:2048
v_rcp_f32 v13, v20
v_mfma_f32_16x16x32_bf16 v[140:143], v[40:43], a[76:79], v[140:143]
ds_read_b64_tr_b16 v[106:107], v57 offset:2048
ds_write_b32 v60, v13
v_mfma_f32_16x16x32_bf16 v[144:147], v[40:43], a[80:83], v[144:147]
ds_read_b128 v[52:55], v61
ds_read_b64_tr_b16 v[114:115], v59 offset:0
v_mfma_f32_16x16x32_bf16 v[148:151], v[40:43], a[84:87], v[148:151]
ds_read_b64_tr_b16 v[112:113], v58 offset:0
ds_read_b64_tr_b16 v[120:121], v58 offset:2048
v_mfma_f32_16x16x32_bf16 v[152:155], v[40:43], a[88:91], v[152:155]
ds_read_b64_tr_b16 v[122:123], v59 offset:2048
v_max3_u32 v12, v12, v20, v13
v_mfma_f32_16x16x32_bf16 v[156:159], v[40:43], a[92:95], v[156:159]
s_waitcnt lgkmcnt(8)
buffer_store_dwordx4 v[96:99], v6, s[12:15], s82 offen offset:0 sc1
s_waitcnt lgkmcnt(6)
buffer_store_dwordx4 v[104:107], v6, s[12:15], s83 offen offset:0 sc1
s_waitcnt lgkmcnt(4)
v_pk_mul_f32 v[150:151], v[150:151], v[54:55]
v_pk_mul_f32 v[134:135], v[134:135], v[54:55]
v_pk_mul_f32 v[146:147], v[146:147], v[54:55]
v_pk_mul_f32 v[148:149], v[148:149], v[52:53]
v_pk_mul_f32 v[136:137], v[136:137], v[52:53]
v_pk_mul_f32 v[132:133], v[132:133], v[52:53]
v_pk_mul_f32 v[156:157], v[156:157], v[52:53]
v_pk_mul_f32 v[128:129], v[128:129], v[52:53]
v_pk_mul_f32 v[158:159], v[158:159], v[54:55]
v_cvt_pk_bf16_f32 v146, v146, v150
v_cvt_pk_bf16_f32 v128, v128, v132
v_pk_mul_f32 v[142:143], v[142:143], v[54:55]
v_pk_mul_f32 v[130:131], v[130:131], v[54:55]
v_pk_mul_f32 v[140:141], v[140:141], v[52:53]
v_pk_mul_f32 v[144:145], v[144:145], v[52:53]
v_pk_mul_f32 v[154:155], v[154:155], v[54:55]
v_cvt_pk_bf16_f32 v144, v144, v148
v_cvt_pk_bf16_f32 v148, v145, v149
v_cvt_pk_bf16_f32 v150, v147, v151
v_cvt_pk_bf16_f32 v130, v130, v134
v_cvt_pk_bf16_f32 v134, v131, v135
v_cvt_pk_bf16_f32 v132, v129, v133
v_cvt_pk_bf16_f32 v133, v137, v141
v_pk_mul_f32 v[138:139], v[138:139], v[54:55]
v_pk_mul_f32 v[152:153], v[152:153], v[52:53]
v_cvt_pk_bf16_f32 v149, v153, v157
v_cvt_pk_bf16_f32 v145, v152, v156
v_cvt_pk_bf16_f32 v135, v139, v143
v_cvt_pk_bf16_f32 v131, v138, v142
v_cvt_pk_bf16_f32 v129, v136, v140
v_cvt_pk_bf16_f32 v151, v155, v159
v_cvt_pk_bf16_f32 v147, v154, v158
ds_write2_b64 v5, v[130:131], v[146:147] offset0:80 offset1:64
s_waitcnt lgkmcnt(3)
buffer_store_dwordx4 v[112:115], v6, s[12:15], s82 offen offset:128 sc1
ds_write2_b64 v0, v[134:135], v[150:151] offset0:112 offset1:96
s_waitcnt lgkmcnt(2)
buffer_store_dwordx4 v[120:123], v6, s[12:15], s83 offen offset:128 sc1
ds_write2_b64 v5, v[128:129], v[144:145] offset0:0 offset1:16
ds_write2_b64 v0, v[132:133], v[148:149] offset0:32 offset1:48
ds_read_b64_tr_b16 v[128:129], v56 offset:0
ds_read_b64_tr_b16 v[130:131], v57 offset:0
ds_read_b64_tr_b16 v[136:137], v56 offset:2048
ds_read_b64_tr_b16 v[138:139], v57 offset:2048
ds_read_b64_tr_b16 v[144:145], v58 offset:0
ds_read_b64_tr_b16 v[146:147], v59 offset:0
ds_read_b64_tr_b16 v[154:155], v59 offset:2048
ds_read_b64_tr_b16 v[152:153], v58 offset:2048
s_waitcnt lgkmcnt(6)
buffer_store_dwordx4 v[128:131], v6, s[12:15], s84 offen offset:0 sc1
s_waitcnt lgkmcnt(4)
buffer_store_dwordx4 v[136:139], v6, s[12:15], s85 offen offset:0 sc1
s_waitcnt lgkmcnt(2)
buffer_store_dwordx4 v[144:147], v6, s[12:15], s84 offen offset:128 sc1
s_waitcnt lgkmcnt(0)
buffer_store_dwordx4 v[152:155], v6, s[12:15], s85 offen offset:128 sc1
s_waitcnt vmcnt(12)
s_branch L_fin
L_first12:
s_mov_b64 s[4:5], s[16:17]
s_mov_b64 s[8:9], s[22:23]
s_sub_u32 s10, s38, 128992
v_add_u32 v1, 16640, v1
v_add_u32 v2, 16640, v2
v_mbcnt_lo_u32_b32 v13, -1, 0
v_mbcnt_hi_u32_b32 v13, -1, v13
v_lshrrev_b32 v13, 2, v13
v_and_b32 v13, 12, v13
v_sub_u32 v13, s50, v13
v_cvt_f32_i32 v13, v13
v_mov_b32 v14, 0x7c800000
v_fmaak_f32 v16, v13, v14, 0xfc000000
v_fmaak_f32 v17, v13, v14, 0xfcc00000
v_fmaak_f32 v18, v13, v14, 0xfd200000
v_fmaak_f32 v19, v13, v14, 0xfd600000
v_min_f32 v16, 0, v16
v_min_f32 v17, 0, v17
v_min_f32 v18, 0, v18
v_min_f32 v19, 0, v19
v_mov_b32 v42, 0
v_mov_b32 v43, 0
s_mov_b32 s30, 0
s_sub_u32 s26, s40, 8
s_sub_u32 s32, s49, 5
s_waitcnt vmcnt(8)
buffer_load_dwordx4 v3, s[4:7], s27 offen lds
buffer_load_dwordx4 v4, s[4:7], s27 offen offset:1056 lds
ds_read_b128 v[192:195], v11 offset:0
ds_read_b128 v[196:199], v11 offset:64
ds_read_b128 v[200:203], v11 offset:128
ds_read_b128 v[204:207], v11 offset:192
v_add_u32 v11, 49920, v11
buffer_load_dwordx4 v3, s[8:11], s27 offen offset:2080 lds
buffer_load_dwordx4 v4, s[8:11], s27 offen offset:3136 lds
s_waitcnt lgkmcnt(3)
v_mfma_f32_16x16x32_bf16 v[64:67], a[146:149], v[192:195], 0
s_add_u32 m0, s28, 66560
s_add_u32 s27, s27, 262144
v_mfma_f32_16x16x32_bf16 v[68:71], a[144:147], v[192:195], 0
v_mfma_f32_16x16x32_bf16 v[64:67], a[150:153], v[192:195], v[64:67]
v_mfma_f32_16x16x32_bf16 v[68:71], a[148:151], v[192:195], v[68:71]
s_waitcnt lgkmcnt(2)
v_mfma_f32_16x16x32_bf16 v[72:75], a[146:149], v[196:199], 0
s_nop 4
v_cvt_pk_bf16_f32 v192, v64, v65
v_mfma_f32_16x16x32_bf16 v[76:79], a[144:147], v[196:199], 0
v_cvt_pk_bf16_f32 v193, v66, v67
v_cvt_pk_bf16_f32 v194, v68, v69
v_mfma_f32_16x16x32_bf16 v[72:75], a[150:153], v[196:199], v[72:75]
v_cvt_pk_bf16_f32 v195, v70, v71
v_mfma_f32_16x16x32_bf16 v[76:79], a[148:151], v[196:199], v[76:79]
s_waitcnt lgkmcnt(1)
v_mfma_f32_16x16x32_bf16 v[80:83], a[146:149], v[200:203], 0
s_nop 3
v_cvt_pk_bf16_f32 v196, v72, v73
v_mfma_f32_16x16x32_bf16 v[84:87], a[144:147], v[200:203], 0
v_cvt_pk_bf16_f32 v197, v74, v75
v_cvt_pk_bf16_f32 v198, v76, v77
v_mfma_f32_16x16x32_bf16 v[80:83], a[150:153], v[200:203], v[80:83]
s_waitcnt lgkmcnt(0)
s_waitcnt vmcnt(8)
s_barrier
v_mfma_f32_16x16x32_bf16 v[84:87], a[148:151], v[200:203], v[84:87]
buffer_load_dwordx4 v3, s[4:7], s27 offen lds
v_mfma_f32_16x16x32_bf16 v[88:91], a[146:149], v[204:207], 0
buffer_load_dwordx4 v4, s[4:7], s27 offen offset:1056 lds
v_mfma_f32_16x16x32_bf16 v[92:95], a[144:147], v[204:207], 0
ds_read_b128 a[0:3], v1 offset:0
ds_read_b128 a[4:7], v1 offset:64
v_mfma_f32_16x16x32_bf16 v[88:91], a[150:153], v[204:207], v[88:91]
ds_read_b128 a[8:11], v1 offset:128
ds_read_b128 a[12:15], v1 offset:192
v_mfma_f32_16x16x32_bf16 v[92:95], a[148:151], v[204:207], v[92:95]
buffer_load_dwordx4 v3, s[8:11], s27 offen offset:2080 lds
ds_read_b128 a[16:19], v1 offset:512
ds_read_b128 a[20:23], v1 offset:576
v_cvt_pk_bf16_f32 v199, v78, v79
v_cvt_pk_bf16_f32 v200, v80, v81
ds_read_b128 a[24:27], v1 offset:640
v_cvt_pk_bf16_f32 v201, v82, v83
v_cvt_pk_bf16_f32 v202, v84, v85
v_cvt_pk_bf16_f32 v203, v86, v87
ds_read_b128 a[28:31], v1 offset:704
v_add_u32 v1, 16640, v1
v_cvt_pk_bf16_f32 v204, v88, v89
v_cvt_pk_bf16_f32 v205, v90, v91
ds_read_b64_tr_b16 a[64:65], v2 offset:0
v_cvt_pk_bf16_f32 v206, v92, v93
buffer_load_dwordx4 v4, s[8:11], s27 offen offset:3136 lds
ds_read_b64_tr_b16 a[66:67], v2 offset:512
ds_read_b64_tr_b16 a[68:69], v2 offset:32
ds_read_b64_tr_b16 a[70:71], v2 offset:544
s_add_u32 m0, s28, 83200
s_waitcnt lgkmcnt(11)
v_mfma_f32_16x16x32_bf16 v[24:27], a[0:3], v[192:195], v[16:19]
s_add_u32 s27, s27, 262144
ds_read_b64_tr_b16 a[72:73], v2 offset:64
ds_read_b64_tr_b16 a[74:75], v2 offset:576
s_waitcnt lgkmcnt(12)
v_mfma_f32_16x16x32_bf16 v[24:27], a[4:7], v[196:199], v[24:27]
ds_read_b64_tr_b16 a[76:77], v2 offset:96
ds_read_b64_tr_b16 a[78:79], v2 offset:608
s_waitcnt lgkmcnt(13)
v_mfma_f32_16x16x32_bf16 v[24:27], a[8:11], v[200:203], v[24:27]
ds_read_b64_tr_b16 a[80:81], v2 offset:128
ds_read_b64_tr_b16 a[82:83], v2 offset:640
ds_read_b64_tr_b16 a[84:85], v2 offset:160
v_cvt_pk_bf16_f32 v207, v94, v95
ds_read_b64_tr_b16 a[86:87], v2 offset:672
ds_read_b64_tr_b16 a[88:89], v2 offset:192
s_waitcnt lgkmcnt(15)
v_mfma_f32_16x16x32_bf16 v[24:27], a[12:15], v[204:207], v[24:27]
ds_read_b64_tr_b16 a[90:91], v2 offset:704
ds_read_b64_tr_b16 a[92:93], v2 offset:224
ds_read_b64_tr_b16 a[94:95], v2 offset:736
v_add_u32 v2, 16640, v2
s_nop 3
v_exp_f32 v24, v24
v_exp_f32 v25, v25
v_exp_f32 v26, v26
v_exp_f32 v27, v27
v_cvt_pk_bf16_f32 v40, v24, v25
v_cvt_pk_bf16_f32 v41, v26, v27
s_waitcnt lgkmcnt(0)
s_waitcnt vmcnt(8)
s_barrier
buffer_load_dwordx4 v3, s[4:7], s27 offen lds
buffer_load_dwordx4 v4, s[4:7], s27 offen offset:1056 lds
s_mov_b64 s[4:5], s[18:19]
ds_read_b128 a[32:35], v1 offset:0
ds_read_b128 a[36:39], v1 offset:64
ds_read_b128 a[40:43], v1 offset:128
ds_read_b128 a[44:47], v1 offset:192
ds_read_b128 a[48:51], v1 offset:512
ds_read_b128 a[52:55], v1 offset:576
buffer_load_dwordx4 v3, s[8:11], s27 offen offset:2080 lds
ds_read_b128 a[56:59], v1 offset:640
ds_read_b128 a[60:63], v1 offset:704
v_add_u32 v1, 66560, v1
ds_read_b64_tr_b16 a[96:97], v2 offset:0
ds_read_b64_tr_b16 a[98:99], v2 offset:512
ds_read_b64_tr_b16 a[100:101], v2 offset:32
buffer_load_dwordx4 v4, s[8:11], s27 offen offset:3136 lds
s_add_u32 m0, s28, 99840
s_waitcnt lgkmcnt(10)
v_mfma_f32_16x16x32_bf16 v[32:35], a[32:35], v[192:195], 0
s_mov_b64 s[8:9], s[20:21]
s_add_u32 s10, s38, 2080
ds_read_b64_tr_b16 a[102:103], v2 offset:544
s_waitcnt lgkmcnt(10)
v_mfma_f32_16x16x32_bf16 v[32:35], a[36:39], v[196:199], v[32:35]
s_add_u32 s27, s27, 262144
ds_read_b64_tr_b16 a[104:105], v2 offset:64
ds_read_b64_tr_b16 a[106:107], v2 offset:576
s_waitcnt lgkmcnt(11)
v_mfma_f32_16x16x32_bf16 v[32:35], a[40:43], v[200:203], v[32:35]
ds_read_b64_tr_b16 a[108:109], v2 offset:96
ds_read_b64_tr_b16 a[110:111], v2 offset:608
s_waitcnt lgkmcnt(12)
v_mfma_f32_16x16x32_bf16 v[32:35], a[44:47], v[204:207], v[32:35]
ds_read_b64_tr_b16 a[112:113], v2 offset:128
ds_read_b64_tr_b16 a[114:115], v2 offset:640
ds_read_b64_tr_b16 a[116:117], v2 offset:160
ds_read_b64_tr_b16 a[118:119], v2 offset:672
ds_read_b64_tr_b16 a[120:121], v2 offset:192
ds_read_b64_tr_b16 a[122:123], v2 offset:704
ds_read_b64_tr_b16 a[124:125], v2 offset:224
ds_read_b64_tr_b16 a[126:127], v2 offset:736
s_waitcnt lgkmcnt(15)
v_mfma_f32_16x16x32_bf16 v[36:39], a[60:63], v[204:207], 0
v_exp_f32 v32, v32
v_mfma_f32_16x16x32_bf16 v[36:39], a[56:59], v[200:203], v[36:39]
v_exp_f32 v33, v33
v_mfma_f32_16x16x32_bf16 v[36:39], a[52:55], v[196:199], v[36:39]
v_exp_f32 v34, v34
v_mfma_f32_16x16x32_bf16 v[36:39], a[48:51], v[192:195], v[36:39]
v_exp_f32 v35, v35
v_mfma_f32_16x16x32_bf16 v[64:67], v[40:43], a[64:67], 0
v_cvt_pk_bf16_f32 v44, v32, v33
v_cvt_pk_bf16_f32 v45, v34, v35
v_mfma_f32_16x16x32_bf16 v[68:71], v[40:43], a[68:71], 0
v_add_u32 v2, 66560, v2
s_nop 1
v_exp_f32 v36, v36
v_mfma_f32_16x16x32_bf16 v[72:75], v[40:43], a[72:75], 0
v_exp_f32 v37, v37
v_mfma_f32_16x16x32_bf16 v[76:79], v[40:43], a[76:79], 0
v_exp_f32 v38, v38
v_mfma_f32_16x16x32_bf16 v[80:83], v[40:43], a[80:83], 0
v_exp_f32 v39, v39
v_mfma_f32_16x16x32_bf16 v[84:87], v[40:43], a[84:87], 0
v_cvt_pk_bf16_f32 v46, v36, v37
v_cvt_pk_bf16_f32 v47, v38, v39
v_mfma_f32_16x16x32_bf16 v[88:91], v[40:43], a[88:91], 0
v_mfma_f32_16x16x32_bf16 v[92:95], v[40:43], a[92:95], 0
v_mfma_f32_16x16x32_bf16 a[132:135], a[128:131], v[40:43], 0
s_waitcnt vmcnt(8)
buffer_load_dwordx4 v3, s[4:7], s24 offen lds
buffer_load_dwordx4 v4, s[4:7], s24 offen offset:1056 lds
ds_read_b128 v[208:211], v11 offset:0
ds_read_b128 v[212:215], v11 offset:64
ds_read_b128 v[216:219], v11 offset:128
ds_read_b128 v[220:223], v11 offset:192
v_add_u32 v11, 16640, v11
buffer_load_dwordx4 v3, s[8:11], s24 offen offset:2080 lds
buffer_load_dwordx4 v4, s[8:11], s24 offen offset:3136 lds
s_waitcnt lgkmcnt(3)
v_mfma_f32_16x16x32_bf16 v[96:99], a[146:149], v[208:211], 0
s_add_u32 m0, s28, 116480
s_add_u32 s24, s24, -131072
v_mfma_f32_16x16x32_bf16 v[100:103], a[144:147], v[208:211], 0
v_mfma_f32_16x16x32_bf16 v[96:99], a[150:153], v[208:211], v[96:99]
v_mfma_f32_16x16x32_bf16 v[100:103], a[148:151], v[208:211], v[100:103]
s_waitcnt lgkmcnt(2)
v_mfma_f32_16x16x32_bf16 v[104:107], a[146:149], v[212:215], 0
s_nop 4
v_cvt_pk_bf16_f32 v208, v96, v97
v_mfma_f32_16x16x32_bf16 v[108:111], a[144:147], v[212:215], 0
v_cvt_pk_bf16_f32 v209, v98, v99
v_cvt_pk_bf16_f32 v210, v100, v101
v_mfma_f32_16x16x32_bf16 v[104:107], a[150:153], v[212:215], v[104:107]
v_cvt_pk_bf16_f32 v211, v102, v103
v_mfma_f32_16x16x32_bf16 v[108:111], a[148:151], v[212:215], v[108:111]
s_waitcnt lgkmcnt(1)
v_mfma_f32_16x16x32_bf16 v[112:115], a[146:149], v[216:219], 0
s_nop 3
v_cvt_pk_bf16_f32 v212, v104, v105
v_mfma_f32_16x16x32_bf16 v[116:119], a[144:147], v[216:219], 0
v_cvt_pk_bf16_f32 v213, v106, v107
v_cvt_pk_bf16_f32 v214, v108, v109
v_mfma_f32_16x16x32_bf16 v[112:115], a[150:153], v[216:219], v[112:115]
v_cvt_pk_bf16_f32 v215, v110, v111
v_mfma_f32_16x16x32_bf16 v[116:119], a[148:151], v[216:219], v[116:119]
s_waitcnt lgkmcnt(0)
v_mfma_f32_16x16x32_bf16 v[120:123], a[146:149], v[220:223], 0
s_nop 3
v_cvt_pk_bf16_f32 v216, v112, v113
v_mfma_f32_16x16x32_bf16 v[124:127], a[144:147], v[220:223], 0
v_cvt_pk_bf16_f32 v217, v114, v115
v_cvt_pk_bf16_f32 v218, v116, v117
v_mfma_f32_16x16x32_bf16 v[120:123], a[150:153], v[220:223], v[120:123]
v_cvt_pk_bf16_f32 v219, v118, v119
v_mfma_f32_16x16x32_bf16 v[124:127], a[148:151], v[220:223], v[124:127]
v_mfma_f32_16x16x32_bf16 v[24:27], a[0:3], v[208:211], v[16:19]
s_nop 4
v_cvt_pk_bf16_f32 v220, v120, v121
v_mfma_f32_16x16x32_bf16 v[24:27], a[4:7], v[212:215], v[24:27]
v_cvt_pk_bf16_f32 v221, v122, v123
v_cvt_pk_bf16_f32 v222, v124, v125
v_mfma_f32_16x16x32_bf16 v[24:27], a[8:11], v[216:219], v[24:27]
v_cvt_pk_bf16_f32 v223, v126, v127
s_nop 1
v_mfma_f32_16x16x32_bf16 v[24:27], a[12:15], v[220:223], v[24:27]
v_mfma_f32_16x16x32_bf16 v[64:67], v[44:47], a[96:99], v[64:67]
v_mfma_f32_16x16x32_bf16 v[68:71], v[44:47], a[100:103], v[68:71]
s_nop 5
v_exp_f32 v24, v24
v_mfma_f32_16x16x32_bf16 v[72:75], v[44:47], a[104:107], v[72:75]
v_exp_f32 v25, v25
v_mfma_f32_16x16x32_bf16 v[76:79], v[44:47], a[108:111], v[76:79]
v_exp_f32 v26, v26
v_mfma_f32_16x16x32_bf16 v[80:83], v[44:47], a[112:115], v[80:83]
v_exp_f32 v27, v27
v_mfma_f32_16x16x32_bf16 v[84:87], v[44:47], a[116:119], v[84:87]
v_cvt_pk_bf16_f32 v40, v24, v25
v_cvt_pk_bf16_f32 v41, v26, v27
v_mfma_f32_16x16x32_bf16 v[88:91], v[44:47], a[120:123], v[88:91]
v_mov_b32 v48, v24
v_mov_b32 v49, v25
v_mfma_f32_16x16x32_bf16 v[92:95], v[44:47], a[124:127], v[92:95]
v_add_f32 v48, v48, v26
v_add_f32 v49, v49, v27
v_mfma_f32_16x16x32_bf16 a[132:135], a[128:131], v[44:47], a[132:135]
v_mfma_f32_16x16x32_bf16 v[32:35], a[32:35], v[208:211], 0
v_mfma_f32_16x16x32_bf16 v[32:35], a[36:39], v[212:215], v[32:35]
v_mfma_f32_16x16x32_bf16 v[32:35], a[40:43], v[216:219], v[32:35]
v_mfma_f32_16x16x32_bf16 v[32:35], a[44:47], v[220:223], v[32:35]
v_mfma_f32_16x16x32_bf16 v[36:39], a[60:63], v[220:223], 0
v_mfma_f32_16x16x32_bf16 v[36:39], a[56:59], v[216:219], v[36:39]
s_nop 5
v_exp_f32 v32, v32
v_mfma_f32_16x16x32_bf16 v[36:39], a[52:55], v[212:215], v[36:39]
v_exp_f32 v33, v33
v_mfma_f32_16x16x32_bf16 v[36:39], a[48:51], v[208:211], v[36:39]
v_exp_f32 v34, v34
v_mfma_f32_16x16x32_bf16 v[96:99], v[40:43], a[64:67], 0
v_exp_f32 v35, v35
v_mfma_f32_16x16x32_bf16 v[100:103], v[40:43], a[68:71], 0
v_cvt_pk_bf16_f32 v44, v32, v33
v_cvt_pk_bf16_f32 v45, v34, v35
v_mfma_f32_16x16x32_bf16 v[104:107], v[40:43], a[72:75], 0
s_nop 0
v_exp_f32 v36, v36
v_mfma_f32_16x16x32_bf16 v[108:111], v[40:43], a[76:79], 0
s_waitcnt vmcnt(8)
ds_read_b128 v[224:227], v11 offset:0
v_mfma_f32_16x16x32_bf16 v[112:115], v[40:43], a[80:83], 0
buffer_load_dwordx4 v3, s[4:7], s24 offen lds
v_mfma_f32_16x16x32_bf16 v[116:119], v[40:43], a[84:87], 0
buffer_load_dwordx4 v4, s[4:7], s24 offen offset:1056 lds
v_mfma_f32_16x16x32_bf16 v[120:123], v[40:43], a[88:91], 0
ds_read_b128 v[228:231], v11 offset:64
ds_read_b128 v[232:235], v11 offset:128
v_mfma_f32_16x16x32_bf16 v[124:127], v[40:43], a[92:95], 0
ds_read_b128 v[236:239], v11 offset:192
v_add_u32 v11, 16640, v11
v_exp_f32 v37, v37
buffer_load_dwordx4 v3, s[8:11], s24 offen offset:2080 lds
v_exp_f32 v38, v38
v_exp_f32 v39, v39
v_cvt_pk_bf16_f32 v46, v36, v37
v_cvt_pk_bf16_f32 v47, v38, v39
v_add_f32 v48, v48, v32
v_add_f32 v49, v49, v33
v_add_f32 v48, v48, v34
s_waitcnt lgkmcnt(3)
v_mfma_f32_16x16x32_bf16 v[128:131], a[146:149], v[224:227], 0
v_add_f32 v49, v49, v35
v_add_f32 v48, v48, v36
v_mfma_f32_16x16x32_bf16 v[132:135], a[144:147], v[224:227], 0
buffer_load_dwordx4 v4, s[8:11], s24 offen offset:3136 lds
v_mfma_f32_16x16x32_bf16 v[128:131], a[150:153], v[224:227], v[128:131]
s_add_u32 m0, s28, 0
s_add_u32 s24, s24, -131072
v_add_f32 v49, v49, v37
v_mfma_f32_16x16x32_bf16 v[132:135], a[148:151], v[224:227], v[132:135]
v_add_f32 v48, v48, v38
v_add_f32 v49, v49, v39
s_waitcnt lgkmcnt(2)
v_mfma_f32_16x16x32_bf16 v[136:139], a[146:149], v[228:231], 0
v_cvt_pk_bf16_f32 v224, v128, v129
v_mfma_f32_16x16x32_bf16 v[140:143], a[144:147], v[228:231], 0
v_cvt_pk_bf16_f32 v225, v130, v131
s_nop 0
v_cvt_pk_bf16_f32 v226, v132, v133
v_mfma_f32_16x16x32_bf16 v[136:139], a[150:153], v[228:231], v[136:139]
v_cvt_pk_bf16_f32 v227, v134, v135
v_mfma_f32_16x16x32_bf16 v[140:143], a[148:151], v[228:231], v[140:143]
s_waitcnt lgkmcnt(1)
v_mfma_f32_16x16x32_bf16 v[144:147], a[146:149], v[232:235], 0
s_nop 3
v_cvt_pk_bf16_f32 v228, v136, v137
v_mfma_f32_16x16x32_bf16 v[148:151], a[144:147], v[232:235], 0
v_cvt_pk_bf16_f32 v229, v138, v139
v_cvt_pk_bf16_f32 v230, v140, v141
v_mfma_f32_16x16x32_bf16 v[144:147], a[150:153], v[232:235], v[144:147]
v_cvt_pk_bf16_f32 v231, v142, v143
v_mfma_f32_16x16x32_bf16 v[148:151], a[148:151], v[232:235], v[148:151]
s_waitcnt lgkmcnt(0)
v_mfma_f32_16x16x32_bf16 v[152:155], a[146:149], v[236:239], 0
s_nop 3
v_cvt_pk_bf16_f32 v232, v144, v145
v_mfma_f32_16x16x32_bf16 v[156:159], a[144:147], v[236:239], 0
v_cvt_pk_bf16_f32 v233, v146, v147
v_cvt_pk_bf16_f32 v234, v148, v149
v_mfma_f32_16x16x32_bf16 v[152:155], a[150:153], v[236:239], v[152:155]
v_cvt_pk_bf16_f32 v235, v150, v151
v_mfma_f32_16x16x32_bf16 v[156:159], a[148:151], v[236:239], v[156:159]
v_mfma_f32_16x16x32_bf16 v[24:27], a[0:3], v[224:227], v[16:19]
s_nop 4
v_cvt_pk_bf16_f32 v236, v152, v153
v_mfma_f32_16x16x32_bf16 v[24:27], a[4:7], v[228:231], v[24:27]
v_cvt_pk_bf16_f32 v237, v154, v155
v_cvt_pk_bf16_f32 v238, v156, v157
v_mfma_f32_16x16x32_bf16 v[24:27], a[8:11], v[232:235], v[24:27]
v_cvt_pk_bf16_f32 v239, v158, v159
s_nop 1
v_mfma_f32_16x16x32_bf16 v[24:27], a[12:15], v[236:239], v[24:27]
v_mfma_f32_16x16x32_bf16 v[96:99], v[44:47], a[96:99], v[96:99]
v_mfma_f32_16x16x32_bf16 v[100:103], v[44:47], a[100:103], v[100:103]
s_nop 5
v_exp_f32 v24, v24
v_mfma_f32_16x16x32_bf16 v[104:107], v[44:47], a[104:107], v[104:107]
v_exp_f32 v25, v25
v_mfma_f32_16x16x32_bf16 v[108:111], v[44:47], a[108:111], v[108:111]
v_exp_f32 v26, v26
v_mfma_f32_16x16x32_bf16 v[112:115], v[44:47], a[112:115], v[112:115]
v_exp_f32 v27, v27
v_mfma_f32_16x16x32_bf16 v[116:119], v[44:47], a[116:119], v[116:119]
v_cvt_pk_bf16_f32 v40, v24, v25
v_cvt_pk_bf16_f32 v41, v26, v27
v_mfma_f32_16x16x32_bf16 v[120:123], v[44:47], a[120:123], v[120:123]
v_mfma_f32_16x16x32_bf16 v[124:127], v[44:47], a[124:127], v[124:127]
v_mfma_f32_16x16x32_bf16 v[32:35], a[32:35], v[224:227], 0
v_mfma_f32_16x16x32_bf16 v[32:35], a[36:39], v[228:231], v[32:35]
v_mfma_f32_16x16x32_bf16 v[32:35], a[40:43], v[232:235], v[32:35]
v_mfma_f32_16x16x32_bf16 v[32:35], a[44:47], v[236:239], v[32:35]
v_mfma_f32_16x16x32_bf16 v[36:39], a[60:63], v[236:239], 0
v_mfma_f32_16x16x32_bf16 v[36:39], a[56:59], v[232:235], v[36:39]
s_nop 5
v_exp_f32 v32, v32
v_mfma_f32_16x16x32_bf16 v[36:39], a[52:55], v[228:231], v[36:39]
v_exp_f32 v33, v33
v_mfma_f32_16x16x32_bf16 v[36:39], a[48:51], v[224:227], v[36:39]
v_exp_f32 v34, v34
v_mfma_f32_16x16x32_bf16 v[128:131], v[40:43], a[64:67], 0
v_exp_f32 v35, v35
v_mfma_f32_16x16x32_bf16 v[132:135], v[40:43], a[68:71], 0
v_cvt_pk_bf16_f32 v44, v32, v33
s_nop 2
v_exp_f32 v36, v36
v_mfma_f32_16x16x32_bf16 v[136:139], v[40:43], a[72:75], 0
v_exp_f32 v37, v37
v_mfma_f32_16x16x32_bf16 v[140:143], v[40:43], a[76:79], 0
v_exp_f32 v38, v38
v_mfma_f32_16x16x32_bf16 v[144:147], v[40:43], a[80:83], 0
v_exp_f32 v39, v39
v_mfma_f32_16x16x32_bf16 v[148:151], v[40:43], a[84:87], 0
s_waitcnt vmcnt(8)
buffer_load_dwordx4 v3, s[4:7], s24 offen lds
v_mfma_f32_16x16x32_bf16 v[152:155], v[40:43], a[88:91], 0
buffer_load_dwordx4 v4, s[4:7], s24 offen offset:1056 lds
v_mfma_f32_16x16x32_bf16 v[156:159], v[40:43], a[92:95], 0
ds_read_b128 v[240:243], v11 offset:0
ds_read_b128 v[244:247], v11 offset:64
v_mfma_f32_16x16x32_bf16 a[136:139], a[128:131], v[40:43], 0
ds_read_b128 v[248:251], v11 offset:128
ds_read_b128 v[252:255], v11 offset:192
v_cvt_pk_bf16_f32 v45, v34, v35
v_cvt_pk_bf16_f32 v46, v36, v37
buffer_load_dwordx4 v3, s[8:11], s24 offen offset:2080 lds
v_cvt_pk_bf16_f32 v47, v38, v39
buffer_load_dwordx4 v4, s[8:11], s24 offen offset:3136 lds
s_add_u32 m0, s28, 16640
s_add_u32 s24, s24, -131072
s_waitcnt lgkmcnt(3)
v_mfma_f32_16x16x32_bf16 v[160:163], a[146:149], v[240:243], 0
v_mfma_f32_16x16x32_bf16 v[164:167], a[144:147], v[240:243], 0
v_mfma_f32_16x16x32_bf16 v[160:163], a[150:153], v[240:243], v[160:163]
v_mfma_f32_16x16x32_bf16 v[164:167], a[148:151], v[240:243], v[164:167]
s_waitcnt lgkmcnt(2)
v_mfma_f32_16x16x32_bf16 v[168:171], a[146:149], v[244:247], 0
s_nop 4
v_cvt_pk_bf16_f32 v240, v160, v161
v_mfma_f32_16x16x32_bf16 v[172:175], a[144:147], v[244:247], 0
v_cvt_pk_bf16_f32 v241, v162, v163
v_cvt_pk_bf16_f32 v242, v164, v165
v_mfma_f32_16x16x32_bf16 v[168:171], a[150:153], v[244:247], v[168:171]
v_cvt_pk_bf16_f32 v243, v166, v167
v_mfma_f32_16x16x32_bf16 v[172:175], a[148:151], v[244:247], v[172:175]
s_waitcnt lgkmcnt(1)
v_mfma_f32_16x16x32_bf16 v[176:179], a[146:149], v[248:251], 0
s_nop 3
v_cvt_pk_bf16_f32 v244, v168, v169
v_mfma_f32_16x16x32_bf16 v[180:183], a[144:147], v[248:251], 0
s_waitcnt lgkmcnt(0)
s_waitcnt vmcnt(8)
s_barrier
v_mfma_f32_16x16x32_bf16 v[176:179], a[150:153], v[248:251], v[176:179]
buffer_load_dwordx4 v3, s[4:7], s24 offen lds
v_mfma_f32_16x16x32_bf16 v[180:183], a[148:151], v[248:251], v[180:183]
buffer_load_dwordx4 v4, s[4:7], s24 offen offset:1056 lds
v_mfma_f32_16x16x32_bf16 v[184:187], a[146:149], v[252:255], 0
v_cvt_pk_bf16_f32 v245, v170, v171
v_cvt_pk_bf16_f32 v246, v172, v173
v_mfma_f32_16x16x32_bf16 v[188:191], a[144:147], v[252:255], 0
v_cvt_pk_bf16_f32 v247, v174, v175
v_cvt_pk_bf16_f32 v248, v176, v177
v_mfma_f32_16x16x32_bf16 v[184:187], a[150:153], v[252:255], v[184:187]
buffer_load_dwordx4 v3, s[8:11], s24 offen offset:2080 lds
v_mfma_f32_16x16x32_bf16 v[188:191], a[148:151], v[252:255], v[188:191]
v_cvt_pk_bf16_f32 v249, v178, v179
v_cvt_pk_bf16_f32 v250, v180, v181
v_mfma_f32_16x16x32_bf16 v[24:27], a[0:3], v[240:243], v[16:19]
v_cvt_pk_bf16_f32 v251, v182, v183
s_nop 1
v_cvt_pk_bf16_f32 v252, v184, v185
v_mfma_f32_16x16x32_bf16 v[24:27], a[4:7], v[244:247], v[24:27]
v_cvt_pk_bf16_f32 v253, v186, v187
v_cvt_pk_bf16_f32 v254, v188, v189
v_mfma_f32_16x16x32_bf16 v[24:27], a[8:11], v[248:251], v[24:27]
buffer_load_dwordx4 v4, s[8:11], s24 offen offset:3136 lds
v_cvt_pk_bf16_f32 v255, v190, v191
ds_read_b128 a[0:3], v1 offset:0
ds_read_b128 a[4:7], v1 offset:64
v_mfma_f32_16x16x32_bf16 v[24:27], a[12:15], v[252:255], v[24:27]
s_add_u32 m0, s28, 33280
ds_read_b128 a[8:11], v1 offset:128
ds_read_b128 a[12:15], v1 offset:192
v_mfma_f32_16x16x32_bf16 v[128:131], v[44:47], a[96:99], v[128:131]
s_add_u32 s24, s24, -131072
ds_read_b128 a[16:19], v1 offset:512
v_mfma_f32_16x16x32_bf16 v[132:135], v[44:47], a[100:103], v[132:135]
ds_read_b128 a[20:23], v1 offset:576
v_exp_f32 v24, v24
v_mfma_f32_16x16x32_bf16 v[136:139], v[44:47], a[104:107], v[136:139]
ds_read_b128 a[24:27], v1 offset:640
v_exp_f32 v25, v25
v_mfma_f32_16x16x32_bf16 v[140:143], v[44:47], a[108:111], v[140:143]
ds_read_b128 a[28:31], v1 offset:704
v_exp_f32 v26, v26
v_mfma_f32_16x16x32_bf16 v[144:147], v[44:47], a[112:115], v[144:147]
v_exp_f32 v27, v27
v_mfma_f32_16x16x32_bf16 v[148:151], v[44:47], a[116:119], v[148:151]
v_cvt_pk_bf16_f32 v40, v24, v25
v_cvt_pk_bf16_f32 v41, v26, v27
v_mfma_f32_16x16x32_bf16 v[152:155], v[44:47], a[120:123], v[152:155]
v_mov_b32 v50, v24
v_mov_b32 v51, v25
v_mfma_f32_16x16x32_bf16 v[156:159], v[44:47], a[124:127], v[156:159]
v_add_f32 v50, v50, v26
v_add_f32 v51, v51, v27
v_mfma_f32_16x16x32_bf16 a[136:139], a[128:131], v[44:47], a[136:139]
v_add_u32 v1, 16640, v1
v_mfma_f32_16x16x32_bf16 v[32:35], a[32:35], v[240:243], 0
v_mfma_f32_16x16x32_bf16 v[32:35], a[36:39], v[244:247], v[32:35]
v_mfma_f32_16x16x32_bf16 v[32:35], a[40:43], v[248:251], v[32:35]
v_mfma_f32_16x16x32_bf16 v[32:35], a[44:47], v[252:255], v[32:35]
v_mfma_f32_16x16x32_bf16 v[36:39], a[60:63], v[252:255], 0
v_mfma_f32_16x16x32_bf16 v[36:39], a[56:59], v[248:251], v[36:39]
s_nop 5
v_exp_f32 v32, v32
v_mfma_f32_16x16x32_bf16 v[36:39], a[52:55], v[244:247], v[36:39]
v_exp_f32 v33, v33
v_mfma_f32_16x16x32_bf16 v[36:39], a[48:51], v[240:243], v[36:39]
v_exp_f32 v34, v34
v_mfma_f32_16x16x32_bf16 v[160:163], v[40:43], a[64:67], 0
ds_read_b64_tr_b16 a[64:65], v2 offset:0
ds_read_b64_tr_b16 a[66:67], v2 offset:512
v_mfma_f32_16x16x32_bf16 v[164:167], v[40:43], a[68:71], 0
ds_read_b64_tr_b16 a[68:69], v2 offset:32
ds_read_b64_tr_b16 a[70:71], v2 offset:544
v_mfma_f32_16x16x32_bf16 v[168:171], v[40:43], a[72:75], 0
ds_read_b64_tr_b16 a[72:73], v2 offset:64
ds_read_b64_tr_b16 a[74:75], v2 offset:576
v_mfma_f32_16x16x32_bf16 v[172:175], v[40:43], a[76:79], 0
ds_read_b64_tr_b16 a[76:77], v2 offset:96
ds_read_b64_tr_b16 a[78:79], v2 offset:608
v_mfma_f32_16x16x32_bf16 v[176:179], v[40:43], a[80:83], 0
ds_read_b64_tr_b16 a[80:81], v2 offset:128
ds_read_b64_tr_b16 a[82:83], v2 offset:640
v_mfma_f32_16x16x32_bf16 v[180:183], v[40:43], a[84:87], 0
ds_read_b64_tr_b16 a[84:85], v2 offset:160
ds_read_b64_tr_b16 a[86:87], v2 offset:672
v_mfma_f32_16x16x32_bf16 v[184:187], v[40:43], a[88:91], 0
ds_read_b64_tr_b16 a[88:89], v2 offset:192
ds_read_b64_tr_b16 a[90:91], v2 offset:704
v_mfma_f32_16x16x32_bf16 v[188:191], v[40:43], a[92:95], 0
ds_read_b64_tr_b16 a[92:93], v2 offset:224
ds_read_b64_tr_b16 a[94:95], v2 offset:736
s_waitcnt lgkmcnt(15)
v_mfma_f32_16x16x32_bf16 v[24:27], a[0:3], v[192:195], 0
v_exp_f32 v35, v35
v_mfma_f32_16x16x32_bf16 v[24:27], a[4:7], v[196:199], v[24:27]
v_exp_f32 v36, v36
v_mfma_f32_16x16x32_bf16 v[24:27], a[8:11], v[200:203], v[24:27]
v_exp_f32 v37, v37
v_mfma_f32_16x16x32_bf16 v[24:27], a[12:15], v[204:207], v[24:27]
v_exp_f32 v38, v38
v_mfma_f32_16x16x32_bf16 v[28:31], a[28:31], v[204:207], 0
v_exp_f32 v39, v39
v_mfma_f32_16x16x32_bf16 v[28:31], a[24:27], v[200:203], v[28:31]
v_cvt_pk_bf16_f32 v44, v32, v33
v_cvt_pk_bf16_f32 v45, v34, v35
v_mfma_f32_16x16x32_bf16 v[28:31], a[20:23], v[196:199], v[28:31]
v_cvt_pk_bf16_f32 v46, v36, v37
v_cvt_pk_bf16_f32 v47, v38, v39
v_mfma_f32_16x16x32_bf16 v[28:31], a[16:19], v[192:195], v[28:31]
s_waitcnt lgkmcnt(0)
s_waitcnt vmcnt(8)
s_barrier
v_mfma_f32_16x16x32_bf16 v[160:163], v[44:47], a[96:99], v[160:163]
buffer_load_dwordx4 v3, s[4:7], s24 offen lds
v_mfma_f32_16x16x32_bf16 v[164:167], v[44:47], a[100:103], v[164:167]
buffer_load_dwordx4 v4, s[4:7], s24 offen offset:1056 lds
v_mfma_f32_16x16x32_bf16 v[168:171], v[44:47], a[104:107], v[168:171]
v_add_f32 v50, v50, v32
v_add_f32 v51, v51, v33
v_mfma_f32_16x16x32_bf16 v[172:175], v[44:47], a[108:111], v[172:175]
v_exp_f32 v24, v24
v_mfma_f32_16x16x32_bf16 v[176:179], v[44:47], a[112:115], v[176:179]
buffer_load_dwordx4 v3, s[8:11], s24 offen offset:2080 lds
v_mfma_f32_16x16x32_bf16 v[180:183], v[44:47], a[116:119], v[180:183]
v_exp_f32 v25, v25
v_mfma_f32_16x16x32_bf16 v[184:187], v[44:47], a[120:123], v[184:187]
v_exp_f32 v26, v26
v_mfma_f32_16x16x32_bf16 v[188:191], v[44:47], a[124:127], v[188:191]
v_exp_f32 v27, v27
v_add_f32 v50, v50, v34
v_add_f32 v51, v51, v35
buffer_load_dwordx4 v4, s[8:11], s24 offen offset:3136 lds
v_add_f32 v50, v50, v36
v_add_f32 v51, v51, v37
v_exp_f32 v28, v28
v_add_f32 v50, v50, v38
v_add_f32 v51, v51, v39
v_cvt_pk_bf16_f32 v40, v24, v25
v_cvt_pk_bf16_f32 v41, v26, v27
s_add_u32 m0, s28, 49920
s_add_u32 s24, s24, -131072
v_add_u32 v2, 16640, v2
L_step2_4:
v_mfma_f32_16x16x32_bf16 v[32:35], a[0:3], v[208:211], 0
buffer_load_dwordx4 v3, s[4:7], s24 offen lds
v_mfma_f32_16x16x32_bf16 v[32:35], a[4:7], v[212:215], v[32:35]
s_sub_u32 s30, s30, 1
v_exp_f32 v29, v29
v_mfma_f32_16x16x32_bf16 v[32:35], a[8:11], v[216:219], v[32:35]
s_cselect_b32 s31, s35, s34
ds_read_b128 a[32:35], v1 offset:0
v_cvt_pk_bf16_f32 v42, v28, v29
v_mfma_f32_16x16x32_bf16 v[32:35], a[12:15], v[220:223], v[32:35]
s_cselect_b32 s30, 7, s30
v_exp_f32 v30, v30
v_mfma_f32_16x16x32_bf16 v[36:39], a[28:31], v[220:223], 0
buffer_load_dwordx4 v4, s[4:7], s24 offen offset:1056 lds
v_mfma_f32_16x16x32_bf16 v[36:39], a[24:27], v[216:219], v[36:39]
s_add_u32 s33, s33, 1
v_exp_f32 v31, v31
v_mfma_f32_16x16x32_bf16 v[36:39], a[20:23], v[212:215], v[36:39]
ds_read_b128 a[36:39], v1 offset:64
v_cvt_pk_bf16_f32 v43, v30, v31
v_mfma_f32_16x16x32_bf16 v[36:39], a[16:19], v[208:211], v[36:39]
v_exp_f32 v32, v32
v_mfma_f32_16x16x32_bf16 v[64:67], v[40:43], a[64:67], v[64:67]
buffer_load_dwordx4 v3, s[8:11], s24 offen offset:2080 lds
v_mfma_f32_16x16x32_bf16 v[68:71], v[40:43], a[68:71], v[68:71]
v_exp_f32 v33, v33
v_mfma_f32_16x16x32_bf16 v[72:75], v[40:43], a[72:75], v[72:75]
v_cvt_pk_bf16_f32 v44, v32, v33
v_add_f32 v48, v48, v32
v_mfma_f32_16x16x32_bf16 v[76:79], v[40:43], a[76:79], v[76:79]
v_exp_f32 v34, v34
v_mfma_f32_16x16x32_bf16 v[80:83], v[40:43], a[80:83], v[80:83]
buffer_load_dwordx4 v4, s[8:11], s24 offen offset:3136 lds
v_mfma_f32_16x16x32_bf16 v[84:87], v[40:43], a[84:87], v[84:87]
s_add_u32 m0, m0, s34
v_exp_f32 v35, v35
v_mfma_f32_16x16x32_bf16 v[88:91], v[40:43], a[88:91], v[88:91]
s_cmp_eq_u32 m0, s29
v_cvt_pk_bf16_f32 v45, v34, v35
v_add_f32 v49, v49, v33
v_mfma_f32_16x16x32_bf16 v[92:95], v[40:43], a[92:95], v[92:95]
s_cselect_b32 m0, s28, m0
v_exp_f32 v36, v36
v_mfma_f32_16x16x32_bf16 a[132:135], a[128:131], v[40:43], a[132:135]
s_add_u32 s24, s24, s25
v_add_f32 v48, v48, v34
v_add_f32 v49, v49, v35
v_mfma_f32_16x16x32_bf16 v[24:27], a[0:3], v[224:227], 0
s_sub_u32 s26, s26, 1
ds_read_b128 a[40:43], v1 offset:128
v_add_f32 v48, v48, v36
v_mfma_f32_16x16x32_bf16 v[24:27], a[4:7], v[228:231], v[24:27]
v_exp_f32 v37, v37
v_mfma_f32_16x16x32_bf16 v[24:27], a[8:11], v[232:235], v[24:27]
v_cvt_pk_bf16_f32 v46, v36, v37
v_add_f32 v49, v49, v37
v_mfma_f32_16x16x32_bf16 v[24:27], a[12:15], v[236:239], v[24:27]
v_exp_f32 v38, v38
v_mfma_f32_16x16x32_bf16 v[28:31], a[28:31], v[236:239], 0
ds_read_b128 a[44:47], v1 offset:192
v_add_f32 v48, v48, v38
v_mfma_f32_16x16x32_bf16 v[28:31], a[24:27], v[232:235], v[28:31]
v_exp_f32 v39, v39
v_mfma_f32_16x16x32_bf16 v[28:31], a[20:23], v[228:231], v[28:31]
v_cvt_pk_bf16_f32 v47, v38, v39
v_add_f32 v49, v49, v39
v_mfma_f32_16x16x32_bf16 v[28:31], a[16:19], v[224:227], v[28:31]
s_waitcnt vmcnt(12)
v_exp_f32 v24, v24
v_mfma_f32_16x16x32_bf16 v[96:99], v[44:47], a[64:67], v[96:99]
ds_add_u32 v8, v10
ds_read_b128 a[48:51], v1 offset:512
v_mfma_f32_16x16x32_bf16 v[100:103], v[44:47], a[68:71], v[100:103]
v_exp_f32 v25, v25
v_mfma_f32_16x16x32_bf16 v[104:107], v[44:47], a[72:75], v[104:107]
ds_read_b128 a[52:55], v1 offset:576
v_cvt_pk_bf16_f32 v40, v24, v25
v_mfma_f32_16x16x32_bf16 v[108:111], v[44:47], a[76:79], v[108:111]
v_exp_f32 v26, v26
v_mfma_f32_16x16x32_bf16 v[112:115], v[44:47], a[80:83], v[112:115]
ds_read_b128 a[56:59], v1 offset:640
ds_read_b128 a[60:63], v1 offset:704
v_mfma_f32_16x16x32_bf16 v[116:119], v[44:47], a[84:87], v[116:119]
v_exp_f32 v27, v27
v_mfma_f32_16x16x32_bf16 v[120:123], v[44:47], a[88:91], v[120:123]
ds_read_b64_tr_b16 a[96:97], v2 offset:0
v_cvt_pk_bf16_f32 v41, v26, v27
v_mfma_f32_16x16x32_bf16 v[124:127], v[44:47], a[92:95], v[124:127]
v_exp_f32 v28, v28
v_mfma_f32_16x16x32_bf16 v[32:35], a[0:3], v[240:243], 0
ds_read_b64_tr_b16 a[98:99], v2 offset:512
ds_read_b64_tr_b16 a[100:101], v2 offset:32
v_mfma_f32_16x16x32_bf16 v[32:35], a[4:7], v[244:247], v[32:35]
v_exp_f32 v29, v29
v_mfma_f32_16x16x32_bf16 v[32:35], a[8:11], v[248:251], v[32:35]
ds_read_b64_tr_b16 a[102:103], v2 offset:544
v_cvt_pk_bf16_f32 v42, v28, v29
v_mfma_f32_16x16x32_bf16 v[32:35], a[12:15], v[252:255], v[32:35]
v_exp_f32 v30, v30
v_mfma_f32_16x16x32_bf16 v[36:39], a[28:31], v[252:255], 0
ds_read_b64_tr_b16 a[104:105], v2 offset:64
ds_read_b64_tr_b16 a[106:107], v2 offset:576
v_mfma_f32_16x16x32_bf16 v[36:39], a[24:27], v[248:251], v[36:39]
v_exp_f32 v31, v31
v_mfma_f32_16x16x32_bf16 v[36:39], a[20:23], v[244:247], v[36:39]
ds_read_b64_tr_b16 a[108:109], v2 offset:96
v_cvt_pk_bf16_f32 v43, v30, v31
v_mfma_f32_16x16x32_bf16 v[36:39], a[16:19], v[240:243], v[36:39]
v_exp_f32 v32, v32
v_mfma_f32_16x16x32_bf16 v[128:131], v[40:43], a[64:67], v[128:131]
ds_read_b64_tr_b16 a[110:111], v2 offset:608
ds_read_b64_tr_b16 a[112:113], v2 offset:128
v_mfma_f32_16x16x32_bf16 v[132:135], v[40:43], a[68:71], v[132:135]
v_exp_f32 v33, v33
v_mfma_f32_16x16x32_bf16 v[136:139], v[40:43], a[72:75], v[136:139]
ds_read_b64_tr_b16 a[114:115], v2 offset:640
v_cvt_pk_bf16_f32 v44, v32, v33
v_mfma_f32_16x16x32_bf16 v[140:143], v[40:43], a[76:79], v[140:143]
v_exp_f32 v34, v34
v_mfma_f32_16x16x32_bf16 v[144:147], v[40:43], a[80:83], v[144:147]
ds_read_b64_tr_b16 a[116:117], v2 offset:160
ds_read_b64_tr_b16 a[118:119], v2 offset:672
v_mfma_f32_16x16x32_bf16 v[148:151], v[40:43], a[84:87], v[148:151]
v_exp_f32 v35, v35
v_mfma_f32_16x16x32_bf16 v[152:155], v[40:43], a[88:91], v[152:155]
ds_read_b64_tr_b16 a[120:121], v2 offset:192
v_cvt_pk_bf16_f32 v45, v34, v35
v_mfma_f32_16x16x32_bf16 v[156:159], v[40:43], a[92:95], v[156:159]
v_exp_f32 v36, v36
v_mfma_f32_16x16x32_bf16 a[136:139], a[128:131], v[40:43], a[136:139]
s_waitcnt lgkmcnt(13)
ds_read_b64_tr_b16 a[122:123], v2 offset:704
ds_read_b64_tr_b16 a[124:125], v2 offset:224
v_mfma_f32_16x16x32_bf16 v[24:27], a[32:35], v[192:195], 0
ds_read_b64_tr_b16 a[126:127], v2 offset:736
v_add_f32 v50, v50, v32
v_mfma_f32_16x16x32_bf16 v[24:27], a[36:39], v[196:199], v[24:27]
v_exp_f32 v37, v37
v_mfma_f32_16x16x32_bf16 v[24:27], a[40:43], v[200:203], v[24:27]
v_cvt_pk_bf16_f32 v46, v36, v37
v_add_f32 v51, v51, v33
v_mfma_f32_16x16x32_bf16 v[24:27], a[44:47], v[204:207], v[24:27]
v_exp_f32 v38, v38
v_mfma_f32_16x16x32_bf16 v[28:31], a[60:63], v[204:207], 0
ds_read_b32 v11, v9
v_add_f32 v50, v50, v34
v_mfma_f32_16x16x32_bf16 v[28:31], a[56:59], v[200:203], v[28:31]
v_exp_f32 v39, v39
v_mfma_f32_16x16x32_bf16 v[28:31], a[52:55], v[196:199], v[28:31]
v_cvt_pk_bf16_f32 v47, v38, v39
v_add_f32 v51, v51, v35
v_mfma_f32_16x16x32_bf16 v[28:31], a[48:51], v[192:195], v[28:31]
v_exp_f32 v24, v24
v_mfma_f32_16x16x32_bf16 v[160:163], v[44:47], a[64:67], v[160:163]
v_add_f32 v50, v50, v36
v_add_f32 v51, v51, v37
v_mfma_f32_16x16x32_bf16 v[164:167], v[44:47], a[68:71], v[164:167]
s_waitcnt lgkmcnt(0)
v_exp_f32 v25, v25
v_mfma_f32_16x16x32_bf16 v[168:171], v[44:47], a[72:75], v[168:171]
v_cvt_pk_bf16_f32 v40, v24, v25
v_add_f32 v50, v50, v38
v_cmp_gt_u32 vcc, s33, v11
v_mfma_f32_16x16x32_bf16 v[172:175], v[44:47], a[76:79], v[172:175]
v_exp_f32 v26, v26
v_mfma_f32_16x16x32_bf16 v[176:179], v[44:47], a[80:83], v[176:179]
v_add_f32 v51, v51, v39
v_add_u32 v1, s31, v1
v_mfma_f32_16x16x32_bf16 v[180:183], v[44:47], a[84:87], v[180:183]
s_waitcnt lgkmcnt(0)
v_exp_f32 v27, v27
v_mfma_f32_16x16x32_bf16 v[184:187], v[44:47], a[88:91], v[184:187]
v_cvt_pk_bf16_f32 v41, v26, v27
v_add_u32 v2, s31, v2
v_mfma_f32_16x16x32_bf16 v[188:191], v[44:47], a[92:95], v[188:191]
s_cbranch_vccnz L_spin_47
L_spinret_48:
v_exp_f32 v28, v28
buffer_load_dwordx4 v3, s[4:7], s24 offen lds
buffer_load_dwordx4 v4, s[4:7], s24 offen offset:1056 lds
buffer_load_dwordx4 v3, s[8:11], s24 offen offset:2080 lds
buffer_load_dwordx4 v4, s[8:11], s24 offen offset:3136 lds
s_add_u32 m0, m0, s34
s_cmp_eq_u32 m0, s29
s_cselect_b32 m0, s28, m0
s_add_u32 s24, s24, s25
s_sub_u32 s26, s26, 1
.p2align 6
L_loop4:
v_mfma_f32_16x16x32_bf16 v[32:35], a[32:35], v[208:211], 0
buffer_load_dwordx4 v3, s[4:7], s24 offen lds
v_mfma_f32_16x16x32_bf16 v[32:35], a[36:39], v[212:215], v[32:35]
s_sub_u32 s30, s30, 1
v_exp_f32 v29, v29
v_mfma_f32_16x16x32_bf16 v[32:35], a[40:43], v[216:219], v[32:35]
s_cselect_b32 s31, s35, s34
ds_read_b128 a[0:3], v1 offset:0
v_cvt_pk_bf16_f32 v42, v28, v29
v_mfma_f32_16x16x32_bf16 v[32:35], a[44:47], v[220:223], v[32:35]
s_cselect_b32 s30, 7, s30
v_exp_f32 v30, v30
v_mfma_f32_16x16x32_bf16 v[36:39], a[60:63], v[220:223], 0
buffer_load_dwordx4 v4, s[4:7], s24 offen offset:1056 lds
v_mfma_f32_16x16x32_bf16 v[36:39], a[56:59], v[216:219], v[36:39]
s_add_u32 s33, s33, 1
v_exp_f32 v31, v31
v_mfma_f32_16x16x32_bf16 v[36:39], a[52:55], v[212:215], v[36:39]
ds_read_b128 a[4:7], v1 offset:64
v_cvt_pk_bf16_f32 v43, v30, v31
v_mfma_f32_16x16x32_bf16 v[36:39], a[48:51], v[208:211], v[36:39]
v_exp_f32 v32, v32
v_mfma_f32_16x16x32_bf16 v[64:67], v[40:43], a[96:99], v[64:67]
buffer_load_dwordx4 v3, s[8:11], s24 offen offset:2080 lds
v_mfma_f32_16x16x32_bf16 v[68:71], v[40:43], a[100:103], v[68:71]
v_exp_f32 v33, v33
v_mfma_f32_16x16x32_bf16 v[72:75], v[40:43], a[104:107], v[72:75]
v_cvt_pk_bf16_f32 v44, v32, v33
v_add_f32 v48, v48, v32
v_mfma_f32_16x16x32_bf16 v[76:79], v[40:43], a[108:111], v[76:79]
v_exp_f32 v34, v34
v_mfma_f32_16x16x32_bf16 v[80:83], v[40:43], a[112:115], v[80:83]
buffer_load_dwordx4 v4, s[8:11], s24 offen offset:3136 lds
v_mfma_f32_16x16x32_bf16 v[84:87], v[40:43], a[116:119], v[84:87]
s_add_u32 m0, m0, s34
v_exp_f32 v35, v35
v_mfma_f32_16x16x32_bf16 v[88:91], v[40:43], a[120:123], v[88:91]
s_cmp_eq_u32 m0, s29
v_cvt_pk_bf16_f32 v45, v34, v35
v_add_f32 v49, v49, v33
v_mfma_f32_16x16x32_bf16 v[92:95], v[40:43], a[124:127], v[92:95]
s_cselect_b32 m0, s28, m0
v_exp_f32 v36, v36
v_mfma_f32_16x16x32_bf16 a[132:135], a[128:131], v[40:43], a[132:135]
s_add_u32 s24, s24, s25
v_add_f32 v48, v48, v34
v_add_f32 v49, v49, v35
v_mfma_f32_16x16x32_bf16 v[24:27], a[32:35], v[224:227], 0
s_sub_u32 s26, s26, 1
ds_read_b128 a[8:11], v1 offset:128
v_add_f32 v48, v48, v36
v_mfma_f32_16x16x32_bf16 v[24:27], a[36:39], v[228:231], v[24:27]
s_cmov_b64 s[4:5], s[52:53]
v_exp_f32 v37, v37
v_mfma_f32_16x16x32_bf16 v[24:27], a[40:43], v[232:235], v[24:27]
s_cmov_b64 s[8:9], s[54:55]
v_cvt_pk_bf16_f32 v46, v36, v37
v_add_f32 v49, v49, v37
v_mfma_f32_16x16x32_bf16 v[24:27], a[44:47], v[236:239], v[24:27]
s_cmov_b64 s[24:25], s[56:57]
v_exp_f32 v38, v38
v_mfma_f32_16x16x32_bf16 v[28:31], a[60:63], v[236:239], 0
s_cmov_b32 s6, s58
ds_read_b128 a[12:15], v1 offset:192
v_add_f32 v48, v48, v38
v_mfma_f32_16x16x32_bf16 v[28:31], a[56:59], v[232:235], v[28:31]
s_cmov_b32 s10, s59
v_exp_f32 v39, v39
v_mfma_f32_16x16x32_bf16 v[28:31], a[52:55], v[228:231], v[28:31]
s_cmov_b32 s26, s60
v_cvt_pk_bf16_f32 v47, v38, v39
v_add_f32 v49, v49, v39
v_mfma_f32_16x16x32_bf16 v[28:31], a[48:51], v[224:227], v[28:31]
s_waitcnt vmcnt(12)
v_exp_f32 v24, v24
v_mfma_f32_16x16x32_bf16 v[96:99], v[44:47], a[96:99], v[96:99]
s_cmov_b64 s[52:53], s[62:63]
ds_add_u32 v8, v10
ds_read_b128 a[16:19], v1 offset:512
v_mfma_f32_16x16x32_bf16 v[100:103], v[44:47], a[100:103], v[100:103]
s_cmov_b64 s[54:55], s[64:65]
v_exp_f32 v25, v25
v_mfma_f32_16x16x32_bf16 v[104:107], v[44:47], a[104:107], v[104:107]
s_cmov_b64 s[56:57], s[66:67]
ds_read_b128 a[20:23], v1 offset:576
v_cvt_pk_bf16_f32 v40, v24, v25
v_mfma_f32_16x16x32_bf16 v[108:111], v[44:47], a[108:111], v[108:111]
s_cmov_b64 s[58:59], s[68:69]
v_exp_f32 v26, v26
v_mfma_f32_16x16x32_bf16 v[112:115], v[44:47], a[112:115], v[112:115]
s_cmov_b32 s60, s70
ds_read_b128 a[24:27], v1 offset:640
ds_read_b128 a[28:31], v1 offset:704
v_mfma_f32_16x16x32_bf16 v[116:119], v[44:47], a[116:119], v[116:119]
s_cmov_b64 s[68:69], 0
v_exp_f32 v27, v27
v_mfma_f32_16x16x32_bf16 v[120:123], v[44:47], a[120:123], v[120:123]
s_cmov_b32 s70, 0x7fffffff
ds_read_b64_tr_b16 a[64:65], v2 offset:0
v_cvt_pk_bf16_f32 v41, v26, v27
v_mfma_f32_16x16x32_bf16 v[124:127], v[44:47], a[124:127], v[124:127]
s_sub_u32 s32, s32, 1
v_exp_f32 v28, v28
v_mfma_f32_16x16x32_bf16 v[32:35], a[32:35], v[240:243], 0
ds_read_b64_tr_b16 a[66:67], v2 offset:512
ds_read_b64_tr_b16 a[68:69], v2 offset:32
v_mfma_f32_16x16x32_bf16 v[32:35], a[36:39], v[244:247], v[32:35]
v_exp_f32 v29, v29
v_mfma_f32_16x16x32_bf16 v[32:35], a[40:43], v[248:251], v[32:35]
ds_read_b64_tr_b16 a[70:71], v2 offset:544
v_cvt_pk_bf16_f32 v42, v28, v29
v_mfma_f32_16x16x32_bf16 v[32:35], a[44:47], v[252:255], v[32:35]
v_exp_f32 v30, v30
v_mfma_f32_16x16x32_bf16 v[36:39], a[60:63], v[252:255], 0
ds_read_b64_tr_b16 a[72:73], v2 offset:64
ds_read_b64_tr_b16 a[74:75], v2 offset:576
v_mfma_f32_16x16x32_bf16 v[36:39], a[56:59], v[248:251], v[36:39]
v_exp_f32 v31, v31
v_mfma_f32_16x16x32_bf16 v[36:39], a[52:55], v[244:247], v[36:39]
ds_read_b64_tr_b16 a[76:77], v2 offset:96
v_cvt_pk_bf16_f32 v43, v30, v31
v_mfma_f32_16x16x32_bf16 v[36:39], a[48:51], v[240:243], v[36:39]
v_exp_f32 v32, v32
v_mfma_f32_16x16x32_bf16 v[128:131], v[40:43], a[96:99], v[128:131]
ds_read_b64_tr_b16 a[78:79], v2 offset:608
ds_read_b64_tr_b16 a[80:81], v2 offset:128
v_mfma_f32_16x16x32_bf16 v[132:135], v[40:43], a[100:103], v[132:135]
v_exp_f32 v33, v33
v_mfma_f32_16x16x32_bf16 v[136:139], v[40:43], a[104:107], v[136:139]
ds_read_b64_tr_b16 a[82:83], v2 offset:640
v_cvt_pk_bf16_f32 v44, v32, v33
v_mfma_f32_16x16x32_bf16 v[140:143], v[40:43], a[108:111], v[140:143]
v_exp_f32 v34, v34
v_mfma_f32_16x16x32_bf16 v[144:147], v[40:43], a[112:115], v[144:147]
ds_read_b64_tr_b16 a[84:85], v2 offset:160
ds_read_b64_tr_b16 a[86:87], v2 offset:672
v_mfma_f32_16x16x32_bf16 v[148:151], v[40:43], a[116:119], v[148:151]
v_exp_f32 v35, v35
v_mfma_f32_16x16x32_bf16 v[152:155], v[40:43], a[120:123], v[152:155]
ds_read_b64_tr_b16 a[88:89], v2 offset:192
v_cvt_pk_bf16_f32 v45, v34, v35
v_mfma_f32_16x16x32_bf16 v[156:159], v[40:43], a[124:127], v[156:159]
v_exp_f32 v36, v36
v_mfma_f32_16x16x32_bf16 a[136:139], a[128:131], v[40:43], a[136:139]
s_waitcnt lgkmcnt(13)
ds_read_b64_tr_b16 a[90:91], v2 offset:704
ds_read_b64_tr_b16 a[92:93], v2 offset:224
v_mfma_f32_16x16x32_bf16 v[24:27], a[0:3], v[192:195], 0
ds_read_b64_tr_b16 a[94:95], v2 offset:736
v_add_f32 v50, v50, v32
v_mfma_f32_16x16x32_bf16 v[24:27], a[4:7], v[196:199], v[24:27]
v_exp_f32 v37, v37
v_mfma_f32_16x16x32_bf16 v[24:27], a[8:11], v[200:203], v[24:27]
v_cvt_pk_bf16_f32 v46, v36, v37
v_add_f32 v51, v51, v33
v_mfma_f32_16x16x32_bf16 v[24:27], a[12:15], v[204:207], v[24:27]
v_exp_f32 v38, v38
v_mfma_f32_16x16x32_bf16 v[28:31], a[28:31], v[204:207], 0
ds_read_b32 v11, v9
v_add_f32 v50, v50, v34
v_mfma_f32_16x16x32_bf16 v[28:31], a[24:27], v[200:203], v[28:31]
v_exp_f32 v39, v39
v_mfma_f32_16x16x32_bf16 v[28:31], a[20:23], v[196:199], v[28:31]
v_cvt_pk_bf16_f32 v47, v38, v39
v_add_f32 v51, v51, v35
v_mfma_f32_16x16x32_bf16 v[28:31], a[16:19], v[192:195], v[28:31]
v_exp_f32 v24, v24
v_mfma_f32_16x16x32_bf16 v[160:163], v[44:47], a[96:99], v[160:163]
v_add_f32 v50, v50, v36
v_add_f32 v51, v51, v37
v_mfma_f32_16x16x32_bf16 v[164:167], v[44:47], a[100:103], v[164:167]
s_waitcnt lgkmcnt(0)
v_exp_f32 v25, v25
v_mfma_f32_16x16x32_bf16 v[168:171], v[44:47], a[104:107], v[168:171]
v_cvt_pk_bf16_f32 v40, v24, v25
v_add_f32 v50, v50, v38
v_cmp_gt_u32 vcc, s33, v11
v_mfma_f32_16x16x32_bf16 v[172:175], v[44:47], a[108:111], v[172:175]
v_exp_f32 v26, v26
v_mfma_f32_16x16x32_bf16 v[176:179], v[44:47], a[112:115], v[176:179]
v_add_f32 v51, v51, v39
v_add_u32 v1, s31, v1
v_mfma_f32_16x16x32_bf16 v[180:183], v[44:47], a[116:119], v[180:183]
s_waitcnt lgkmcnt(0)
v_exp_f32 v27, v27
v_mfma_f32_16x16x32_bf16 v[184:187], v[44:47], a[120:123], v[184:187]
v_cvt_pk_bf16_f32 v41, v26, v27
v_add_u32 v2, s31, v2
v_mfma_f32_16x16x32_bf16 v[188:191], v[44:47], a[124:127], v[188:191]
s_cbranch_vccnz L_spin_3
L_spinret_4:
v_exp_f32 v28, v28
s_cbranch_scc1 L_last0_4
v_mfma_f32_16x16x32_bf16 v[32:35], a[0:3], v[208:211], 0
buffer_load_dwordx4 v3, s[4:7], s24 offen lds
v_mfma_f32_16x16x32_bf16 v[32:35], a[4:7], v[212:215], v[32:35]
s_sub_u32 s30, s30, 1
v_exp_f32 v29, v29
v_mfma_f32_16x16x32_bf16 v[32:35], a[8:11], v[216:219], v[32:35]
s_cselect_b32 s31, s35, s34
ds_read_b128 a[32:35], v1 offset:0
v_cvt_pk_bf16_f32 v42, v28, v29
v_mfma_f32_16x16x32_bf16 v[32:35], a[12:15], v[220:223], v[32:35]
s_cselect_b32 s30, 7, s30
v_exp_f32 v30, v30
v_mfma_f32_16x16x32_bf16 v[36:39], a[28:31], v[220:223], 0
buffer_load_dwordx4 v4, s[4:7], s24 offen offset:1056 lds
v_mfma_f32_16x16x32_bf16 v[36:39], a[24:27], v[216:219], v[36:39]
v_exp_f32 v31, v31
v_mfma_f32_16x16x32_bf16 v[36:39], a[20:23], v[212:215], v[36:39]
ds_read_b128 a[36:39], v1 offset:64
v_cvt_pk_bf16_f32 v43, v30, v31
v_mfma_f32_16x16x32_bf16 v[36:39], a[16:19], v[208:211], v[36:39]
v_exp_f32 v32, v32
v_mfma_f32_16x16x32_bf16 v[64:67], v[40:43], a[64:67], v[64:67]
buffer_load_dwordx4 v3, s[8:11], s24 offen offset:2080 lds
v_mfma_f32_16x16x32_bf16 v[68:71], v[40:43], a[68:71], v[68:71]
v_exp_f32 v33, v33
v_mfma_f32_16x16x32_bf16 v[72:75], v[40:43], a[72:75], v[72:75]
v_cvt_pk_bf16_f32 v44, v32, v33
v_add_f32 v48, v48, v32
v_mfma_f32_16x16x32_bf16 v[76:79], v[40:43], a[76:79], v[76:79]
v_exp_f32 v34, v34
v_mfma_f32_16x16x32_bf16 v[80:83], v[40:43], a[80:83], v[80:83]
buffer_load_dwordx4 v4, s[8:11], s24 offen offset:3136 lds
v_mfma_f32_16x16x32_bf16 v[84:87], v[40:43], a[84:87], v[84:87]
s_add_u32 m0, m0, s34
v_exp_f32 v35, v35
v_mfma_f32_16x16x32_bf16 v[88:91], v[40:43], a[88:91], v[88:91]
s_cmp_eq_u32 m0, s29
v_cvt_pk_bf16_f32 v45, v34, v35
v_add_f32 v49, v49, v33
v_mfma_f32_16x16x32_bf16 v[92:95], v[40:43], a[92:95], v[92:95]
s_cselect_b32 m0, s28, m0
v_exp_f32 v36, v36
v_mfma_f32_16x16x32_bf16 a[132:135], a[128:131], v[40:43], a[132:135]
s_add_u32 s24, s24, s25
v_add_f32 v48, v48, v34
v_add_f32 v49, v49, v35
v_mfma_f32_16x16x32_bf16 v[24:27], a[0:3], v[224:227], 0
s_sub_u32 s26, s26, 1
ds_read_b128 a[40:43], v1 offset:128
v_add_f32 v48, v48, v36
v_mfma_f32_16x16x32_bf16 v[24:27], a[4:7], v[228:231], v[24:27]
s_cmov_b64 s[4:5], s[52:53]
v_exp_f32 v37, v37
v_mfma_f32_16x16x32_bf16 v[24:27], a[8:11], v[232:235], v[24:27]
s_cmov_b64 s[8:9], s[54:55]
v_cvt_pk_bf16_f32 v46, v36, v37
v_add_f32 v49, v49, v37
v_mfma_f32_16x16x32_bf16 v[24:27], a[12:15], v[236:239], v[24:27]
s_cmov_b64 s[24:25], s[56:57]
v_exp_f32 v38, v38
v_mfma_f32_16x16x32_bf16 v[28:31], a[28:31], v[236:239], 0
s_cmov_b32 s6, s58
ds_read_b128 a[44:47], v1 offset:192
v_add_f32 v48, v48, v38
v_mfma_f32_16x16x32_bf16 v[28:31], a[24:27], v[232:235], v[28:31]
s_cmov_b32 s10, s59
v_exp_f32 v39, v39
v_mfma_f32_16x16x32_bf16 v[28:31], a[20:23], v[228:231], v[28:31]
s_cmov_b32 s26, s60
v_cvt_pk_bf16_f32 v47, v38, v39
v_add_f32 v49, v49, v39
v_mfma_f32_16x16x32_bf16 v[28:31], a[16:19], v[224:227], v[28:31]
s_cmov_b64 s[52:53], s[62:63]
v_exp_f32 v24, v24
v_mfma_f32_16x16x32_bf16 v[96:99], v[44:47], a[64:67], v[96:99]
s_cmov_b64 s[54:55], s[64:65]
ds_read_b128 a[48:51], v1 offset:512
ds_read_b128 a[52:55], v1 offset:576
v_mfma_f32_16x16x32_bf16 v[100:103], v[44:47], a[68:71], v[100:103]
s_cmov_b64 s[56:57], s[66:67]
v_exp_f32 v25, v25
v_mfma_f32_16x16x32_bf16 v[104:107], v[44:47], a[72:75], v[104:107]
s_cmov_b64 s[58:59], s[68:69]
ds_read_b128 a[56:59], v1 offset:640
v_cvt_pk_bf16_f32 v40, v24, v25
v_mfma_f32_16x16x32_bf16 v[108:111], v[44:47], a[76:79], v[108:111]
s_cmov_b32 s60, s70
v_exp_f32 v26, v26
v_mfma_f32_16x16x32_bf16 v[112:115], v[44:47], a[80:83], v[112:115]
s_cmov_b64 s[68:69], 0
ds_read_b128 a[60:63], v1 offset:704
ds_read_b64_tr_b16 a[96:97], v2 offset:0
v_mfma_f32_16x16x32_bf16 v[116:119], v[44:47], a[84:87], v[116:119]
s_cmov_b32 s70, 0x7fffffff
v_exp_f32 v27, v27
v_mfma_f32_16x16x32_bf16 v[120:123], v[44:47], a[88:91], v[120:123]
s_sub_u32 s32, s32, 1
ds_read_b64_tr_b16 a[98:99], v2 offset:512
v_cvt_pk_bf16_f32 v41, v26, v27
v_mfma_f32_16x16x32_bf16 v[124:127], v[44:47], a[92:95], v[124:127]
v_exp_f32 v28, v28
v_mfma_f32_16x16x32_bf16 v[32:35], a[0:3], v[240:243], 0
ds_read_b64_tr_b16 a[100:101], v2 offset:32
ds_read_b64_tr_b16 a[102:103], v2 offset:544
v_mfma_f32_16x16x32_bf16 v[32:35], a[4:7], v[244:247], v[32:35]
v_exp_f32 v29, v29
v_mfma_f32_16x16x32_bf16 v[32:35], a[8:11], v[248:251], v[32:35]
ds_read_b64_tr_b16 a[104:105], v2 offset:64
v_cvt_pk_bf16_f32 v42, v28, v29
v_mfma_f32_16x16x32_bf16 v[32:35], a[12:15], v[252:255], v[32:35]
v_exp_f32 v30, v30
v_mfma_f32_16x16x32_bf16 v[36:39], a[28:31], v[252:255], 0
ds_read_b64_tr_b16 a[106:107], v2 offset:576
ds_read_b64_tr_b16 a[108:109], v2 offset:96
v_mfma_f32_16x16x32_bf16 v[36:39], a[24:27], v[248:251], v[36:39]
v_exp_f32 v31, v31
v_mfma_f32_16x16x32_bf16 v[36:39], a[20:23], v[244:247], v[36:39]
ds_read_b64_tr_b16 a[110:111], v2 offset:608
v_cvt_pk_bf16_f32 v43, v30, v31
v_mfma_f32_16x16x32_bf16 v[36:39], a[16:19], v[240:243], v[36:39]
v_exp_f32 v32, v32
v_mfma_f32_16x16x32_bf16 v[128:131], v[40:43], a[64:67], v[128:131]
ds_read_b64_tr_b16 a[112:113], v2 offset:128
ds_read_b64_tr_b16 a[114:115], v2 offset:640
v_mfma_f32_16x16x32_bf16 v[132:135], v[40:43], a[68:71], v[132:135]
v_exp_f32 v33, v33
v_mfma_f32_16x16x32_bf16 v[136:139], v[40:43], a[72:75], v[136:139]
ds_read_b64_tr_b16 a[116:117], v2 offset:160
v_cvt_pk_bf16_f32 v44, v32, v33
v_mfma_f32_16x16x32_bf16 v[140:143], v[40:43], a[76:79], v[140:143]
v_exp_f32 v34, v34
v_mfma_f32_16x16x32_bf16 v[144:147], v[40:43], a[80:83], v[144:147]
ds_read_b64_tr_b16 a[118:119], v2 offset:672
ds_read_b64_tr_b16 a[120:121], v2 offset:192
v_mfma_f32_16x16x32_bf16 v[148:151], v[40:43], a[84:87], v[148:151]
v_exp_f32 v35, v35
v_mfma_f32_16x16x32_bf16 v[152:155], v[40:43], a[88:91], v[152:155]
ds_read_b64_tr_b16 a[122:123], v2 offset:704
v_cvt_pk_bf16_f32 v45, v34, v35
v_mfma_f32_16x16x32_bf16 v[156:159], v[40:43], a[92:95], v[156:159]
v_exp_f32 v36, v36
v_mfma_f32_16x16x32_bf16 a[136:139], a[128:131], v[40:43], a[136:139]
s_waitcnt lgkmcnt(14)
ds_read_b64_tr_b16 a[124:125], v2 offset:224
ds_read_b64_tr_b16 a[126:127], v2 offset:736
v_mfma_f32_16x16x32_bf16 v[24:27], a[32:35], v[192:195], 0
v_add_f32 v50, v50, v32
v_add_f32 v51, v51, v33
v_mfma_f32_16x16x32_bf16 v[24:27], a[36:39], v[196:199], v[24:27]
v_exp_f32 v37, v37
v_mfma_f32_16x16x32_bf16 v[24:27], a[40:43], v[200:203], v[24:27]
v_cvt_pk_bf16_f32 v46, v36, v37
v_add_f32 v50, v50, v34
v_mfma_f32_16x16x32_bf16 v[24:27], a[44:47], v[204:207], v[24:27]
v_exp_f32 v38, v38
v_mfma_f32_16x16x32_bf16 v[28:31], a[60:63], v[204:207], 0
v_add_f32 v51, v51, v35
v_add_f32 v50, v50, v36
v_mfma_f32_16x16x32_bf16 v[28:31], a[56:59], v[200:203], v[28:31]
v_exp_f32 v39, v39
v_mfma_f32_16x16x32_bf16 v[28:31], a[52:55], v[196:199], v[28:31]
v_cvt_pk_bf16_f32 v47, v38, v39
v_add_f32 v51, v51, v37
v_mfma_f32_16x16x32_bf16 v[28:31], a[48:51], v[192:195], v[28:31]
v_exp_f32 v24, v24
v_mfma_f32_16x16x32_bf16 v[160:163], v[44:47], a[64:67], v[160:163]
v_add_f32 v50, v50, v38
v_add_f32 v51, v51, v39
v_mfma_f32_16x16x32_bf16 v[164:167], v[44:47], a[68:71], v[164:167]
v_exp_f32 v25, v25
v_mfma_f32_16x16x32_bf16 v[168:171], v[44:47], a[72:75], v[168:171]
v_cvt_pk_bf16_f32 v40, v24, v25
v_add_u32 v1, s31, v1
v_mfma_f32_16x16x32_bf16 v[172:175], v[44:47], a[76:79], v[172:175]
v_exp_f32 v26, v26
v_mfma_f32_16x16x32_bf16 v[176:179], v[44:47], a[80:83], v[176:179]
v_add_u32 v2, s31, v2
v_mfma_f32_16x16x32_bf16 v[180:183], v[44:47], a[84:87], v[180:183]
s_waitcnt lgkmcnt(0)
v_exp_f32 v27, v27
v_mfma_f32_16x16x32_bf16 v[184:187], v[44:47], a[88:91], v[184:187]
v_cvt_pk_bf16_f32 v41, v26, v27
v_mfma_f32_16x16x32_bf16 v[188:191], v[44:47], a[92:95], v[188:191]
v_exp_f32 v28, v28
s_cbranch_scc0 L_loop4
L_last1_4:
s_cmp_eq_u32 s73, 0
s_cbranch_scc1 L_t4_1_0
L_t4_1_11:
v_mfma_f32_16x16x32_bf16 v[32:35], a[32:35], v[208:211], 0
s_mov_b32 s14, s47
v_exp_f32 v29, v29
v_mfma_f32_16x16x32_bf16 v[32:35], a[36:39], v[212:215], v[32:35]
s_add_u32 s80, s46, 0
v_exp_f32 v30, v30
v_mfma_f32_16x16x32_bf16 v[32:35], a[40:43], v[216:219], v[32:35]
s_add_u32 s81, s46, 131072
v_exp_f32 v31, v31
v_mfma_f32_16x16x32_bf16 v[32:35], a[44:47], v[220:223], v[32:35]
s_add_u32 s82, s46, 262144
v_cvt_pk_bf16_f32 v42, v28, v29
v_cvt_pk_bf16_f32 v43, v30, v31
v_mfma_f32_16x16x32_bf16 v[36:39], a[60:63], v[220:223], 0
s_add_u32 s83, s46, 393216
buffer_load_dwordx4 v3, s[4:7], s24 offen lds
buffer_load_dwordx4 v4, s[4:7], s24 offen offset:1056 lds
s_nop 0
v_exp_f32 v32, v32
v_mfma_f32_16x16x32_bf16 v[36:39], a[56:59], v[216:219], v[36:39]
s_waitcnt vmcnt(18)
v_exp_f32 v33, v33
v_mfma_f32_16x16x32_bf16 v[36:39], a[52:55], v[212:215], v[36:39]
s_add_u32 s84, s46, 524288
v_exp_f32 v34, v34
v_mfma_f32_16x16x32_bf16 v[36:39], a[48:51], v[208:211], v[36:39]
s_add_u32 s85, s46, 655360
v_exp_f32 v35, v35
v_mfma_f32_16x16x32_bf16 a[132:135], a[128:131], v[40:43], a[132:135]
s_add_u32 s33, s33, 1
v_add_f32 v48, v48, v32
v_add_f32 v49, v49, v33
v_mfma_f32_16x16x32_bf16 v[64:67], v[40:43], a[96:99], v[64:67]
s_add_u32 s86, s46, 786432
v_add_f32 v48, v48, v34
v_exp_f32 v36, v36
v_mfma_f32_16x16x32_bf16 v[68:71], v[40:43], a[100:103], v[68:71]
s_add_u32 s87, s46, 917504
v_accvgpr_read_b32 v16, a132
v_rcp_f32 v13, v16
v_mfma_f32_16x16x32_bf16 v[72:75], v[40:43], a[104:107], v[72:75]
s_sub_u32 s30, s30, 1
ds_write_b32 v60, v13
ds_read_b128 v[52:55], v61
v_exp_f32 v37, v37
v_mfma_f32_16x16x32_bf16 v[76:79], v[40:43], a[108:111], v[76:79]
s_cselect_b32 s31, s35, s34
v_exp_f32 v38, v38
v_mfma_f32_16x16x32_bf16 v[80:83], v[40:43], a[112:115], v[80:83]
s_cselect_b32 s30, 7, s30
v_exp_f32 v39, v39
v_mfma_f32_16x16x32_bf16 v[84:87], v[40:43], a[116:119], v[84:87]
s_lshr_b32 s77, s43, 12
v_add_f32 v49, v49, v35
v_add_f32 v48, v48, v36
v_mfma_f32_16x16x32_bf16 v[88:91], v[40:43], a[120:123], v[88:91]
s_lshr_b32 s78, s42, 12
v_add_f32 v49, v49, v37
v_add_f32 v48, v48, v38
v_mfma_f32_16x16x32_bf16 v[92:95], v[40:43], a[124:127], v[92:95]
s_sub_u32 s77, s77, s78
v_add_f32 v49, v49, v39
v_add_f32 v48, v48, v49
v_mfma_f32_16x16x32_bf16 v[24:27], a[32:35], v[224:227], 0
s_lshl_b32 s78, s45, 5
v_mov_b32 v49, v48
v_cvt_pk_bf16_f32 v44, v32, v33
v_mfma_f32_16x16x32_bf16 v[24:27], a[36:39], v[228:231], v[24:27]
s_sub_u32 s77, s77, s78
v_permlane16_swap_b32 v48, v49
v_mfma_f32_16x16x32_bf16 v[24:27], a[40:43], v[232:235], v[24:27]
s_add_u32 s50, s77, 32
v_add_f32 v48, v48, v49
v_mov_b32 v49, v48
v_mfma_f32_16x16x32_bf16 v[24:27], a[44:47], v[236:239], v[24:27]
s_sub_u32 s26, s26, 1
s_waitcnt lgkmcnt(0)
v_pk_mul_f32 v[64:65], v[64:65], v[52:53]
v_pk_mul_f32 v[68:69], v[68:69], v[52:53]
v_pk_mul_f32 v[80:81], v[80:81], v[52:53]
v_pk_mul_f32 v[84:85], v[84:85], v[52:53]
v_pk_mul_f32 v[66:67], v[66:67], v[54:55]
v_pk_mul_f32 v[70:71], v[70:71], v[54:55]
v_pk_mul_f32 v[82:83], v[82:83], v[54:55]
v_pk_mul_f32 v[86:87], v[86:87], v[54:55]
v_pk_mul_f32 v[72:73], v[72:73], v[52:53]
v_pk_mul_f32 v[76:77], v[76:77], v[52:53]
v_pk_mul_f32 v[88:89], v[88:89], v[52:53]
v_pk_mul_f32 v[92:93], v[92:93], v[52:53]
v_pk_mul_f32 v[74:75], v[74:75], v[54:55]
v_pk_mul_f32 v[78:79], v[78:79], v[54:55]
v_pk_mul_f32 v[90:91], v[90:91], v[54:55]
v_pk_mul_f32 v[94:95], v[94:95], v[54:55]
v_mfma_f32_16x16x32_bf16 v[28:31], a[60:63], v[236:239], 0
s_waitcnt vmcnt(14)
v_cvt_pk_bf16_f32 v64, v64, v68
v_cvt_pk_bf16_f32 v80, v80, v84
v_mfma_f32_16x16x32_bf16 v[28:31], a[56:59], v[232:235], v[28:31]
s_sub_u32 s26, s26, 1
v_cvt_pk_bf16_f32 v66, v66, v70
v_cvt_pk_bf16_f32 v82, v82, v86
v_mfma_f32_16x16x32_bf16 v[28:31], a[52:55], v[228:231], v[28:31]
s_sub_u32 s26, s26, 1
v_cvt_pk_bf16_f32 v68, v65, v69
v_cvt_pk_bf16_f32 v84, v81, v85
v_mfma_f32_16x16x32_bf16 v[28:31], a[48:51], v[224:227], v[28:31]
s_sub_u32 s26, s26, 1
v_cvt_pk_bf16_f32 v70, v67, v71
v_cvt_pk_bf16_f32 v86, v83, v87
v_cvt_pk_bf16_f32 v65, v72, v76
v_cvt_pk_bf16_f32 v69, v73, v77
v_cvt_pk_bf16_f32 v81, v88, v92
v_cvt_pk_bf16_f32 v85, v89, v93
v_cvt_pk_bf16_f32 v67, v74, v78
v_cvt_pk_bf16_f32 v71, v75, v79
v_cvt_pk_bf16_f32 v83, v90, v94
v_cvt_pk_bf16_f32 v87, v91, v95
ds_write2_b64 v5, v[64:65], v[80:81] offset0:0 offset1:16
v_permlane32_swap_b32 v48, v49
ds_write2_b64 v0, v[68:69], v[84:85] offset0:32 offset1:48
v_cvt_pk_bf16_f32 v45, v34, v35
v_cvt_pk_bf16_f32 v46, v36, v37
v_cvt_pk_bf16_f32 v47, v38, v39
v_max3_u32 v12, v12, v16, v13
v_add_f32 v48, v48, v49
v_mfma_f32_16x16x32_bf16 v[96:99], v[44:47], a[96:99], v[96:99]
s_mov_b32 s49, s45
ds_write2_b64 v5, v[66:67], v[82:83] offset0:80 offset1:64
v_rcp_f32 v13, v48
v_mfma_f32_16x16x32_bf16 v[100:103], v[44:47], a[100:103], v[100:103]
s_sub_u32 s26, s26, 1
v_exp_f32 v24, v24
v_mfma_f32_16x16x32_bf16 v[104:107], v[44:47], a[104:107], v[104:107]
s_mov_b32 s46, s41
ds_write2_b64 v0, v[70:71], v[86:87] offset0:112 offset1:96
v_exp_f32 v25, v25
v_mfma_f32_16x16x32_bf16 v[108:111], v[44:47], a[108:111], v[108:111]
s_mov_b32 s47, s43
v_exp_f32 v26, v26
v_mfma_f32_16x16x32_bf16 v[112:115], v[44:47], a[112:115], v[112:115]
s_mov_b32 s73, 0
ds_read_b64_tr_b16 v[64:65], v56 offset:0
ds_read_b64_tr_b16 v[66:67], v57 offset:0
ds_read_b64_tr_b16 v[72:73], v56 offset:2048
ds_read_b64_tr_b16 v[74:75], v57 offset:2048
ds_write_b32 v60, v13
ds_read_b128 v[208:211], v61
v_exp_f32 v27, v27
v_mfma_f32_16x16x32_bf16 v[116:119], v[44:47], a[116:119], v[116:119]
s_sub_u32 s32, s49, 3
ds_read_b64_tr_b16 v[80:81], v58 offset:0
ds_read_b64_tr_b16 v[82:83], v59 offset:0
ds_read_b64_tr_b16 v[88:89], v58 offset:2048
ds_read_b64_tr_b16 v[90:91], v59 offset:2048
v_exp_f32 v28, v28
v_mfma_f32_16x16x32_bf16 v[120:123], v[44:47], a[120:123], v[120:123]
buffer_load_dwordx4 v3, s[8:11], s24 offen offset:2080 lds
v_exp_f32 v29, v29
v_mfma_f32_16x16x32_bf16 v[124:127], v[44:47], a[124:127], v[124:127]
buffer_load_dwordx4 v4, s[8:11], s24 offen offset:3136 lds
v_exp_f32 v30, v30
v_mfma_f32_16x16x32_bf16 v[32:35], a[32:35], v[240:243], 0
s_waitcnt vmcnt(12)
v_exp_f32 v31, v31
v_mfma_f32_16x16x32_bf16 v[32:35], a[36:39], v[244:247], v[32:35]
s_add_u32 m0, m0, s34
s_waitcnt lgkmcnt(8)
buffer_store_dwordx4 v[64:67], v6, s[12:15], s80 offen offset:0 sc1
s_waitcnt lgkmcnt(4)
v_pk_mul_f32 v[96:97], v[96:97], v[208:209]
v_pk_mul_f32 v[100:101], v[100:101], v[208:209]
v_pk_mul_f32 v[112:113], v[112:113], v[208:209]
v_pk_mul_f32 v[116:117], v[116:117], v[208:209]
v_pk_mul_f32 v[98:99], v[98:99], v[210:211]
v_pk_mul_f32 v[102:103], v[102:103], v[210:211]
v_pk_mul_f32 v[114:115], v[114:115], v[210:211]
v_pk_mul_f32 v[118:119], v[118:119], v[210:211]
v_pk_mul_f32 v[104:105], v[104:105], v[208:209]
v_pk_mul_f32 v[108:109], v[108:109], v[208:209]
v_pk_mul_f32 v[120:121], v[120:121], v[208:209]
v_pk_mul_f32 v[124:125], v[124:125], v[208:209]
v_pk_mul_f32 v[106:107], v[106:107], v[210:211]
v_pk_mul_f32 v[110:111], v[110:111], v[210:211]
v_pk_mul_f32 v[122:123], v[122:123], v[210:211]
v_pk_mul_f32 v[126:127], v[126:127], v[210:211]
v_mfma_f32_16x16x32_bf16 v[32:35], a[40:43], v[248:251], v[32:35]
s_cmp_eq_u32 m0, s29
buffer_store_dwordx4 v[72:75], v6, s[12:15], s81 offen offset:0 sc1
v_cvt_pk_bf16_f32 v96, v96, v100
v_mfma_f32_16x16x32_bf16 v[32:35], a[44:47], v[252:255], v[32:35]
s_cselect_b32 m0, s28, m0
v_cvt_pk_bf16_f32 v112, v112, v116
v_cvt_pk_bf16_f32 v98, v98, v102
v_mfma_f32_16x16x32_bf16 v[36:39], a[60:63], v[252:255], 0
s_add_u32 s24, s24, s25
v_cvt_pk_bf16_f32 v114, v114, v118
v_cvt_pk_bf16_f32 v100, v97, v101
v_mfma_f32_16x16x32_bf16 v[36:39], a[56:59], v[248:251], v[36:39]
s_waitcnt lgkmcnt(2)
buffer_store_dwordx4 v[80:83], v6, s[12:15], s80 offen offset:128 sc1
v_cvt_pk_bf16_f32 v116, v113, v117
v_mfma_f32_16x16x32_bf16 v[36:39], a[52:55], v[244:247], v[36:39]
s_waitcnt lgkmcnt(0)
buffer_store_dwordx4 v[88:91], v6, s[12:15], s81 offen offset:128 sc1
v_cvt_pk_bf16_f32 v102, v99, v103
v_mfma_f32_16x16x32_bf16 v[36:39], a[48:51], v[240:243], v[36:39]
v_cvt_pk_bf16_f32 v118, v115, v119
v_cvt_pk_bf16_f32 v97, v104, v108
v_cvt_pk_bf16_f32 v101, v105, v109
v_cvt_pk_bf16_f32 v113, v120, v124
v_cvt_pk_bf16_f32 v117, v121, v125
v_cvt_pk_bf16_f32 v99, v106, v110
v_cvt_pk_bf16_f32 v103, v107, v111
v_cvt_pk_bf16_f32 v115, v122, v126
v_cvt_pk_bf16_f32 v119, v123, v127
ds_write2_b64 v5, v[96:97], v[112:113] offset0:0 offset1:16
v_cvt_pk_bf16_f32 v40, v24, v25
v_cvt_pk_bf16_f32 v41, v26, v27
ds_write2_b64 v0, v[100:101], v[116:117] offset0:32 offset1:48
v_cvt_pk_bf16_f32 v42, v28, v29
v_cvt_pk_bf16_f32 v43, v30, v31
v_max3_u32 v12, v12, v48, v13
v_exp_f32 v32, v32
v_mfma_f32_16x16x32_bf16 a[136:139], a[128:131], v[40:43], a[136:139]
ds_write2_b64 v5, v[98:99], v[114:115] offset0:80 offset1:64
v_exp_f32 v33, v33
v_mfma_f32_16x16x32_bf16 v[128:131], v[40:43], a[96:99], v[128:131]
s_nop 4
v_accvgpr_read_b32 v18, a136
v_rcp_f32 v13, v18
v_mfma_f32_16x16x32_bf16 v[132:135], v[40:43], a[100:103], v[132:135]
ds_write2_b64 v0, v[102:103], v[118:119] offset0:112 offset1:96
s_waitcnt vmcnt(12)
v_mfma_f32_16x16x32_bf16 v[136:139], v[40:43], a[104:107], v[136:139]
v_exp_f32 v34, v34
v_mfma_f32_16x16x32_bf16 v[140:143], v[40:43], a[108:111], v[140:143]
ds_read_b64_tr_b16 v[96:97], v56 offset:0
ds_read_b64_tr_b16 v[98:99], v57 offset:0
ds_read_b64_tr_b16 v[104:105], v56 offset:2048
ds_read_b64_tr_b16 v[106:107], v57 offset:2048
ds_read_b64_tr_b16 v[112:113], v58 offset:0
ds_read_b64_tr_b16 v[114:115], v59 offset:0
ds_read_b64_tr_b16 v[120:121], v58 offset:2048
ds_read_b64_tr_b16 v[122:123], v59 offset:2048
ds_write_b32 v60, v13
ds_read_b128 v[52:55], v61
v_exp_f32 v35, v35
v_mfma_f32_16x16x32_bf16 v[144:147], v[40:43], a[112:115], v[144:147]
ds_add_u32 v8, v10
v_exp_f32 v36, v36
v_mfma_f32_16x16x32_bf16 v[148:151], v[40:43], a[116:119], v[148:151]
v_exp_f32 v37, v37
v_mfma_f32_16x16x32_bf16 v[152:155], v[40:43], a[120:123], v[152:155]
v_add_f32 v50, v50, v32
v_add_f32 v51, v51, v33
v_mfma_f32_16x16x32_bf16 v[156:159], v[40:43], a[124:127], v[156:159]
v_exp_f32 v38, v38
v_exp_f32 v39, v39
s_waitcnt lgkmcnt(9)
buffer_store_dwordx4 v[96:99], v6, s[12:15], s82 offen offset:0 sc1
s_waitcnt lgkmcnt(7)
buffer_store_dwordx4 v[104:107], v6, s[12:15], s83 offen offset:0 sc1
s_waitcnt lgkmcnt(5)
buffer_store_dwordx4 v[112:115], v6, s[12:15], s82 offen offset:128 sc1
s_waitcnt lgkmcnt(1)
v_pk_mul_f32 v[128:129], v[128:129], v[52:53]
v_pk_mul_f32 v[132:133], v[132:133], v[52:53]
v_pk_mul_f32 v[144:145], v[144:145], v[52:53]
v_pk_mul_f32 v[148:149], v[148:149], v[52:53]
v_pk_mul_f32 v[130:131], v[130:131], v[54:55]
v_pk_mul_f32 v[134:135], v[134:135], v[54:55]
v_pk_mul_f32 v[146:147], v[146:147], v[54:55]
v_pk_mul_f32 v[150:151], v[150:151], v[54:55]
buffer_store_dwordx4 v[120:123], v6, s[12:15], s83 offen offset:128 sc1
v_cvt_pk_bf16_f32 v128, v128, v132
v_cvt_pk_bf16_f32 v144, v144, v148
v_cvt_pk_bf16_f32 v130, v130, v134
v_cvt_pk_bf16_f32 v146, v146, v150
v_pk_mul_f32 v[136:137], v[136:137], v[52:53]
v_pk_mul_f32 v[140:141], v[140:141], v[52:53]
v_cvt_pk_bf16_f32 v132, v129, v133
v_pk_mul_f32 v[152:153], v[152:153], v[52:53]
v_pk_mul_f32 v[156:157], v[156:157], v[52:53]
v_cvt_pk_bf16_f32 v148, v145, v149
v_pk_mul_f32 v[138:139], v[138:139], v[54:55]
v_pk_mul_f32 v[142:143], v[142:143], v[54:55]
v_cvt_pk_bf16_f32 v134, v131, v135
v_pk_mul_f32 v[154:155], v[154:155], v[54:55]
v_pk_mul_f32 v[158:159], v[158:159], v[54:55]
v_cvt_pk_bf16_f32 v150, v147, v151
v_cvt_pk_bf16_f32 v129, v136, v140
v_cvt_pk_bf16_f32 v133, v137, v141
v_cvt_pk_bf16_f32 v145, v152, v156
v_cvt_pk_bf16_f32 v149, v153, v157
v_cvt_pk_bf16_f32 v131, v138, v142
v_cvt_pk_bf16_f32 v135, v139, v143
v_cvt_pk_bf16_f32 v147, v154, v158
v_cvt_pk_bf16_f32 v151, v155, v159
ds_write2_b64 v5, v[128:129], v[144:145] offset0:0 offset1:16
v_add_f32 v50, v50, v34
v_add_f32 v51, v51, v35
ds_write2_b64 v0, v[132:133], v[148:149] offset0:32 offset1:48
v_add_f32 v50, v50, v36
v_add_f32 v51, v51, v37
v_add_f32 v50, v50, v38
v_add_f32 v51, v51, v39
v_add_f32 v50, v50, v51
v_mov_b32 v51, v50
v_cvt_pk_bf16_f32 v44, v32, v33
ds_write2_b64 v5, v[130:131], v[146:147] offset0:80 offset1:64
v_permlane16_swap_b32 v50, v51
v_add_f32 v50, v50, v51
v_mov_b32 v51, v50
v_cvt_pk_bf16_f32 v45, v34, v35
v_cvt_pk_bf16_f32 v46, v36, v37
v_permlane32_swap_b32 v50, v51
ds_write2_b64 v0, v[134:135], v[150:151] offset0:112 offset1:96
v_cvt_pk_bf16_f32 v47, v38, v39
v_max3_u32 v12, v12, v18, v13
v_add_f32 v50, v50, v51
v_mfma_f32_16x16x32_bf16 v[160:163], v[44:47], a[96:99], v[160:163]
v_rcp_f32 v13, v50
v_mfma_f32_16x16x32_bf16 v[164:167], v[44:47], a[100:103], v[164:167]
ds_read_b64_tr_b16 v[128:129], v56 offset:0
ds_read_b64_tr_b16 v[130:131], v57 offset:0
ds_read_b64_tr_b16 v[136:137], v56 offset:2048
ds_read_b64_tr_b16 v[138:139], v57 offset:2048
ds_read_b64_tr_b16 v[144:145], v58 offset:0
ds_read_b64_tr_b16 v[146:147], v59 offset:0
ds_read_b64_tr_b16 v[152:153], v58 offset:2048
ds_read_b64_tr_b16 v[154:155], v59 offset:2048
ds_read_b32 v11, v9
ds_write_b32 v60, v13
ds_read_b128 v[208:211], v61
v_add_u32 v17, v1, v7
v_mfma_f32_16x16x32_bf16 v[168:171], v[44:47], a[104:107], v[168:171]
ds_read_b128 v[192:195], v17 offset:0
ds_read_b128 v[196:199], v17 offset:64
v_add_u32 v1, s31, v1
v_mfma_f32_16x16x32_bf16 v[172:175], v[44:47], a[108:111], v[172:175]
ds_read_b128 v[200:203], v17 offset:128
ds_read_b128 v[204:207], v17 offset:192
v_add_u32 v2, s31, v2
v_mfma_f32_16x16x32_bf16 v[176:179], v[44:47], a[112:115], v[176:179]
s_sub_u32 s30, s30, 1
v_add_u32 v19, v1, v7
s_cselect_b32 s31, s35, s34
v_mfma_f32_16x16x32_bf16 v[180:183], v[44:47], a[116:119], v[180:183]
s_cselect_b32 s30, 7, s30
s_waitcnt lgkmcnt(13)
buffer_store_dwordx4 v[128:131], v6, s[12:15], s84 offen offset:0 sc1
s_waitcnt lgkmcnt(11)
buffer_store_dwordx4 v[136:139], v6, s[12:15], s85 offen offset:0 sc1
s_waitcnt lgkmcnt(9)
buffer_store_dwordx4 v[144:147], v6, s[12:15], s84 offen offset:128 sc1
s_waitcnt lgkmcnt(6)
v_cmp_gt_u32 vcc, s33, v11
v_mfma_f32_16x16x32_bf16 v[184:187], v[44:47], a[120:123], v[184:187]
ds_read_b128 v[212:215], v19 offset:64
v_add_u32 v1, s31, v1
v_mfma_f32_16x16x32_bf16 v[188:191], v[44:47], a[124:127], v[188:191]
s_cbranch_vccnz L_spin_49
L_spinret_50:
buffer_store_dwordx4 v[152:155], v6, s[12:15], s85 offen offset:128 sc1
v_add_u32 v2, s31, v2
s_waitcnt lgkmcnt(5)
v_pk_mul_f32 v[160:161], v[160:161], v[208:209]
v_pk_mul_f32 v[164:165], v[164:165], v[208:209]
v_pk_mul_f32 v[176:177], v[176:177], v[208:209]
v_pk_mul_f32 v[180:181], v[180:181], v[208:209]
v_pk_mul_f32 v[162:163], v[162:163], v[210:211]
v_pk_mul_f32 v[166:167], v[166:167], v[210:211]
v_pk_mul_f32 v[178:179], v[178:179], v[210:211]
v_pk_mul_f32 v[182:183], v[182:183], v[210:211]
v_pk_mul_f32 v[168:169], v[168:169], v[208:209]
v_pk_mul_f32 v[172:173], v[172:173], v[208:209]
v_pk_mul_f32 v[184:185], v[184:185], v[208:209]
v_pk_mul_f32 v[188:189], v[188:189], v[208:209]
v_pk_mul_f32 v[170:171], v[170:171], v[210:211]
v_pk_mul_f32 v[174:175], v[174:175], v[210:211]
v_pk_mul_f32 v[186:187], v[186:187], v[210:211]
v_pk_mul_f32 v[190:191], v[190:191], v[210:211]
s_waitcnt lgkmcnt(4)
v_mfma_f32_16x16x32_bf16 v[64:67], a[146:149], v[192:195], 0
s_sub_u32 s30, s30, 1
buffer_load_dwordx4 v3, s[4:7], s24 offen lds
v_cvt_pk_bf16_f32 v160, v160, v164
v_mfma_f32_16x16x32_bf16 v[68:71], a[144:147], v[192:195], 0
s_cselect_b32 s31, s35, s34
v_cvt_pk_bf16_f32 v176, v176, v180
v_cvt_pk_bf16_f32 v162, v162, v166
v_mfma_f32_16x16x32_bf16 v[64:67], a[150:153], v[192:195], v[64:67]
s_cselect_b32 s30, 7, s30
v_cvt_pk_bf16_f32 v178, v178, v182
buffer_load_dwordx4 v4, s[4:7], s24 offen offset:1056 lds
v_cvt_pk_bf16_f32 v164, v161, v165
v_mfma_f32_16x16x32_bf16 v[68:71], a[148:151], v[192:195], v[68:71]
s_add_u32 s33, s33, 1
v_cvt_pk_bf16_f32 v180, v177, v181
v_cvt_pk_bf16_f32 v166, v163, v167
s_waitcnt lgkmcnt(3)
v_mfma_f32_16x16x32_bf16 v[72:75], a[146:149], v[196:199], 0
buffer_load_dwordx4 v3, s[8:11], s24 offen offset:2080 lds
v_cvt_pk_bf16_f32 v182, v179, v183
v_mfma_f32_16x16x32_bf16 v[76:79], a[144:147], v[196:199], 0
ds_read_b128 v[208:211], v19 offset:0
v_cvt_pk_bf16_f32 v161, v168, v172
v_mfma_f32_16x16x32_bf16 v[72:75], a[150:153], v[196:199], v[72:75]
ds_read_b128 v[216:219], v19 offset:128
v_cvt_pk_bf16_f32 v165, v169, v173
v_mfma_f32_16x16x32_bf16 v[76:79], a[148:151], v[196:199], v[76:79]
s_waitcnt vmcnt(19)
v_cvt_pk_bf16_f32 v177, v184, v188
v_cvt_pk_bf16_f32 v181, v185, v189
s_waitcnt lgkmcnt(4)
v_mfma_f32_16x16x32_bf16 v[80:83], a[146:149], v[200:203], 0
ds_write2_b64 v5, v[160:161], v[176:177] offset0:0 offset1:16
v_cvt_pk_bf16_f32 v163, v170, v174
v_mfma_f32_16x16x32_bf16 v[84:87], a[144:147], v[200:203], 0
ds_write2_b64 v0, v[164:165], v[180:181] offset0:32 offset1:48
v_cvt_pk_bf16_f32 v167, v171, v175
v_mfma_f32_16x16x32_bf16 v[80:83], a[150:153], v[200:203], v[80:83]
buffer_load_dwordx4 v4, s[8:11], s24 offen offset:3136 lds
v_cvt_pk_bf16_f32 v179, v186, v190
v_mfma_f32_16x16x32_bf16 v[84:87], a[148:151], v[200:203], v[84:87]
s_add_u32 m0, m0, s34
v_cvt_pk_bf16_f32 v183, v187, v191
ds_write2_b64 v5, v[162:163], v[178:179] offset0:80 offset1:64
s_cmp_eq_u32 m0, s29
s_waitcnt lgkmcnt(6)
v_mfma_f32_16x16x32_bf16 v[88:91], a[146:149], v[204:207], 0
s_cselect_b32 m0, s28, m0
ds_write2_b64 v0, v[166:167], v[182:183] offset0:112 offset1:96
s_add_u32 s24, s24, s25
v_mfma_f32_16x16x32_bf16 v[92:95], a[144:147], v[204:207], 0
buffer_load_dwordx4 v3, s[4:7], s24 offen lds
buffer_load_dwordx4 v4, s[4:7], s24 offen offset:1056 lds
ds_read_b64_tr_b16 v[160:161], v56 offset:0
ds_read_b64_tr_b16 v[162:163], v57 offset:0
ds_read_b64_tr_b16 v[168:169], v56 offset:2048
ds_read_b64_tr_b16 v[170:171], v57 offset:2048
ds_read_b64_tr_b16 v[176:177], v58 offset:0
buffer_load_dwordx4 v3, s[8:11], s24 offen offset:2080 lds
ds_read_b64_tr_b16 v[178:179], v59 offset:0
ds_add_u32 v8, v10
ds_read_b64_tr_b16 v[184:185], v58 offset:2048
ds_read_b64_tr_b16 v[186:187], v59 offset:2048
v_add_u32 v21, v1, v7
v_mfma_f32_16x16x32_bf16 v[88:91], a[150:153], v[204:207], v[88:91]
ds_read_b128 v[220:223], v19 offset:192
buffer_load_dwordx4 v4, s[8:11], s24 offen offset:3136 lds
v_add_u32 v1, s31, v1
v_mfma_f32_16x16x32_bf16 v[92:95], a[148:151], v[204:207], v[92:95]
s_add_u32 m0, m0, s34
ds_read_b128 a[0:3], v1 offset:0
ds_read_b128 a[4:7], v1 offset:64
ds_read_b128 a[8:11], v1 offset:128
v_max3_u32 v12, v12, v50, v13
s_waitcnt lgkmcnt(15)
v_mfma_f32_16x16x32_bf16 v[96:99], a[146:149], v[208:211], 0
s_cmp_eq_u32 m0, s29
ds_read_b128 a[12:15], v1 offset:192
s_waitcnt lgkmcnt(12)
buffer_store_dwordx4 v[160:163], v6, s[12:15], s86 offen offset:0 sc1
v_mbcnt_lo_u32_b32 v13, -1, 0
v_mfma_f32_16x16x32_bf16 v[100:103], a[144:147], v[208:211], 0
s_cselect_b32 m0, s28, m0
v_mbcnt_hi_u32_b32 v13, -1, v13
v_lshrrev_b32 v13, 2, v13
v_mfma_f32_16x16x32_bf16 v[96:99], a[150:153], v[208:211], v[96:99]
s_add_u32 s24, s24, s25
s_waitcnt lgkmcnt(10)
buffer_store_dwordx4 v[168:171], v6, s[12:15], s87 offen offset:0 sc1
v_and_b32 v13, 12, v13
v_mfma_f32_16x16x32_bf16 v[100:103], a[148:151], v[208:211], v[100:103]
ds_read_b128 v[224:227], v21 offset:0
v_sub_u32 v13, s50, v13
v_mfma_f32_16x16x32_bf16 v[104:107], a[146:149], v[212:215], 0
s_waitcnt lgkmcnt(9)
buffer_store_dwordx4 v[176:179], v6, s[12:15], s86 offen offset:128 sc1
v_cvt_f32_i32 v13, v13
v_mfma_f32_16x16x32_bf16 v[108:111], a[144:147], v[212:215], 0
ds_read_b32 v11, v9
v_mov_b32 v14, 0x7c800000
v_mfma_f32_16x16x32_bf16 v[104:107], a[150:153], v[212:215], v[104:107]
s_waitcnt lgkmcnt(7)
buffer_store_dwordx4 v[184:187], v6, s[12:15], s87 offen offset:128 sc1
v_fmaak_f32 v16, v13, v14, 0xfc000000
v_mfma_f32_16x16x32_bf16 v[108:111], a[148:151], v[212:215], v[108:111]
ds_read_b128 v[228:231], v21 offset:64
v_fmaak_f32 v17, v13, v14, 0xfcc00000
v_mfma_f32_16x16x32_bf16 v[112:115], a[146:149], v[216:219], 0
ds_read_b128 v[232:235], v21 offset:128
v_fmaak_f32 v18, v13, v14, 0xfd200000
v_mfma_f32_16x16x32_bf16 v[116:119], a[144:147], v[216:219], 0
ds_read_b128 v[236:239], v21 offset:192
v_fmaak_f32 v19, v13, v14, 0xfd600000
v_mfma_f32_16x16x32_bf16 v[112:115], a[150:153], v[216:219], v[112:115]
ds_read_b128 a[16:19], v1 offset:512
v_min_f32 v16, 0, v16
v_mfma_f32_16x16x32_bf16 v[116:119], a[148:151], v[216:219], v[116:119]
ds_read_b128 a[20:23], v1 offset:576
v_min_f32 v17, 0, v17
s_waitcnt lgkmcnt(11)
v_mfma_f32_16x16x32_bf16 v[120:123], a[146:149], v[220:223], 0
ds_read_b128 a[24:27], v1 offset:640
v_min_f32 v18, 0, v18
v_mfma_f32_16x16x32_bf16 v[124:127], a[144:147], v[220:223], 0
ds_read_b128 a[28:31], v1 offset:704
v_min_f32 v19, 0, v19
v_mfma_f32_16x16x32_bf16 v[120:123], a[150:153], v[220:223], v[120:123]
buffer_load_dwordx4 v3, s[4:7], s24 offen lds
v_cvt_pk_bf16_f32 v192, v64, v65
v_mfma_f32_16x16x32_bf16 v[124:127], a[148:151], v[220:223], v[124:127]
buffer_load_dwordx4 v4, s[4:7], s24 offen offset:1056 lds
v_cvt_pk_bf16_f32 v193, v66, v67
s_waitcnt lgkmcnt(8)
v_mfma_f32_16x16x32_bf16 v[128:131], a[146:149], v[224:227], 0
v_cvt_pk_bf16_f32 v194, v68, v69
v_cvt_pk_bf16_f32 v195, v70, v71
v_mfma_f32_16x16x32_bf16 v[132:135], a[144:147], v[224:227], 0
buffer_load_dwordx4 v3, s[8:11], s24 offen offset:2080 lds
v_cvt_pk_bf16_f32 v196, v72, v73
v_mfma_f32_16x16x32_bf16 v[24:27], a[0:3], v[192:195], v[16:19]
v_cvt_pk_bf16_f32 v197, v74, v75
v_cvt_pk_bf16_f32 v198, v76, v77
v_mfma_f32_16x16x32_bf16 v[128:131], a[150:153], v[224:227], v[128:131]
v_cvt_pk_bf16_f32 v199, v78, v79
v_cvt_pk_bf16_f32 v200, v80, v81
v_mfma_f32_16x16x32_bf16 v[132:135], a[148:151], v[224:227], v[132:135]
v_cvt_pk_bf16_f32 v201, v82, v83
v_cvt_pk_bf16_f32 v202, v84, v85
v_mfma_f32_16x16x32_bf16 v[24:27], a[4:7], v[196:199], v[24:27]
buffer_load_dwordx4 v4, s[8:11], s24 offen offset:3136 lds
v_cvt_pk_bf16_f32 v203, v86, v87
s_waitcnt lgkmcnt(6)
v_mfma_f32_16x16x32_bf16 v[136:139], a[146:149], v[228:231], 0
s_add_u32 m0, m0, s34
v_add_u32 v2, s31, v2
ds_read_b64_tr_b16 a[64:65], v2 offset:0
ds_read_b64_tr_b16 a[66:67], v2 offset:512
v_cvt_pk_bf16_f32 v204, v88, v89
v_mfma_f32_16x16x32_bf16 v[24:27], a[8:11], v[200:203], v[24:27]
s_sub_u32 s30, s30, 1
v_cvt_pk_bf16_f32 v205, v90, v91
v_cvt_pk_bf16_f32 v206, v92, v93
v_mfma_f32_16x16x32_bf16 v[140:143], a[144:147], v[228:231], 0
s_cselect_b32 s31, s35, s34
v_cvt_pk_bf16_f32 v207, v94, v95
ds_read_b64_tr_b16 a[68:69], v2 offset:32
ds_read_b64_tr_b16 a[70:71], v2 offset:544
v_cvt_pk_bf16_f32 v208, v96, v97
v_mfma_f32_16x16x32_bf16 v[24:27], a[12:15], v[204:207], v[24:27]
s_cselect_b32 s30, 7, s30
v_cvt_pk_bf16_f32 v209, v98, v99
v_cvt_pk_bf16_f32 v210, v100, v101
v_mfma_f32_16x16x32_bf16 v[136:139], a[150:153], v[228:231], v[136:139]
s_cmp_eq_u32 m0, s29
v_cvt_pk_bf16_f32 v211, v102, v103
ds_read_b64_tr_b16 a[72:73], v2 offset:64
ds_read_b64_tr_b16 a[74:75], v2 offset:576
v_cvt_pk_bf16_f32 v212, v104, v105
v_mfma_f32_16x16x32_bf16 v[32:35], a[0:3], v[208:211], v[16:19]
s_cselect_b32 m0, s28, m0
v_cvt_pk_bf16_f32 v213, v106, v107
v_cvt_pk_bf16_f32 v214, v108, v109
v_mfma_f32_16x16x32_bf16 v[140:143], a[148:151], v[228:231], v[140:143]
s_add_u32 s24, s24, s25
v_cvt_pk_bf16_f32 v215, v110, v111
ds_read_b64_tr_b16 a[76:77], v2 offset:96
ds_read_b64_tr_b16 a[78:79], v2 offset:608
v_cvt_pk_bf16_f32 v216, v112, v113
v_mfma_f32_16x16x32_bf16 v[32:35], a[4:7], v[212:215], v[32:35]
ds_read_b64_tr_b16 a[80:81], v2 offset:128
v_cvt_pk_bf16_f32 v217, v114, v115
s_waitcnt lgkmcnt(14)
v_mfma_f32_16x16x32_bf16 v[144:147], a[146:149], v[232:235], 0
ds_read_b64_tr_b16 a[82:83], v2 offset:640
v_cvt_pk_bf16_f32 v218, v116, v117
v_mfma_f32_16x16x32_bf16 v[148:151], a[144:147], v[232:235], 0
ds_read_b64_tr_b16 a[84:85], v2 offset:160
v_cvt_pk_bf16_f32 v219, v118, v119
v_mfma_f32_16x16x32_bf16 v[144:147], a[150:153], v[232:235], v[144:147]
ds_read_b64_tr_b16 a[86:87], v2 offset:672
v_cvt_pk_bf16_f32 v220, v120, v121
v_mfma_f32_16x16x32_bf16 v[32:35], a[8:11], v[216:219], v[32:35]
ds_read_b64_tr_b16 a[88:89], v2 offset:192
v_cvt_pk_bf16_f32 v221, v122, v123
v_mfma_f32_16x16x32_bf16 v[148:151], a[148:151], v[232:235], v[148:151]
ds_read_b64_tr_b16 a[90:91], v2 offset:704
v_cvt_pk_bf16_f32 v222, v124, v125
s_waitcnt lgkmcnt(15)
v_mfma_f32_16x16x32_bf16 v[152:155], a[146:149], v[236:239], 0
ds_read_b64_tr_b16 a[92:93], v2 offset:224
v_cvt_pk_bf16_f32 v223, v126, v127
v_mfma_f32_16x16x32_bf16 v[156:159], a[144:147], v[236:239], 0
ds_read_b64_tr_b16 a[94:95], v2 offset:736
v_exp_f32 v24, v24
v_mfma_f32_16x16x32_bf16 v[32:35], a[12:15], v[220:223], v[32:35]
s_waitcnt vmcnt(28)
ds_add_u32 v8, v10
v_exp_f32 v25, v25
v_mfma_f32_16x16x32_bf16 v[152:155], a[150:153], v[236:239], v[152:155]
buffer_load_dwordx4 v3, s[4:7], s24 offen lds
v_exp_f32 v26, v26
v_mfma_f32_16x16x32_bf16 v[156:159], a[148:151], v[236:239], v[156:159]
buffer_load_dwordx4 v4, s[4:7], s24 offen offset:1056 lds
v_exp_f32 v27, v27
v_mov_b32 v42, 0
v_mov_b32 v43, 0
v_cvt_pk_bf16_f32 v40, v24, v25
v_cvt_pk_bf16_f32 v41, v26, v27
v_cvt_pk_bf16_f32 v224, v128, v129
v_cvt_pk_bf16_f32 v225, v130, v131
s_waitcnt lgkmcnt(15)
v_mfma_f32_16x16x32_bf16 v[64:67], v[40:43], a[64:67], 0
buffer_load_dwordx4 v3, s[8:11], s24 offen offset:2080 lds
v_cvt_pk_bf16_f32 v226, v132, v133
s_waitcnt lgkmcnt(13)
v_mfma_f32_16x16x32_bf16 v[68:71], v[40:43], a[68:71], 0
v_cvt_pk_bf16_f32 v227, v134, v135
v_cvt_pk_bf16_f32 v228, v136, v137
s_waitcnt lgkmcnt(11)
v_mfma_f32_16x16x32_bf16 v[72:75], v[40:43], a[72:75], 0
v_cvt_pk_bf16_f32 v229, v138, v139
v_cvt_pk_bf16_f32 v230, v140, v141
s_waitcnt lgkmcnt(9)
v_mfma_f32_16x16x32_bf16 v[76:79], v[40:43], a[76:79], 0
buffer_load_dwordx4 v4, s[8:11], s24 offen offset:3136 lds
v_cvt_pk_bf16_f32 v231, v142, v143
s_waitcnt lgkmcnt(7)
v_mfma_f32_16x16x32_bf16 v[80:83], v[40:43], a[80:83], 0
s_add_u32 m0, m0, s34
v_cvt_pk_bf16_f32 v232, v144, v145
v_cvt_pk_bf16_f32 v233, v146, v147
s_waitcnt lgkmcnt(5)
v_mfma_f32_16x16x32_bf16 v[84:87], v[40:43], a[84:87], 0
s_cmp_eq_u32 m0, s29
v_cvt_pk_bf16_f32 v234, v148, v149
v_cvt_pk_bf16_f32 v235, v150, v151
s_waitcnt lgkmcnt(3)
v_mfma_f32_16x16x32_bf16 v[88:91], v[40:43], a[88:91], 0
s_cselect_b32 m0, s28, m0
v_cvt_pk_bf16_f32 v236, v152, v153
v_cvt_pk_bf16_f32 v237, v154, v155
s_waitcnt lgkmcnt(1)
v_mfma_f32_16x16x32_bf16 v[92:95], v[40:43], a[92:95], 0
s_add_u32 s24, s24, s25
v_cvt_pk_bf16_f32 v238, v156, v157
v_cvt_pk_bf16_f32 v239, v158, v159
v_mfma_f32_16x16x32_bf16 a[132:135], a[128:131], v[40:43], 0
v_exp_f32 v32, v32
v_mfma_f32_16x16x32_bf16 v[24:27], a[0:3], v[224:227], v[16:19]
v_exp_f32 v33, v33
v_mfma_f32_16x16x32_bf16 v[24:27], a[4:7], v[228:231], v[24:27]
v_exp_f32 v34, v34
v_mfma_f32_16x16x32_bf16 v[24:27], a[8:11], v[232:235], v[24:27]
v_exp_f32 v35, v35
v_mfma_f32_16x16x32_bf16 v[24:27], a[12:15], v[236:239], v[24:27]
v_cmp_gt_u32 vcc, s33, v11
v_mov_b32 v46, 0
v_mov_b32 v47, 0
v_cvt_pk_bf16_f32 v44, v32, v33
v_cvt_pk_bf16_f32 v45, v34, v35
v_add_u32 v1, s31, v1
s_cbranch_vccnz L_spin_51
L_spinret_52:
v_mfma_f32_16x16x32_bf16 v[96:99], v[44:47], a[64:67], 0
s_add_u32 s33, s33, 1
ds_read_b128 a[32:35], v1 offset:0
ds_read_b128 a[36:39], v1 offset:64
ds_read_b128 a[40:43], v1 offset:128
v_exp_f32 v24, v24
v_mfma_f32_16x16x32_bf16 v[100:103], v[44:47], a[68:71], 0
ds_read_b128 a[44:47], v1 offset:192
ds_read_b128 a[60:63], v1 offset:704
v_exp_f32 v25, v25
v_mfma_f32_16x16x32_bf16 v[104:107], v[44:47], a[72:75], 0
ds_read_b128 a[56:59], v1 offset:640
ds_read_b128 a[52:55], v1 offset:576
v_exp_f32 v26, v26
v_mfma_f32_16x16x32_bf16 v[108:111], v[44:47], a[76:79], 0
ds_read_b128 a[48:51], v1 offset:512
v_exp_f32 v27, v27
v_mfma_f32_16x16x32_bf16 v[112:115], v[44:47], a[80:83], 0
v_cvt_pk_bf16_f32 v40, v24, v25
v_cvt_pk_bf16_f32 v41, v26, v27
v_mfma_f32_16x16x32_bf16 v[116:119], v[44:47], a[84:87], 0
v_add_u32 v2, s31, v2
ds_read_b64_tr_b16 a[96:97], v2 offset:0
ds_read_b64_tr_b16 a[98:99], v2 offset:512
ds_read_b64_tr_b16 a[100:101], v2 offset:32
ds_read_b64_tr_b16 a[102:103], v2 offset:544
ds_read_b64_tr_b16 a[104:105], v2 offset:64
ds_read_b64_tr_b16 a[106:107], v2 offset:576
ds_read_b64_tr_b16 a[108:109], v2 offset:96
ds_read_b64_tr_b16 a[110:111], v2 offset:608
ds_read_b64_tr_b16 a[112:113], v2 offset:128
ds_read_b64_tr_b16 a[114:115], v2 offset:640
ds_read_b64_tr_b16 a[116:117], v2 offset:160
ds_read_b64_tr_b16 a[118:119], v2 offset:672
ds_read_b64_tr_b16 a[120:121], v2 offset:192
ds_read_b64_tr_b16 a[122:123], v2 offset:704
ds_read_b64_tr_b16 a[124:125], v2 offset:224
ds_read_b64_tr_b16 a[126:127], v2 offset:736
s_sub_u32 s30, s30, 1
v_mfma_f32_16x16x32_bf16 v[120:123], v[44:47], a[88:91], 0
s_cselect_b32 s31, s35, s34
ds_read_b32 v11, v9
s_cselect_b32 s30, 7, s30
v_mfma_f32_16x16x32_bf16 v[124:127], v[44:47], a[92:95], 0
v_add_u32 v1, s31, v1
v_add_u32 v2, s31, v2
v_mfma_f32_16x16x32_bf16 a[136:139], a[128:131], v[44:47], 0
s_waitcnt lgkmcnt(15)
v_mfma_f32_16x16x32_bf16 v[32:35], a[32:35], v[192:195], 0
v_mfma_f32_16x16x32_bf16 v[32:35], a[36:39], v[196:199], v[32:35]
v_mfma_f32_16x16x32_bf16 v[32:35], a[40:43], v[200:203], v[32:35]
v_mfma_f32_16x16x32_bf16 v[32:35], a[44:47], v[204:207], v[32:35]
v_mfma_f32_16x16x32_bf16 v[36:39], a[60:63], v[204:207], 0
v_mfma_f32_16x16x32_bf16 v[36:39], a[56:59], v[200:203], v[36:39]
s_nop 5
v_exp_f32 v32, v32
v_mfma_f32_16x16x32_bf16 v[36:39], a[52:55], v[196:199], v[36:39]
v_exp_f32 v33, v33
v_mfma_f32_16x16x32_bf16 v[36:39], a[48:51], v[192:195], v[36:39]
s_waitcnt lgkmcnt(0)
v_cmp_gt_u32 vcc, s33, v11
v_cvt_pk_bf16_f32 v44, v32, v33
v_mfma_f32_16x16x32_bf16 v[128:131], v[40:43], a[64:67], 0
v_exp_f32 v34, v34
v_mfma_f32_16x16x32_bf16 v[132:135], v[40:43], a[68:71], 0
s_cbranch_vccnz L_spin_53
L_spinret_54:
v_exp_f32 v35, v35
v_mfma_f32_16x16x32_bf16 v[136:139], v[40:43], a[72:75], 0
v_exp_f32 v36, v36
v_mfma_f32_16x16x32_bf16 v[140:143], v[40:43], a[76:79], 0
v_cvt_pk_bf16_f32 v45, v34, v35
v_mfma_f32_16x16x32_bf16 v[144:147], v[40:43], a[80:83], 0
v_mfma_f32_16x16x32_bf16 v[148:151], v[40:43], a[84:87], 0
v_mfma_f32_16x16x32_bf16 v[152:155], v[40:43], a[88:91], 0
v_mfma_f32_16x16x32_bf16 v[156:159], v[40:43], a[92:95], 0
v_mfma_f32_16x16x32_bf16 a[140:143], a[128:131], v[40:43], 0
s_branch L_loop3
L_t4_1_0:
v_mfma_f32_16x16x32_bf16 v[32:35], a[32:35], v[208:211], 0
s_mov_b32 s14, s47
v_exp_f32 v30, v30
v_mfma_f32_16x16x32_bf16 v[32:35], a[36:39], v[212:215], v[32:35]
s_add_u32 s80, s46, 0
v_exp_f32 v29, v29
v_mfma_f32_16x16x32_bf16 v[32:35], a[40:43], v[216:219], v[32:35]
s_add_u32 s81, s46, 131072
v_exp_f32 v31, v31
v_mfma_f32_16x16x32_bf16 v[32:35], a[44:47], v[220:223], v[32:35]
s_add_u32 s82, s46, 262144
v_cvt_pk_bf16_f32 v42, v28, v29
v_cvt_pk_bf16_f32 v43, v30, v31
v_mfma_f32_16x16x32_bf16 v[36:39], a[60:63], v[220:223], 0
s_add_u32 s83, s46, 393216
s_add_u32 s84, s46, 524288
s_add_u32 s85, s46, 655360
v_mfma_f32_16x16x32_bf16 v[36:39], a[56:59], v[216:219], v[36:39]
s_add_u32 s86, s46, 786432
s_add_u32 s87, s46, 917504
v_exp_f32 v33, v33
v_mfma_f32_16x16x32_bf16 v[36:39], a[52:55], v[212:215], v[36:39]
v_exp_f32 v34, v34
v_mfma_f32_16x16x32_bf16 v[36:39], a[48:51], v[208:211], v[36:39]
v_exp_f32 v32, v32
v_mfma_f32_16x16x32_bf16 a[132:135], a[128:131], v[40:43], a[132:135]
v_add_f32 v48, v48, v32
v_cvt_pk_bf16_f32 v44, v32, v33
v_mfma_f32_16x16x32_bf16 v[64:67], v[40:43], a[96:99], v[64:67]
v_add_f32 v48, v48, v34
s_nop 1
v_exp_f32 v37, v37
v_mfma_f32_16x16x32_bf16 v[68:71], v[40:43], a[100:103], v[68:71]
v_accvgpr_read_b32 v16, a132
v_rcp_f32 v13, v16
v_mfma_f32_16x16x32_bf16 v[72:75], v[40:43], a[104:107], v[72:75]
ds_write_b32 v60, v13
v_exp_f32 v38, v38
v_mfma_f32_16x16x32_bf16 v[76:79], v[40:43], a[108:111], v[76:79]
ds_read_b128 v[52:55], v61
v_exp_f32 v36, v36
v_mfma_f32_16x16x32_bf16 v[80:83], v[40:43], a[112:115], v[80:83]
v_exp_f32 v39, v39
v_mfma_f32_16x16x32_bf16 v[84:87], v[40:43], a[116:119], v[84:87]
v_cvt_pk_bf16_f32 v47, v38, v39
v_exp_f32 v35, v35
v_mfma_f32_16x16x32_bf16 v[88:91], v[40:43], a[120:123], v[88:91]
v_cvt_pk_bf16_f32 v46, v36, v37
v_add_f32 v48, v48, v36
v_mfma_f32_16x16x32_bf16 v[92:95], v[40:43], a[124:127], v[92:95]
v_add_f32 v48, v48, v38
v_add_f32 v49, v49, v33
v_mfma_f32_16x16x32_bf16 v[24:27], a[32:35], v[224:227], 0
v_add_f32 v49, v49, v35
v_add_f32 v49, v49, v37
v_mfma_f32_16x16x32_bf16 v[24:27], a[36:39], v[228:231], v[24:27]
v_add_f32 v49, v49, v39
v_add_f32 v48, v48, v49
v_mfma_f32_16x16x32_bf16 v[24:27], a[40:43], v[232:235], v[24:27]
v_mov_b32 v49, v48
v_cvt_pk_bf16_f32 v45, v34, v35
v_mfma_f32_16x16x32_bf16 v[24:27], a[44:47], v[236:239], v[24:27]
v_permlane16_swap_b32 v48, v49
v_mfma_f32_16x16x32_bf16 v[28:31], a[60:63], v[236:239], 0
s_waitcnt lgkmcnt(0)
v_pk_mul_f32 v[82:83], v[82:83], v[54:55]
v_pk_mul_f32 v[70:71], v[70:71], v[54:55]
v_pk_mul_f32 v[90:91], v[90:91], v[54:55]
v_pk_mul_f32 v[64:65], v[64:65], v[52:53]
v_pk_mul_f32 v[66:67], v[66:67], v[54:55]
v_pk_mul_f32 v[80:81], v[80:81], v[52:53]
v_pk_mul_f32 v[84:85], v[84:85], v[52:53]
v_pk_mul_f32 v[74:75], v[74:75], v[54:55]
v_pk_mul_f32 v[78:79], v[78:79], v[54:55]
v_pk_mul_f32 v[72:73], v[72:73], v[52:53]
v_pk_mul_f32 v[86:87], v[86:87], v[54:55]
v_pk_mul_f32 v[68:69], v[68:69], v[52:53]
v_pk_mul_f32 v[76:77], v[76:77], v[52:53]
v_pk_mul_f32 v[94:95], v[94:95], v[54:55]
v_pk_mul_f32 v[92:93], v[92:93], v[52:53]
v_pk_mul_f32 v[88:89], v[88:89], v[52:53]
v_mfma_f32_16x16x32_bf16 v[28:31], a[56:59], v[232:235], v[28:31]
v_add_f32 v48, v48, v49
v_mov_b32 v49, v48
v_mfma_f32_16x16x32_bf16 v[28:31], a[52:55], v[228:231], v[28:31]
s_nop 0
v_permlane32_swap_b32 v48, v49
v_mfma_f32_16x16x32_bf16 v[28:31], a[48:51], v[224:227], v[28:31]
v_add_f32 v48, v48, v49
v_max3_u32 v12, v12, v16, v13
v_mfma_f32_16x16x32_bf16 v[96:99], v[44:47], a[96:99], v[96:99]
v_rcp_f32 v13, v48
v_mfma_f32_16x16x32_bf16 v[100:103], v[44:47], a[100:103], v[100:103]
ds_write_b32 v60, v13
v_cvt_pk_bf16_f32 v82, v82, v86
v_mfma_f32_16x16x32_bf16 v[104:107], v[44:47], a[104:107], v[104:107]
v_cvt_pk_bf16_f32 v86, v83, v87
v_cvt_pk_bf16_f32 v64, v64, v68
v_mfma_f32_16x16x32_bf16 v[108:111], v[44:47], a[108:111], v[108:111]
v_cvt_pk_bf16_f32 v68, v65, v69
v_cvt_pk_bf16_f32 v69, v73, v77
v_mfma_f32_16x16x32_bf16 v[112:115], v[44:47], a[112:115], v[112:115]
v_cvt_pk_bf16_f32 v83, v90, v94
v_cvt_pk_bf16_f32 v65, v72, v76
v_mfma_f32_16x16x32_bf16 v[116:119], v[44:47], a[116:119], v[116:119]
v_cvt_pk_bf16_f32 v66, v66, v70
v_cvt_pk_bf16_f32 v70, v67, v71
v_mfma_f32_16x16x32_bf16 v[120:123], v[44:47], a[120:123], v[120:123]
v_cvt_pk_bf16_f32 v67, v74, v78
v_cvt_pk_bf16_f32 v71, v75, v79
v_mfma_f32_16x16x32_bf16 v[124:127], v[44:47], a[124:127], v[124:127]
ds_write2_b64 v5, v[66:67], v[82:83] offset0:80 offset1:64
v_cvt_pk_bf16_f32 v80, v80, v84
v_mfma_f32_16x16x32_bf16 v[32:35], a[32:35], v[240:243], 0
v_cvt_pk_bf16_f32 v84, v81, v85
v_cvt_pk_bf16_f32 v81, v88, v92
v_mfma_f32_16x16x32_bf16 v[32:35], a[36:39], v[244:247], v[32:35]
ds_write2_b64 v5, v[64:65], v[80:81] offset0:0 offset1:16
v_cvt_pk_bf16_f32 v85, v89, v93
v_mfma_f32_16x16x32_bf16 v[32:35], a[40:43], v[248:251], v[32:35]
ds_write2_b64 v0, v[68:69], v[84:85] offset0:32 offset1:48
v_cvt_pk_bf16_f32 v87, v91, v95
v_mfma_f32_16x16x32_bf16 v[32:35], a[44:47], v[252:255], v[32:35]
v_exp_f32 v30, v30
v_mfma_f32_16x16x32_bf16 v[36:39], a[60:63], v[252:255], 0
ds_write2_b64 v0, v[70:71], v[86:87] offset0:112 offset1:96
v_exp_f32 v28, v28
v_mfma_f32_16x16x32_bf16 v[36:39], a[56:59], v[248:251], v[36:39]
v_exp_f32 v27, v27
v_mfma_f32_16x16x32_bf16 v[36:39], a[52:55], v[244:247], v[36:39]
ds_read_b64_tr_b16 v[64:65], v56 offset:0
ds_read_b64_tr_b16 v[66:67], v57 offset:0
v_exp_f32 v31, v31
v_mfma_f32_16x16x32_bf16 v[36:39], a[48:51], v[240:243], v[36:39]
ds_read_b64_tr_b16 v[74:75], v57 offset:2048
v_exp_f32 v26, v26
v_exp_f32 v25, v25
v_cvt_pk_bf16_f32 v41, v26, v27
v_exp_f32 v29, v29
v_cvt_pk_bf16_f32 v43, v30, v31
v_cvt_pk_bf16_f32 v42, v28, v29
v_exp_f32 v24, v24
ds_read_b64_tr_b16 v[72:73], v56 offset:2048
v_cvt_pk_bf16_f32 v40, v24, v25
ds_read_b128 v[192:195], v61
ds_read_b64_tr_b16 v[82:83], v59 offset:0
v_max3_u32 v12, v12, v48, v13
v_mfma_f32_16x16x32_bf16 a[136:139], a[128:131], v[40:43], a[136:139]
ds_read_b64_tr_b16 v[80:81], v58 offset:0
ds_read_b64_tr_b16 v[88:89], v58 offset:2048
ds_read_b64_tr_b16 v[90:91], v59 offset:2048
v_exp_f32 v37, v37
v_mfma_f32_16x16x32_bf16 v[128:131], v[40:43], a[96:99], v[128:131]
s_nop 2
v_accvgpr_read_b32 v18, a136
v_rcp_f32 v13, v18
v_mfma_f32_16x16x32_bf16 v[132:135], v[40:43], a[100:103], v[132:135]
ds_write_b32 v60, v13
s_waitcnt lgkmcnt(8)
buffer_store_dwordx4 v[64:67], v6, s[12:15], s80 offen offset:0 sc1
v_exp_f32 v35, v35
v_mfma_f32_16x16x32_bf16 v[136:139], v[40:43], a[104:107], v[136:139]
s_waitcnt lgkmcnt(6)
buffer_store_dwordx4 v[72:75], v6, s[12:15], s81 offen offset:0 sc1
s_waitcnt lgkmcnt(5)
v_pk_mul_f32 v[118:119], v[118:119], v[194:195]
v_pk_mul_f32 v[116:117], v[116:117], v[192:193]
v_pk_mul_f32 v[108:109], v[108:109], v[192:193]
v_pk_mul_f32 v[110:111], v[110:111], v[194:195]
v_pk_mul_f32 v[112:113], v[112:113], v[192:193]
v_pk_mul_f32 v[114:115], v[114:115], v[194:195]
v_pk_mul_f32 v[122:123], v[122:123], v[194:195]
v_pk_mul_f32 v[120:121], v[120:121], v[192:193]
v_pk_mul_f32 v[98:99], v[98:99], v[194:195]
v_pk_mul_f32 v[106:107], v[106:107], v[194:195]
v_pk_mul_f32 v[124:125], v[124:125], v[192:193]
v_pk_mul_f32 v[96:97], v[96:97], v[192:193]
v_pk_mul_f32 v[126:127], v[126:127], v[194:195]
v_pk_mul_f32 v[102:103], v[102:103], v[194:195]
v_pk_mul_f32 v[100:101], v[100:101], v[192:193]
v_pk_mul_f32 v[104:105], v[104:105], v[192:193]
v_mfma_f32_16x16x32_bf16 v[140:143], v[40:43], a[108:111], v[140:143]
s_waitcnt lgkmcnt(3)
buffer_store_dwordx4 v[80:83], v6, s[12:15], s80 offen offset:128 sc1
v_cvt_pk_bf16_f32 v112, v112, v116
v_mfma_f32_16x16x32_bf16 v[144:147], v[40:43], a[112:115], v[144:147]
v_cvt_pk_bf16_f32 v116, v113, v117
v_cvt_pk_bf16_f32 v96, v96, v100
v_mfma_f32_16x16x32_bf16 v[148:151], v[40:43], a[116:119], v[148:151]
v_cvt_pk_bf16_f32 v114, v114, v118
v_cvt_pk_bf16_f32 v100, v97, v101
v_mfma_f32_16x16x32_bf16 v[152:155], v[40:43], a[120:123], v[152:155]
v_cvt_pk_bf16_f32 v97, v104, v108
v_cvt_pk_bf16_f32 v117, v121, v125
v_mfma_f32_16x16x32_bf16 v[156:159], v[40:43], a[124:127], v[156:159]
s_waitcnt lgkmcnt(1)
buffer_store_dwordx4 v[88:91], v6, s[12:15], s81 offen offset:128 sc1
v_cvt_pk_bf16_f32 v101, v105, v109
v_cvt_pk_bf16_f32 v118, v115, v119
v_cvt_pk_bf16_f32 v115, v122, v126
v_cvt_pk_bf16_f32 v119, v123, v127
ds_write2_b64 v0, v[100:101], v[116:117] offset0:32 offset1:48
v_cvt_pk_bf16_f32 v98, v98, v102
v_cvt_pk_bf16_f32 v102, v99, v103
v_cvt_pk_bf16_f32 v103, v107, v111
v_cvt_pk_bf16_f32 v99, v106, v110
ds_write2_b64 v5, v[98:99], v[114:115] offset0:80 offset1:64
v_cvt_pk_bf16_f32 v113, v120, v124
v_exp_f32 v39, v39
v_exp_f32 v33, v33
ds_write2_b64 v5, v[96:97], v[112:113] offset0:0 offset1:16
v_add_f32 v51, v51, v33
v_exp_f32 v34, v34
v_exp_f32 v32, v32
v_add_f32 v51, v51, v35
v_add_f32 v51, v51, v37
ds_write2_b64 v0, v[102:103], v[118:119] offset0:112 offset1:96
v_add_f32 v51, v51, v39
v_exp_f32 v38, v38
v_exp_f32 v36, v36
v_add_f32 v50, v50, v32
v_add_f32 v50, v50, v34
ds_read_b64_tr_b16 v[98:99], v57 offset:0
ds_read_b64_tr_b16 v[96:97], v56 offset:0
v_add_f32 v50, v50, v36
v_add_f32 v50, v50, v38
v_add_f32 v50, v50, v51
v_mov_b32 v51, v50
ds_read_b64_tr_b16 v[106:107], v57 offset:2048
s_nop 0
v_permlane16_swap_b32 v50, v51
v_max3_u32 v12, v12, v18, v13
ds_read_b64_tr_b16 v[104:105], v56 offset:2048
v_add_f32 v50, v50, v51
v_mov_b32 v51, v50
ds_read_b128 v[52:55], v61
s_nop 0
v_permlane32_swap_b32 v50, v51
v_add_f32 v50, v50, v51
v_rcp_f32 v13, v50
ds_read_b64_tr_b16 v[112:113], v58 offset:0
ds_read_b64_tr_b16 v[114:115], v59 offset:0
ds_write_b32 v60, v13
ds_read_b64_tr_b16 v[120:121], v58 offset:2048
ds_read_b64_tr_b16 v[122:123], v59 offset:2048
v_cvt_pk_bf16_f32 v44, v32, v33
v_cvt_pk_bf16_f32 v46, v36, v37
v_cvt_pk_bf16_f32 v45, v34, v35
v_cvt_pk_bf16_f32 v47, v38, v39
ds_read_b128 v[192:195], v61
v_max3_u32 v12, v12, v50, v13
v_mfma_f32_16x16x32_bf16 v[160:163], v[44:47], a[96:99], v[160:163]
s_waitcnt lgkmcnt(9)
buffer_store_dwordx4 v[96:99], v6, s[12:15], s82 offen offset:0 sc1
s_waitcnt lgkmcnt(7)
buffer_store_dwordx4 v[104:107], v6, s[12:15], s83 offen offset:0 sc1
s_waitcnt lgkmcnt(6)
v_pk_mul_f32 v[146:147], v[146:147], v[54:55]
v_pk_mul_f32 v[132:133], v[132:133], v[52:53]
v_pk_mul_f32 v[144:145], v[144:145], v[52:53]
v_pk_mul_f32 v[150:151], v[150:151], v[54:55]
v_pk_mul_f32 v[148:149], v[148:149], v[52:53]
v_pk_mul_f32 v[134:135], v[134:135], v[54:55]
v_pk_mul_f32 v[152:153], v[152:153], v[52:53]
v_pk_mul_f32 v[130:131], v[130:131], v[54:55]
v_pk_mul_f32 v[142:143], v[142:143], v[54:55]
v_pk_mul_f32 v[158:159], v[158:159], v[54:55]
v_pk_mul_f32 v[138:139], v[138:139], v[54:55]
v_pk_mul_f32 v[136:137], v[136:137], v[52:53]
v_pk_mul_f32 v[128:129], v[128:129], v[52:53]
v_pk_mul_f32 v[140:141], v[140:141], v[52:53]
v_pk_mul_f32 v[156:157], v[156:157], v[52:53]
v_pk_mul_f32 v[154:155], v[154:155], v[54:55]
v_mfma_f32_16x16x32_bf16 v[164:167], v[44:47], a[100:103], v[164:167]
s_waitcnt lgkmcnt(4)
buffer_store_dwordx4 v[112:115], v6, s[12:15], s82 offen offset:128 sc1
v_cvt_pk_bf16_f32 v144, v144, v148
v_mfma_f32_16x16x32_bf16 v[168:171], v[44:47], a[104:107], v[168:171]
v_cvt_pk_bf16_f32 v130, v130, v134
v_cvt_pk_bf16_f32 v134, v131, v135
v_mfma_f32_16x16x32_bf16 v[172:175], v[44:47], a[108:111], v[172:175]
v_cvt_pk_bf16_f32 v131, v138, v142
v_cvt_pk_bf16_f32 v135, v139, v143
v_mfma_f32_16x16x32_bf16 v[176:179], v[44:47], a[112:115], v[176:179]
v_cvt_pk_bf16_f32 v148, v145, v149
v_cvt_pk_bf16_f32 v145, v152, v156
v_mfma_f32_16x16x32_bf16 v[180:183], v[44:47], a[116:119], v[180:183]
v_cvt_pk_bf16_f32 v128, v128, v132
v_cvt_pk_bf16_f32 v132, v129, v133
v_mfma_f32_16x16x32_bf16 v[184:187], v[44:47], a[120:123], v[184:187]
v_cvt_pk_bf16_f32 v133, v137, v141
v_cvt_pk_bf16_f32 v129, v136, v140
v_mfma_f32_16x16x32_bf16 v[188:191], v[44:47], a[124:127], v[188:191]
ds_write2_b64 v5, v[128:129], v[144:145] offset0:0 offset1:16
v_cvt_pk_bf16_f32 v146, v146, v150
v_cvt_pk_bf16_f32 v150, v147, v151
v_cvt_pk_bf16_f32 v151, v155, v159
ds_write2_b64 v0, v[134:135], v[150:151] offset0:112 offset1:96
v_cvt_pk_bf16_f32 v147, v154, v158
v_cvt_pk_bf16_f32 v149, v153, v157
s_waitcnt lgkmcnt(3)
buffer_store_dwordx4 v[120:123], v6, s[12:15], s83 offen offset:128 sc1
ds_write2_b64 v0, v[132:133], v[148:149] offset0:32 offset1:48
s_waitcnt lgkmcnt(3)
v_pk_mul_f32 v[182:183], v[182:183], v[194:195]
v_pk_mul_f32 v[180:181], v[180:181], v[192:193]
v_pk_mul_f32 v[186:187], v[186:187], v[194:195]
ds_write2_b64 v5, v[130:131], v[146:147] offset0:80 offset1:64
v_pk_mul_f32 v[176:177], v[176:177], v[192:193]
v_pk_mul_f32 v[168:169], v[168:169], v[192:193]
v_pk_mul_f32 v[162:163], v[162:163], v[194:195]
v_pk_mul_f32 v[184:185], v[184:185], v[192:193]
v_pk_mul_f32 v[166:167], v[166:167], v[194:195]
v_cvt_pk_bf16_f32 v162, v162, v166
v_pk_mul_f32 v[188:189], v[188:189], v[192:193]
ds_read_b64_tr_b16 v[130:131], v57 offset:0
ds_read_b64_tr_b16 v[128:129], v56 offset:0
ds_read_b64_tr_b16 v[138:139], v57 offset:2048
ds_read_b64_tr_b16 v[136:137], v56 offset:2048
ds_read_b64_tr_b16 v[144:145], v58 offset:0
ds_read_b64_tr_b16 v[146:147], v59 offset:0
ds_read_b64_tr_b16 v[152:153], v58 offset:2048
ds_read_b64_tr_b16 v[154:155], v59 offset:2048
v_pk_mul_f32 v[178:179], v[178:179], v[194:195]
v_cvt_pk_bf16_f32 v178, v178, v182
v_pk_mul_f32 v[164:165], v[164:165], v[192:193]
v_cvt_pk_bf16_f32 v176, v176, v180
v_cvt_pk_bf16_f32 v180, v177, v181
v_cvt_pk_bf16_f32 v181, v185, v189
v_cvt_pk_bf16_f32 v177, v184, v188
v_pk_mul_f32 v[190:191], v[190:191], v[194:195]
v_cvt_pk_bf16_f32 v166, v163, v167
v_pk_mul_f32 v[172:173], v[172:173], v[192:193]
v_pk_mul_f32 v[174:175], v[174:175], v[194:195]
v_pk_mul_f32 v[160:161], v[160:161], v[192:193]
v_cvt_pk_bf16_f32 v160, v160, v164
v_cvt_pk_bf16_f32 v164, v161, v165
v_cvt_pk_bf16_f32 v161, v168, v172
ds_write2_b64 v5, v[160:161], v[176:177] offset0:0 offset1:16
v_cvt_pk_bf16_f32 v182, v179, v183
v_cvt_pk_bf16_f32 v183, v187, v191
v_cvt_pk_bf16_f32 v179, v186, v190
v_pk_mul_f32 v[170:171], v[170:171], v[194:195]
v_cvt_pk_bf16_f32 v163, v170, v174
s_waitcnt lgkmcnt(7)
buffer_store_dwordx4 v[128:131], v6, s[12:15], s84 offen offset:0 sc1
s_waitcnt lgkmcnt(5)
buffer_store_dwordx4 v[136:139], v6, s[12:15], s85 offen offset:0 sc1
ds_write2_b64 v5, v[162:163], v[178:179] offset0:80 offset1:64
v_cvt_pk_bf16_f32 v167, v171, v175
v_cvt_pk_bf16_f32 v165, v169, v173
s_waitcnt lgkmcnt(4)
buffer_store_dwordx4 v[144:147], v6, s[12:15], s84 offen offset:128 sc1
ds_write2_b64 v0, v[166:167], v[182:183] offset0:112 offset1:96
ds_write2_b64 v0, v[164:165], v[180:181] offset0:32 offset1:48
s_waitcnt lgkmcnt(4)
buffer_store_dwordx4 v[152:155], v6, s[12:15], s85 offen offset:128 sc1
ds_read_b64_tr_b16 v[162:163], v57 offset:0
ds_read_b64_tr_b16 v[160:161], v56 offset:0
ds_read_b64_tr_b16 v[168:169], v56 offset:2048
ds_read_b64_tr_b16 v[170:171], v57 offset:2048
ds_read_b64_tr_b16 v[178:179], v59 offset:0
ds_read_b64_tr_b16 v[176:177], v58 offset:0
ds_read_b64_tr_b16 v[184:185], v58 offset:2048
ds_read_b64_tr_b16 v[186:187], v59 offset:2048
s_waitcnt lgkmcnt(6)
buffer_store_dwordx4 v[160:163], v6, s[12:15], s86 offen offset:0 sc1
s_waitcnt lgkmcnt(4)
buffer_store_dwordx4 v[168:171], v6, s[12:15], s87 offen offset:0 sc1
s_waitcnt lgkmcnt(2)
buffer_store_dwordx4 v[176:179], v6, s[12:15], s86 offen offset:128 sc1
s_waitcnt lgkmcnt(0)
buffer_store_dwordx4 v[184:187], v6, s[12:15], s87 offen offset:128 sc1
s_waitcnt vmcnt(16)
s_branch L_fin
L_last0_4:
L_t4_0_0:
v_mfma_f32_16x16x32_bf16 v[32:35], a[0:3], v[208:211], 0
s_mov_b32 s14, s47
v_exp_f32 v29, v29
v_mfma_f32_16x16x32_bf16 v[32:35], a[4:7], v[212:215], v[32:35]
s_add_u32 s80, s46, 0
v_exp_f32 v30, v30
v_mfma_f32_16x16x32_bf16 v[32:35], a[8:11], v[216:219], v[32:35]
s_add_u32 s81, s46, 131072
v_exp_f32 v31, v31
v_mfma_f32_16x16x32_bf16 v[32:35], a[12:15], v[220:223], v[32:35]
s_add_u32 s82, s46, 262144
v_cvt_pk_bf16_f32 v42, v28, v29
v_cvt_pk_bf16_f32 v43, v30, v31
v_mfma_f32_16x16x32_bf16 v[36:39], a[28:31], v[220:223], 0
s_add_u32 s83, s46, 393216
s_add_u32 s84, s46, 524288
s_add_u32 s85, s46, 655360
v_mfma_f32_16x16x32_bf16 v[36:39], a[24:27], v[216:219], v[36:39]
s_add_u32 s86, s46, 786432
s_add_u32 s87, s46, 917504
v_exp_f32 v32, v32
v_mfma_f32_16x16x32_bf16 v[36:39], a[20:23], v[212:215], v[36:39]
v_exp_f32 v33, v33
v_mfma_f32_16x16x32_bf16 v[36:39], a[16:19], v[208:211], v[36:39]
v_exp_f32 v34, v34
v_mfma_f32_16x16x32_bf16 a[132:135], a[128:131], v[40:43], a[132:135]
v_exp_f32 v35, v35
v_mfma_f32_16x16x32_bf16 v[64:67], v[40:43], a[64:67], v[64:67]
v_add_f32 v48, v48, v32
s_nop 2
v_exp_f32 v36, v36
v_mfma_f32_16x16x32_bf16 v[68:71], v[40:43], a[68:71], v[68:71]
v_accvgpr_read_b32 v16, a132
v_rcp_f32 v13, v16
v_mfma_f32_16x16x32_bf16 v[72:75], v[40:43], a[72:75], v[72:75]
ds_write_b32 v60, v13
v_mfma_f32_16x16x32_bf16 v[76:79], v[40:43], a[76:79], v[76:79]
ds_read_b128 v[52:55], v61
v_exp_f32 v37, v37
v_mfma_f32_16x16x32_bf16 v[80:83], v[40:43], a[80:83], v[80:83]
v_exp_f32 v38, v38
v_mfma_f32_16x16x32_bf16 v[84:87], v[40:43], a[84:87], v[84:87]
v_exp_f32 v39, v39
v_mfma_f32_16x16x32_bf16 v[88:91], v[40:43], a[88:91], v[88:91]
v_add_f32 v49, v49, v33
v_add_f32 v48, v48, v34
v_mfma_f32_16x16x32_bf16 v[92:95], v[40:43], a[92:95], v[92:95]
v_add_f32 v49, v49, v35
v_cvt_pk_bf16_f32 v44, v32, v33
v_mfma_f32_16x16x32_bf16 v[24:27], a[0:3], v[224:227], 0
v_cvt_pk_bf16_f32 v45, v34, v35
v_add_f32 v48, v48, v36
v_mfma_f32_16x16x32_bf16 v[24:27], a[4:7], v[228:231], v[24:27]
s_waitcnt lgkmcnt(0)
v_pk_mul_f32 v[64:65], v[64:65], v[52:53]
v_pk_mul_f32 v[68:69], v[68:69], v[52:53]
v_pk_mul_f32 v[80:81], v[80:81], v[52:53]
v_pk_mul_f32 v[84:85], v[84:85], v[52:53]
v_pk_mul_f32 v[66:67], v[66:67], v[54:55]
v_pk_mul_f32 v[70:71], v[70:71], v[54:55]
v_pk_mul_f32 v[82:83], v[82:83], v[54:55]
v_pk_mul_f32 v[86:87], v[86:87], v[54:55]
v_pk_mul_f32 v[72:73], v[72:73], v[52:53]
v_pk_mul_f32 v[76:77], v[76:77], v[52:53]
v_pk_mul_f32 v[88:89], v[88:89], v[52:53]
v_pk_mul_f32 v[92:93], v[92:93], v[52:53]
v_pk_mul_f32 v[74:75], v[74:75], v[54:55]
v_pk_mul_f32 v[78:79], v[78:79], v[54:55]
v_pk_mul_f32 v[90:91], v[90:91], v[54:55]
v_pk_mul_f32 v[94:95], v[94:95], v[54:55]
v_mfma_f32_16x16x32_bf16 v[24:27], a[8:11], v[232:235], v[24:27]
v_cvt_pk_bf16_f32 v64, v64, v68
v_cvt_pk_bf16_f32 v80, v80, v84
v_mfma_f32_16x16x32_bf16 v[24:27], a[12:15], v[236:239], v[24:27]
v_cvt_pk_bf16_f32 v66, v66, v70
v_cvt_pk_bf16_f32 v82, v82, v86
v_mfma_f32_16x16x32_bf16 v[28:31], a[28:31], v[236:239], 0
v_cvt_pk_bf16_f32 v68, v65, v69
v_cvt_pk_bf16_f32 v84, v81, v85
v_mfma_f32_16x16x32_bf16 v[28:31], a[24:27], v[232:235], v[28:31]
v_cvt_pk_bf16_f32 v70, v67, v71
v_cvt_pk_bf16_f32 v86, v83, v87
v_mfma_f32_16x16x32_bf16 v[28:31], a[20:23], v[228:231], v[28:31]
v_cvt_pk_bf16_f32 v65, v72, v76
v_cvt_pk_bf16_f32 v69, v73, v77
v_mfma_f32_16x16x32_bf16 v[28:31], a[16:19], v[224:227], v[28:31]
v_cvt_pk_bf16_f32 v81, v88, v92
v_cvt_pk_bf16_f32 v85, v89, v93
v_cvt_pk_bf16_f32 v67, v74, v78
v_cvt_pk_bf16_f32 v71, v75, v79
v_cvt_pk_bf16_f32 v83, v90, v94
v_cvt_pk_bf16_f32 v87, v91, v95
ds_write2_b64 v5, v[64:65], v[80:81] offset0:0 offset1:16
ds_write2_b64 v0, v[68:69], v[84:85] offset0:32 offset1:48
v_add_f32 v49, v49, v37
v_cvt_pk_bf16_f32 v46, v36, v37
v_cvt_pk_bf16_f32 v47, v38, v39
v_add_f32 v48, v48, v38
ds_write2_b64 v5, v[66:67], v[82:83] offset0:80 offset1:64
v_mfma_f32_16x16x32_bf16 v[96:99], v[44:47], a[64:67], v[96:99]
v_add_f32 v49, v49, v39
v_add_f32 v48, v48, v49
v_mfma_f32_16x16x32_bf16 v[100:103], v[44:47], a[68:71], v[100:103]
v_mov_b32 v49, v48
ds_write2_b64 v0, v[70:71], v[86:87] offset0:112 offset1:96
v_mfma_f32_16x16x32_bf16 v[104:107], v[44:47], a[72:75], v[104:107]
v_permlane16_swap_b32 v48, v49
v_mfma_f32_16x16x32_bf16 v[108:111], v[44:47], a[76:79], v[108:111]
v_add_f32 v48, v48, v49
ds_read_b64_tr_b16 v[64:65], v56 offset:0
v_mfma_f32_16x16x32_bf16 v[112:115], v[44:47], a[80:83], v[112:115]
ds_read_b64_tr_b16 v[66:67], v57 offset:0
v_mov_b32 v49, v48
v_mfma_f32_16x16x32_bf16 v[116:119], v[44:47], a[84:87], v[116:119]
ds_read_b64_tr_b16 v[72:73], v56 offset:2048
v_permlane32_swap_b32 v48, v49
v_mfma_f32_16x16x32_bf16 v[120:123], v[44:47], a[88:91], v[120:123]
ds_read_b64_tr_b16 v[74:75], v57 offset:2048
v_max3_u32 v12, v12, v16, v13
v_mfma_f32_16x16x32_bf16 v[124:127], v[44:47], a[92:95], v[124:127]
ds_read_b64_tr_b16 v[80:81], v58 offset:0
v_add_f32 v48, v48, v49
v_mfma_f32_16x16x32_bf16 v[32:35], a[0:3], v[240:243], 0
ds_read_b64_tr_b16 v[82:83], v59 offset:0
v_rcp_f32 v13, v48
v_mfma_f32_16x16x32_bf16 v[32:35], a[4:7], v[244:247], v[32:35]
ds_write_b32 v60, v13
v_mfma_f32_16x16x32_bf16 v[32:35], a[8:11], v[248:251], v[32:35]
ds_read_b128 v[192:195], v61
s_waitcnt lgkmcnt(6)
buffer_store_dwordx4 v[64:67], v6, s[12:15], s80 offen offset:0 sc1
v_mfma_f32_16x16x32_bf16 v[32:35], a[12:15], v[252:255], v[32:35]
ds_read_b64_tr_b16 v[88:89], v58 offset:2048
ds_read_b64_tr_b16 v[90:91], v59 offset:2048
v_mfma_f32_16x16x32_bf16 v[36:39], a[28:31], v[252:255], 0
s_waitcnt lgkmcnt(6)
buffer_store_dwordx4 v[72:75], v6, s[12:15], s81 offen offset:0 sc1
v_mfma_f32_16x16x32_bf16 v[36:39], a[24:27], v[248:251], v[36:39]
s_waitcnt lgkmcnt(2)
v_pk_mul_f32 v[96:97], v[96:97], v[192:193]
v_pk_mul_f32 v[100:101], v[100:101], v[192:193]
v_pk_mul_f32 v[112:113], v[112:113], v[192:193]
v_pk_mul_f32 v[116:117], v[116:117], v[192:193]
v_pk_mul_f32 v[98:99], v[98:99], v[194:195]
v_pk_mul_f32 v[102:103], v[102:103], v[194:195]
v_pk_mul_f32 v[114:115], v[114:115], v[194:195]
v_pk_mul_f32 v[118:119], v[118:119], v[194:195]
v_pk_mul_f32 v[104:105], v[104:105], v[192:193]
v_pk_mul_f32 v[108:109], v[108:109], v[192:193]
v_pk_mul_f32 v[120:121], v[120:121], v[192:193]
v_pk_mul_f32 v[124:125], v[124:125], v[192:193]
v_pk_mul_f32 v[106:107], v[106:107], v[194:195]
v_pk_mul_f32 v[110:111], v[110:111], v[194:195]
v_pk_mul_f32 v[122:123], v[122:123], v[194:195]
v_pk_mul_f32 v[126:127], v[126:127], v[194:195]
v_mfma_f32_16x16x32_bf16 v[36:39], a[20:23], v[244:247], v[36:39]
buffer_store_dwordx4 v[80:83], v6, s[12:15], s80 offen offset:128 sc1
v_mfma_f32_16x16x32_bf16 v[36:39], a[16:19], v[240:243], v[36:39]
s_waitcnt lgkmcnt(0)
buffer_store_dwordx4 v[88:91], v6, s[12:15], s81 offen offset:128 sc1
v_cvt_pk_bf16_f32 v96, v96, v100
v_cvt_pk_bf16_f32 v112, v112, v116
v_cvt_pk_bf16_f32 v98, v98, v102
v_cvt_pk_bf16_f32 v114, v114, v118
v_cvt_pk_bf16_f32 v100, v97, v101
v_cvt_pk_bf16_f32 v116, v113, v117
v_cvt_pk_bf16_f32 v102, v99, v103
v_cvt_pk_bf16_f32 v118, v115, v119
v_cvt_pk_bf16_f32 v97, v104, v108
v_cvt_pk_bf16_f32 v101, v105, v109
v_cvt_pk_bf16_f32 v113, v120, v124
v_cvt_pk_bf16_f32 v117, v121, v125
v_cvt_pk_bf16_f32 v99, v106, v110
v_cvt_pk_bf16_f32 v103, v107, v111
v_cvt_pk_bf16_f32 v115, v122, v126
v_cvt_pk_bf16_f32 v119, v123, v127
ds_write2_b64 v5, v[96:97], v[112:113] offset0:0 offset1:16
ds_write2_b64 v0, v[100:101], v[116:117] offset0:32 offset1:48
v_exp_f32 v24, v24
v_exp_f32 v25, v25
ds_write2_b64 v5, v[98:99], v[114:115] offset0:80 offset1:64
v_exp_f32 v26, v26
v_exp_f32 v27, v27
v_exp_f32 v28, v28
v_exp_f32 v29, v29
ds_write2_b64 v0, v[102:103], v[118:119] offset0:112 offset1:96
v_exp_f32 v30, v30
v_exp_f32 v31, v31
v_cvt_pk_bf16_f32 v40, v24, v25
v_cvt_pk_bf16_f32 v41, v26, v27
ds_read_b64_tr_b16 v[96:97], v56 offset:0
v_cvt_pk_bf16_f32 v42, v28, v29
ds_read_b64_tr_b16 v[98:99], v57 offset:0
v_cvt_pk_bf16_f32 v43, v30, v31
v_max3_u32 v12, v12, v48, v13
ds_read_b64_tr_b16 v[104:105], v56 offset:2048
v_mfma_f32_16x16x32_bf16 a[136:139], a[128:131], v[40:43], a[136:139]
ds_read_b64_tr_b16 v[106:107], v57 offset:2048
ds_read_b64_tr_b16 v[112:113], v58 offset:0
v_mfma_f32_16x16x32_bf16 v[128:131], v[40:43], a[64:67], v[128:131]
ds_read_b64_tr_b16 v[114:115], v59 offset:0
ds_read_b64_tr_b16 v[120:121], v58 offset:2048
v_mfma_f32_16x16x32_bf16 v[132:135], v[40:43], a[68:71], v[132:135]
ds_read_b64_tr_b16 v[122:123], v59 offset:2048
s_nop 0
v_accvgpr_read_b32 v18, a136
v_mfma_f32_16x16x32_bf16 v[136:139], v[40:43], a[72:75], v[136:139]
v_rcp_f32 v13, v18
v_mfma_f32_16x16x32_bf16 v[140:143], v[40:43], a[76:79], v[140:143]
ds_write_b32 v60, v13
v_mfma_f32_16x16x32_bf16 v[144:147], v[40:43], a[80:83], v[144:147]
ds_read_b128 v[52:55], v61
s_waitcnt lgkmcnt(8)
buffer_store_dwordx4 v[96:99], v6, s[12:15], s82 offen offset:0 sc1
v_mfma_f32_16x16x32_bf16 v[148:151], v[40:43], a[84:87], v[148:151]
s_waitcnt lgkmcnt(6)
buffer_store_dwordx4 v[104:107], v6, s[12:15], s83 offen offset:0 sc1
v_mfma_f32_16x16x32_bf16 v[152:155], v[40:43], a[88:91], v[152:155]
s_waitcnt lgkmcnt(4)
buffer_store_dwordx4 v[112:115], v6, s[12:15], s82 offen offset:128 sc1
s_waitcnt lgkmcnt(0)
v_pk_mul_f32 v[128:129], v[128:129], v[52:53]
v_pk_mul_f32 v[132:133], v[132:133], v[52:53]
v_pk_mul_f32 v[144:145], v[144:145], v[52:53]
v_pk_mul_f32 v[148:149], v[148:149], v[52:53]
v_pk_mul_f32 v[130:131], v[130:131], v[54:55]
v_pk_mul_f32 v[134:135], v[134:135], v[54:55]
v_pk_mul_f32 v[146:147], v[146:147], v[54:55]
v_pk_mul_f32 v[150:151], v[150:151], v[54:55]
v_pk_mul_f32 v[136:137], v[136:137], v[52:53]
v_pk_mul_f32 v[140:141], v[140:141], v[52:53]
v_pk_mul_f32 v[152:153], v[152:153], v[52:53]
v_pk_mul_f32 v[138:139], v[138:139], v[54:55]
v_pk_mul_f32 v[142:143], v[142:143], v[54:55]
v_pk_mul_f32 v[154:155], v[154:155], v[54:55]
v_mfma_f32_16x16x32_bf16 v[156:159], v[40:43], a[92:95], v[156:159]
buffer_store_dwordx4 v[120:123], v6, s[12:15], s83 offen offset:128 sc1
v_cvt_pk_bf16_f32 v128, v128, v132
v_cvt_pk_bf16_f32 v144, v144, v148
v_cvt_pk_bf16_f32 v130, v130, v134
v_cvt_pk_bf16_f32 v146, v146, v150
v_cvt_pk_bf16_f32 v132, v129, v133
s_nop 1
v_pk_mul_f32 v[156:157], v[156:157], v[52:53]
v_cvt_pk_bf16_f32 v148, v145, v149
v_cvt_pk_bf16_f32 v134, v131, v135
v_pk_mul_f32 v[158:159], v[158:159], v[54:55]
v_cvt_pk_bf16_f32 v150, v147, v151
v_cvt_pk_bf16_f32 v129, v136, v140
v_cvt_pk_bf16_f32 v133, v137, v141
v_cvt_pk_bf16_f32 v145, v152, v156
v_cvt_pk_bf16_f32 v149, v153, v157
v_cvt_pk_bf16_f32 v131, v138, v142
v_cvt_pk_bf16_f32 v135, v139, v143
v_cvt_pk_bf16_f32 v147, v154, v158
v_cvt_pk_bf16_f32 v151, v155, v159
ds_write2_b64 v5, v[128:129], v[144:145] offset0:0 offset1:16
ds_write2_b64 v0, v[132:133], v[148:149] offset0:32 offset1:48
v_exp_f32 v32, v32
v_exp_f32 v33, v33
ds_write2_b64 v5, v[130:131], v[146:147] offset0:80 offset1:64
v_exp_f32 v34, v34
v_exp_f32 v35, v35
v_exp_f32 v36, v36
v_exp_f32 v37, v37
ds_write2_b64 v0, v[134:135], v[150:151] offset0:112 offset1:96
v_add_f32 v50, v50, v32
v_add_f32 v51, v51, v33
v_exp_f32 v38, v38
v_exp_f32 v39, v39
v_add_f32 v50, v50, v34
v_add_f32 v51, v51, v35
ds_read_b64_tr_b16 v[128:129], v56 offset:0
ds_read_b64_tr_b16 v[130:131], v57 offset:0
v_add_f32 v50, v50, v36
v_add_f32 v51, v51, v37
v_add_f32 v50, v50, v38
v_add_f32 v51, v51, v39
v_add_f32 v50, v50, v51
v_mov_b32 v51, v50
v_cvt_pk_bf16_f32 v44, v32, v33
v_cvt_pk_bf16_f32 v45, v34, v35
v_permlane16_swap_b32 v50, v51
v_add_f32 v50, v50, v51
v_mov_b32 v51, v50
v_cvt_pk_bf16_f32 v46, v36, v37
v_cvt_pk_bf16_f32 v47, v38, v39
v_permlane32_swap_b32 v50, v51
s_nop 0
v_mfma_f32_16x16x32_bf16 v[160:163], v[44:47], a[64:67], v[160:163]
ds_read_b64_tr_b16 v[136:137], v56 offset:2048
v_max3_u32 v12, v12, v18, v13
v_mfma_f32_16x16x32_bf16 v[164:167], v[44:47], a[68:71], v[164:167]
ds_read_b64_tr_b16 v[138:139], v57 offset:2048
v_add_f32 v50, v50, v51
v_mfma_f32_16x16x32_bf16 v[168:171], v[44:47], a[72:75], v[168:171]
ds_read_b64_tr_b16 v[144:145], v58 offset:0
v_rcp_f32 v13, v50
v_mfma_f32_16x16x32_bf16 v[172:175], v[44:47], a[76:79], v[172:175]
ds_write_b32 v60, v13
v_mfma_f32_16x16x32_bf16 v[176:179], v[44:47], a[80:83], v[176:179]
ds_read_b128 v[192:195], v61
ds_read_b64_tr_b16 v[146:147], v59 offset:0
v_mfma_f32_16x16x32_bf16 v[180:183], v[44:47], a[84:87], v[180:183]
s_waitcnt lgkmcnt(6)
buffer_store_dwordx4 v[128:131], v6, s[12:15], s84 offen offset:0 sc1
v_mfma_f32_16x16x32_bf16 v[184:187], v[44:47], a[88:91], v[184:187]
ds_read_b64_tr_b16 v[152:153], v58 offset:2048
ds_read_b64_tr_b16 v[154:155], v59 offset:2048
v_mfma_f32_16x16x32_bf16 v[188:191], v[44:47], a[92:95], v[188:191]
s_waitcnt lgkmcnt(6)
buffer_store_dwordx4 v[136:139], v6, s[12:15], s85 offen offset:0 sc1
s_waitcnt lgkmcnt(3)
v_pk_mul_f32 v[160:161], v[160:161], v[192:193]
v_pk_mul_f32 v[164:165], v[164:165], v[192:193]
v_pk_mul_f32 v[176:177], v[176:177], v[192:193]
v_pk_mul_f32 v[180:181], v[180:181], v[192:193]
v_pk_mul_f32 v[162:163], v[162:163], v[194:195]
v_pk_mul_f32 v[166:167], v[166:167], v[194:195]
v_pk_mul_f32 v[178:179], v[178:179], v[194:195]
v_pk_mul_f32 v[182:183], v[182:183], v[194:195]
v_cvt_pk_bf16_f32 v160, v160, v164
v_cvt_pk_bf16_f32 v176, v176, v180
v_cvt_pk_bf16_f32 v162, v162, v166
v_cvt_pk_bf16_f32 v178, v178, v182
v_pk_mul_f32 v[168:169], v[168:169], v[192:193]
v_pk_mul_f32 v[172:173], v[172:173], v[192:193]
v_cvt_pk_bf16_f32 v164, v161, v165
v_pk_mul_f32 v[184:185], v[184:185], v[192:193]
v_pk_mul_f32 v[188:189], v[188:189], v[192:193]
v_cvt_pk_bf16_f32 v180, v177, v181
v_pk_mul_f32 v[170:171], v[170:171], v[194:195]
v_pk_mul_f32 v[174:175], v[174:175], v[194:195]
v_cvt_pk_bf16_f32 v166, v163, v167
v_pk_mul_f32 v[186:187], v[186:187], v[194:195]
v_pk_mul_f32 v[190:191], v[190:191], v[194:195]
v_cvt_pk_bf16_f32 v182, v179, v183
v_cvt_pk_bf16_f32 v161, v168, v172
v_cvt_pk_bf16_f32 v165, v169, v173
v_cvt_pk_bf16_f32 v177, v184, v188
v_cvt_pk_bf16_f32 v181, v185, v189
v_cvt_pk_bf16_f32 v163, v170, v174
v_cvt_pk_bf16_f32 v167, v171, v175
v_cvt_pk_bf16_f32 v179, v186, v190
v_cvt_pk_bf16_f32 v183, v187, v191
ds_write2_b64 v5, v[160:161], v[176:177] offset0:0 offset1:16
ds_write2_b64 v0, v[164:165], v[180:181] offset0:32 offset1:48
s_waitcnt lgkmcnt(4)
buffer_store_dwordx4 v[144:147], v6, s[12:15], s84 offen offset:128 sc1
ds_write2_b64 v5, v[162:163], v[178:179] offset0:80 offset1:64
s_waitcnt lgkmcnt(3)
buffer_store_dwordx4 v[152:155], v6, s[12:15], s85 offen offset:128 sc1
ds_write2_b64 v0, v[166:167], v[182:183] offset0:112 offset1:96
v_max3_u32 v12, v12, v50, v13
ds_read_b64_tr_b16 v[160:161], v56 offset:0
ds_read_b64_tr_b16 v[162:163], v57 offset:0
ds_read_b64_tr_b16 v[168:169], v56 offset:2048
ds_read_b64_tr_b16 v[170:171], v57 offset:2048
ds_read_b64_tr_b16 v[176:177], v58 offset:0
ds_read_b64_tr_b16 v[178:179], v59 offset:0
ds_read_b64_tr_b16 v[184:185], v58 offset:2048
ds_read_b64_tr_b16 v[186:187], v59 offset:2048
s_waitcnt lgkmcnt(6)
buffer_store_dwordx4 v[160:163], v6, s[12:15], s86 offen offset:0 sc1
s_waitcnt lgkmcnt(4)
buffer_store_dwordx4 v[168:171], v6, s[12:15], s87 offen offset:0 sc1
s_waitcnt lgkmcnt(2)
buffer_store_dwordx4 v[176:179], v6, s[12:15], s86 offen offset:128 sc1
s_waitcnt lgkmcnt(0)
buffer_store_dwordx4 v[184:187], v6, s[12:15], s87 offen offset:128 sc1
s_waitcnt vmcnt(16)
s_branch L_fin
L_first13:
s_mov_b64 s[4:5], s[16:17]
s_mov_b64 s[8:9], s[22:23]
s_sub_u32 s10, s38, 128992
v_add_u32 v1, 16640, v1
v_add_u32 v2, 16640, v2
v_mbcnt_lo_u32_b32 v13, -1, 0
v_mbcnt_hi_u32_b32 v13, -1, v13
v_lshrrev_b32 v13, 2, v13
v_and_b32 v13, 12, v13
v_sub_u32 v13, s50, v13
v_cvt_f32_i32 v13, v13
v_mov_b32 v14, 0x7c800000
v_fmaak_f32 v16, v13, v14, 0xfc000000
v_fmaak_f32 v17, v13, v14, 0xfcc00000
v_fmaak_f32 v18, v13, v14, 0xfd200000
v_fmaak_f32 v19, v13, v14, 0xfd600000
v_min_f32 v16, 0, v16
v_min_f32 v17, 0, v17
v_min_f32 v18, 0, v18
v_min_f32 v19, 0, v19
v_mov_b32 v42, 0
v_mov_b32 v43, 0
s_mov_b32 s30, 7
s_sub_u32 s26, s40, 8
s_sub_u32 s32, s49, 5
s_waitcnt vmcnt(8)
ds_read_b128 v[224:227], v11 offset:0
ds_read_b128 v[228:231], v11 offset:64
ds_read_b128 v[232:235], v11 offset:128
ds_read_b128 v[236:239], v11 offset:192
v_add_u32 v11, 49920, v11
s_waitcnt lgkmcnt(3)
v_mfma_f32_16x16x32_bf16 v[64:67], a[146:149], v[224:227], 0
v_mfma_f32_16x16x32_bf16 v[68:71], a[144:147], v[224:227], 0
v_mfma_f32_16x16x32_bf16 v[64:67], a[150:153], v[224:227], v[64:67]
v_mfma_f32_16x16x32_bf16 v[68:71], a[148:151], v[224:227], v[68:71]
s_waitcnt lgkmcnt(2)
v_mfma_f32_16x16x32_bf16 v[72:75], a[146:149], v[228:231], 0
s_nop 4
v_cvt_pk_bf16_f32 v224, v64, v65
v_mfma_f32_16x16x32_bf16 v[76:79], a[144:147], v[228:231], 0
v_cvt_pk_bf16_f32 v225, v66, v67
v_cvt_pk_bf16_f32 v226, v68, v69
v_mfma_f32_16x16x32_bf16 v[72:75], a[150:153], v[228:231], v[72:75]
v_cvt_pk_bf16_f32 v227, v70, v71
v_mfma_f32_16x16x32_bf16 v[76:79], a[148:151], v[228:231], v[76:79]
s_waitcnt lgkmcnt(1)
v_mfma_f32_16x16x32_bf16 v[80:83], a[146:149], v[232:235], 0
s_nop 3
v_cvt_pk_bf16_f32 v228, v72, v73
v_mfma_f32_16x16x32_bf16 v[84:87], a[144:147], v[232:235], 0
v_cvt_pk_bf16_f32 v229, v74, v75
v_cvt_pk_bf16_f32 v230, v76, v77
v_mfma_f32_16x16x32_bf16 v[80:83], a[150:153], v[232:235], v[80:83]
v_cvt_pk_bf16_f32 v231, v78, v79
s_waitcnt lgkmcnt(0)
s_waitcnt vmcnt(4)
s_barrier
v_mfma_f32_16x16x32_bf16 v[84:87], a[148:151], v[232:235], v[84:87]
buffer_load_dwordx4 v3, s[4:7], s27 offen lds
v_mfma_f32_16x16x32_bf16 v[88:91], a[146:149], v[236:239], 0
buffer_load_dwordx4 v4, s[4:7], s27 offen offset:1056 lds
v_mfma_f32_16x16x32_bf16 v[92:95], a[144:147], v[236:239], 0
ds_read_b128 a[0:3], v1 offset:0
ds_read_b128 a[4:7], v1 offset:64
v_mfma_f32_16x16x32_bf16 v[88:91], a[150:153], v[236:239], v[88:91]
ds_read_b128 a[8:11], v1 offset:128
ds_read_b128 a[12:15], v1 offset:192
v_mfma_f32_16x16x32_bf16 v[92:95], a[148:151], v[236:239], v[92:95]
buffer_load_dwordx4 v3, s[8:11], s27 offen offset:2080 lds
ds_read_b128 a[16:19], v1 offset:512
ds_read_b128 a[20:23], v1 offset:576
v_cvt_pk_bf16_f32 v232, v80, v81
v_cvt_pk_bf16_f32 v233, v82, v83
ds_read_b128 a[24:27], v1 offset:640
v_cvt_pk_bf16_f32 v234, v84, v85
v_cvt_pk_bf16_f32 v235, v86, v87
v_cvt_pk_bf16_f32 v236, v88, v89
ds_read_b128 a[28:31], v1 offset:704
v_add_u32 v1, 16640, v1
v_cvt_pk_bf16_f32 v237, v90, v91
v_cvt_pk_bf16_f32 v238, v92, v93
ds_read_b64_tr_b16 a[64:65], v2 offset:0
v_cvt_pk_bf16_f32 v239, v94, v95
buffer_load_dwordx4 v4, s[8:11], s27 offen offset:3136 lds
ds_read_b64_tr_b16 a[66:67], v2 offset:512
ds_read_b64_tr_b16 a[68:69], v2 offset:32
ds_read_b64_tr_b16 a[70:71], v2 offset:544
s_add_u32 m0, s28, 66560
s_waitcnt lgkmcnt(11)
v_mfma_f32_16x16x32_bf16 v[24:27], a[0:3], v[224:227], v[16:19]
s_add_u32 s27, s27, 262144
ds_read_b64_tr_b16 a[72:73], v2 offset:64
ds_read_b64_tr_b16 a[74:75], v2 offset:576
s_waitcnt lgkmcnt(12)
v_mfma_f32_16x16x32_bf16 v[24:27], a[4:7], v[228:231], v[24:27]
ds_read_b64_tr_b16 a[76:77], v2 offset:96
ds_read_b64_tr_b16 a[78:79], v2 offset:608
s_waitcnt lgkmcnt(13)
v_mfma_f32_16x16x32_bf16 v[24:27], a[8:11], v[232:235], v[24:27]
ds_read_b64_tr_b16 a[80:81], v2 offset:128
ds_read_b64_tr_b16 a[82:83], v2 offset:640
s_waitcnt lgkmcnt(14)
v_mfma_f32_16x16x32_bf16 v[24:27], a[12:15], v[236:239], v[24:27]
ds_read_b64_tr_b16 a[84:85], v2 offset:160
ds_read_b64_tr_b16 a[86:87], v2 offset:672
ds_read_b64_tr_b16 a[88:89], v2 offset:192
ds_read_b64_tr_b16 a[90:91], v2 offset:704
ds_read_b64_tr_b16 a[92:93], v2 offset:224
ds_read_b64_tr_b16 a[94:95], v2 offset:736
v_add_u32 v2, 16640, v2
s_nop 0
v_exp_f32 v24, v24
v_exp_f32 v25, v25
v_exp_f32 v26, v26
v_exp_f32 v27, v27
v_cvt_pk_bf16_f32 v40, v24, v25
v_cvt_pk_bf16_f32 v41, v26, v27
s_waitcnt lgkmcnt(0)
s_waitcnt vmcnt(4)
s_barrier
buffer_load_dwordx4 v3, s[4:7], s27 offen lds
buffer_load_dwordx4 v4, s[4:7], s27 offen offset:1056 lds
ds_read_b128 a[32:35], v1 offset:0
ds_read_b128 a[36:39], v1 offset:64
ds_read_b128 a[40:43], v1 offset:128
ds_read_b128 a[44:47], v1 offset:192
ds_read_b128 a[48:51], v1 offset:512
ds_read_b128 a[52:55], v1 offset:576
buffer_load_dwordx4 v3, s[8:11], s27 offen offset:2080 lds
ds_read_b128 a[56:59], v1 offset:640
ds_read_b128 a[60:63], v1 offset:704
v_add_u32 v1, 83200, v1
ds_read_b64_tr_b16 a[96:97], v2 offset:0
ds_read_b64_tr_b16 a[98:99], v2 offset:512
ds_read_b64_tr_b16 a[100:101], v2 offset:32
buffer_load_dwordx4 v4, s[8:11], s27 offen offset:3136 lds
s_waitcnt lgkmcnt(10)
v_mfma_f32_16x16x32_bf16 v[32:35], a[32:35], v[224:227], 0
s_add_u32 m0, s28, 83200
s_add_u32 s27, s27, 262144
ds_read_b64_tr_b16 a[102:103], v2 offset:544
s_waitcnt lgkmcnt(10)
v_mfma_f32_16x16x32_bf16 v[32:35], a[36:39], v[228:231], v[32:35]
ds_read_b64_tr_b16 a[104:105], v2 offset:64
ds_read_b64_tr_b16 a[106:107], v2 offset:576
s_waitcnt lgkmcnt(11)
v_mfma_f32_16x16x32_bf16 v[32:35], a[40:43], v[232:235], v[32:35]
ds_read_b64_tr_b16 a[108:109], v2 offset:96
ds_read_b64_tr_b16 a[110:111], v2 offset:608
s_waitcnt lgkmcnt(12)
v_mfma_f32_16x16x32_bf16 v[32:35], a[44:47], v[236:239], v[32:35]
ds_read_b64_tr_b16 a[112:113], v2 offset:128
ds_read_b64_tr_b16 a[114:115], v2 offset:640
ds_read_b64_tr_b16 a[116:117], v2 offset:160
ds_read_b64_tr_b16 a[118:119], v2 offset:672
ds_read_b64_tr_b16 a[120:121], v2 offset:192
ds_read_b64_tr_b16 a[122:123], v2 offset:704
ds_read_b64_tr_b16 a[124:125], v2 offset:224
ds_read_b64_tr_b16 a[126:127], v2 offset:736
s_waitcnt lgkmcnt(15)
v_mfma_f32_16x16x32_bf16 v[36:39], a[60:63], v[236:239], 0
v_exp_f32 v32, v32
v_mfma_f32_16x16x32_bf16 v[36:39], a[56:59], v[232:235], v[36:39]
v_exp_f32 v33, v33
v_mfma_f32_16x16x32_bf16 v[36:39], a[52:55], v[228:231], v[36:39]
v_exp_f32 v34, v34
v_mfma_f32_16x16x32_bf16 v[36:39], a[48:51], v[224:227], v[36:39]
v_exp_f32 v35, v35
v_mfma_f32_16x16x32_bf16 v[64:67], v[40:43], a[64:67], 0
v_cvt_pk_bf16_f32 v44, v32, v33
v_cvt_pk_bf16_f32 v45, v34, v35
v_mfma_f32_16x16x32_bf16 v[68:71], v[40:43], a[68:71], 0
v_add_u32 v2, 83200, v2
s_nop 1
v_exp_f32 v36, v36
v_mfma_f32_16x16x32_bf16 v[72:75], v[40:43], a[72:75], 0
v_exp_f32 v37, v37
v_mfma_f32_16x16x32_bf16 v[76:79], v[40:43], a[76:79], 0
v_exp_f32 v38, v38
v_mfma_f32_16x16x32_bf16 v[80:83], v[40:43], a[80:83], 0
v_exp_f32 v39, v39
v_mfma_f32_16x16x32_bf16 v[84:87], v[40:43], a[84:87], 0
v_cvt_pk_bf16_f32 v46, v36, v37
v_cvt_pk_bf16_f32 v47, v38, v39
v_mfma_f32_16x16x32_bf16 v[88:91], v[40:43], a[88:91], 0
v_mfma_f32_16x16x32_bf16 v[92:95], v[40:43], a[92:95], 0
v_mfma_f32_16x16x32_bf16 a[132:135], a[128:131], v[40:43], 0
s_waitcnt vmcnt(4)
buffer_load_dwordx4 v3, s[4:7], s27 offen lds
buffer_load_dwordx4 v4, s[4:7], s27 offen offset:1056 lds
ds_read_b128 v[240:243], v11 offset:0
ds_read_b128 v[244:247], v11 offset:64
ds_read_b128 v[248:251], v11 offset:128
ds_read_b128 v[252:255], v11 offset:192
v_add_u32 v11, 16640, v11
buffer_load_dwordx4 v3, s[8:11], s27 offen offset:2080 lds
buffer_load_dwordx4 v4, s[8:11], s27 offen offset:3136 lds
s_waitcnt lgkmcnt(3)
v_mfma_f32_16x16x32_bf16 v[96:99], a[146:149], v[240:243], 0
s_add_u32 m0, s28, 99840
s_add_u32 s27, s27, 262144
v_mfma_f32_16x16x32_bf16 v[100:103], a[144:147], v[240:243], 0
v_mfma_f32_16x16x32_bf16 v[96:99], a[150:153], v[240:243], v[96:99]
v_mfma_f32_16x16x32_bf16 v[100:103], a[148:151], v[240:243], v[100:103]
s_waitcnt lgkmcnt(2)
v_mfma_f32_16x16x32_bf16 v[104:107], a[146:149], v[244:247], 0
s_nop 4
v_cvt_pk_bf16_f32 v240, v96, v97
v_mfma_f32_16x16x32_bf16 v[108:111], a[144:147], v[244:247], 0
v_cvt_pk_bf16_f32 v241, v98, v99
v_cvt_pk_bf16_f32 v242, v100, v101
v_mfma_f32_16x16x32_bf16 v[104:107], a[150:153], v[244:247], v[104:107]
v_cvt_pk_bf16_f32 v243, v102, v103
v_mfma_f32_16x16x32_bf16 v[108:111], a[148:151], v[244:247], v[108:111]
s_waitcnt lgkmcnt(1)
v_mfma_f32_16x16x32_bf16 v[112:115], a[146:149], v[248:251], 0
s_nop 3
v_cvt_pk_bf16_f32 v244, v104, v105
v_mfma_f32_16x16x32_bf16 v[116:119], a[144:147], v[248:251], 0
v_cvt_pk_bf16_f32 v245, v106, v107
v_cvt_pk_bf16_f32 v246, v108, v109
v_mfma_f32_16x16x32_bf16 v[112:115], a[150:153], v[248:251], v[112:115]
v_cvt_pk_bf16_f32 v247, v110, v111
v_mfma_f32_16x16x32_bf16 v[116:119], a[148:151], v[248:251], v[116:119]
s_waitcnt lgkmcnt(0)
v_mfma_f32_16x16x32_bf16 v[120:123], a[146:149], v[252:255], 0
s_nop 3
v_cvt_pk_bf16_f32 v248, v112, v113
v_mfma_f32_16x16x32_bf16 v[124:127], a[144:147], v[252:255], 0
v_cvt_pk_bf16_f32 v249, v114, v115
v_cvt_pk_bf16_f32 v250, v116, v117
v_mfma_f32_16x16x32_bf16 v[120:123], a[150:153], v[252:255], v[120:123]
v_cvt_pk_bf16_f32 v251, v118, v119
v_mfma_f32_16x16x32_bf16 v[124:127], a[148:151], v[252:255], v[124:127]
v_mfma_f32_16x16x32_bf16 v[24:27], a[0:3], v[240:243], v[16:19]
s_nop 4
v_cvt_pk_bf16_f32 v252, v120, v121
v_mfma_f32_16x16x32_bf16 v[24:27], a[4:7], v[244:247], v[24:27]
v_cvt_pk_bf16_f32 v253, v122, v123
v_cvt_pk_bf16_f32 v254, v124, v125
v_mfma_f32_16x16x32_bf16 v[24:27], a[8:11], v[248:251], v[24:27]
v_cvt_pk_bf16_f32 v255, v126, v127
s_nop 1
v_mfma_f32_16x16x32_bf16 v[24:27], a[12:15], v[252:255], v[24:27]
v_mfma_f32_16x16x32_bf16 v[64:67], v[44:47], a[96:99], v[64:67]
v_mfma_f32_16x16x32_bf16 v[68:71], v[44:47], a[100:103], v[68:71]
s_nop 5
v_exp_f32 v24, v24
v_mfma_f32_16x16x32_bf16 v[72:75], v[44:47], a[104:107], v[72:75]
v_exp_f32 v25, v25
v_mfma_f32_16x16x32_bf16 v[76:79], v[44:47], a[108:111], v[76:79]
v_exp_f32 v26, v26
v_mfma_f32_16x16x32_bf16 v[80:83], v[44:47], a[112:115], v[80:83]
v_exp_f32 v27, v27
v_mfma_f32_16x16x32_bf16 v[84:87], v[44:47], a[116:119], v[84:87]
v_cvt_pk_bf16_f32 v40, v24, v25
v_cvt_pk_bf16_f32 v41, v26, v27
v_mfma_f32_16x16x32_bf16 v[88:91], v[44:47], a[120:123], v[88:91]
v_mov_b32 v48, v24
v_mov_b32 v49, v25
v_mfma_f32_16x16x32_bf16 v[92:95], v[44:47], a[124:127], v[92:95]
v_add_f32 v48, v48, v26
v_add_f32 v49, v49, v27
v_mfma_f32_16x16x32_bf16 a[132:135], a[128:131], v[44:47], a[132:135]
v_mfma_f32_16x16x32_bf16 v[32:35], a[32:35], v[240:243], 0
v_mfma_f32_16x16x32_bf16 v[32:35], a[36:39], v[244:247], v[32:35]
v_mfma_f32_16x16x32_bf16 v[32:35], a[40:43], v[248:251], v[32:35]
v_mfma_f32_16x16x32_bf16 v[32:35], a[44:47], v[252:255], v[32:35]
v_mfma_f32_16x16x32_bf16 v[36:39], a[60:63], v[252:255], 0
v_mfma_f32_16x16x32_bf16 v[36:39], a[56:59], v[248:251], v[36:39]
s_nop 5
v_exp_f32 v32, v32
v_mfma_f32_16x16x32_bf16 v[36:39], a[52:55], v[244:247], v[36:39]
v_exp_f32 v33, v33
v_mfma_f32_16x16x32_bf16 v[36:39], a[48:51], v[240:243], v[36:39]
v_exp_f32 v34, v34
v_mfma_f32_16x16x32_bf16 v[96:99], v[40:43], a[64:67], 0
v_exp_f32 v35, v35
v_mfma_f32_16x16x32_bf16 v[100:103], v[40:43], a[68:71], 0
v_cvt_pk_bf16_f32 v44, v32, v33
s_nop 2
v_exp_f32 v36, v36
v_mfma_f32_16x16x32_bf16 v[104:107], v[40:43], a[72:75], 0
v_exp_f32 v37, v37
v_mfma_f32_16x16x32_bf16 v[108:111], v[40:43], a[76:79], 0
s_waitcnt vmcnt(4)
buffer_load_dwordx4 v3, s[4:7], s27 offen lds
v_mfma_f32_16x16x32_bf16 v[112:115], v[40:43], a[80:83], 0
buffer_load_dwordx4 v4, s[4:7], s27 offen offset:1056 lds
v_mfma_f32_16x16x32_bf16 v[116:119], v[40:43], a[84:87], 0
s_mov_b64 s[4:5], s[18:19]
ds_read_b128 a[160:163], v11 offset:0
ds_read_b128 a[164:167], v11 offset:64
v_mfma_f32_16x16x32_bf16 v[120:123], v[40:43], a[88:91], 0
ds_read_b128 a[168:171], v11 offset:128
ds_read_b128 a[172:175], v11 offset:192
v_mfma_f32_16x16x32_bf16 v[124:127], v[40:43], a[92:95], 0
buffer_load_dwordx4 v3, s[8:11], s27 offen offset:2080 lds
v_add_u32 v11, 16640, v11
v_exp_f32 v38, v38
v_exp_f32 v39, v39
v_cvt_pk_bf16_f32 v45, v34, v35
v_cvt_pk_bf16_f32 v46, v36, v37
v_cvt_pk_bf16_f32 v47, v38, v39
v_add_f32 v48, v48, v32
v_add_f32 v49, v49, v33
v_add_f32 v48, v48, v34
v_add_f32 v49, v49, v35
v_add_f32 v48, v48, v36
v_add_f32 v49, v49, v37
buffer_load_dwordx4 v4, s[8:11], s27 offen offset:3136 lds
s_add_u32 m0, s28, 116480
s_mov_b64 s[8:9], s[20:21]
s_add_u32 s10, s38, 2080
v_add_f32 v48, v48, v38
s_waitcnt lgkmcnt(3)
v_mfma_f32_16x16x32_bf16 v[128:131], a[146:149], a[160:163], 0
s_add_u32 s27, s27, 262144
v_add_f32 v49, v49, v39
v_mfma_f32_16x16x32_bf16 v[132:135], a[144:147], a[160:163], 0
v_mfma_f32_16x16x32_bf16 v[128:131], a[150:153], a[160:163], v[128:131]
v_mfma_f32_16x16x32_bf16 v[132:135], a[148:151], a[160:163], v[132:135]
s_waitcnt lgkmcnt(2)
v_mfma_f32_16x16x32_bf16 v[136:139], a[146:149], a[164:167], 0
s_nop 4
v_cvt_pk_bf16_f32 v128, v128, v129
v_mfma_f32_16x16x32_bf16 v[140:143], a[144:147], a[164:167], 0
v_cvt_pk_bf16_f32 v130, v130, v131
v_cvt_pk_bf16_f32 v132, v132, v133
v_mfma_f32_16x16x32_bf16 v[136:139], a[150:153], a[164:167], v[136:139]
v_cvt_pk_bf16_f32 v134, v134, v135
v_accvgpr_write_b32 a160, v128
v_mfma_f32_16x16x32_bf16 v[140:143], a[148:151], a[164:167], v[140:143]
v_accvgpr_write_b32 a161, v130
v_accvgpr_write_b32 a162, v132
s_waitcnt lgkmcnt(1)
v_mfma_f32_16x16x32_bf16 v[144:147], a[146:149], a[168:171], 0
v_accvgpr_write_b32 a163, v134
v_cvt_pk_bf16_f32 v136, v136, v137
v_mfma_f32_16x16x32_bf16 v[148:151], a[144:147], a[168:171], 0
v_cvt_pk_bf16_f32 v138, v138, v139
v_cvt_pk_bf16_f32 v140, v140, v141
v_mfma_f32_16x16x32_bf16 v[144:147], a[150:153], a[168:171], v[144:147]
v_cvt_pk_bf16_f32 v142, v142, v143
v_accvgpr_write_b32 a164, v136
v_mfma_f32_16x16x32_bf16 v[148:151], a[148:151], a[168:171], v[148:151]
v_accvgpr_write_b32 a165, v138
v_accvgpr_write_b32 a166, v140
s_waitcnt lgkmcnt(0)
v_mfma_f32_16x16x32_bf16 v[152:155], a[146:149], a[172:175], 0
v_accvgpr_write_b32 a167, v142
v_cvt_pk_bf16_f32 v144, v144, v145
v_mfma_f32_16x16x32_bf16 v[156:159], a[144:147], a[172:175], 0
v_cvt_pk_bf16_f32 v146, v146, v147
v_cvt_pk_bf16_f32 v148, v148, v149
v_mfma_f32_16x16x32_bf16 v[152:155], a[150:153], a[172:175], v[152:155]
v_cvt_pk_bf16_f32 v150, v150, v151
v_accvgpr_write_b32 a168, v144
v_mfma_f32_16x16x32_bf16 v[156:159], a[148:151], a[172:175], v[156:159]
v_accvgpr_write_b32 a169, v146
v_accvgpr_write_b32 a170, v148
v_mfma_f32_16x16x32_bf16 v[24:27], a[0:3], a[160:163], v[16:19]
v_accvgpr_write_b32 a171, v150
s_nop 0
v_cvt_pk_bf16_f32 v152, v152, v153
v_mfma_f32_16x16x32_bf16 v[24:27], a[4:7], a[164:167], v[24:27]
v_cvt_pk_bf16_f32 v154, v154, v155
v_cvt_pk_bf16_f32 v156, v156, v157
v_mfma_f32_16x16x32_bf16 v[24:27], a[8:11], a[168:171], v[24:27]
v_cvt_pk_bf16_f32 v158, v158, v159
v_accvgpr_write_b32 a172, v152
v_accvgpr_write_b32 a173, v154
v_accvgpr_write_b32 a174, v156
v_accvgpr_write_b32 a175, v158
s_nop 1
v_mfma_f32_16x16x32_bf16 v[24:27], a[12:15], a[172:175], v[24:27]
v_mfma_f32_16x16x32_bf16 v[96:99], v[44:47], a[96:99], v[96:99]
v_mfma_f32_16x16x32_bf16 v[100:103], v[44:47], a[100:103], v[100:103]
s_nop 5
v_exp_f32 v24, v24
v_mfma_f32_16x16x32_bf16 v[104:107], v[44:47], a[104:107], v[104:107]
v_exp_f32 v25, v25
v_mfma_f32_16x16x32_bf16 v[108:111], v[44:47], a[108:111], v[108:111]
v_exp_f32 v26, v26
v_mfma_f32_16x16x32_bf16 v[112:115], v[44:47], a[112:115], v[112:115]
v_exp_f32 v27, v27
v_mfma_f32_16x16x32_bf16 v[116:119], v[44:47], a[116:119], v[116:119]
v_cvt_pk_bf16_f32 v40, v24, v25
v_cvt_pk_bf16_f32 v41, v26, v27
v_mfma_f32_16x16x32_bf16 v[120:123], v[44:47], a[120:123], v[120:123]
v_mov_b32 v50, v24
v_mov_b32 v51, v25
v_mfma_f32_16x16x32_bf16 v[124:127], v[44:47], a[124:127], v[124:127]
v_add_f32 v50, v50, v26
v_add_f32 v51, v51, v27
v_mfma_f32_16x16x32_bf16 v[32:35], a[32:35], a[160:163], 0
v_mfma_f32_16x16x32_bf16 v[32:35], a[36:39], a[164:167], v[32:35]
v_mfma_f32_16x16x32_bf16 v[32:35], a[40:43], a[168:171], v[32:35]
v_mfma_f32_16x16x32_bf16 v[32:35], a[44:47], a[172:175], v[32:35]
v_mfma_f32_16x16x32_bf16 v[36:39], a[60:63], a[172:175], 0
v_mfma_f32_16x16x32_bf16 v[36:39], a[56:59], a[168:171], v[36:39]
s_nop 5
v_exp_f32 v32, v32
v_mfma_f32_16x16x32_bf16 v[36:39], a[52:55], a[164:167], v[36:39]
v_exp_f32 v33, v33
v_mfma_f32_16x16x32_bf16 v[36:39], a[48:51], a[160:163], v[36:39]
v_exp_f32 v34, v34
v_mfma_f32_16x16x32_bf16 v[128:131], v[40:43], a[64:67], 0
v_exp_f32 v35, v35
v_mfma_f32_16x16x32_bf16 v[132:135], v[40:43], a[68:71], 0
v_cvt_pk_bf16_f32 v44, v32, v33
s_nop 2
v_exp_f32 v36, v36
v_mfma_f32_16x16x32_bf16 v[136:139], v[40:43], a[72:75], 0
s_waitcnt vmcnt(4)
buffer_load_dwordx4 v3, s[4:7], s24 offen lds
v_mfma_f32_16x16x32_bf16 v[140:143], v[40:43], a[76:79], 0
buffer_load_dwordx4 v4, s[4:7], s24 offen offset:1056 lds
v_mfma_f32_16x16x32_bf16 v[144:147], v[40:43], a[80:83], 0
ds_read_b128 a[176:179], v11 offset:0
ds_read_b128 a[180:183], v11 offset:64
v_mfma_f32_16x16x32_bf16 v[148:151], v[40:43], a[84:87], 0
ds_read_b128 a[184:187], v11 offset:128
ds_read_b128 a[188:191], v11 offset:192
v_mfma_f32_16x16x32_bf16 v[152:155], v[40:43], a[88:91], 0
buffer_load_dwordx4 v3, s[8:11], s24 offen offset:2080 lds
v_mfma_f32_16x16x32_bf16 v[156:159], v[40:43], a[92:95], 0
v_add_u32 v11, 16640, v11
v_exp_f32 v37, v37
v_exp_f32 v38, v38
v_exp_f32 v39, v39
v_cvt_pk_bf16_f32 v45, v34, v35
v_cvt_pk_bf16_f32 v46, v36, v37
v_cvt_pk_bf16_f32 v47, v38, v39
v_add_f32 v50, v50, v32
v_add_f32 v51, v51, v33
buffer_load_dwordx4 v4, s[8:11], s24 offen offset:3136 lds
s_add_u32 m0, s28, 0
s_add_u32 s24, s24, -131072
v_add_f32 v50, v50, v34
v_add_f32 v51, v51, v35
s_waitcnt lgkmcnt(3)
v_mfma_f32_16x16x32_bf16 v[160:163], a[146:149], a[176:179], 0
v_add_f32 v50, v50, v36
v_add_f32 v51, v51, v37
v_mfma_f32_16x16x32_bf16 v[164:167], a[144:147], a[176:179], 0
v_add_f32 v50, v50, v38
v_add_f32 v51, v51, v39
v_mfma_f32_16x16x32_bf16 v[160:163], a[150:153], a[176:179], v[160:163]
v_mfma_f32_16x16x32_bf16 v[164:167], a[148:151], a[176:179], v[164:167]
s_waitcnt lgkmcnt(2)
v_mfma_f32_16x16x32_bf16 v[168:171], a[146:149], a[180:183], 0
s_nop 4
v_cvt_pk_bf16_f32 v160, v160, v161
v_mfma_f32_16x16x32_bf16 v[172:175], a[144:147], a[180:183], 0
v_cvt_pk_bf16_f32 v162, v162, v163
v_cvt_pk_bf16_f32 v164, v164, v165
v_mfma_f32_16x16x32_bf16 v[168:171], a[150:153], a[180:183], v[168:171]
v_cvt_pk_bf16_f32 v166, v166, v167
v_accvgpr_write_b32 a176, v160
v_mfma_f32_16x16x32_bf16 v[172:175], a[148:151], a[180:183], v[172:175]
v_accvgpr_write_b32 a177, v162
v_accvgpr_write_b32 a178, v164
s_waitcnt lgkmcnt(1)
v_mfma_f32_16x16x32_bf16 v[176:179], a[146:149], a[184:187], 0
v_accvgpr_write_b32 a179, v166
v_cvt_pk_bf16_f32 v168, v168, v169
v_mfma_f32_16x16x32_bf16 v[180:183], a[144:147], a[184:187], 0
v_cvt_pk_bf16_f32 v170, v170, v171
v_cvt_pk_bf16_f32 v172, v172, v173
v_mfma_f32_16x16x32_bf16 v[176:179], a[150:153], a[184:187], v[176:179]
v_cvt_pk_bf16_f32 v174, v174, v175
v_accvgpr_write_b32 a180, v168
v_mfma_f32_16x16x32_bf16 v[180:183], a[148:151], a[184:187], v[180:183]
v_accvgpr_write_b32 a181, v170
v_accvgpr_write_b32 a182, v172
s_waitcnt lgkmcnt(0)
v_mfma_f32_16x16x32_bf16 v[184:187], a[146:149], a[188:191], 0
v_accvgpr_write_b32 a183, v174
v_cvt_pk_bf16_f32 v176, v176, v177
v_mfma_f32_16x16x32_bf16 v[188:191], a[144:147], a[188:191], 0
v_cvt_pk_bf16_f32 v178, v178, v179
v_cvt_pk_bf16_f32 v180, v180, v181
v_mfma_f32_16x16x32_bf16 v[184:187], a[150:153], a[188:191], v[184:187]
v_cvt_pk_bf16_f32 v182, v182, v183
v_accvgpr_write_b32 a184, v176
v_mfma_f32_16x16x32_bf16 v[188:191], a[148:151], a[188:191], v[188:191]
v_accvgpr_write_b32 a185, v178
v_accvgpr_write_b32 a186, v180
v_mfma_f32_16x16x32_bf16 v[24:27], a[0:3], a[176:179], v[16:19]
v_accvgpr_write_b32 a187, v182
s_nop 0
v_cvt_pk_bf16_f32 v184, v184, v185
v_mfma_f32_16x16x32_bf16 v[24:27], a[4:7], a[180:183], v[24:27]
v_cvt_pk_bf16_f32 v186, v186, v187
v_cvt_pk_bf16_f32 v188, v188, v189
v_mfma_f32_16x16x32_bf16 v[24:27], a[8:11], a[184:187], v[24:27]
v_cvt_pk_bf16_f32 v190, v190, v191
v_accvgpr_write_b32 a188, v184
v_accvgpr_write_b32 a189, v186
v_accvgpr_write_b32 a190, v188
v_accvgpr_write_b32 a191, v190
s_nop 1
v_mfma_f32_16x16x32_bf16 v[24:27], a[12:15], a[188:191], v[24:27]
v_mfma_f32_16x16x32_bf16 v[128:131], v[44:47], a[96:99], v[128:131]
v_mfma_f32_16x16x32_bf16 v[132:135], v[44:47], a[100:103], v[132:135]
s_nop 5
v_exp_f32 v24, v24
v_mfma_f32_16x16x32_bf16 v[136:139], v[44:47], a[104:107], v[136:139]
v_exp_f32 v25, v25
v_mfma_f32_16x16x32_bf16 v[140:143], v[44:47], a[108:111], v[140:143]
v_exp_f32 v26, v26
v_mfma_f32_16x16x32_bf16 v[144:147], v[44:47], a[112:115], v[144:147]
v_exp_f32 v27, v27
v_mfma_f32_16x16x32_bf16 v[148:151], v[44:47], a[116:119], v[148:151]
v_cvt_pk_bf16_f32 v40, v24, v25
v_cvt_pk_bf16_f32 v41, v26, v27
v_mfma_f32_16x16x32_bf16 v[152:155], v[44:47], a[120:123], v[152:155]
v_mfma_f32_16x16x32_bf16 v[156:159], v[44:47], a[124:127], v[156:159]
v_mfma_f32_16x16x32_bf16 v[32:35], a[32:35], a[176:179], 0
v_mfma_f32_16x16x32_bf16 v[32:35], a[36:39], a[180:183], v[32:35]
v_mfma_f32_16x16x32_bf16 v[32:35], a[40:43], a[184:187], v[32:35]
v_mfma_f32_16x16x32_bf16 v[32:35], a[44:47], a[188:191], v[32:35]
v_mfma_f32_16x16x32_bf16 v[36:39], a[60:63], a[188:191], 0
v_mfma_f32_16x16x32_bf16 v[36:39], a[56:59], a[184:187], v[36:39]
s_nop 5
v_exp_f32 v32, v32
v_mfma_f32_16x16x32_bf16 v[36:39], a[52:55], a[180:183], v[36:39]
v_exp_f32 v33, v33
v_mfma_f32_16x16x32_bf16 v[36:39], a[48:51], a[176:179], v[36:39]
v_exp_f32 v34, v34
v_mfma_f32_16x16x32_bf16 v[160:163], v[40:43], a[64:67], 0
v_exp_f32 v35, v35
v_mfma_f32_16x16x32_bf16 v[164:167], v[40:43], a[68:71], 0
v_cvt_pk_bf16_f32 v44, v32, v33
s_nop 2
v_exp_f32 v36, v36
v_mfma_f32_16x16x32_bf16 v[168:171], v[40:43], a[72:75], 0
s_waitcnt vmcnt(4)
buffer_load_dwordx4 v3, s[4:7], s24 offen lds
v_mfma_f32_16x16x32_bf16 v[172:175], v[40:43], a[76:79], 0
buffer_load_dwordx4 v4, s[4:7], s24 offen offset:1056 lds
v_mfma_f32_16x16x32_bf16 v[176:179], v[40:43], a[80:83], 0
ds_read_b128 a[192:195], v11 offset:0
ds_read_b128 a[196:199], v11 offset:64
v_mfma_f32_16x16x32_bf16 v[180:183], v[40:43], a[84:87], 0
ds_read_b128 a[200:203], v11 offset:128
ds_read_b128 a[204:207], v11 offset:192
v_mfma_f32_16x16x32_bf16 v[184:187], v[40:43], a[88:91], 0
buffer_load_dwordx4 v3, s[8:11], s24 offen offset:2080 lds
v_mfma_f32_16x16x32_bf16 v[188:191], v[40:43], a[92:95], 0
v_exp_f32 v37, v37
v_mfma_f32_16x16x32_bf16 a[136:139], a[128:131], v[40:43], 0
v_exp_f32 v38, v38
v_exp_f32 v39, v39
v_cvt_pk_bf16_f32 v45, v34, v35
v_cvt_pk_bf16_f32 v46, v36, v37
v_cvt_pk_bf16_f32 v47, v38, v39
buffer_load_dwordx4 v4, s[8:11], s24 offen offset:3136 lds
s_add_u32 m0, s28, 16640
s_add_u32 s24, s24, -131072
s_waitcnt lgkmcnt(3)
v_mfma_f32_16x16x32_bf16 v[192:195], a[146:149], a[192:195], 0
v_mfma_f32_16x16x32_bf16 v[196:199], a[144:147], a[192:195], 0
v_mfma_f32_16x16x32_bf16 v[192:195], a[150:153], a[192:195], v[192:195]
v_mfma_f32_16x16x32_bf16 v[196:199], a[148:151], a[192:195], v[196:199]
s_waitcnt lgkmcnt(2)
v_mfma_f32_16x16x32_bf16 v[200:203], a[146:149], a[196:199], 0
s_nop 4
v_cvt_pk_bf16_f32 v192, v192, v193
v_mfma_f32_16x16x32_bf16 v[204:207], a[144:147], a[196:199], 0
v_cvt_pk_bf16_f32 v194, v194, v195
v_cvt_pk_bf16_f32 v196, v196, v197
v_mfma_f32_16x16x32_bf16 v[200:203], a[150:153], a[196:199], v[200:203]
v_cvt_pk_bf16_f32 v198, v198, v199
v_accvgpr_write_b32 a192, v192
v_mfma_f32_16x16x32_bf16 v[204:207], a[148:151], a[196:199], v[204:207]
v_accvgpr_write_b32 a193, v194
v_accvgpr_write_b32 a194, v196
s_waitcnt lgkmcnt(1)
v_mfma_f32_16x16x32_bf16 v[208:211], a[146:149], a[200:203], 0
v_accvgpr_write_b32 a195, v198
v_cvt_pk_bf16_f32 v200, v200, v201
v_mfma_f32_16x16x32_bf16 v[212:215], a[144:147], a[200:203], 0
s_waitcnt lgkmcnt(0)
s_waitcnt vmcnt(4)
s_barrier
v_mfma_f32_16x16x32_bf16 v[208:211], a[150:153], a[200:203], v[208:211]
buffer_load_dwordx4 v3, s[4:7], s24 offen lds
v_mfma_f32_16x16x32_bf16 v[212:215], a[148:151], a[200:203], v[212:215]
buffer_load_dwordx4 v4, s[4:7], s24 offen offset:1056 lds
v_mfma_f32_16x16x32_bf16 v[216:219], a[146:149], a[204:207], 0
v_cvt_pk_bf16_f32 v202, v202, v203
v_cvt_pk_bf16_f32 v204, v204, v205
v_mfma_f32_16x16x32_bf16 v[220:223], a[144:147], a[204:207], 0
v_cvt_pk_bf16_f32 v206, v206, v207
v_accvgpr_write_b32 a196, v200
v_mfma_f32_16x16x32_bf16 v[216:219], a[150:153], a[204:207], v[216:219]
buffer_load_dwordx4 v3, s[8:11], s24 offen offset:2080 lds
v_mfma_f32_16x16x32_bf16 v[220:223], a[148:151], a[204:207], v[220:223]
v_accvgpr_write_b32 a197, v202
v_accvgpr_write_b32 a198, v204
v_mfma_f32_16x16x32_bf16 v[24:27], a[0:3], a[192:195], v[16:19]
v_accvgpr_write_b32 a199, v206
v_cvt_pk_bf16_f32 v208, v208, v209
v_cvt_pk_bf16_f32 v210, v210, v211
v_mfma_f32_16x16x32_bf16 v[24:27], a[4:7], a[196:199], v[24:27]
v_cvt_pk_bf16_f32 v212, v212, v213
v_cvt_pk_bf16_f32 v214, v214, v215
v_accvgpr_write_b32 a200, v208
buffer_load_dwordx4 v4, s[8:11], s24 offen offset:3136 lds
v_accvgpr_write_b32 a201, v210
v_accvgpr_write_b32 a202, v212
v_accvgpr_write_b32 a203, v214
v_cvt_pk_bf16_f32 v216, v216, v217
v_cvt_pk_bf16_f32 v218, v218, v219
v_mfma_f32_16x16x32_bf16 v[24:27], a[8:11], a[200:203], v[24:27]
s_add_u32 m0, s28, 33280
v_cvt_pk_bf16_f32 v220, v220, v221
v_cvt_pk_bf16_f32 v222, v222, v223
v_accvgpr_write_b32 a204, v216
v_accvgpr_write_b32 a205, v218
v_accvgpr_write_b32 a206, v220
v_accvgpr_write_b32 a207, v222
ds_read_b128 a[0:3], v1 offset:0
ds_read_b128 a[4:7], v1 offset:64
v_mfma_f32_16x16x32_bf16 v[24:27], a[12:15], a[204:207], v[24:27]
s_add_u32 s24, s24, -131072
ds_read_b128 a[8:11], v1 offset:128
ds_read_b128 a[12:15], v1 offset:192
v_mfma_f32_16x16x32_bf16 v[160:163], v[44:47], a[96:99], v[160:163]
ds_read_b128 a[16:19], v1 offset:512
v_mfma_f32_16x16x32_bf16 v[164:167], v[44:47], a[100:103], v[164:167]
ds_read_b128 a[20:23], v1 offset:576
s_nop 0
v_exp_f32 v24, v24
v_mfma_f32_16x16x32_bf16 v[168:171], v[44:47], a[104:107], v[168:171]
ds_read_b128 a[24:27], v1 offset:640
v_exp_f32 v25, v25
v_mfma_f32_16x16x32_bf16 v[172:175], v[44:47], a[108:111], v[172:175]
ds_read_b128 a[28:31], v1 offset:704
v_exp_f32 v26, v26
v_mfma_f32_16x16x32_bf16 v[176:179], v[44:47], a[112:115], v[176:179]
v_exp_f32 v27, v27
v_mfma_f32_16x16x32_bf16 v[180:183], v[44:47], a[116:119], v[180:183]
v_cvt_pk_bf16_f32 v40, v24, v25
v_cvt_pk_bf16_f32 v41, v26, v27
v_mfma_f32_16x16x32_bf16 v[184:187], v[44:47], a[120:123], v[184:187]
v_mov_b32 v52, v24
v_mov_b32 v53, v25
v_mfma_f32_16x16x32_bf16 v[188:191], v[44:47], a[124:127], v[188:191]
v_add_f32 v52, v52, v26
v_add_f32 v53, v53, v27
v_mfma_f32_16x16x32_bf16 a[136:139], a[128:131], v[44:47], a[136:139]
v_add_u32 v1, -116480, v1
v_mfma_f32_16x16x32_bf16 v[32:35], a[32:35], a[192:195], 0
v_mfma_f32_16x16x32_bf16 v[32:35], a[36:39], a[196:199], v[32:35]
v_mfma_f32_16x16x32_bf16 v[32:35], a[40:43], a[200:203], v[32:35]
v_mfma_f32_16x16x32_bf16 v[32:35], a[44:47], a[204:207], v[32:35]
v_mfma_f32_16x16x32_bf16 v[36:39], a[60:63], a[204:207], 0
v_mfma_f32_16x16x32_bf16 v[36:39], a[56:59], a[200:203], v[36:39]
s_nop 5
v_exp_f32 v32, v32
v_mfma_f32_16x16x32_bf16 v[36:39], a[52:55], a[196:199], v[36:39]
v_exp_f32 v33, v33
v_mfma_f32_16x16x32_bf16 v[36:39], a[48:51], a[192:195], v[36:39]
v_exp_f32 v34, v34
v_mfma_f32_16x16x32_bf16 v[192:195], v[40:43], a[64:67], 0
ds_read_b64_tr_b16 a[64:65], v2 offset:0
ds_read_b64_tr_b16 a[66:67], v2 offset:512
v_mfma_f32_16x16x32_bf16 v[196:199], v[40:43], a[68:71], 0
ds_read_b64_tr_b16 a[68:69], v2 offset:32
ds_read_b64_tr_b16 a[70:71], v2 offset:544
v_mfma_f32_16x16x32_bf16 v[200:203], v[40:43], a[72:75], 0
ds_read_b64_tr_b16 a[72:73], v2 offset:64
ds_read_b64_tr_b16 a[74:75], v2 offset:576
v_mfma_f32_16x16x32_bf16 v[204:207], v[40:43], a[76:79], 0
ds_read_b64_tr_b16 a[76:77], v2 offset:96
ds_read_b64_tr_b16 a[78:79], v2 offset:608
v_mfma_f32_16x16x32_bf16 v[208:211], v[40:43], a[80:83], 0
ds_read_b64_tr_b16 a[80:81], v2 offset:128
ds_read_b64_tr_b16 a[82:83], v2 offset:640
v_mfma_f32_16x16x32_bf16 v[212:215], v[40:43], a[84:87], 0
ds_read_b64_tr_b16 a[84:85], v2 offset:160
ds_read_b64_tr_b16 a[86:87], v2 offset:672
v_mfma_f32_16x16x32_bf16 v[216:219], v[40:43], a[88:91], 0
ds_read_b64_tr_b16 a[88:89], v2 offset:192
ds_read_b64_tr_b16 a[90:91], v2 offset:704
v_mfma_f32_16x16x32_bf16 v[220:223], v[40:43], a[92:95], 0
ds_read_b64_tr_b16 a[92:93], v2 offset:224
ds_read_b64_tr_b16 a[94:95], v2 offset:736
s_waitcnt lgkmcnt(15)
v_mfma_f32_16x16x32_bf16 v[24:27], a[0:3], v[224:227], 0
v_exp_f32 v35, v35
v_mfma_f32_16x16x32_bf16 v[24:27], a[4:7], v[228:231], v[24:27]
v_exp_f32 v36, v36
v_mfma_f32_16x16x32_bf16 v[24:27], a[8:11], v[232:235], v[24:27]
v_exp_f32 v37, v37
v_mfma_f32_16x16x32_bf16 v[24:27], a[12:15], v[236:239], v[24:27]
v_exp_f32 v38, v38
v_mfma_f32_16x16x32_bf16 v[28:31], a[28:31], v[236:239], 0
v_exp_f32 v39, v39
v_mfma_f32_16x16x32_bf16 v[28:31], a[24:27], v[232:235], v[28:31]
v_cvt_pk_bf16_f32 v44, v32, v33
v_cvt_pk_bf16_f32 v45, v34, v35
v_mfma_f32_16x16x32_bf16 v[28:31], a[20:23], v[228:231], v[28:31]
v_cvt_pk_bf16_f32 v46, v36, v37
v_cvt_pk_bf16_f32 v47, v38, v39
v_mfma_f32_16x16x32_bf16 v[28:31], a[16:19], v[224:227], v[28:31]
s_waitcnt lgkmcnt(0)
s_waitcnt vmcnt(4)
s_barrier
v_mfma_f32_16x16x32_bf16 v[192:195], v[44:47], a[96:99], v[192:195]
buffer_load_dwordx4 v3, s[4:7], s24 offen lds
v_mfma_f32_16x16x32_bf16 v[196:199], v[44:47], a[100:103], v[196:199]
buffer_load_dwordx4 v4, s[4:7], s24 offen offset:1056 lds
v_mfma_f32_16x16x32_bf16 v[200:203], v[44:47], a[104:107], v[200:203]
v_add_f32 v52, v52, v32
v_add_f32 v53, v53, v33
v_mfma_f32_16x16x32_bf16 v[204:207], v[44:47], a[108:111], v[204:207]
v_exp_f32 v24, v24
v_mfma_f32_16x16x32_bf16 v[208:211], v[44:47], a[112:115], v[208:211]
buffer_load_dwordx4 v3, s[8:11], s24 offen offset:2080 lds
v_mfma_f32_16x16x32_bf16 v[212:215], v[44:47], a[116:119], v[212:215]
v_exp_f32 v25, v25
v_mfma_f32_16x16x32_bf16 v[216:219], v[44:47], a[120:123], v[216:219]
v_exp_f32 v26, v26
v_mfma_f32_16x16x32_bf16 v[220:223], v[44:47], a[124:127], v[220:223]
v_exp_f32 v27, v27
v_add_f32 v52, v52, v34
v_add_f32 v53, v53, v35
buffer_load_dwordx4 v4, s[8:11], s24 offen offset:3136 lds
s_add_u32 m0, s28, 49920
s_add_u32 s24, s24, -131072
v_add_f32 v52, v52, v36
v_add_f32 v53, v53, v37
v_exp_f32 v28, v28
v_add_f32 v52, v52, v38
v_add_f32 v53, v53, v39
v_cvt_pk_bf16_f32 v40, v24, v25
v_cvt_pk_bf16_f32 v41, v26, v27
v_add_u32 v2, -116480, v2
buffer_load_dwordx4 v3, s[4:7], s24 offen lds
buffer_load_dwordx4 v4, s[4:7], s24 offen offset:1056 lds
buffer_load_dwordx4 v3, s[8:11], s24 offen offset:2080 lds
buffer_load_dwordx4 v4, s[8:11], s24 offen offset:3136 lds
s_add_u32 m0, s28, 66560
s_add_u32 s24, s24, -131072
L_step2_5:
v_mfma_f32_16x16x32_bf16 v[32:35], a[0:3], v[240:243], 0
buffer_load_dwordx4 v3, s[4:7], s24 offen lds
v_mfma_f32_16x16x32_bf16 v[32:35], a[4:7], v[244:247], v[32:35]
s_sub_u32 s30, s30, 1
v_exp_f32 v29, v29
v_mfma_f32_16x16x32_bf16 v[32:35], a[8:11], v[248:251], v[32:35]
s_cselect_b32 s31, s35, s34
ds_read_b128 a[32:35], v1 offset:0
v_cvt_pk_bf16_f32 v42, v28, v29
v_mfma_f32_16x16x32_bf16 v[32:35], a[12:15], v[252:255], v[32:35]
s_cselect_b32 s30, 7, s30
v_exp_f32 v30, v30
v_mfma_f32_16x16x32_bf16 v[36:39], a[28:31], v[252:255], 0
buffer_load_dwordx4 v4, s[4:7], s24 offen offset:1056 lds
v_mfma_f32_16x16x32_bf16 v[36:39], a[24:27], v[248:251], v[36:39]
s_add_u32 s33, s33, 1
v_exp_f32 v31, v31
v_mfma_f32_16x16x32_bf16 v[36:39], a[20:23], v[244:247], v[36:39]
ds_read_b128 a[36:39], v1 offset:64
v_cvt_pk_bf16_f32 v43, v30, v31
v_mfma_f32_16x16x32_bf16 v[36:39], a[16:19], v[240:243], v[36:39]
v_exp_f32 v32, v32
v_mfma_f32_16x16x32_bf16 v[64:67], v[40:43], a[64:67], v[64:67]
buffer_load_dwordx4 v3, s[8:11], s24 offen offset:2080 lds
v_mfma_f32_16x16x32_bf16 v[68:71], v[40:43], a[68:71], v[68:71]
v_exp_f32 v33, v33
v_mfma_f32_16x16x32_bf16 v[72:75], v[40:43], a[72:75], v[72:75]
v_cvt_pk_bf16_f32 v44, v32, v33
v_add_f32 v48, v48, v32
v_mfma_f32_16x16x32_bf16 v[76:79], v[40:43], a[76:79], v[76:79]
v_exp_f32 v34, v34
v_mfma_f32_16x16x32_bf16 v[80:83], v[40:43], a[80:83], v[80:83]
buffer_load_dwordx4 v4, s[8:11], s24 offen offset:3136 lds
v_mfma_f32_16x16x32_bf16 v[84:87], v[40:43], a[84:87], v[84:87]
s_add_u32 m0, m0, s34
v_exp_f32 v35, v35
v_mfma_f32_16x16x32_bf16 v[88:91], v[40:43], a[88:91], v[88:91]
s_cmp_eq_u32 m0, s29
v_cvt_pk_bf16_f32 v45, v34, v35
v_add_f32 v49, v49, v33
v_mfma_f32_16x16x32_bf16 v[92:95], v[40:43], a[92:95], v[92:95]
s_cselect_b32 m0, s28, m0
v_exp_f32 v36, v36
v_mfma_f32_16x16x32_bf16 a[132:135], a[128:131], v[40:43], a[132:135]
s_add_u32 s24, s24, s25
v_add_f32 v48, v48, v34
v_add_f32 v49, v49, v35
v_mfma_f32_16x16x32_bf16 v[24:27], a[0:3], a[160:163], 0
s_sub_u32 s26, s26, 1
ds_read_b128 a[40:43], v1 offset:128
v_add_f32 v48, v48, v36
v_mfma_f32_16x16x32_bf16 v[24:27], a[4:7], a[164:167], v[24:27]
v_exp_f32 v37, v37
v_mfma_f32_16x16x32_bf16 v[24:27], a[8:11], a[168:171], v[24:27]
v_cvt_pk_bf16_f32 v46, v36, v37
v_add_f32 v49, v49, v37
v_mfma_f32_16x16x32_bf16 v[24:27], a[12:15], a[172:175], v[24:27]
v_exp_f32 v38, v38
v_mfma_f32_16x16x32_bf16 v[28:31], a[28:31], a[172:175], 0
ds_read_b128 a[44:47], v1 offset:192
v_add_f32 v48, v48, v38
v_mfma_f32_16x16x32_bf16 v[28:31], a[24:27], a[168:171], v[28:31]
v_exp_f32 v39, v39
v_mfma_f32_16x16x32_bf16 v[28:31], a[20:23], a[164:167], v[28:31]
v_cvt_pk_bf16_f32 v47, v38, v39
v_add_f32 v49, v49, v39
v_mfma_f32_16x16x32_bf16 v[28:31], a[16:19], a[160:163], v[28:31]
v_exp_f32 v24, v24
v_mfma_f32_16x16x32_bf16 v[96:99], v[44:47], a[64:67], v[96:99]
ds_read_b128 a[48:51], v1 offset:512
v_add_f32 v50, v50, v24
v_mfma_f32_16x16x32_bf16 v[100:103], v[44:47], a[68:71], v[100:103]
v_exp_f32 v25, v25
v_mfma_f32_16x16x32_bf16 v[104:107], v[44:47], a[72:75], v[104:107]
v_cvt_pk_bf16_f32 v40, v24, v25
v_add_f32 v51, v51, v25
v_mfma_f32_16x16x32_bf16 v[108:111], v[44:47], a[76:79], v[108:111]
v_exp_f32 v26, v26
v_mfma_f32_16x16x32_bf16 v[112:115], v[44:47], a[80:83], v[112:115]
ds_read_b128 a[52:55], v1 offset:576
v_add_f32 v50, v50, v26
v_mfma_f32_16x16x32_bf16 v[116:119], v[44:47], a[84:87], v[116:119]
v_exp_f32 v27, v27
v_mfma_f32_16x16x32_bf16 v[120:123], v[44:47], a[88:91], v[120:123]
v_cvt_pk_bf16_f32 v41, v26, v27
v_add_f32 v51, v51, v27
v_mfma_f32_16x16x32_bf16 v[124:127], v[44:47], a[92:95], v[124:127]
s_waitcnt vmcnt(12)
v_exp_f32 v28, v28
v_mfma_f32_16x16x32_bf16 v[32:35], a[0:3], a[176:179], 0
ds_add_u32 v8, v10
v_add_f32 v50, v50, v28
v_mfma_f32_16x16x32_bf16 v[32:35], a[4:7], a[180:183], v[32:35]
v_exp_f32 v29, v29
v_mfma_f32_16x16x32_bf16 v[32:35], a[8:11], a[184:187], v[32:35]
v_cvt_pk_bf16_f32 v42, v28, v29
v_add_f32 v51, v51, v29
v_mfma_f32_16x16x32_bf16 v[32:35], a[12:15], a[188:191], v[32:35]
v_exp_f32 v30, v30
v_mfma_f32_16x16x32_bf16 v[36:39], a[28:31], a[188:191], 0
ds_read_b128 a[56:59], v1 offset:640
v_add_f32 v50, v50, v30
v_mfma_f32_16x16x32_bf16 v[36:39], a[24:27], a[184:187], v[36:39]
v_exp_f32 v31, v31
v_mfma_f32_16x16x32_bf16 v[36:39], a[20:23], a[180:183], v[36:39]
v_cvt_pk_bf16_f32 v43, v30, v31
v_add_f32 v51, v51, v31
v_mfma_f32_16x16x32_bf16 v[36:39], a[16:19], a[176:179], v[36:39]
v_exp_f32 v32, v32
v_mfma_f32_16x16x32_bf16 v[128:131], v[40:43], a[64:67], v[128:131]
ds_read_b128 a[60:63], v1 offset:704
ds_read_b64_tr_b16 a[96:97], v2 offset:0
v_mfma_f32_16x16x32_bf16 v[132:135], v[40:43], a[68:71], v[132:135]
v_exp_f32 v33, v33
v_mfma_f32_16x16x32_bf16 v[136:139], v[40:43], a[72:75], v[136:139]
ds_read_b64_tr_b16 a[98:99], v2 offset:512
v_cvt_pk_bf16_f32 v44, v32, v33
v_mfma_f32_16x16x32_bf16 v[140:143], v[40:43], a[76:79], v[140:143]
v_exp_f32 v34, v34
v_mfma_f32_16x16x32_bf16 v[144:147], v[40:43], a[80:83], v[144:147]
ds_read_b64_tr_b16 a[100:101], v2 offset:32
ds_read_b64_tr_b16 a[102:103], v2 offset:544
v_mfma_f32_16x16x32_bf16 v[148:151], v[40:43], a[84:87], v[148:151]
v_exp_f32 v35, v35
v_mfma_f32_16x16x32_bf16 v[152:155], v[40:43], a[88:91], v[152:155]
ds_read_b64_tr_b16 a[104:105], v2 offset:64
v_cvt_pk_bf16_f32 v45, v34, v35
v_mfma_f32_16x16x32_bf16 v[156:159], v[40:43], a[92:95], v[156:159]
v_exp_f32 v36, v36
v_mfma_f32_16x16x32_bf16 v[24:27], a[0:3], a[192:195], 0
ds_read_b64_tr_b16 a[106:107], v2 offset:576
ds_read_b64_tr_b16 a[108:109], v2 offset:96
v_mfma_f32_16x16x32_bf16 v[24:27], a[4:7], a[196:199], v[24:27]
v_exp_f32 v37, v37
v_mfma_f32_16x16x32_bf16 v[24:27], a[8:11], a[200:203], v[24:27]
ds_read_b64_tr_b16 a[110:111], v2 offset:608
v_cvt_pk_bf16_f32 v46, v36, v37
v_mfma_f32_16x16x32_bf16 v[24:27], a[12:15], a[204:207], v[24:27]
v_exp_f32 v38, v38
v_mfma_f32_16x16x32_bf16 v[28:31], a[28:31], a[204:207], 0
ds_read_b64_tr_b16 a[112:113], v2 offset:128
ds_read_b64_tr_b16 a[114:115], v2 offset:640
v_mfma_f32_16x16x32_bf16 v[28:31], a[24:27], a[200:203], v[28:31]
v_exp_f32 v39, v39
v_mfma_f32_16x16x32_bf16 v[28:31], a[20:23], a[196:199], v[28:31]
ds_read_b64_tr_b16 a[116:117], v2 offset:160
v_cvt_pk_bf16_f32 v47, v38, v39
v_mfma_f32_16x16x32_bf16 v[28:31], a[16:19], a[192:195], v[28:31]
v_exp_f32 v24, v24
v_mfma_f32_16x16x32_bf16 v[160:163], v[44:47], a[64:67], v[160:163]
ds_read_b64_tr_b16 a[118:119], v2 offset:672
ds_read_b64_tr_b16 a[120:121], v2 offset:192
v_mfma_f32_16x16x32_bf16 v[164:167], v[44:47], a[68:71], v[164:167]
v_exp_f32 v25, v25
v_mfma_f32_16x16x32_bf16 v[168:171], v[44:47], a[72:75], v[168:171]
ds_read_b64_tr_b16 a[122:123], v2 offset:704
v_cvt_pk_bf16_f32 v40, v24, v25
v_mfma_f32_16x16x32_bf16 v[172:175], v[44:47], a[76:79], v[172:175]
v_exp_f32 v26, v26
v_mfma_f32_16x16x32_bf16 v[176:179], v[44:47], a[80:83], v[176:179]
ds_read_b64_tr_b16 a[124:125], v2 offset:224
ds_read_b64_tr_b16 a[126:127], v2 offset:736
v_mfma_f32_16x16x32_bf16 v[180:183], v[44:47], a[84:87], v[180:183]
v_exp_f32 v27, v27
v_mfma_f32_16x16x32_bf16 v[184:187], v[44:47], a[88:91], v[184:187]
v_cvt_pk_bf16_f32 v41, v26, v27
v_add_f32 v52, v52, v24
v_mfma_f32_16x16x32_bf16 v[188:191], v[44:47], a[92:95], v[188:191]
v_exp_f32 v28, v28
v_mfma_f32_16x16x32_bf16 a[136:139], a[128:131], v[44:47], a[136:139]
s_waitcnt lgkmcnt(15)
v_add_f32 v53, v53, v25
v_add_f32 v52, v52, v26
v_mfma_f32_16x16x32_bf16 v[32:35], a[32:35], v[224:227], 0
v_add_f32 v53, v53, v27
v_add_f32 v52, v52, v28
v_mfma_f32_16x16x32_bf16 v[32:35], a[36:39], v[228:231], v[32:35]
v_exp_f32 v29, v29
v_mfma_f32_16x16x32_bf16 v[32:35], a[40:43], v[232:235], v[32:35]
v_cvt_pk_bf16_f32 v42, v28, v29
v_add_f32 v53, v53, v29
v_mfma_f32_16x16x32_bf16 v[32:35], a[44:47], v[236:239], v[32:35]
v_exp_f32 v30, v30
v_mfma_f32_16x16x32_bf16 v[36:39], a[60:63], v[236:239], 0
ds_read_b32 v11, v9
v_add_f32 v52, v52, v30
v_mfma_f32_16x16x32_bf16 v[36:39], a[56:59], v[232:235], v[36:39]
v_exp_f32 v31, v31
v_mfma_f32_16x16x32_bf16 v[36:39], a[52:55], v[228:231], v[36:39]
v_cvt_pk_bf16_f32 v43, v30, v31
v_add_f32 v53, v53, v31
v_mfma_f32_16x16x32_bf16 v[36:39], a[48:51], v[224:227], v[36:39]
v_exp_f32 v32, v32
v_mfma_f32_16x16x32_bf16 v[192:195], v[40:43], a[64:67], v[192:195]
v_add_u32 v1, s31, v1
v_add_u32 v2, s31, v2
v_mfma_f32_16x16x32_bf16 v[196:199], v[40:43], a[68:71], v[196:199]
s_waitcnt lgkmcnt(0)
v_exp_f32 v33, v33
v_mfma_f32_16x16x32_bf16 v[200:203], v[40:43], a[72:75], v[200:203]
v_cvt_pk_bf16_f32 v44, v32, v33
v_cmp_gt_u32 vcc, s33, v11
v_mfma_f32_16x16x32_bf16 v[204:207], v[40:43], a[76:79], v[204:207]
v_exp_f32 v34, v34
v_mfma_f32_16x16x32_bf16 v[208:211], v[40:43], a[80:83], v[208:211]
v_mfma_f32_16x16x32_bf16 v[212:215], v[40:43], a[84:87], v[212:215]
s_waitcnt lgkmcnt(0)
v_exp_f32 v35, v35
v_mfma_f32_16x16x32_bf16 v[216:219], v[40:43], a[88:91], v[216:219]
v_cvt_pk_bf16_f32 v45, v34, v35
v_mfma_f32_16x16x32_bf16 v[220:223], v[40:43], a[92:95], v[220:223]
s_cbranch_vccnz L_spin_55
L_spinret_56:
v_exp_f32 v36, v36
buffer_load_dwordx4 v3, s[4:7], s24 offen lds
buffer_load_dwordx4 v4, s[4:7], s24 offen offset:1056 lds
buffer_load_dwordx4 v3, s[8:11], s24 offen offset:2080 lds
buffer_load_dwordx4 v4, s[8:11], s24 offen offset:3136 lds
s_add_u32 m0, m0, s34
s_cmp_eq_u32 m0, s29
s_cselect_b32 m0, s28, m0
s_add_u32 s24, s24, s25
s_sub_u32 s26, s26, 1
.p2align 6
L_loop5:
v_mfma_f32_16x16x32_bf16 v[24:27], a[32:35], v[240:243], 0
buffer_load_dwordx4 v3, s[4:7], s24 offen lds
v_mfma_f32_16x16x32_bf16 v[24:27], a[36:39], v[244:247], v[24:27]
s_sub_u32 s30, s30, 1
v_exp_f32 v37, v37
v_mfma_f32_16x16x32_bf16 v[24:27], a[40:43], v[248:251], v[24:27]
s_cselect_b32 s31, s35, s34
ds_read_b128 a[0:3], v1 offset:0
v_cvt_pk_bf16_f32 v46, v36, v37
v_mfma_f32_16x16x32_bf16 v[24:27], a[44:47], v[252:255], v[24:27]
s_cselect_b32 s30, 7, s30
v_exp_f32 v38, v38
v_mfma_f32_16x16x32_bf16 v[28:31], a[60:63], v[252:255], 0
buffer_load_dwordx4 v4, s[4:7], s24 offen offset:1056 lds
v_mfma_f32_16x16x32_bf16 v[28:31], a[56:59], v[248:251], v[28:31]
s_add_u32 s33, s33, 1
v_exp_f32 v39, v39
v_mfma_f32_16x16x32_bf16 v[28:31], a[52:55], v[244:247], v[28:31]
ds_read_b128 a[4:7], v1 offset:64
v_cvt_pk_bf16_f32 v47, v38, v39
v_mfma_f32_16x16x32_bf16 v[28:31], a[48:51], v[240:243], v[28:31]
v_exp_f32 v24, v24
v_mfma_f32_16x16x32_bf16 v[64:67], v[44:47], a[96:99], v[64:67]
buffer_load_dwordx4 v3, s[8:11], s24 offen offset:2080 lds
v_mfma_f32_16x16x32_bf16 v[68:71], v[44:47], a[100:103], v[68:71]
v_exp_f32 v25, v25
v_mfma_f32_16x16x32_bf16 v[72:75], v[44:47], a[104:107], v[72:75]
v_cvt_pk_bf16_f32 v40, v24, v25
v_add_f32 v48, v48, v24
v_mfma_f32_16x16x32_bf16 v[76:79], v[44:47], a[108:111], v[76:79]
v_exp_f32 v26, v26
v_mfma_f32_16x16x32_bf16 v[80:83], v[44:47], a[112:115], v[80:83]
buffer_load_dwordx4 v4, s[8:11], s24 offen offset:3136 lds
v_mfma_f32_16x16x32_bf16 v[84:87], v[44:47], a[116:119], v[84:87]
s_add_u32 m0, m0, s34
v_exp_f32 v27, v27
v_mfma_f32_16x16x32_bf16 v[88:91], v[44:47], a[120:123], v[88:91]
s_cmp_eq_u32 m0, s29
v_cvt_pk_bf16_f32 v41, v26, v27
v_add_f32 v49, v49, v25
v_mfma_f32_16x16x32_bf16 v[92:95], v[44:47], a[124:127], v[92:95]
s_cselect_b32 m0, s28, m0
v_exp_f32 v28, v28
v_mfma_f32_16x16x32_bf16 a[132:135], a[128:131], v[44:47], a[132:135]
s_add_u32 s24, s24, s25
v_add_f32 v48, v48, v26
v_add_f32 v49, v49, v27
v_mfma_f32_16x16x32_bf16 v[32:35], a[32:35], a[160:163], 0
s_sub_u32 s26, s26, 1
ds_read_b128 a[8:11], v1 offset:128
v_add_f32 v48, v48, v28
v_mfma_f32_16x16x32_bf16 v[32:35], a[36:39], a[164:167], v[32:35]
s_cmov_b64 s[4:5], s[52:53]
v_exp_f32 v29, v29
v_mfma_f32_16x16x32_bf16 v[32:35], a[40:43], a[168:171], v[32:35]
s_cmov_b64 s[8:9], s[54:55]
v_cvt_pk_bf16_f32 v42, v28, v29
v_add_f32 v49, v49, v29
v_mfma_f32_16x16x32_bf16 v[32:35], a[44:47], a[172:175], v[32:35]
s_cmov_b64 s[24:25], s[56:57]
v_exp_f32 v30, v30
v_mfma_f32_16x16x32_bf16 v[36:39], a[60:63], a[172:175], 0
s_cmov_b32 s6, s58
ds_read_b128 a[12:15], v1 offset:192
v_add_f32 v48, v48, v30
v_mfma_f32_16x16x32_bf16 v[36:39], a[56:59], a[168:171], v[36:39]
s_cmov_b32 s10, s59
v_exp_f32 v31, v31
v_mfma_f32_16x16x32_bf16 v[36:39], a[52:55], a[164:167], v[36:39]
s_cmov_b32 s26, s60
v_cvt_pk_bf16_f32 v43, v30, v31
v_add_f32 v49, v49, v31
v_mfma_f32_16x16x32_bf16 v[36:39], a[48:51], a[160:163], v[36:39]
s_cmov_b64 s[52:53], s[62:63]
v_exp_f32 v32, v32
v_mfma_f32_16x16x32_bf16 v[96:99], v[40:43], a[96:99], v[96:99]
s_cmov_b64 s[54:55], s[64:65]
ds_read_b128 a[16:19], v1 offset:512
v_add_f32 v50, v50, v32
v_mfma_f32_16x16x32_bf16 v[100:103], v[40:43], a[100:103], v[100:103]
s_cmov_b64 s[56:57], s[66:67]
v_exp_f32 v33, v33
v_mfma_f32_16x16x32_bf16 v[104:107], v[40:43], a[104:107], v[104:107]
s_cmov_b64 s[58:59], s[68:69]
v_cvt_pk_bf16_f32 v44, v32, v33
v_add_f32 v51, v51, v33
v_mfma_f32_16x16x32_bf16 v[108:111], v[40:43], a[108:111], v[108:111]
s_cmov_b32 s60, s70
v_exp_f32 v34, v34
v_mfma_f32_16x16x32_bf16 v[112:115], v[40:43], a[112:115], v[112:115]
s_cmov_b64 s[68:69], 0
ds_read_b128 a[20:23], v1 offset:576
v_add_f32 v50, v50, v34
v_mfma_f32_16x16x32_bf16 v[116:119], v[40:43], a[116:119], v[116:119]
s_cmov_b32 s70, 0x7fffffff
v_exp_f32 v35, v35
v_mfma_f32_16x16x32_bf16 v[120:123], v[40:43], a[120:123], v[120:123]
s_sub_u32 s32, s32, 1
v_cvt_pk_bf16_f32 v45, v34, v35
v_add_f32 v51, v51, v35
v_mfma_f32_16x16x32_bf16 v[124:127], v[40:43], a[124:127], v[124:127]
s_waitcnt vmcnt(12)
v_exp_f32 v36, v36
v_mfma_f32_16x16x32_bf16 v[24:27], a[32:35], a[176:179], 0
ds_add_u32 v8, v10
v_add_f32 v50, v50, v36
v_mfma_f32_16x16x32_bf16 v[24:27], a[36:39], a[180:183], v[24:27]
v_exp_f32 v37, v37
v_mfma_f32_16x16x32_bf16 v[24:27], a[40:43], a[184:187], v[24:27]
v_cvt_pk_bf16_f32 v46, v36, v37
v_add_f32 v51, v51, v37
v_mfma_f32_16x16x32_bf16 v[24:27], a[44:47], a[188:191], v[24:27]
v_exp_f32 v38, v38
v_mfma_f32_16x16x32_bf16 v[28:31], a[60:63], a[188:191], 0
ds_read_b128 a[24:27], v1 offset:640
v_add_f32 v50, v50, v38
v_mfma_f32_16x16x32_bf16 v[28:31], a[56:59], a[184:187], v[28:31]
v_exp_f32 v39, v39
v_mfma_f32_16x16x32_bf16 v[28:31], a[52:55], a[180:183], v[28:31]
v_cvt_pk_bf16_f32 v47, v38, v39
v_add_f32 v51, v51, v39
v_mfma_f32_16x16x32_bf16 v[28:31], a[48:51], a[176:179], v[28:31]
v_exp_f32 v24, v24
v_mfma_f32_16x16x32_bf16 v[128:131], v[44:47], a[96:99], v[128:131]
ds_read_b128 a[28:31], v1 offset:704
ds_read_b64_tr_b16 a[64:65], v2 offset:0
v_mfma_f32_16x16x32_bf16 v[132:135], v[44:47], a[100:103], v[132:135]
v_exp_f32 v25, v25
v_mfma_f32_16x16x32_bf16 v[136:139], v[44:47], a[104:107], v[136:139]
ds_read_b64_tr_b16 a[66:67], v2 offset:512
v_cvt_pk_bf16_f32 v40, v24, v25
v_mfma_f32_16x16x32_bf16 v[140:143], v[44:47], a[108:111], v[140:143]
v_exp_f32 v26, v26
v_mfma_f32_16x16x32_bf16 v[144:147], v[44:47], a[112:115], v[144:147]
ds_read_b64_tr_b16 a[68:69], v2 offset:32
ds_read_b64_tr_b16 a[70:71], v2 offset:544
v_mfma_f32_16x16x32_bf16 v[148:151], v[44:47], a[116:119], v[148:151]
v_exp_f32 v27, v27
v_mfma_f32_16x16x32_bf16 v[152:155], v[44:47], a[120:123], v[152:155]
ds_read_b64_tr_b16 a[72:73], v2 offset:64
v_cvt_pk_bf16_f32 v41, v26, v27
v_mfma_f32_16x16x32_bf16 v[156:159], v[44:47], a[124:127], v[156:159]
v_exp_f32 v28, v28
v_mfma_f32_16x16x32_bf16 v[32:35], a[32:35], a[192:195], 0
ds_read_b64_tr_b16 a[74:75], v2 offset:576
ds_read_b64_tr_b16 a[76:77], v2 offset:96
v_mfma_f32_16x16x32_bf16 v[32:35], a[36:39], a[196:199], v[32:35]
v_exp_f32 v29, v29
v_mfma_f32_16x16x32_bf16 v[32:35], a[40:43], a[200:203], v[32:35]
ds_read_b64_tr_b16 a[78:79], v2 offset:608
v_cvt_pk_bf16_f32 v42, v28, v29
v_mfma_f32_16x16x32_bf16 v[32:35], a[44:47], a[204:207], v[32:35]
v_exp_f32 v30, v30
v_mfma_f32_16x16x32_bf16 v[36:39], a[60:63], a[204:207], 0
ds_read_b64_tr_b16 a[80:81], v2 offset:128
ds_read_b64_tr_b16 a[82:83], v2 offset:640
v_mfma_f32_16x16x32_bf16 v[36:39], a[56:59], a[200:203], v[36:39]
v_exp_f32 v31, v31
v_mfma_f32_16x16x32_bf16 v[36:39], a[52:55], a[196:199], v[36:39]
ds_read_b64_tr_b16 a[84:85], v2 offset:160
v_cvt_pk_bf16_f32 v43, v30, v31
v_mfma_f32_16x16x32_bf16 v[36:39], a[48:51], a[192:195], v[36:39]
v_exp_f32 v32, v32
v_mfma_f32_16x16x32_bf16 v[160:163], v[40:43], a[96:99], v[160:163]
ds_read_b64_tr_b16 a[86:87], v2 offset:672
ds_read_b64_tr_b16 a[88:89], v2 offset:192
v_mfma_f32_16x16x32_bf16 v[164:167], v[40:43], a[100:103], v[164:167]
v_exp_f32 v33, v33
v_mfma_f32_16x16x32_bf16 v[168:171], v[40:43], a[104:107], v[168:171]
ds_read_b64_tr_b16 a[90:91], v2 offset:704
v_cvt_pk_bf16_f32 v44, v32, v33
v_mfma_f32_16x16x32_bf16 v[172:175], v[40:43], a[108:111], v[172:175]
v_exp_f32 v34, v34
v_mfma_f32_16x16x32_bf16 v[176:179], v[40:43], a[112:115], v[176:179]
ds_read_b64_tr_b16 a[92:93], v2 offset:224
ds_read_b64_tr_b16 a[94:95], v2 offset:736
v_mfma_f32_16x16x32_bf16 v[180:183], v[40:43], a[116:119], v[180:183]
v_exp_f32 v35, v35
v_mfma_f32_16x16x32_bf16 v[184:187], v[40:43], a[120:123], v[184:187]
v_cvt_pk_bf16_f32 v45, v34, v35
v_add_f32 v52, v52, v32
v_mfma_f32_16x16x32_bf16 v[188:191], v[40:43], a[124:127], v[188:191]
v_exp_f32 v36, v36
v_mfma_f32_16x16x32_bf16 a[136:139], a[128:131], v[40:43], a[136:139]
s_waitcnt lgkmcnt(15)
v_add_f32 v53, v53, v33
v_add_f32 v52, v52, v34
v_mfma_f32_16x16x32_bf16 v[24:27], a[0:3], v[224:227], 0
v_add_f32 v53, v53, v35
v_add_f32 v52, v52, v36
v_mfma_f32_16x16x32_bf16 v[24:27], a[4:7], v[228:231], v[24:27]
v_exp_f32 v37, v37
v_mfma_f32_16x16x32_bf16 v[24:27], a[8:11], v[232:235], v[24:27]
v_cvt_pk_bf16_f32 v46, v36, v37
v_add_f32 v53, v53, v37
v_mfma_f32_16x16x32_bf16 v[24:27], a[12:15], v[236:239], v[24:27]
v_exp_f32 v38, v38
v_mfma_f32_16x16x32_bf16 v[28:31], a[28:31], v[236:239], 0
ds_read_b32 v11, v9
v_add_f32 v52, v52, v38
v_mfma_f32_16x16x32_bf16 v[28:31], a[24:27], v[232:235], v[28:31]
v_exp_f32 v39, v39
v_mfma_f32_16x16x32_bf16 v[28:31], a[20:23], v[228:231], v[28:31]
v_cvt_pk_bf16_f32 v47, v38, v39
v_add_f32 v53, v53, v39
v_mfma_f32_16x16x32_bf16 v[28:31], a[16:19], v[224:227], v[28:31]
v_exp_f32 v24, v24
v_mfma_f32_16x16x32_bf16 v[192:195], v[44:47], a[96:99], v[192:195]
v_add_u32 v1, s31, v1
v_add_u32 v2, s31, v2
v_mfma_f32_16x16x32_bf16 v[196:199], v[44:47], a[100:103], v[196:199]
s_waitcnt lgkmcnt(0)
v_exp_f32 v25, v25
v_mfma_f32_16x16x32_bf16 v[200:203], v[44:47], a[104:107], v[200:203]
v_cvt_pk_bf16_f32 v40, v24, v25
v_cmp_gt_u32 vcc, s33, v11
v_mfma_f32_16x16x32_bf16 v[204:207], v[44:47], a[108:111], v[204:207]
v_exp_f32 v26, v26
v_mfma_f32_16x16x32_bf16 v[208:211], v[44:47], a[112:115], v[208:211]
v_mfma_f32_16x16x32_bf16 v[212:215], v[44:47], a[116:119], v[212:215]
s_waitcnt lgkmcnt(0)
v_exp_f32 v27, v27
v_mfma_f32_16x16x32_bf16 v[216:219], v[44:47], a[120:123], v[216:219]
v_cvt_pk_bf16_f32 v41, v26, v27
v_mfma_f32_16x16x32_bf16 v[220:223], v[44:47], a[124:127], v[220:223]
s_cbranch_vccnz L_spin_5
L_spinret_6:
v_exp_f32 v28, v28
s_cbranch_scc1 L_last0_5
v_mfma_f32_16x16x32_bf16 v[32:35], a[0:3], v[240:243], 0
buffer_load_dwordx4 v3, s[4:7], s24 offen lds
v_mfma_f32_16x16x32_bf16 v[32:35], a[4:7], v[244:247], v[32:35]
s_sub_u32 s30, s30, 1
v_exp_f32 v29, v29
v_mfma_f32_16x16x32_bf16 v[32:35], a[8:11], v[248:251], v[32:35]
s_cselect_b32 s31, s35, s34
ds_read_b128 a[32:35], v1 offset:0
v_cvt_pk_bf16_f32 v42, v28, v29
v_mfma_f32_16x16x32_bf16 v[32:35], a[12:15], v[252:255], v[32:35]
s_cselect_b32 s30, 7, s30
v_exp_f32 v30, v30
v_mfma_f32_16x16x32_bf16 v[36:39], a[28:31], v[252:255], 0
buffer_load_dwordx4 v4, s[4:7], s24 offen offset:1056 lds
v_mfma_f32_16x16x32_bf16 v[36:39], a[24:27], v[248:251], v[36:39]
v_exp_f32 v31, v31
v_mfma_f32_16x16x32_bf16 v[36:39], a[20:23], v[244:247], v[36:39]
ds_read_b128 a[36:39], v1 offset:64
v_cvt_pk_bf16_f32 v43, v30, v31
v_mfma_f32_16x16x32_bf16 v[36:39], a[16:19], v[240:243], v[36:39]
v_exp_f32 v32, v32
v_mfma_f32_16x16x32_bf16 v[64:67], v[40:43], a[64:67], v[64:67]
buffer_load_dwordx4 v3, s[8:11], s24 offen offset:2080 lds
v_mfma_f32_16x16x32_bf16 v[68:71], v[40:43], a[68:71], v[68:71]
v_exp_f32 v33, v33
v_mfma_f32_16x16x32_bf16 v[72:75], v[40:43], a[72:75], v[72:75]
v_cvt_pk_bf16_f32 v44, v32, v33
v_add_f32 v48, v48, v32
v_mfma_f32_16x16x32_bf16 v[76:79], v[40:43], a[76:79], v[76:79]
v_exp_f32 v34, v34
v_mfma_f32_16x16x32_bf16 v[80:83], v[40:43], a[80:83], v[80:83]
buffer_load_dwordx4 v4, s[8:11], s24 offen offset:3136 lds
v_mfma_f32_16x16x32_bf16 v[84:87], v[40:43], a[84:87], v[84:87]
s_add_u32 m0, m0, s34
v_exp_f32 v35, v35
v_mfma_f32_16x16x32_bf16 v[88:91], v[40:43], a[88:91], v[88:91]
s_cmp_eq_u32 m0, s29
v_cvt_pk_bf16_f32 v45, v34, v35
v_add_f32 v49, v49, v33
v_mfma_f32_16x16x32_bf16 v[92:95], v[40:43], a[92:95], v[92:95]
s_cselect_b32 m0, s28, m0
v_exp_f32 v36, v36
v_mfma_f32_16x16x32_bf16 a[132:135], a[128:131], v[40:43], a[132:135]
s_add_u32 s24, s24, s25
v_add_f32 v48, v48, v34
v_add_f32 v49, v49, v35
v_mfma_f32_16x16x32_bf16 v[24:27], a[0:3], a[160:163], 0
s_sub_u32 s26, s26, 1
ds_read_b128 a[40:43], v1 offset:128
v_add_f32 v48, v48, v36
v_mfma_f32_16x16x32_bf16 v[24:27], a[4:7], a[164:167], v[24:27]
s_cmov_b64 s[4:5], s[52:53]
v_exp_f32 v37, v37
v_mfma_f32_16x16x32_bf16 v[24:27], a[8:11], a[168:171], v[24:27]
s_cmov_b64 s[8:9], s[54:55]
v_cvt_pk_bf16_f32 v46, v36, v37
v_add_f32 v49, v49, v37
v_mfma_f32_16x16x32_bf16 v[24:27], a[12:15], a[172:175], v[24:27]
s_cmov_b64 s[24:25], s[56:57]
v_exp_f32 v38, v38
v_mfma_f32_16x16x32_bf16 v[28:31], a[28:31], a[172:175], 0
s_cmov_b32 s6, s58
ds_read_b128 a[44:47], v1 offset:192
v_add_f32 v48, v48, v38
v_mfma_f32_16x16x32_bf16 v[28:31], a[24:27], a[168:171], v[28:31]
s_cmov_b32 s10, s59
v_exp_f32 v39, v39
v_mfma_f32_16x16x32_bf16 v[28:31], a[20:23], a[164:167], v[28:31]
s_cmov_b32 s26, s60
v_cvt_pk_bf16_f32 v47, v38, v39
v_add_f32 v49, v49, v39
v_mfma_f32_16x16x32_bf16 v[28:31], a[16:19], a[160:163], v[28:31]
s_cmov_b64 s[52:53], s[62:63]
v_exp_f32 v24, v24
v_mfma_f32_16x16x32_bf16 v[96:99], v[44:47], a[64:67], v[96:99]
s_cmov_b64 s[54:55], s[64:65]
ds_read_b128 a[48:51], v1 offset:512
v_add_f32 v50, v50, v24
v_mfma_f32_16x16x32_bf16 v[100:103], v[44:47], a[68:71], v[100:103]
s_cmov_b64 s[56:57], s[66:67]
v_exp_f32 v25, v25
v_mfma_f32_16x16x32_bf16 v[104:107], v[44:47], a[72:75], v[104:107]
s_cmov_b64 s[58:59], s[68:69]
v_cvt_pk_bf16_f32 v40, v24, v25
v_add_f32 v51, v51, v25
v_mfma_f32_16x16x32_bf16 v[108:111], v[44:47], a[76:79], v[108:111]
s_cmov_b32 s60, s70
v_exp_f32 v26, v26
v_mfma_f32_16x16x32_bf16 v[112:115], v[44:47], a[80:83], v[112:115]
s_cmov_b64 s[68:69], 0
ds_read_b128 a[52:55], v1 offset:576
v_add_f32 v50, v50, v26
v_mfma_f32_16x16x32_bf16 v[116:119], v[44:47], a[84:87], v[116:119]
s_cmov_b32 s70, 0x7fffffff
v_exp_f32 v27, v27
v_mfma_f32_16x16x32_bf16 v[120:123], v[44:47], a[88:91], v[120:123]
s_sub_u32 s32, s32, 1
v_cvt_pk_bf16_f32 v41, v26, v27
v_add_f32 v51, v51, v27
v_mfma_f32_16x16x32_bf16 v[124:127], v[44:47], a[92:95], v[124:127]
v_exp_f32 v28, v28
v_mfma_f32_16x16x32_bf16 v[32:35], a[0:3], a[176:179], 0
ds_read_b128 a[56:59], v1 offset:640
v_add_f32 v50, v50, v28
v_mfma_f32_16x16x32_bf16 v[32:35], a[4:7], a[180:183], v[32:35]
v_exp_f32 v29, v29
v_mfma_f32_16x16x32_bf16 v[32:35], a[8:11], a[184:187], v[32:35]
v_cvt_pk_bf16_f32 v42, v28, v29
v_add_f32 v51, v51, v29
v_mfma_f32_16x16x32_bf16 v[32:35], a[12:15], a[188:191], v[32:35]
v_exp_f32 v30, v30
v_mfma_f32_16x16x32_bf16 v[36:39], a[28:31], a[188:191], 0
ds_read_b128 a[60:63], v1 offset:704
v_add_f32 v50, v50, v30
v_mfma_f32_16x16x32_bf16 v[36:39], a[24:27], a[184:187], v[36:39]
v_exp_f32 v31, v31
v_mfma_f32_16x16x32_bf16 v[36:39], a[20:23], a[180:183], v[36:39]
v_cvt_pk_bf16_f32 v43, v30, v31
v_add_f32 v51, v51, v31
v_mfma_f32_16x16x32_bf16 v[36:39], a[16:19], a[176:179], v[36:39]
v_exp_f32 v32, v32
v_mfma_f32_16x16x32_bf16 v[128:131], v[40:43], a[64:67], v[128:131]
ds_read_b64_tr_b16 a[96:97], v2 offset:0
ds_read_b64_tr_b16 a[98:99], v2 offset:512
v_mfma_f32_16x16x32_bf16 v[132:135], v[40:43], a[68:71], v[132:135]
v_exp_f32 v33, v33
v_mfma_f32_16x16x32_bf16 v[136:139], v[40:43], a[72:75], v[136:139]
ds_read_b64_tr_b16 a[100:101], v2 offset:32
v_cvt_pk_bf16_f32 v44, v32, v33
v_mfma_f32_16x16x32_bf16 v[140:143], v[40:43], a[76:79], v[140:143]
v_exp_f32 v34, v34
v_mfma_f32_16x16x32_bf16 v[144:147], v[40:43], a[80:83], v[144:147]
ds_read_b64_tr_b16 a[102:103], v2 offset:544
ds_read_b64_tr_b16 a[104:105], v2 offset:64
v_mfma_f32_16x16x32_bf16 v[148:151], v[40:43], a[84:87], v[148:151]
v_exp_f32 v35, v35
v_mfma_f32_16x16x32_bf16 v[152:155], v[40:43], a[88:91], v[152:155]
ds_read_b64_tr_b16 a[106:107], v2 offset:576
v_cvt_pk_bf16_f32 v45, v34, v35
v_mfma_f32_16x16x32_bf16 v[156:159], v[40:43], a[92:95], v[156:159]
v_exp_f32 v36, v36
v_mfma_f32_16x16x32_bf16 v[24:27], a[0:3], a[192:195], 0
ds_read_b64_tr_b16 a[108:109], v2 offset:96
ds_read_b64_tr_b16 a[110:111], v2 offset:608
v_mfma_f32_16x16x32_bf16 v[24:27], a[4:7], a[196:199], v[24:27]
v_exp_f32 v37, v37
v_mfma_f32_16x16x32_bf16 v[24:27], a[8:11], a[200:203], v[24:27]
ds_read_b64_tr_b16 a[112:113], v2 offset:128
v_cvt_pk_bf16_f32 v46, v36, v37
v_mfma_f32_16x16x32_bf16 v[24:27], a[12:15], a[204:207], v[24:27]
v_exp_f32 v38, v38
v_mfma_f32_16x16x32_bf16 v[28:31], a[28:31], a[204:207], 0
ds_read_b64_tr_b16 a[114:115], v2 offset:640
ds_read_b64_tr_b16 a[116:117], v2 offset:160
v_mfma_f32_16x16x32_bf16 v[28:31], a[24:27], a[200:203], v[28:31]
v_exp_f32 v39, v39
v_mfma_f32_16x16x32_bf16 v[28:31], a[20:23], a[196:199], v[28:31]
ds_read_b64_tr_b16 a[118:119], v2 offset:672
v_cvt_pk_bf16_f32 v47, v38, v39
v_mfma_f32_16x16x32_bf16 v[28:31], a[16:19], a[192:195], v[28:31]
v_exp_f32 v24, v24
v_mfma_f32_16x16x32_bf16 v[160:163], v[44:47], a[64:67], v[160:163]
ds_read_b64_tr_b16 a[120:121], v2 offset:192
ds_read_b64_tr_b16 a[122:123], v2 offset:704
v_mfma_f32_16x16x32_bf16 v[164:167], v[44:47], a[68:71], v[164:167]
v_exp_f32 v25, v25
v_mfma_f32_16x16x32_bf16 v[168:171], v[44:47], a[72:75], v[168:171]
ds_read_b64_tr_b16 a[124:125], v2 offset:224
v_cvt_pk_bf16_f32 v40, v24, v25
v_mfma_f32_16x16x32_bf16 v[172:175], v[44:47], a[76:79], v[172:175]
v_exp_f32 v26, v26
v_mfma_f32_16x16x32_bf16 v[176:179], v[44:47], a[80:83], v[176:179]
ds_read_b64_tr_b16 a[126:127], v2 offset:736
v_add_f32 v52, v52, v24
v_mfma_f32_16x16x32_bf16 v[180:183], v[44:47], a[84:87], v[180:183]
v_exp_f32 v27, v27
v_mfma_f32_16x16x32_bf16 v[184:187], v[44:47], a[88:91], v[184:187]
v_cvt_pk_bf16_f32 v41, v26, v27
v_add_f32 v53, v53, v25
v_mfma_f32_16x16x32_bf16 v[188:191], v[44:47], a[92:95], v[188:191]
v_exp_f32 v28, v28
v_mfma_f32_16x16x32_bf16 a[136:139], a[128:131], v[44:47], a[136:139]
s_waitcnt lgkmcnt(15)
v_add_f32 v52, v52, v26
v_add_f32 v53, v53, v27
v_mfma_f32_16x16x32_bf16 v[32:35], a[32:35], v[224:227], 0
v_add_f32 v52, v52, v28
v_add_u32 v1, s31, v1
v_mfma_f32_16x16x32_bf16 v[32:35], a[36:39], v[228:231], v[32:35]
v_exp_f32 v29, v29
v_mfma_f32_16x16x32_bf16 v[32:35], a[40:43], v[232:235], v[32:35]
v_cvt_pk_bf16_f32 v42, v28, v29
v_add_f32 v53, v53, v29
v_mfma_f32_16x16x32_bf16 v[32:35], a[44:47], v[236:239], v[32:35]
v_exp_f32 v30, v30
v_mfma_f32_16x16x32_bf16 v[36:39], a[60:63], v[236:239], 0
v_add_f32 v52, v52, v30
v_add_u32 v2, s31, v2
v_mfma_f32_16x16x32_bf16 v[36:39], a[56:59], v[232:235], v[36:39]
v_exp_f32 v31, v31
v_mfma_f32_16x16x32_bf16 v[36:39], a[52:55], v[228:231], v[36:39]
v_cvt_pk_bf16_f32 v43, v30, v31
v_add_f32 v53, v53, v31
v_mfma_f32_16x16x32_bf16 v[36:39], a[48:51], v[224:227], v[36:39]
v_exp_f32 v32, v32
v_mfma_f32_16x16x32_bf16 v[192:195], v[40:43], a[64:67], v[192:195]
v_mfma_f32_16x16x32_bf16 v[196:199], v[40:43], a[68:71], v[196:199]
v_exp_f32 v33, v33
v_mfma_f32_16x16x32_bf16 v[200:203], v[40:43], a[72:75], v[200:203]
v_cvt_pk_bf16_f32 v44, v32, v33
v_mfma_f32_16x16x32_bf16 v[204:207], v[40:43], a[76:79], v[204:207]
v_exp_f32 v34, v34
v_mfma_f32_16x16x32_bf16 v[208:211], v[40:43], a[80:83], v[208:211]
v_mfma_f32_16x16x32_bf16 v[212:215], v[40:43], a[84:87], v[212:215]
s_waitcnt lgkmcnt(0)
v_exp_f32 v35, v35
v_mfma_f32_16x16x32_bf16 v[216:219], v[40:43], a[88:91], v[216:219]
v_cvt_pk_bf16_f32 v45, v34, v35
v_mfma_f32_16x16x32_bf16 v[220:223], v[40:43], a[92:95], v[220:223]
v_exp_f32 v36, v36
s_cbranch_scc0 L_loop5
L_last1_5:
L_t5_1_0:
v_mfma_f32_16x16x32_bf16 v[24:27], a[32:35], v[240:243], 0
s_mov_b32 s14, s47
v_exp_f32 v37, v37
v_mfma_f32_16x16x32_bf16 v[24:27], a[36:39], v[244:247], v[24:27]
s_add_u32 s80, s46, 0
v_exp_f32 v38, v38
v_mfma_f32_16x16x32_bf16 v[24:27], a[40:43], v[248:251], v[24:27]
s_add_u32 s81, s46, 131072
v_exp_f32 v39, v39
v_mfma_f32_16x16x32_bf16 v[24:27], a[44:47], v[252:255], v[24:27]
s_add_u32 s82, s46, 262144
v_cvt_pk_bf16_f32 v46, v36, v37
v_cvt_pk_bf16_f32 v47, v38, v39
v_mfma_f32_16x16x32_bf16 v[28:31], a[60:63], v[252:255], 0
s_add_u32 s83, s46, 393216
s_add_u32 s84, s46, 524288
s_add_u32 s85, s46, 655360
v_mfma_f32_16x16x32_bf16 v[28:31], a[56:59], v[248:251], v[28:31]
s_add_u32 s86, s46, 786432
s_add_u32 s87, s46, 917504
v_exp_f32 v24, v24
v_mfma_f32_16x16x32_bf16 v[28:31], a[52:55], v[244:247], v[28:31]
s_add_u32 s88, s46, 1048576
v_exp_f32 v25, v25
v_mfma_f32_16x16x32_bf16 v[28:31], a[48:51], v[240:243], v[28:31]
s_add_u32 s89, s46, 1179648
v_exp_f32 v26, v26
v_mfma_f32_16x16x32_bf16 a[132:135], a[128:131], v[44:47], a[132:135]
v_exp_f32 v27, v27
v_mfma_f32_16x16x32_bf16 v[64:67], v[44:47], a[96:99], v[64:67]
v_add_f32 v48, v48, v24
s_nop 1
v_exp_f32 v28, v28
v_mfma_f32_16x16x32_bf16 v[68:71], v[44:47], a[100:103], v[68:71]
s_nop 0
v_accvgpr_read_b32 v16, a132
v_rcp_f32 v13, v16
v_mfma_f32_16x16x32_bf16 v[72:75], v[44:47], a[104:107], v[72:75]
ds_write_b32 v60, v13
v_mfma_f32_16x16x32_bf16 v[76:79], v[44:47], a[108:111], v[76:79]
ds_read_b128 v[224:227], v61
v_exp_f32 v29, v29
v_mfma_f32_16x16x32_bf16 v[80:83], v[44:47], a[112:115], v[80:83]
v_exp_f32 v30, v30
v_mfma_f32_16x16x32_bf16 v[84:87], v[44:47], a[116:119], v[84:87]
v_exp_f32 v31, v31
v_mfma_f32_16x16x32_bf16 v[88:91], v[44:47], a[120:123], v[88:91]
v_add_f32 v49, v49, v25
v_add_f32 v48, v48, v26
v_mfma_f32_16x16x32_bf16 v[92:95], v[44:47], a[124:127], v[92:95]
v_add_f32 v49, v49, v27
v_cvt_pk_bf16_f32 v40, v24, v25
v_mfma_f32_16x16x32_bf16 v[32:35], a[32:35], a[160:163], 0
v_cvt_pk_bf16_f32 v41, v26, v27
v_add_f32 v48, v48, v28
v_mfma_f32_16x16x32_bf16 v[32:35], a[36:39], a[164:167], v[32:35]
v_add_f32 v49, v49, v29
v_cvt_pk_bf16_f32 v42, v28, v29
v_mfma_f32_16x16x32_bf16 v[32:35], a[40:43], a[168:171], v[32:35]
s_waitcnt lgkmcnt(0)
v_pk_mul_f32 v[64:65], v[64:65], v[224:225]
v_pk_mul_f32 v[68:69], v[68:69], v[224:225]
v_pk_mul_f32 v[80:81], v[80:81], v[224:225]
v_pk_mul_f32 v[84:85], v[84:85], v[224:225]
v_pk_mul_f32 v[66:67], v[66:67], v[226:227]
v_pk_mul_f32 v[70:71], v[70:71], v[226:227]
v_pk_mul_f32 v[82:83], v[82:83], v[226:227]
v_pk_mul_f32 v[86:87], v[86:87], v[226:227]
v_pk_mul_f32 v[72:73], v[72:73], v[224:225]
v_pk_mul_f32 v[76:77], v[76:77], v[224:225]
v_pk_mul_f32 v[88:89], v[88:89], v[224:225]
v_pk_mul_f32 v[92:93], v[92:93], v[224:225]
v_pk_mul_f32 v[74:75], v[74:75], v[226:227]
v_pk_mul_f32 v[78:79], v[78:79], v[226:227]
v_pk_mul_f32 v[90:91], v[90:91], v[226:227]
v_pk_mul_f32 v[94:95], v[94:95], v[226:227]
v_mfma_f32_16x16x32_bf16 v[32:35], a[44:47], a[172:175], v[32:35]
v_cvt_pk_bf16_f32 v64, v64, v68
v_cvt_pk_bf16_f32 v80, v80, v84
v_mfma_f32_16x16x32_bf16 v[36:39], a[60:63], a[172:175], 0
v_cvt_pk_bf16_f32 v66, v66, v70
v_cvt_pk_bf16_f32 v82, v82, v86
v_mfma_f32_16x16x32_bf16 v[36:39], a[56:59], a[168:171], v[36:39]
v_cvt_pk_bf16_f32 v68, v65, v69
v_cvt_pk_bf16_f32 v84, v81, v85
v_mfma_f32_16x16x32_bf16 v[36:39], a[52:55], a[164:167], v[36:39]
v_cvt_pk_bf16_f32 v70, v67, v71
v_cvt_pk_bf16_f32 v86, v83, v87
v_mfma_f32_16x16x32_bf16 v[36:39], a[48:51], a[160:163], v[36:39]
v_cvt_pk_bf16_f32 v65, v72, v76
v_cvt_pk_bf16_f32 v69, v73, v77
v_cvt_pk_bf16_f32 v81, v88, v92
v_cvt_pk_bf16_f32 v85, v89, v93
v_cvt_pk_bf16_f32 v67, v74, v78
v_cvt_pk_bf16_f32 v71, v75, v79
v_cvt_pk_bf16_f32 v83, v90, v94
v_cvt_pk_bf16_f32 v87, v91, v95
ds_write2_b64 v5, v[64:65], v[80:81] offset0:0 offset1:16
ds_write2_b64 v0, v[68:69], v[84:85] offset0:32 offset1:48
v_cvt_pk_bf16_f32 v43, v30, v31
v_add_f32 v48, v48, v30
v_add_f32 v49, v49, v31
v_mfma_f32_16x16x32_bf16 v[96:99], v[40:43], a[96:99], v[96:99]
ds_write2_b64 v5, v[66:67], v[82:83] offset0:80 offset1:64
v_mfma_f32_16x16x32_bf16 v[100:103], v[40:43], a[100:103], v[100:103]
v_add_f32 v48, v48, v49
v_mov_b32 v49, v48
v_mfma_f32_16x16x32_bf16 v[104:107], v[40:43], a[104:107], v[104:107]
ds_write2_b64 v0, v[70:71], v[86:87] offset0:112 offset1:96
v_mfma_f32_16x16x32_bf16 v[108:111], v[40:43], a[108:111], v[108:111]
v_permlane16_swap_b32 v48, v49
v_mfma_f32_16x16x32_bf16 v[112:115], v[40:43], a[112:115], v[112:115]
v_add_f32 v48, v48, v49
ds_read_b64_tr_b16 v[64:65], v56 offset:0
v_mfma_f32_16x16x32_bf16 v[116:119], v[40:43], a[116:119], v[116:119]
ds_read_b64_tr_b16 v[66:67], v57 offset:0
v_mov_b32 v49, v48
v_mfma_f32_16x16x32_bf16 v[120:123], v[40:43], a[120:123], v[120:123]
ds_read_b64_tr_b16 v[72:73], v56 offset:2048
v_permlane32_swap_b32 v48, v49
v_mfma_f32_16x16x32_bf16 v[124:127], v[40:43], a[124:127], v[124:127]
ds_read_b64_tr_b16 v[74:75], v57 offset:2048
v_max3_u32 v12, v12, v16, v13
v_mfma_f32_16x16x32_bf16 v[24:27], a[32:35], a[176:179], 0
ds_read_b64_tr_b16 v[80:81], v58 offset:0
v_add_f32 v48, v48, v49
v_mfma_f32_16x16x32_bf16 v[24:27], a[36:39], a[180:183], v[24:27]
ds_read_b64_tr_b16 v[82:83], v59 offset:0
v_rcp_f32 v13, v48
v_mfma_f32_16x16x32_bf16 v[24:27], a[40:43], a[184:187], v[24:27]
ds_write_b32 v60, v13
v_mfma_f32_16x16x32_bf16 v[24:27], a[44:47], a[188:191], v[24:27]
ds_read_b128 v[228:231], v61
ds_read_b64_tr_b16 v[88:89], v58 offset:2048
v_mfma_f32_16x16x32_bf16 v[28:31], a[60:63], a[188:191], 0
s_waitcnt lgkmcnt(7)
buffer_store_dwordx4 v[64:67], v6, s[12:15], s80 offen offset:0 sc1
v_mfma_f32_16x16x32_bf16 v[28:31], a[56:59], a[184:187], v[28:31]
ds_read_b64_tr_b16 v[90:91], v59 offset:2048
s_waitcnt lgkmcnt(6)
buffer_store_dwordx4 v[72:75], v6, s[12:15], s81 offen offset:0 sc1
v_mfma_f32_16x16x32_bf16 v[28:31], a[52:55], a[180:183], v[28:31]
s_waitcnt lgkmcnt(4)
buffer_store_dwordx4 v[80:83], v6, s[12:15], s80 offen offset:128 sc1
v_mfma_f32_16x16x32_bf16 v[28:31], a[48:51], a[176:179], v[28:31]
v_exp_f32 v32, v32
s_waitcnt lgkmcnt(2)
v_pk_mul_f32 v[96:97], v[96:97], v[228:229]
v_pk_mul_f32 v[100:101], v[100:101], v[228:229]
v_pk_mul_f32 v[112:113], v[112:113], v[228:229]
v_pk_mul_f32 v[116:117], v[116:117], v[228:229]
v_pk_mul_f32 v[98:99], v[98:99], v[230:231]
v_pk_mul_f32 v[102:103], v[102:103], v[230:231]
v_pk_mul_f32 v[114:115], v[114:115], v[230:231]
v_pk_mul_f32 v[118:119], v[118:119], v[230:231]
v_cvt_pk_bf16_f32 v96, v96, v100
v_cvt_pk_bf16_f32 v112, v112, v116
v_cvt_pk_bf16_f32 v98, v98, v102
v_cvt_pk_bf16_f32 v114, v114, v118
v_pk_mul_f32 v[104:105], v[104:105], v[228:229]
v_pk_mul_f32 v[108:109], v[108:109], v[228:229]
v_cvt_pk_bf16_f32 v100, v97, v101
v_pk_mul_f32 v[120:121], v[120:121], v[228:229]
v_pk_mul_f32 v[124:125], v[124:125], v[228:229]
v_cvt_pk_bf16_f32 v116, v113, v117
v_pk_mul_f32 v[106:107], v[106:107], v[230:231]
v_pk_mul_f32 v[110:111], v[110:111], v[230:231]
v_cvt_pk_bf16_f32 v102, v99, v103
v_pk_mul_f32 v[122:123], v[122:123], v[230:231]
v_pk_mul_f32 v[126:127], v[126:127], v[230:231]
v_cvt_pk_bf16_f32 v118, v115, v119
v_cvt_pk_bf16_f32 v97, v104, v108
v_cvt_pk_bf16_f32 v101, v105, v109
v_cvt_pk_bf16_f32 v113, v120, v124
v_cvt_pk_bf16_f32 v117, v121, v125
v_cvt_pk_bf16_f32 v99, v106, v110
v_cvt_pk_bf16_f32 v103, v107, v111
v_cvt_pk_bf16_f32 v115, v122, v126
v_cvt_pk_bf16_f32 v119, v123, v127
ds_write2_b64 v5, v[96:97], v[112:113] offset0:0 offset1:16
ds_write2_b64 v0, v[100:101], v[116:117] offset0:32 offset1:48
v_exp_f32 v33, v33
v_exp_f32 v34, v34
ds_write2_b64 v5, v[98:99], v[114:115] offset0:80 offset1:64
v_exp_f32 v35, v35
v_exp_f32 v36, v36
v_exp_f32 v37, v37
v_exp_f32 v38, v38
ds_write2_b64 v0, v[102:103], v[118:119] offset0:112 offset1:96
v_exp_f32 v39, v39
v_add_f32 v50, v50, v32
v_add_f32 v51, v51, v33
v_add_f32 v50, v50, v34
v_add_f32 v51, v51, v35
ds_read_b64_tr_b16 v[96:97], v56 offset:0
v_cvt_pk_bf16_f32 v44, v32, v33
ds_read_b64_tr_b16 v[98:99], v57 offset:0
v_cvt_pk_bf16_f32 v45, v34, v35
v_add_f32 v50, v50, v36
v_add_f32 v51, v51, v37
v_cvt_pk_bf16_f32 v46, v36, v37
v_cvt_pk_bf16_f32 v47, v38, v39
v_add_f32 v50, v50, v38
v_add_f32 v51, v51, v39
v_mfma_f32_16x16x32_bf16 v[128:131], v[44:47], a[96:99], v[128:131]
ds_read_b64_tr_b16 v[104:105], v56 offset:2048
v_add_f32 v50, v50, v51
v_mfma_f32_16x16x32_bf16 v[132:135], v[44:47], a[100:103], v[132:135]
ds_read_b64_tr_b16 v[106:107], v57 offset:2048
v_mov_b32 v51, v50
v_mfma_f32_16x16x32_bf16 v[136:139], v[44:47], a[104:107], v[136:139]
s_waitcnt lgkmcnt(8)
buffer_store_dwordx4 v[88:91], v6, s[12:15], s81 offen offset:128 sc1
v_mfma_f32_16x16x32_bf16 v[140:143], v[44:47], a[108:111], v[140:143]
ds_read_b64_tr_b16 v[112:113], v58 offset:0
v_permlane16_swap_b32 v50, v51
v_mfma_f32_16x16x32_bf16 v[144:147], v[44:47], a[112:115], v[144:147]
ds_read_b64_tr_b16 v[114:115], v59 offset:0
v_add_f32 v50, v50, v51
v_mfma_f32_16x16x32_bf16 v[148:151], v[44:47], a[116:119], v[148:151]
s_waitcnt lgkmcnt(4)
buffer_store_dwordx4 v[96:99], v6, s[12:15], s82 offen offset:0 sc1
v_mfma_f32_16x16x32_bf16 v[152:155], v[44:47], a[120:123], v[152:155]
ds_read_b64_tr_b16 v[120:121], v58 offset:2048
v_mov_b32 v51, v50
v_mfma_f32_16x16x32_bf16 v[156:159], v[44:47], a[124:127], v[156:159]
ds_read_b64_tr_b16 v[122:123], v59 offset:2048
v_permlane32_swap_b32 v50, v51
v_mfma_f32_16x16x32_bf16 v[32:35], a[32:35], a[192:195], 0
s_waitcnt lgkmcnt(4)
buffer_store_dwordx4 v[104:107], v6, s[12:15], s83 offen offset:0 sc1
v_mfma_f32_16x16x32_bf16 v[32:35], a[36:39], a[196:199], v[32:35]
s_waitcnt lgkmcnt(2)
buffer_store_dwordx4 v[112:115], v6, s[12:15], s82 offen offset:128 sc1
v_mfma_f32_16x16x32_bf16 v[32:35], a[40:43], a[200:203], v[32:35]
v_max3_u32 v12, v12, v48, v13
v_add_f32 v50, v50, v51
v_mfma_f32_16x16x32_bf16 v[32:35], a[44:47], a[204:207], v[32:35]
v_rcp_f32 v13, v50
v_mfma_f32_16x16x32_bf16 v[36:39], a[60:63], a[204:207], 0
ds_write_b32 v60, v13
v_mfma_f32_16x16x32_bf16 v[36:39], a[56:59], a[200:203], v[36:39]
ds_read_b128 v[224:227], v61
v_exp_f32 v24, v24
v_mfma_f32_16x16x32_bf16 v[36:39], a[52:55], a[196:199], v[36:39]
s_waitcnt lgkmcnt(2)
buffer_store_dwordx4 v[120:123], v6, s[12:15], s83 offen offset:128 sc1
v_mfma_f32_16x16x32_bf16 v[36:39], a[48:51], a[192:195], v[36:39]
v_exp_f32 v25, v25
v_exp_f32 v26, v26
v_exp_f32 v27, v27
v_exp_f32 v28, v28
v_exp_f32 v29, v29
v_exp_f32 v30, v30
v_exp_f32 v31, v31
v_cvt_pk_bf16_f32 v40, v24, v25
v_cvt_pk_bf16_f32 v41, v26, v27
v_cvt_pk_bf16_f32 v42, v28, v29
s_waitcnt lgkmcnt(0)
v_pk_mul_f32 v[128:129], v[128:129], v[224:225]
v_pk_mul_f32 v[132:133], v[132:133], v[224:225]
v_pk_mul_f32 v[144:145], v[144:145], v[224:225]
v_pk_mul_f32 v[148:149], v[148:149], v[224:225]
v_pk_mul_f32 v[130:131], v[130:131], v[226:227]
v_pk_mul_f32 v[134:135], v[134:135], v[226:227]
v_pk_mul_f32 v[146:147], v[146:147], v[226:227]
v_pk_mul_f32 v[150:151], v[150:151], v[226:227]
v_cvt_pk_bf16_f32 v128, v128, v132
v_cvt_pk_bf16_f32 v144, v144, v148
v_cvt_pk_bf16_f32 v130, v130, v134
v_cvt_pk_bf16_f32 v146, v146, v150
v_pk_mul_f32 v[136:137], v[136:137], v[224:225]
v_pk_mul_f32 v[140:141], v[140:141], v[224:225]
v_cvt_pk_bf16_f32 v132, v129, v133
v_pk_mul_f32 v[152:153], v[152:153], v[224:225]
v_pk_mul_f32 v[156:157], v[156:157], v[224:225]
v_cvt_pk_bf16_f32 v148, v145, v149
v_pk_mul_f32 v[138:139], v[138:139], v[226:227]
v_pk_mul_f32 v[142:143], v[142:143], v[226:227]
v_cvt_pk_bf16_f32 v134, v131, v135
v_pk_mul_f32 v[154:155], v[154:155], v[226:227]
v_pk_mul_f32 v[158:159], v[158:159], v[226:227]
v_cvt_pk_bf16_f32 v150, v147, v151
v_cvt_pk_bf16_f32 v129, v136, v140
v_cvt_pk_bf16_f32 v133, v137, v141
v_cvt_pk_bf16_f32 v145, v152, v156
v_cvt_pk_bf16_f32 v149, v153, v157
v_cvt_pk_bf16_f32 v131, v138, v142
v_cvt_pk_bf16_f32 v135, v139, v143
v_cvt_pk_bf16_f32 v147, v154, v158
v_cvt_pk_bf16_f32 v151, v155, v159
ds_write2_b64 v5, v[128:129], v[144:145] offset0:0 offset1:16
ds_write2_b64 v0, v[132:133], v[148:149] offset0:32 offset1:48
v_cvt_pk_bf16_f32 v43, v30, v31
v_max3_u32 v12, v12, v50, v13
v_exp_f32 v32, v32
v_mfma_f32_16x16x32_bf16 a[136:139], a[128:131], v[40:43], a[136:139]
ds_write2_b64 v5, v[130:131], v[146:147] offset0:80 offset1:64
v_mfma_f32_16x16x32_bf16 v[160:163], v[40:43], a[96:99], v[160:163]
v_exp_f32 v33, v33
v_mfma_f32_16x16x32_bf16 v[164:167], v[40:43], a[100:103], v[164:167]
ds_write2_b64 v0, v[134:135], v[150:151] offset0:112 offset1:96
v_mfma_f32_16x16x32_bf16 v[168:171], v[40:43], a[104:107], v[168:171]
s_nop 1
v_accvgpr_read_b32 v18, a136
v_rcp_f32 v13, v18
v_mfma_f32_16x16x32_bf16 v[172:175], v[40:43], a[108:111], v[172:175]
ds_read_b64_tr_b16 v[128:129], v56 offset:0
ds_read_b64_tr_b16 v[130:131], v57 offset:0
v_mfma_f32_16x16x32_bf16 v[176:179], v[40:43], a[112:115], v[176:179]
ds_read_b64_tr_b16 v[136:137], v56 offset:2048
ds_read_b64_tr_b16 v[138:139], v57 offset:2048
v_mfma_f32_16x16x32_bf16 v[180:183], v[40:43], a[116:119], v[180:183]
ds_write_b32 v60, v13
v_mfma_f32_16x16x32_bf16 v[184:187], v[40:43], a[120:123], v[184:187]
ds_read_b128 v[228:231], v61
v_exp_f32 v34, v34
v_mfma_f32_16x16x32_bf16 v[188:191], v[40:43], a[124:127], v[188:191]
ds_read_b64_tr_b16 v[144:145], v58 offset:0
ds_read_b64_tr_b16 v[146:147], v59 offset:0
ds_read_b64_tr_b16 v[152:153], v58 offset:2048
ds_read_b64_tr_b16 v[154:155], v59 offset:2048
v_exp_f32 v35, v35
v_exp_f32 v36, v36
v_exp_f32 v37, v37
v_add_f32 v52, v52, v32
v_add_f32 v53, v53, v33
v_exp_f32 v38, v38
v_exp_f32 v39, v39
s_waitcnt lgkmcnt(8)
buffer_store_dwordx4 v[128:131], v6, s[12:15], s84 offen offset:0 sc1
s_waitcnt lgkmcnt(6)
buffer_store_dwordx4 v[136:139], v6, s[12:15], s85 offen offset:0 sc1
s_waitcnt lgkmcnt(4)
v_pk_mul_f32 v[160:161], v[160:161], v[228:229]
v_pk_mul_f32 v[164:165], v[164:165], v[228:229]
v_pk_mul_f32 v[176:177], v[176:177], v[228:229]
v_pk_mul_f32 v[180:181], v[180:181], v[228:229]
v_pk_mul_f32 v[162:163], v[162:163], v[230:231]
v_pk_mul_f32 v[166:167], v[166:167], v[230:231]
v_pk_mul_f32 v[178:179], v[178:179], v[230:231]
v_pk_mul_f32 v[182:183], v[182:183], v[230:231]
v_cvt_pk_bf16_f32 v160, v160, v164
v_cvt_pk_bf16_f32 v176, v176, v180
v_cvt_pk_bf16_f32 v162, v162, v166
v_cvt_pk_bf16_f32 v178, v178, v182
v_pk_mul_f32 v[168:169], v[168:169], v[228:229]
v_pk_mul_f32 v[172:173], v[172:173], v[228:229]
v_cvt_pk_bf16_f32 v164, v161, v165
v_pk_mul_f32 v[184:185], v[184:185], v[228:229]
v_pk_mul_f32 v[188:189], v[188:189], v[228:229]
v_cvt_pk_bf16_f32 v180, v177, v181
v_pk_mul_f32 v[170:171], v[170:171], v[230:231]
v_pk_mul_f32 v[174:175], v[174:175], v[230:231]
v_cvt_pk_bf16_f32 v166, v163, v167
v_pk_mul_f32 v[186:187], v[186:187], v[230:231]
v_pk_mul_f32 v[190:191], v[190:191], v[230:231]
v_cvt_pk_bf16_f32 v182, v179, v183
v_cvt_pk_bf16_f32 v161, v168, v172
v_cvt_pk_bf16_f32 v165, v169, v173
v_cvt_pk_bf16_f32 v177, v184, v188
v_cvt_pk_bf16_f32 v181, v185, v189
v_cvt_pk_bf16_f32 v163, v170, v174
v_cvt_pk_bf16_f32 v167, v171, v175
v_cvt_pk_bf16_f32 v179, v186, v190
v_cvt_pk_bf16_f32 v183, v187, v191
ds_write2_b64 v5, v[160:161], v[176:177] offset0:0 offset1:16
ds_write2_b64 v0, v[164:165], v[180:181] offset0:32 offset1:48
v_add_f32 v52, v52, v34
v_add_f32 v53, v53, v35
s_waitcnt lgkmcnt(4)
buffer_store_dwordx4 v[144:147], v6, s[12:15], s84 offen offset:128 sc1
ds_write2_b64 v5, v[162:163], v[178:179] offset0:80 offset1:64
v_add_f32 v52, v52, v36
v_add_f32 v53, v53, v37
v_add_f32 v52, v52, v38
ds_write2_b64 v0, v[166:167], v[182:183] offset0:112 offset1:96
v_add_f32 v53, v53, v39
v_add_f32 v52, v52, v53
v_mov_b32 v53, v52
v_cvt_pk_bf16_f32 v44, v32, v33
v_cvt_pk_bf16_f32 v45, v34, v35
v_permlane16_swap_b32 v52, v53
ds_read_b64_tr_b16 v[160:161], v56 offset:0
v_add_f32 v52, v52, v53
ds_read_b64_tr_b16 v[162:163], v57 offset:0
v_mov_b32 v53, v52
v_cvt_pk_bf16_f32 v46, v36, v37
v_cvt_pk_bf16_f32 v47, v38, v39
v_permlane32_swap_b32 v52, v53
s_nop 0
v_mfma_f32_16x16x32_bf16 v[192:195], v[44:47], a[96:99], v[192:195]
ds_read_b64_tr_b16 v[168:169], v56 offset:2048
v_max3_u32 v12, v12, v18, v13
v_mfma_f32_16x16x32_bf16 v[196:199], v[44:47], a[100:103], v[196:199]
ds_read_b64_tr_b16 v[170:171], v57 offset:2048
v_add_f32 v52, v52, v53
v_mfma_f32_16x16x32_bf16 v[200:203], v[44:47], a[104:107], v[200:203]
s_waitcnt lgkmcnt(8)
buffer_store_dwordx4 v[152:155], v6, s[12:15], s85 offen offset:128 sc1
v_mfma_f32_16x16x32_bf16 v[204:207], v[44:47], a[108:111], v[204:207]
ds_read_b64_tr_b16 v[176:177], v58 offset:0
v_rcp_f32 v13, v52
v_mfma_f32_16x16x32_bf16 v[208:211], v[44:47], a[112:115], v[208:211]
ds_write_b32 v60, v13
v_mfma_f32_16x16x32_bf16 v[212:215], v[44:47], a[116:119], v[212:215]
ds_read_b128 v[224:227], v61
ds_read_b64_tr_b16 v[178:179], v59 offset:0
v_mfma_f32_16x16x32_bf16 v[216:219], v[44:47], a[120:123], v[216:219]
s_waitcnt lgkmcnt(6)
buffer_store_dwordx4 v[160:163], v6, s[12:15], s86 offen offset:0 sc1
v_mfma_f32_16x16x32_bf16 v[220:223], v[44:47], a[124:127], v[220:223]
ds_read_b64_tr_b16 v[184:185], v58 offset:2048
ds_read_b64_tr_b16 v[186:187], v59 offset:2048
s_waitcnt lgkmcnt(6)
buffer_store_dwordx4 v[168:171], v6, s[12:15], s87 offen offset:0 sc1
v_max3_u32 v12, v12, v52, v13
s_waitcnt lgkmcnt(3)
v_pk_mul_f32 v[192:193], v[192:193], v[224:225]
v_pk_mul_f32 v[196:197], v[196:197], v[224:225]
v_pk_mul_f32 v[208:209], v[208:209], v[224:225]
v_pk_mul_f32 v[212:213], v[212:213], v[224:225]
v_pk_mul_f32 v[194:195], v[194:195], v[226:227]
v_pk_mul_f32 v[198:199], v[198:199], v[226:227]
v_pk_mul_f32 v[210:211], v[210:211], v[226:227]
v_pk_mul_f32 v[214:215], v[214:215], v[226:227]
v_cvt_pk_bf16_f32 v192, v192, v196
v_cvt_pk_bf16_f32 v208, v208, v212
v_cvt_pk_bf16_f32 v194, v194, v198
v_cvt_pk_bf16_f32 v210, v210, v214
v_pk_mul_f32 v[200:201], v[200:201], v[224:225]
v_pk_mul_f32 v[204:205], v[204:205], v[224:225]
v_cvt_pk_bf16_f32 v196, v193, v197
v_pk_mul_f32 v[216:217], v[216:217], v[224:225]
v_pk_mul_f32 v[220:221], v[220:221], v[224:225]
v_cvt_pk_bf16_f32 v212, v209, v213
v_pk_mul_f32 v[202:203], v[202:203], v[226:227]
v_pk_mul_f32 v[206:207], v[206:207], v[226:227]
v_cvt_pk_bf16_f32 v198, v195, v199
v_pk_mul_f32 v[218:219], v[218:219], v[226:227]
v_pk_mul_f32 v[222:223], v[222:223], v[226:227]
v_cvt_pk_bf16_f32 v214, v211, v215
v_cvt_pk_bf16_f32 v193, v200, v204
v_cvt_pk_bf16_f32 v197, v201, v205
v_cvt_pk_bf16_f32 v209, v216, v220
v_cvt_pk_bf16_f32 v213, v217, v221
v_cvt_pk_bf16_f32 v195, v202, v206
v_cvt_pk_bf16_f32 v199, v203, v207
v_cvt_pk_bf16_f32 v211, v218, v222
v_cvt_pk_bf16_f32 v215, v219, v223
ds_write2_b64 v5, v[192:193], v[208:209] offset0:0 offset1:16
ds_write2_b64 v0, v[196:197], v[212:213] offset0:32 offset1:48
s_waitcnt lgkmcnt(4)
buffer_store_dwordx4 v[176:179], v6, s[12:15], s86 offen offset:128 sc1
ds_write2_b64 v5, v[194:195], v[210:211] offset0:80 offset1:64
s_waitcnt lgkmcnt(3)
buffer_store_dwordx4 v[184:187], v6, s[12:15], s87 offen offset:128 sc1
ds_write2_b64 v0, v[198:199], v[214:215] offset0:112 offset1:96
ds_read_b64_tr_b16 v[192:193], v56 offset:0
ds_read_b64_tr_b16 v[194:195], v57 offset:0
ds_read_b64_tr_b16 v[200:201], v56 offset:2048
ds_read_b64_tr_b16 v[202:203], v57 offset:2048
ds_read_b64_tr_b16 v[208:209], v58 offset:0
ds_read_b64_tr_b16 v[210:211], v59 offset:0
ds_read_b64_tr_b16 v[216:217], v58 offset:2048
ds_read_b64_tr_b16 v[218:219], v59 offset:2048
s_waitcnt lgkmcnt(6)
buffer_store_dwordx4 v[192:195], v6, s[12:15], s88 offen offset:0 sc1
s_waitcnt lgkmcnt(4)
buffer_store_dwordx4 v[200:203], v6, s[12:15], s89 offen offset:0 sc1
s_waitcnt lgkmcnt(2)
buffer_store_dwordx4 v[208:211], v6, s[12:15], s88 offen offset:128 sc1
s_waitcnt lgkmcnt(0)
buffer_store_dwordx4 v[216:219], v6, s[12:15], s89 offen offset:128 sc1
s_waitcnt vmcnt(20)
s_branch L_fin
L_last0_5:
L_t5_0_0:
v_mfma_f32_16x16x32_bf16 v[32:35], a[0:3], v[240:243], 0
s_mov_b32 s14, s47
v_exp_f32 v29, v29
v_mfma_f32_16x16x32_bf16 v[32:35], a[4:7], v[244:247], v[32:35]
s_add_u32 s80, s46, 0
v_exp_f32 v30, v30
v_mfma_f32_16x16x32_bf16 v[32:35], a[8:11], v[248:251], v[32:35]
s_add_u32 s81, s46, 131072
v_exp_f32 v31, v31
v_mfma_f32_16x16x32_bf16 v[32:35], a[12:15], v[252:255], v[32:35]
s_add_u32 s82, s46, 262144
v_cvt_pk_bf16_f32 v42, v28, v29
v_cvt_pk_bf16_f32 v43, v30, v31
v_mfma_f32_16x16x32_bf16 v[36:39], a[28:31], v[252:255], 0
s_add_u32 s83, s46, 393216
s_add_u32 s84, s46, 524288
s_add_u32 s85, s46, 655360
v_mfma_f32_16x16x32_bf16 v[36:39], a[24:27], v[248:251], v[36:39]
s_add_u32 s86, s46, 786432
s_add_u32 s87, s46, 917504
v_exp_f32 v32, v32
v_mfma_f32_16x16x32_bf16 v[36:39], a[20:23], v[244:247], v[36:39]
s_add_u32 s88, s46, 1048576
v_exp_f32 v33, v33
v_mfma_f32_16x16x32_bf16 v[36:39], a[16:19], v[240:243], v[36:39]
s_add_u32 s89, s46, 1179648
v_exp_f32 v34, v34
v_mfma_f32_16x16x32_bf16 a[132:135], a[128:131], v[40:43], a[132:135]
v_exp_f32 v35, v35
v_mfma_f32_16x16x32_bf16 v[64:67], v[40:43], a[64:67], v[64:67]
v_add_f32 v48, v48, v32
s_nop 1
v_exp_f32 v36, v36
v_mfma_f32_16x16x32_bf16 v[68:71], v[40:43], a[68:71], v[68:71]
s_nop 0
v_accvgpr_read_b32 v16, a132
v_rcp_f32 v13, v16
v_mfma_f32_16x16x32_bf16 v[72:75], v[40:43], a[72:75], v[72:75]
ds_write_b32 v60, v13
v_mfma_f32_16x16x32_bf16 v[76:79], v[40:43], a[76:79], v[76:79]
ds_read_b128 v[224:227], v61
v_exp_f32 v37, v37
v_mfma_f32_16x16x32_bf16 v[80:83], v[40:43], a[80:83], v[80:83]
v_exp_f32 v38, v38
v_mfma_f32_16x16x32_bf16 v[84:87], v[40:43], a[84:87], v[84:87]
v_exp_f32 v39, v39
v_mfma_f32_16x16x32_bf16 v[88:91], v[40:43], a[88:91], v[88:91]
v_add_f32 v49, v49, v33
v_add_f32 v48, v48, v34
v_mfma_f32_16x16x32_bf16 v[92:95], v[40:43], a[92:95], v[92:95]
v_add_f32 v49, v49, v35
v_cvt_pk_bf16_f32 v44, v32, v33
v_mfma_f32_16x16x32_bf16 v[24:27], a[0:3], a[160:163], 0
v_cvt_pk_bf16_f32 v45, v34, v35
v_add_f32 v48, v48, v36
v_mfma_f32_16x16x32_bf16 v[24:27], a[4:7], a[164:167], v[24:27]
v_add_f32 v49, v49, v37
v_cvt_pk_bf16_f32 v46, v36, v37
v_mfma_f32_16x16x32_bf16 v[24:27], a[8:11], a[168:171], v[24:27]
s_waitcnt lgkmcnt(0)
v_pk_mul_f32 v[64:65], v[64:65], v[224:225]
v_pk_mul_f32 v[68:69], v[68:69], v[224:225]
v_pk_mul_f32 v[80:81], v[80:81], v[224:225]
v_pk_mul_f32 v[84:85], v[84:85], v[224:225]
v_pk_mul_f32 v[66:67], v[66:67], v[226:227]
v_pk_mul_f32 v[70:71], v[70:71], v[226:227]
v_pk_mul_f32 v[82:83], v[82:83], v[226:227]
v_pk_mul_f32 v[86:87], v[86:87], v[226:227]
v_pk_mul_f32 v[72:73], v[72:73], v[224:225]
v_pk_mul_f32 v[76:77], v[76:77], v[224:225]
v_pk_mul_f32 v[88:89], v[88:89], v[224:225]
v_pk_mul_f32 v[92:93], v[92:93], v[224:225]
v_pk_mul_f32 v[74:75], v[74:75], v[226:227]
v_pk_mul_f32 v[78:79], v[78:79], v[226:227]
v_pk_mul_f32 v[90:91], v[90:91], v[226:227]
v_pk_mul_f32 v[94:95], v[94:95], v[226:227]
v_mfma_f32_16x16x32_bf16 v[24:27], a[12:15], a[172:175], v[24:27]
v_cvt_pk_bf16_f32 v64, v64, v68
v_cvt_pk_bf16_f32 v80, v80, v84
v_mfma_f32_16x16x32_bf16 v[28:31], a[28:31], a[172:175], 0
v_cvt_pk_bf16_f32 v66, v66, v70
v_cvt_pk_bf16_f32 v82, v82, v86
v_mfma_f32_16x16x32_bf16 v[28:31], a[24:27], a[168:171], v[28:31]
v_cvt_pk_bf16_f32 v68, v65, v69
v_cvt_pk_bf16_f32 v84, v81, v85
v_mfma_f32_16x16x32_bf16 v[28:31], a[20:23], a[164:167], v[28:31]
v_cvt_pk_bf16_f32 v70, v67, v71
v_cvt_pk_bf16_f32 v86, v83, v87
v_mfma_f32_16x16x32_bf16 v[28:31], a[16:19], a[160:163], v[28:31]
v_cvt_pk_bf16_f32 v65, v72, v76
v_cvt_pk_bf16_f32 v69, v73, v77
v_cvt_pk_bf16_f32 v81, v88, v92
v_cvt_pk_bf16_f32 v85, v89, v93
v_cvt_pk_bf16_f32 v67, v74, v78
v_cvt_pk_bf16_f32 v71, v75, v79
v_cvt_pk_bf16_f32 v83, v90, v94
v_cvt_pk_bf16_f32 v87, v91, v95
ds_write2_b64 v5, v[64:65], v[80:81] offset0:0 offset1:16
ds_write2_b64 v0, v[68:69], v[84:85] offset0:32 offset1:48
v_cvt_pk_bf16_f32 v47, v38, v39
v_add_f32 v48, v48, v38
v_add_f32 v49, v49, v39
v_mfma_f32_16x16x32_bf16 v[96:99], v[44:47], a[64:67], v[96:99]
ds_write2_b64 v5, v[66:67], v[82:83] offset0:80 offset1:64
v_mfma_f32_16x16x32_bf16 v[100:103], v[44:47], a[68:71], v[100:103]
v_add_f32 v48, v48, v49
v_mov_b32 v49, v48
v_mfma_f32_16x16x32_bf16 v[104:107], v[44:47], a[72:75], v[104:107]
ds_write2_b64 v0, v[70:71], v[86:87] offset0:112 offset1:96
v_mfma_f32_16x16x32_bf16 v[108:111], v[44:47], a[76:79], v[108:111]
v_permlane16_swap_b32 v48, v49
v_mfma_f32_16x16x32_bf16 v[112:115], v[44:47], a[80:83], v[112:115]
v_add_f32 v48, v48, v49
ds_read_b64_tr_b16 v[64:65], v56 offset:0
v_mfma_f32_16x16x32_bf16 v[116:119], v[44:47], a[84:87], v[116:119]
ds_read_b64_tr_b16 v[66:67], v57 offset:0
v_mov_b32 v49, v48
v_mfma_f32_16x16x32_bf16 v[120:123], v[44:47], a[88:91], v[120:123]
ds_read_b64_tr_b16 v[72:73], v56 offset:2048
v_permlane32_swap_b32 v48, v49
v_mfma_f32_16x16x32_bf16 v[124:127], v[44:47], a[92:95], v[124:127]
ds_read_b64_tr_b16 v[74:75], v57 offset:2048
v_max3_u32 v12, v12, v16, v13
v_mfma_f32_16x16x32_bf16 v[32:35], a[0:3], a[176:179], 0
ds_read_b64_tr_b16 v[80:81], v58 offset:0
v_add_f32 v48, v48, v49
v_mfma_f32_16x16x32_bf16 v[32:35], a[4:7], a[180:183], v[32:35]
ds_read_b64_tr_b16 v[82:83], v59 offset:0
v_rcp_f32 v13, v48
v_mfma_f32_16x16x32_bf16 v[32:35], a[8:11], a[184:187], v[32:35]
ds_write_b32 v60, v13
v_mfma_f32_16x16x32_bf16 v[32:35], a[12:15], a[188:191], v[32:35]
ds_read_b128 v[228:231], v61
ds_read_b64_tr_b16 v[88:89], v58 offset:2048
v_mfma_f32_16x16x32_bf16 v[36:39], a[28:31], a[188:191], 0
s_waitcnt lgkmcnt(7)
buffer_store_dwordx4 v[64:67], v6, s[12:15], s80 offen offset:0 sc1
v_mfma_f32_16x16x32_bf16 v[36:39], a[24:27], a[184:187], v[36:39]
ds_read_b64_tr_b16 v[90:91], v59 offset:2048
s_waitcnt lgkmcnt(6)
buffer_store_dwordx4 v[72:75], v6, s[12:15], s81 offen offset:0 sc1
v_mfma_f32_16x16x32_bf16 v[36:39], a[20:23], a[180:183], v[36:39]
s_waitcnt lgkmcnt(4)
buffer_store_dwordx4 v[80:83], v6, s[12:15], s80 offen offset:128 sc1
v_mfma_f32_16x16x32_bf16 v[36:39], a[16:19], a[176:179], v[36:39]
v_exp_f32 v24, v24
s_waitcnt lgkmcnt(2)
v_pk_mul_f32 v[96:97], v[96:97], v[228:229]
v_pk_mul_f32 v[100:101], v[100:101], v[228:229]
v_pk_mul_f32 v[112:113], v[112:113], v[228:229]
v_pk_mul_f32 v[116:117], v[116:117], v[228:229]
v_pk_mul_f32 v[98:99], v[98:99], v[230:231]
v_pk_mul_f32 v[102:103], v[102:103], v[230:231]
v_pk_mul_f32 v[114:115], v[114:115], v[230:231]
v_pk_mul_f32 v[118:119], v[118:119], v[230:231]
v_cvt_pk_bf16_f32 v96, v96, v100
v_cvt_pk_bf16_f32 v112, v112, v116
v_cvt_pk_bf16_f32 v98, v98, v102
v_cvt_pk_bf16_f32 v114, v114, v118
v_pk_mul_f32 v[104:105], v[104:105], v[228:229]
v_pk_mul_f32 v[108:109], v[108:109], v[228:229]
v_cvt_pk_bf16_f32 v100, v97, v101
v_pk_mul_f32 v[120:121], v[120:121], v[228:229]
v_pk_mul_f32 v[124:125], v[124:125], v[228:229]
v_cvt_pk_bf16_f32 v116, v113, v117
v_pk_mul_f32 v[106:107], v[106:107], v[230:231]
v_pk_mul_f32 v[110:111], v[110:111], v[230:231]
v_cvt_pk_bf16_f32 v102, v99, v103
v_pk_mul_f32 v[122:123], v[122:123], v[230:231]
v_pk_mul_f32 v[126:127], v[126:127], v[230:231]
v_cvt_pk_bf16_f32 v118, v115, v119
v_cvt_pk_bf16_f32 v97, v104, v108
v_cvt_pk_bf16_f32 v101, v105, v109
v_cvt_pk_bf16_f32 v113, v120, v124
v_cvt_pk_bf16_f32 v117, v121, v125
v_cvt_pk_bf16_f32 v99, v106, v110
v_cvt_pk_bf16_f32 v103, v107, v111
v_cvt_pk_bf16_f32 v115, v122, v126
v_cvt_pk_bf16_f32 v119, v123, v127
ds_write2_b64 v5, v[96:97], v[112:113] offset0:0 offset1:16
ds_write2_b64 v0, v[100:101], v[116:117] offset0:32 offset1:48
v_exp_f32 v25, v25
v_exp_f32 v26, v26
ds_write2_b64 v5, v[98:99], v[114:115] offset0:80 offset1:64
v_exp_f32 v27, v27
v_exp_f32 v28, v28
v_exp_f32 v29, v29
v_exp_f32 v30, v30
ds_write2_b64 v0, v[102:103], v[118:119] offset0:112 offset1:96
v_exp_f32 v31, v31
v_add_f32 v50, v50, v24
v_add_f32 v51, v51, v25
v_add_f32 v50, v50, v26
v_add_f32 v51, v51, v27
ds_read_b64_tr_b16 v[96:97], v56 offset:0
v_cvt_pk_bf16_f32 v40, v24, v25
ds_read_b64_tr_b16 v[98:99], v57 offset:0
v_cvt_pk_bf16_f32 v41, v26, v27
v_add_f32 v50, v50, v28
v_add_f32 v51, v51, v29
v_cvt_pk_bf16_f32 v42, v28, v29
v_cvt_pk_bf16_f32 v43, v30, v31
v_add_f32 v50, v50, v30
v_add_f32 v51, v51, v31
v_mfma_f32_16x16x32_bf16 v[128:131], v[40:43], a[64:67], v[128:131]
ds_read_b64_tr_b16 v[104:105], v56 offset:2048
v_add_f32 v50, v50, v51
v_mfma_f32_16x16x32_bf16 v[132:135], v[40:43], a[68:71], v[132:135]
ds_read_b64_tr_b16 v[106:107], v57 offset:2048
v_mov_b32 v51, v50
v_mfma_f32_16x16x32_bf16 v[136:139], v[40:43], a[72:75], v[136:139]
s_waitcnt lgkmcnt(8)
buffer_store_dwordx4 v[88:91], v6, s[12:15], s81 offen offset:128 sc1
v_mfma_f32_16x16x32_bf16 v[140:143], v[40:43], a[76:79], v[140:143]
ds_read_b64_tr_b16 v[112:113], v58 offset:0
v_permlane16_swap_b32 v50, v51
v_mfma_f32_16x16x32_bf16 v[144:147], v[40:43], a[80:83], v[144:147]
ds_read_b64_tr_b16 v[114:115], v59 offset:0
v_add_f32 v50, v50, v51
v_mfma_f32_16x16x32_bf16 v[148:151], v[40:43], a[84:87], v[148:151]
s_waitcnt lgkmcnt(4)
buffer_store_dwordx4 v[96:99], v6, s[12:15], s82 offen offset:0 sc1
v_mfma_f32_16x16x32_bf16 v[152:155], v[40:43], a[88:91], v[152:155]
ds_read_b64_tr_b16 v[120:121], v58 offset:2048
v_mov_b32 v51, v50
v_mfma_f32_16x16x32_bf16 v[156:159], v[40:43], a[92:95], v[156:159]
ds_read_b64_tr_b16 v[122:123], v59 offset:2048
v_permlane32_swap_b32 v50, v51
v_mfma_f32_16x16x32_bf16 v[24:27], a[0:3], a[192:195], 0
s_waitcnt lgkmcnt(4)
buffer_store_dwordx4 v[104:107], v6, s[12:15], s83 offen offset:0 sc1
v_mfma_f32_16x16x32_bf16 v[24:27], a[4:7], a[196:199], v[24:27]
s_waitcnt lgkmcnt(2)
buffer_store_dwordx4 v[112:115], v6, s[12:15], s82 offen offset:128 sc1
v_mfma_f32_16x16x32_bf16 v[24:27], a[8:11], a[200:203], v[24:27]
v_max3_u32 v12, v12, v48, v13
v_add_f32 v50, v50, v51
v_mfma_f32_16x16x32_bf16 v[24:27], a[12:15], a[204:207], v[24:27]
v_rcp_f32 v13, v50
v_mfma_f32_16x16x32_bf16 v[28:31], a[28:31], a[204:207], 0
ds_write_b32 v60, v13
v_mfma_f32_16x16x32_bf16 v[28:31], a[24:27], a[200:203], v[28:31]
ds_read_b128 v[224:227], v61
v_exp_f32 v32, v32
v_mfma_f32_16x16x32_bf16 v[28:31], a[20:23], a[196:199], v[28:31]
s_waitcnt lgkmcnt(2)
buffer_store_dwordx4 v[120:123], v6, s[12:15], s83 offen offset:128 sc1
v_mfma_f32_16x16x32_bf16 v[28:31], a[16:19], a[192:195], v[28:31]
v_exp_f32 v33, v33
v_exp_f32 v34, v34
v_exp_f32 v35, v35
v_exp_f32 v36, v36
v_exp_f32 v37, v37
v_exp_f32 v38, v38
v_exp_f32 v39, v39
v_cvt_pk_bf16_f32 v44, v32, v33
v_cvt_pk_bf16_f32 v45, v34, v35
v_cvt_pk_bf16_f32 v46, v36, v37
s_waitcnt lgkmcnt(0)
v_pk_mul_f32 v[128:129], v[128:129], v[224:225]
v_pk_mul_f32 v[132:133], v[132:133], v[224:225]
v_pk_mul_f32 v[144:145], v[144:145], v[224:225]
v_pk_mul_f32 v[148:149], v[148:149], v[224:225]
v_pk_mul_f32 v[130:131], v[130:131], v[226:227]
v_pk_mul_f32 v[134:135], v[134:135], v[226:227]
v_pk_mul_f32 v[146:147], v[146:147], v[226:227]
v_pk_mul_f32 v[150:151], v[150:151], v[226:227]
v_cvt_pk_bf16_f32 v128, v128, v132
v_cvt_pk_bf16_f32 v144, v144, v148
v_cvt_pk_bf16_f32 v130, v130, v134
v_cvt_pk_bf16_f32 v146, v146, v150
v_pk_mul_f32 v[136:137], v[136:137], v[224:225]
v_pk_mul_f32 v[140:141], v[140:141], v[224:225]
v_cvt_pk_bf16_f32 v132, v129, v133
v_pk_mul_f32 v[152:153], v[152:153], v[224:225]
v_pk_mul_f32 v[156:157], v[156:157], v[224:225]
v_cvt_pk_bf16_f32 v148, v145, v149
v_pk_mul_f32 v[138:139], v[138:139], v[226:227]
v_pk_mul_f32 v[142:143], v[142:143], v[226:227]
v_cvt_pk_bf16_f32 v134, v131, v135
v_pk_mul_f32 v[154:155], v[154:155], v[226:227]
v_pk_mul_f32 v[158:159], v[158:159], v[226:227]
v_cvt_pk_bf16_f32 v150, v147, v151
v_cvt_pk_bf16_f32 v129, v136, v140
v_cvt_pk_bf16_f32 v133, v137, v141
v_cvt_pk_bf16_f32 v145, v152, v156
v_cvt_pk_bf16_f32 v149, v153, v157
v_cvt_pk_bf16_f32 v131, v138, v142
v_cvt_pk_bf16_f32 v135, v139, v143
v_cvt_pk_bf16_f32 v147, v154, v158
v_cvt_pk_bf16_f32 v151, v155, v159
ds_write2_b64 v5, v[128:129], v[144:145] offset0:0 offset1:16
ds_write2_b64 v0, v[132:133], v[148:149] offset0:32 offset1:48
v_cvt_pk_bf16_f32 v47, v38, v39
v_max3_u32 v12, v12, v50, v13
v_exp_f32 v24, v24
v_mfma_f32_16x16x32_bf16 a[136:139], a[128:131], v[44:47], a[136:139]
ds_write2_b64 v5, v[130:131], v[146:147] offset0:80 offset1:64
v_mfma_f32_16x16x32_bf16 v[160:163], v[44:47], a[64:67], v[160:163]
v_exp_f32 v25, v25
v_mfma_f32_16x16x32_bf16 v[164:167], v[44:47], a[68:71], v[164:167]
ds_write2_b64 v0, v[134:135], v[150:151] offset0:112 offset1:96
v_mfma_f32_16x16x32_bf16 v[168:171], v[44:47], a[72:75], v[168:171]
s_nop 1
v_accvgpr_read_b32 v18, a136
v_rcp_f32 v13, v18
v_mfma_f32_16x16x32_bf16 v[172:175], v[44:47], a[76:79], v[172:175]
ds_read_b64_tr_b16 v[128:129], v56 offset:0
ds_read_b64_tr_b16 v[130:131], v57 offset:0
v_mfma_f32_16x16x32_bf16 v[176:179], v[44:47], a[80:83], v[176:179]
ds_read_b64_tr_b16 v[136:137], v56 offset:2048
ds_read_b64_tr_b16 v[138:139], v57 offset:2048
v_mfma_f32_16x16x32_bf16 v[180:183], v[44:47], a[84:87], v[180:183]
ds_write_b32 v60, v13
v_mfma_f32_16x16x32_bf16 v[184:187], v[44:47], a[88:91], v[184:187]
ds_read_b128 v[228:231], v61
v_exp_f32 v26, v26
v_mfma_f32_16x16x32_bf16 v[188:191], v[44:47], a[92:95], v[188:191]
ds_read_b64_tr_b16 v[144:145], v58 offset:0
ds_read_b64_tr_b16 v[146:147], v59 offset:0
ds_read_b64_tr_b16 v[152:153], v58 offset:2048
ds_read_b64_tr_b16 v[154:155], v59 offset:2048
v_exp_f32 v27, v27
v_exp_f32 v28, v28
v_exp_f32 v29, v29
v_add_f32 v52, v52, v24
v_add_f32 v53, v53, v25
v_exp_f32 v30, v30
v_exp_f32 v31, v31
s_waitcnt lgkmcnt(8)
buffer_store_dwordx4 v[128:131], v6, s[12:15], s84 offen offset:0 sc1
s_waitcnt lgkmcnt(6)
buffer_store_dwordx4 v[136:139], v6, s[12:15], s85 offen offset:0 sc1
s_waitcnt lgkmcnt(4)
v_pk_mul_f32 v[160:161], v[160:161], v[228:229]
v_pk_mul_f32 v[164:165], v[164:165], v[228:229]
v_pk_mul_f32 v[176:177], v[176:177], v[228:229]
v_pk_mul_f32 v[180:181], v[180:181], v[228:229]
v_pk_mul_f32 v[162:163], v[162:163], v[230:231]
v_pk_mul_f32 v[166:167], v[166:167], v[230:231]
v_pk_mul_f32 v[178:179], v[178:179], v[230:231]
v_pk_mul_f32 v[182:183], v[182:183], v[230:231]
v_cvt_pk_bf16_f32 v160, v160, v164
v_cvt_pk_bf16_f32 v176, v176, v180
v_cvt_pk_bf16_f32 v162, v162, v166
v_cvt_pk_bf16_f32 v178, v178, v182
v_pk_mul_f32 v[168:169], v[168:169], v[228:229]
v_pk_mul_f32 v[172:173], v[172:173], v[228:229]
v_cvt_pk_bf16_f32 v164, v161, v165
v_pk_mul_f32 v[184:185], v[184:185], v[228:229]
v_pk_mul_f32 v[188:189], v[188:189], v[228:229]
v_cvt_pk_bf16_f32 v180, v177, v181
v_pk_mul_f32 v[170:171], v[170:171], v[230:231]
v_pk_mul_f32 v[174:175], v[174:175], v[230:231]
v_cvt_pk_bf16_f32 v166, v163, v167
v_pk_mul_f32 v[186:187], v[186:187], v[230:231]
v_pk_mul_f32 v[190:191], v[190:191], v[230:231]
v_cvt_pk_bf16_f32 v182, v179, v183
v_cvt_pk_bf16_f32 v161, v168, v172
v_cvt_pk_bf16_f32 v165, v169, v173
v_cvt_pk_bf16_f32 v177, v184, v188
v_cvt_pk_bf16_f32 v181, v185, v189
v_cvt_pk_bf16_f32 v163, v170, v174
v_cvt_pk_bf16_f32 v167, v171, v175
v_cvt_pk_bf16_f32 v179, v186, v190
v_cvt_pk_bf16_f32 v183, v187, v191
ds_write2_b64 v5, v[160:161], v[176:177] offset0:0 offset1:16
ds_write2_b64 v0, v[164:165], v[180:181] offset0:32 offset1:48
v_add_f32 v52, v52, v26
v_add_f32 v53, v53, v27
s_waitcnt lgkmcnt(4)
buffer_store_dwordx4 v[144:147], v6, s[12:15], s84 offen offset:128 sc1
ds_write2_b64 v5, v[162:163], v[178:179] offset0:80 offset1:64
v_add_f32 v52, v52, v28
v_add_f32 v53, v53, v29
v_add_f32 v52, v52, v30
ds_write2_b64 v0, v[166:167], v[182:183] offset0:112 offset1:96
v_add_f32 v53, v53, v31
v_add_f32 v52, v52, v53
v_mov_b32 v53, v52
v_cvt_pk_bf16_f32 v40, v24, v25
v_cvt_pk_bf16_f32 v41, v26, v27
v_permlane16_swap_b32 v52, v53
ds_read_b64_tr_b16 v[160:161], v56 offset:0
v_add_f32 v52, v52, v53
ds_read_b64_tr_b16 v[162:163], v57 offset:0
v_mov_b32 v53, v52
v_cvt_pk_bf16_f32 v42, v28, v29
v_cvt_pk_bf16_f32 v43, v30, v31
v_permlane32_swap_b32 v52, v53
s_nop 0
v_mfma_f32_16x16x32_bf16 v[192:195], v[40:43], a[64:67], v[192:195]
ds_read_b64_tr_b16 v[168:169], v56 offset:2048
v_max3_u32 v12, v12, v18, v13
v_mfma_f32_16x16x32_bf16 v[196:199], v[40:43], a[68:71], v[196:199]
ds_read_b64_tr_b16 v[170:171], v57 offset:2048
v_add_f32 v52, v52, v53
v_mfma_f32_16x16x32_bf16 v[200:203], v[40:43], a[72:75], v[200:203]
s_waitcnt lgkmcnt(8)
buffer_store_dwordx4 v[152:155], v6, s[12:15], s85 offen offset:128 sc1
v_mfma_f32_16x16x32_bf16 v[204:207], v[40:43], a[76:79], v[204:207]
ds_read_b64_tr_b16 v[176:177], v58 offset:0
v_rcp_f32 v13, v52
v_mfma_f32_16x16x32_bf16 v[208:211], v[40:43], a[80:83], v[208:211]
ds_write_b32 v60, v13
v_mfma_f32_16x16x32_bf16 v[212:215], v[40:43], a[84:87], v[212:215]
ds_read_b128 v[224:227], v61
ds_read_b64_tr_b16 v[178:179], v59 offset:0
v_mfma_f32_16x16x32_bf16 v[216:219], v[40:43], a[88:91], v[216:219]
s_waitcnt lgkmcnt(6)
buffer_store_dwordx4 v[160:163], v6, s[12:15], s86 offen offset:0 sc1
v_mfma_f32_16x16x32_bf16 v[220:223], v[40:43], a[92:95], v[220:223]
ds_read_b64_tr_b16 v[184:185], v58 offset:2048
ds_read_b64_tr_b16 v[186:187], v59 offset:2048
s_waitcnt lgkmcnt(6)
buffer_store_dwordx4 v[168:171], v6, s[12:15], s87 offen offset:0 sc1
v_max3_u32 v12, v12, v52, v13
s_waitcnt lgkmcnt(3)
v_pk_mul_f32 v[192:193], v[192:193], v[224:225]
v_pk_mul_f32 v[196:197], v[196:197], v[224:225]
v_pk_mul_f32 v[208:209], v[208:209], v[224:225]
v_pk_mul_f32 v[212:213], v[212:213], v[224:225]
v_pk_mul_f32 v[194:195], v[194:195], v[226:227]
v_pk_mul_f32 v[198:199], v[198:199], v[226:227]
v_pk_mul_f32 v[210:211], v[210:211], v[226:227]
v_pk_mul_f32 v[214:215], v[214:215], v[226:227]
v_cvt_pk_bf16_f32 v192, v192, v196
v_cvt_pk_bf16_f32 v208, v208, v212
v_cvt_pk_bf16_f32 v194, v194, v198
v_cvt_pk_bf16_f32 v210, v210, v214
v_pk_mul_f32 v[200:201], v[200:201], v[224:225]
v_pk_mul_f32 v[204:205], v[204:205], v[224:225]
v_cvt_pk_bf16_f32 v196, v193, v197
v_pk_mul_f32 v[216:217], v[216:217], v[224:225]
v_pk_mul_f32 v[220:221], v[220:221], v[224:225]
v_cvt_pk_bf16_f32 v212, v209, v213
v_pk_mul_f32 v[202:203], v[202:203], v[226:227]
v_pk_mul_f32 v[206:207], v[206:207], v[226:227]
v_cvt_pk_bf16_f32 v198, v195, v199
v_pk_mul_f32 v[218:219], v[218:219], v[226:227]
v_pk_mul_f32 v[222:223], v[222:223], v[226:227]
v_cvt_pk_bf16_f32 v214, v211, v215
v_cvt_pk_bf16_f32 v193, v200, v204
v_cvt_pk_bf16_f32 v197, v201, v205
v_cvt_pk_bf16_f32 v209, v216, v220
v_cvt_pk_bf16_f32 v213, v217, v221
v_cvt_pk_bf16_f32 v195, v202, v206
v_cvt_pk_bf16_f32 v199, v203, v207
v_cvt_pk_bf16_f32 v211, v218, v222
v_cvt_pk_bf16_f32 v215, v219, v223
ds_write2_b64 v5, v[192:193], v[208:209] offset0:0 offset1:16
ds_write2_b64 v0, v[196:197], v[212:213] offset0:32 offset1:48
s_waitcnt lgkmcnt(4)
buffer_store_dwordx4 v[176:179], v6, s[12:15], s86 offen offset:128 sc1
ds_write2_b64 v5, v[194:195], v[210:211] offset0:80 offset1:64
s_waitcnt lgkmcnt(3)
buffer_store_dwordx4 v[184:187], v6, s[12:15], s87 offen offset:128 sc1
ds_write2_b64 v0, v[198:199], v[214:215] offset0:112 offset1:96
ds_read_b64_tr_b16 v[192:193], v56 offset:0
ds_read_b64_tr_b16 v[194:195], v57 offset:0
ds_read_b64_tr_b16 v[200:201], v56 offset:2048
ds_read_b64_tr_b16 v[202:203], v57 offset:2048
ds_read_b64_tr_b16 v[208:209], v58 offset:0
ds_read_b64_tr_b16 v[210:211], v59 offset:0
ds_read_b64_tr_b16 v[216:217], v58 offset:2048
ds_read_b64_tr_b16 v[218:219], v59 offset:2048
s_waitcnt lgkmcnt(6)
buffer_store_dwordx4 v[192:195], v6, s[12:15], s88 offen offset:0 sc1
s_waitcnt lgkmcnt(4)
buffer_store_dwordx4 v[200:203], v6, s[12:15], s89 offen offset:0 sc1
s_waitcnt lgkmcnt(2)
buffer_store_dwordx4 v[208:211], v6, s[12:15], s88 offen offset:128 sc1
s_waitcnt lgkmcnt(0)
buffer_store_dwordx4 v[216:219], v6, s[12:15], s89 offen offset:128 sc1
s_waitcnt vmcnt(20)
s_branch L_fin
L_first14:
s_mov_b64 s[4:5], s[16:17]
s_mov_b64 s[8:9], s[22:23]
s_sub_u32 s10, s38, 128992
v_add_u32 v1, 16640, v1
v_add_u32 v2, 16640, v2
v_mbcnt_lo_u32_b32 v13, -1, 0
v_mbcnt_hi_u32_b32 v13, -1, v13
v_lshrrev_b32 v13, 2, v13
v_and_b32 v13, 12, v13
v_sub_u32 v13, s50, v13
v_cvt_f32_i32 v13, v13
v_mov_b32 v14, 0x7c800000
v_fmaak_f32 v16, v13, v14, 0xfc000000
v_fmaak_f32 v17, v13, v14, 0xfcc00000
v_fmaak_f32 v18, v13, v14, 0xfd200000
v_fmaak_f32 v19, v13, v14, 0xfd600000
v_min_f32 v16, 0, v16
v_min_f32 v17, 0, v17
v_min_f32 v18, 0, v18
v_min_f32 v19, 0, v19
v_mov_b32 v42, 0
v_mov_b32 v43, 0
s_mov_b32 s30, 6
s_sub_u32 s26, s40, 8
s_sub_u32 s32, s49, 5
s_waitcnt vmcnt(8)
ds_read_b128 a[160:163], v11 offset:0
ds_read_b128 a[164:167], v11 offset:64
ds_read_b128 a[168:171], v11 offset:128
ds_read_b128 a[172:175], v11 offset:192
v_add_u32 v11, 49920, v11
s_waitcnt lgkmcnt(3)
v_mfma_f32_16x16x32_bf16 v[64:67], a[146:149], a[160:163], 0
v_mfma_f32_16x16x32_bf16 v[68:71], a[144:147], a[160:163], 0
v_mfma_f32_16x16x32_bf16 v[64:67], a[150:153], a[160:163], v[64:67]
v_mfma_f32_16x16x32_bf16 v[68:71], a[148:151], a[160:163], v[68:71]
s_waitcnt lgkmcnt(2)
v_mfma_f32_16x16x32_bf16 v[72:75], a[146:149], a[164:167], 0
s_nop 4
v_cvt_pk_bf16_f32 v64, v64, v65
v_mfma_f32_16x16x32_bf16 v[76:79], a[144:147], a[164:167], 0
v_cvt_pk_bf16_f32 v66, v66, v67
v_cvt_pk_bf16_f32 v68, v68, v69
v_mfma_f32_16x16x32_bf16 v[72:75], a[150:153], a[164:167], v[72:75]
v_cvt_pk_bf16_f32 v70, v70, v71
v_accvgpr_write_b32 a160, v64
v_mfma_f32_16x16x32_bf16 v[76:79], a[148:151], a[164:167], v[76:79]
v_accvgpr_write_b32 a161, v66
v_accvgpr_write_b32 a162, v68
s_waitcnt lgkmcnt(1)
v_mfma_f32_16x16x32_bf16 v[80:83], a[146:149], a[168:171], 0
v_accvgpr_write_b32 a163, v70
v_cvt_pk_bf16_f32 v72, v72, v73
v_mfma_f32_16x16x32_bf16 v[84:87], a[144:147], a[168:171], 0
v_cvt_pk_bf16_f32 v74, v74, v75
v_cvt_pk_bf16_f32 v76, v76, v77
v_mfma_f32_16x16x32_bf16 v[80:83], a[150:153], a[168:171], v[80:83]
v_cvt_pk_bf16_f32 v78, v78, v79
v_accvgpr_write_b32 a164, v72
v_mfma_f32_16x16x32_bf16 v[84:87], a[148:151], a[168:171], v[84:87]
s_waitcnt lgkmcnt(0)
s_waitcnt vmcnt(4)
s_barrier
v_mfma_f32_16x16x32_bf16 v[88:91], a[146:149], a[172:175], 0
buffer_load_dwordx4 v3, s[4:7], s27 offen lds
v_mfma_f32_16x16x32_bf16 v[92:95], a[144:147], a[172:175], 0
buffer_load_dwordx4 v4, s[4:7], s27 offen offset:1056 lds
v_mfma_f32_16x16x32_bf16 v[88:91], a[150:153], a[172:175], v[88:91]
ds_read_b128 a[0:3], v1 offset:0
ds_read_b128 a[4:7], v1 offset:64
v_mfma_f32_16x16x32_bf16 v[92:95], a[148:151], a[172:175], v[92:95]
ds_read_b128 a[8:11], v1 offset:128
ds_read_b128 a[12:15], v1 offset:192
ds_read_b128 a[16:19], v1 offset:512
v_accvgpr_write_b32 a165, v74
buffer_load_dwordx4 v3, s[8:11], s27 offen offset:2080 lds
ds_read_b128 a[20:23], v1 offset:576
v_accvgpr_write_b32 a166, v76
v_accvgpr_write_b32 a167, v78
v_cvt_pk_bf16_f32 v80, v80, v81
ds_read_b128 a[24:27], v1 offset:640
v_cvt_pk_bf16_f32 v82, v82, v83
v_cvt_pk_bf16_f32 v84, v84, v85
v_cvt_pk_bf16_f32 v86, v86, v87
ds_read_b128 a[28:31], v1 offset:704
v_add_u32 v1, 16640, v1
v_accvgpr_write_b32 a168, v80
v_accvgpr_write_b32 a169, v82
ds_read_b64_tr_b16 a[64:65], v2 offset:0
v_accvgpr_write_b32 a170, v84
buffer_load_dwordx4 v4, s[8:11], s27 offen offset:3136 lds
ds_read_b64_tr_b16 a[66:67], v2 offset:512
ds_read_b64_tr_b16 a[68:69], v2 offset:32
ds_read_b64_tr_b16 a[70:71], v2 offset:544
s_add_u32 m0, s28, 66560
s_waitcnt lgkmcnt(11)
v_mfma_f32_16x16x32_bf16 v[24:27], a[0:3], a[160:163], v[16:19]
s_add_u32 s27, s27, 262144
ds_read_b64_tr_b16 a[72:73], v2 offset:64
ds_read_b64_tr_b16 a[74:75], v2 offset:576
s_waitcnt lgkmcnt(12)
v_mfma_f32_16x16x32_bf16 v[24:27], a[4:7], a[164:167], v[24:27]
ds_read_b64_tr_b16 a[76:77], v2 offset:96
ds_read_b64_tr_b16 a[78:79], v2 offset:608
ds_read_b64_tr_b16 a[80:81], v2 offset:128
v_accvgpr_write_b32 a171, v86
ds_read_b64_tr_b16 a[82:83], v2 offset:640
v_cvt_pk_bf16_f32 v88, v88, v89
s_waitcnt lgkmcnt(15)
v_mfma_f32_16x16x32_bf16 v[24:27], a[8:11], a[168:171], v[24:27]
ds_read_b64_tr_b16 a[84:85], v2 offset:160
ds_read_b64_tr_b16 a[86:87], v2 offset:672
ds_read_b64_tr_b16 a[88:89], v2 offset:192
v_cvt_pk_bf16_f32 v90, v90, v91
ds_read_b64_tr_b16 a[90:91], v2 offset:704
v_cvt_pk_bf16_f32 v92, v92, v93
ds_read_b64_tr_b16 a[92:93], v2 offset:224
v_cvt_pk_bf16_f32 v94, v94, v95
ds_read_b64_tr_b16 a[94:95], v2 offset:736
v_add_u32 v2, 16640, v2
v_accvgpr_write_b32 a172, v88
v_accvgpr_write_b32 a173, v90
v_accvgpr_write_b32 a174, v92
v_accvgpr_write_b32 a175, v94
s_waitcnt lgkmcnt(15)
s_nop 0
v_mfma_f32_16x16x32_bf16 v[24:27], a[12:15], a[172:175], v[24:27]
s_nop 7
v_exp_f32 v24, v24
v_exp_f32 v25, v25
v_exp_f32 v26, v26
v_exp_f32 v27, v27
v_cvt_pk_bf16_f32 v40, v24, v25
v_cvt_pk_bf16_f32 v41, v26, v27
s_waitcnt lgkmcnt(0)
s_waitcnt vmcnt(4)
s_barrier
buffer_load_dwordx4 v3, s[4:7], s27 offen lds
buffer_load_dwordx4 v4, s[4:7], s27 offen offset:1056 lds
ds_read_b128 a[32:35], v1 offset:0
ds_read_b128 a[36:39], v1 offset:64
ds_read_b128 a[40:43], v1 offset:128
ds_read_b128 a[44:47], v1 offset:192
ds_read_b128 a[48:51], v1 offset:512
ds_read_b128 a[52:55], v1 offset:576
buffer_load_dwordx4 v3, s[8:11], s27 offen offset:2080 lds
ds_read_b128 a[56:59], v1 offset:640
ds_read_b128 a[60:63], v1 offset:704
v_add_u32 v1, -33280, v1
ds_read_b64_tr_b16 a[96:97], v2 offset:0
ds_read_b64_tr_b16 a[98:99], v2 offset:512
ds_read_b64_tr_b16 a[100:101], v2 offset:32
buffer_load_dwordx4 v4, s[8:11], s27 offen offset:3136 lds
s_waitcnt lgkmcnt(10)
v_mfma_f32_16x16x32_bf16 v[32:35], a[32:35], a[160:163], 0
s_add_u32 m0, s28, 83200
s_add_u32 s27, s27, 262144
ds_read_b64_tr_b16 a[102:103], v2 offset:544
s_waitcnt lgkmcnt(10)
v_mfma_f32_16x16x32_bf16 v[32:35], a[36:39], a[164:167], v[32:35]
ds_read_b64_tr_b16 a[104:105], v2 offset:64
ds_read_b64_tr_b16 a[106:107], v2 offset:576
s_waitcnt lgkmcnt(11)
v_mfma_f32_16x16x32_bf16 v[32:35], a[40:43], a[168:171], v[32:35]
ds_read_b64_tr_b16 a[108:109], v2 offset:96
ds_read_b64_tr_b16 a[110:111], v2 offset:608
s_waitcnt lgkmcnt(12)
v_mfma_f32_16x16x32_bf16 v[32:35], a[44:47], a[172:175], v[32:35]
ds_read_b64_tr_b16 a[112:113], v2 offset:128
ds_read_b64_tr_b16 a[114:115], v2 offset:640
ds_read_b64_tr_b16 a[116:117], v2 offset:160
ds_read_b64_tr_b16 a[118:119], v2 offset:672
ds_read_b64_tr_b16 a[120:121], v2 offset:192
ds_read_b64_tr_b16 a[122:123], v2 offset:704
ds_read_b64_tr_b16 a[124:125], v2 offset:224
ds_read_b64_tr_b16 a[126:127], v2 offset:736
s_waitcnt lgkmcnt(15)
v_mfma_f32_16x16x32_bf16 v[36:39], a[60:63], a[172:175], 0
v_exp_f32 v32, v32
v_mfma_f32_16x16x32_bf16 v[36:39], a[56:59], a[168:171], v[36:39]
v_exp_f32 v33, v33
v_mfma_f32_16x16x32_bf16 v[36:39], a[52:55], a[164:167], v[36:39]
v_exp_f32 v34, v34
v_mfma_f32_16x16x32_bf16 v[36:39], a[48:51], a[160:163], v[36:39]
v_exp_f32 v35, v35
v_mfma_f32_16x16x32_bf16 v[64:67], v[40:43], a[64:67], 0
v_cvt_pk_bf16_f32 v44, v32, v33
v_cvt_pk_bf16_f32 v45, v34, v35
v_mfma_f32_16x16x32_bf16 v[68:71], v[40:43], a[68:71], 0
v_add_u32 v2, -33280, v2
s_nop 1
v_exp_f32 v36, v36
v_mfma_f32_16x16x32_bf16 v[72:75], v[40:43], a[72:75], 0
v_exp_f32 v37, v37
v_mfma_f32_16x16x32_bf16 v[76:79], v[40:43], a[76:79], 0
v_exp_f32 v38, v38
v_mfma_f32_16x16x32_bf16 v[80:83], v[40:43], a[80:83], 0
v_exp_f32 v39, v39
v_mfma_f32_16x16x32_bf16 v[84:87], v[40:43], a[84:87], 0
v_cvt_pk_bf16_f32 v46, v36, v37
v_cvt_pk_bf16_f32 v47, v38, v39
v_mfma_f32_16x16x32_bf16 v[88:91], v[40:43], a[88:91], 0
v_mfma_f32_16x16x32_bf16 v[92:95], v[40:43], a[92:95], 0
v_mfma_f32_16x16x32_bf16 a[132:135], a[128:131], v[40:43], 0
s_waitcnt vmcnt(4)
buffer_load_dwordx4 v3, s[4:7], s27 offen lds
buffer_load_dwordx4 v4, s[4:7], s27 offen offset:1056 lds
ds_read_b128 a[176:179], v11 offset:0
ds_read_b128 a[180:183], v11 offset:64
ds_read_b128 a[184:187], v11 offset:128
ds_read_b128 a[188:191], v11 offset:192
v_add_u32 v11, 16640, v11
buffer_load_dwordx4 v3, s[8:11], s27 offen offset:2080 lds
buffer_load_dwordx4 v4, s[8:11], s27 offen offset:3136 lds
s_waitcnt lgkmcnt(3)
v_mfma_f32_16x16x32_bf16 v[96:99], a[146:149], a[176:179], 0
s_add_u32 m0, s28, 99840
s_add_u32 s27, s27, 262144
v_mfma_f32_16x16x32_bf16 v[100:103], a[144:147], a[176:179], 0
v_mfma_f32_16x16x32_bf16 v[96:99], a[150:153], a[176:179], v[96:99]
v_mfma_f32_16x16x32_bf16 v[100:103], a[148:151], a[176:179], v[100:103]
s_waitcnt lgkmcnt(2)
v_mfma_f32_16x16x32_bf16 v[104:107], a[146:149], a[180:183], 0
s_nop 4
v_cvt_pk_bf16_f32 v96, v96, v97
v_mfma_f32_16x16x32_bf16 v[108:111], a[144:147], a[180:183], 0
v_cvt_pk_bf16_f32 v98, v98, v99
v_cvt_pk_bf16_f32 v100, v100, v101
v_mfma_f32_16x16x32_bf16 v[104:107], a[150:153], a[180:183], v[104:107]
v_cvt_pk_bf16_f32 v102, v102, v103
v_accvgpr_write_b32 a176, v96
v_mfma_f32_16x16x32_bf16 v[108:111], a[148:151], a[180:183], v[108:111]
v_accvgpr_write_b32 a177, v98
v_accvgpr_write_b32 a178, v100
s_waitcnt lgkmcnt(1)
v_mfma_f32_16x16x32_bf16 v[112:115], a[146:149], a[184:187], 0
v_accvgpr_write_b32 a179, v102
v_cvt_pk_bf16_f32 v104, v104, v105
v_mfma_f32_16x16x32_bf16 v[116:119], a[144:147], a[184:187], 0
v_cvt_pk_bf16_f32 v106, v106, v107
v_cvt_pk_bf16_f32 v108, v108, v109
v_mfma_f32_16x16x32_bf16 v[112:115], a[150:153], a[184:187], v[112:115]
v_cvt_pk_bf16_f32 v110, v110, v111
v_accvgpr_write_b32 a180, v104
v_mfma_f32_16x16x32_bf16 v[116:119], a[148:151], a[184:187], v[116:119]
v_accvgpr_write_b32 a181, v106
v_accvgpr_write_b32 a182, v108
s_waitcnt lgkmcnt(0)
v_mfma_f32_16x16x32_bf16 v[120:123], a[146:149], a[188:191], 0
v_accvgpr_write_b32 a183, v110
v_cvt_pk_bf16_f32 v112, v112, v113
v_mfma_f32_16x16x32_bf16 v[124:127], a[144:147], a[188:191], 0
v_cvt_pk_bf16_f32 v114, v114, v115
v_cvt_pk_bf16_f32 v116, v116, v117
v_mfma_f32_16x16x32_bf16 v[120:123], a[150:153], a[188:191], v[120:123]
v_cvt_pk_bf16_f32 v118, v118, v119
v_accvgpr_write_b32 a184, v112
v_mfma_f32_16x16x32_bf16 v[124:127], a[148:151], a[188:191], v[124:127]
v_accvgpr_write_b32 a185, v114
v_accvgpr_write_b32 a186, v116
v_mfma_f32_16x16x32_bf16 v[24:27], a[0:3], a[176:179], v[16:19]
v_accvgpr_write_b32 a187, v118
s_nop 0
v_cvt_pk_bf16_f32 v120, v120, v121
v_mfma_f32_16x16x32_bf16 v[24:27], a[4:7], a[180:183], v[24:27]
v_cvt_pk_bf16_f32 v122, v122, v123
v_cvt_pk_bf16_f32 v124, v124, v125
v_mfma_f32_16x16x32_bf16 v[24:27], a[8:11], a[184:187], v[24:27]
v_cvt_pk_bf16_f32 v126, v126, v127
v_accvgpr_write_b32 a188, v120
v_accvgpr_write_b32 a189, v122
v_accvgpr_write_b32 a190, v124
v_accvgpr_write_b32 a191, v126
s_nop 1
v_mfma_f32_16x16x32_bf16 v[24:27], a[12:15], a[188:191], v[24:27]
v_mfma_f32_16x16x32_bf16 v[64:67], v[44:47], a[96:99], v[64:67]
v_mfma_f32_16x16x32_bf16 v[68:71], v[44:47], a[100:103], v[68:71]
s_nop 5
v_exp_f32 v24, v24
v_mfma_f32_16x16x32_bf16 v[72:75], v[44:47], a[104:107], v[72:75]
v_exp_f32 v25, v25
v_mfma_f32_16x16x32_bf16 v[76:79], v[44:47], a[108:111], v[76:79]
v_exp_f32 v26, v26
v_mfma_f32_16x16x32_bf16 v[80:83], v[44:47], a[112:115], v[80:83]
v_exp_f32 v27, v27
v_mfma_f32_16x16x32_bf16 v[84:87], v[44:47], a[116:119], v[84:87]
v_cvt_pk_bf16_f32 v40, v24, v25
v_cvt_pk_bf16_f32 v41, v26, v27
v_mfma_f32_16x16x32_bf16 v[88:91], v[44:47], a[120:123], v[88:91]
v_mov_b32 v48, v24
v_mov_b32 v49, v25
v_mfma_f32_16x16x32_bf16 v[92:95], v[44:47], a[124:127], v[92:95]
v_add_f32 v48, v48, v26
v_add_f32 v49, v49, v27
v_mfma_f32_16x16x32_bf16 a[132:135], a[128:131], v[44:47], a[132:135]
v_mfma_f32_16x16x32_bf16 v[32:35], a[32:35], a[176:179], 0
v_mfma_f32_16x16x32_bf16 v[32:35], a[36:39], a[180:183], v[32:35]
v_mfma_f32_16x16x32_bf16 v[32:35], a[40:43], a[184:187], v[32:35]
v_mfma_f32_16x16x32_bf16 v[32:35], a[44:47], a[188:191], v[32:35]
v_mfma_f32_16x16x32_bf16 v[36:39], a[60:63], a[188:191], 0
v_mfma_f32_16x16x32_bf16 v[36:39], a[56:59], a[184:187], v[36:39]
s_nop 5
v_exp_f32 v32, v32
v_mfma_f32_16x16x32_bf16 v[36:39], a[52:55], a[180:183], v[36:39]
v_exp_f32 v33, v33
v_mfma_f32_16x16x32_bf16 v[36:39], a[48:51], a[176:179], v[36:39]
v_exp_f32 v34, v34
v_mfma_f32_16x16x32_bf16 v[96:99], v[40:43], a[64:67], 0
v_exp_f32 v35, v35
v_mfma_f32_16x16x32_bf16 v[100:103], v[40:43], a[68:71], 0
v_cvt_pk_bf16_f32 v44, v32, v33
s_nop 2
v_exp_f32 v36, v36
v_mfma_f32_16x16x32_bf16 v[104:107], v[40:43], a[72:75], 0
s_waitcnt vmcnt(4)
buffer_load_dwordx4 v3, s[4:7], s27 offen lds
v_mfma_f32_16x16x32_bf16 v[108:111], v[40:43], a[76:79], 0
buffer_load_dwordx4 v4, s[4:7], s27 offen offset:1056 lds
v_mfma_f32_16x16x32_bf16 v[112:115], v[40:43], a[80:83], 0
ds_read_b128 a[192:195], v11 offset:0
ds_read_b128 a[196:199], v11 offset:64
v_mfma_f32_16x16x32_bf16 v[116:119], v[40:43], a[84:87], 0
ds_read_b128 a[200:203], v11 offset:128
ds_read_b128 a[204:207], v11 offset:192
v_mfma_f32_16x16x32_bf16 v[120:123], v[40:43], a[88:91], 0
buffer_load_dwordx4 v3, s[8:11], s27 offen offset:2080 lds
v_mfma_f32_16x16x32_bf16 v[124:127], v[40:43], a[92:95], 0
v_add_u32 v11, 16640, v11
v_exp_f32 v37, v37
v_exp_f32 v38, v38
v_exp_f32 v39, v39
v_cvt_pk_bf16_f32 v45, v34, v35
v_cvt_pk_bf16_f32 v46, v36, v37
v_cvt_pk_bf16_f32 v47, v38, v39
v_add_f32 v48, v48, v32
v_add_f32 v49, v49, v33
buffer_load_dwordx4 v4, s[8:11], s27 offen offset:3136 lds
s_add_u32 m0, s28, 116480
s_add_u32 s27, s27, 262144
v_add_f32 v48, v48, v34
v_add_f32 v49, v49, v35
s_waitcnt lgkmcnt(3)
v_mfma_f32_16x16x32_bf16 v[128:131], a[146:149], a[192:195], 0
v_add_f32 v48, v48, v36
v_add_f32 v49, v49, v37
v_mfma_f32_16x16x32_bf16 v[132:135], a[144:147], a[192:195], 0
v_add_f32 v48, v48, v38
v_add_f32 v49, v49, v39
v_mfma_f32_16x16x32_bf16 v[128:131], a[150:153], a[192:195], v[128:131]
v_mfma_f32_16x16x32_bf16 v[132:135], a[148:151], a[192:195], v[132:135]
s_waitcnt lgkmcnt(2)
v_mfma_f32_16x16x32_bf16 v[136:139], a[146:149], a[196:199], 0
s_nop 4
v_cvt_pk_bf16_f32 v128, v128, v129
v_mfma_f32_16x16x32_bf16 v[140:143], a[144:147], a[196:199], 0
v_cvt_pk_bf16_f32 v130, v130, v131
v_cvt_pk_bf16_f32 v132, v132, v133
v_mfma_f32_16x16x32_bf16 v[136:139], a[150:153], a[196:199], v[136:139]
v_cvt_pk_bf16_f32 v134, v134, v135
v_accvgpr_write_b32 a192, v128
v_mfma_f32_16x16x32_bf16 v[140:143], a[148:151], a[196:199], v[140:143]
v_accvgpr_write_b32 a193, v130
v_accvgpr_write_b32 a194, v132
s_waitcnt lgkmcnt(1)
v_mfma_f32_16x16x32_bf16 v[144:147], a[146:149], a[200:203], 0
v_accvgpr_write_b32 a195, v134
v_cvt_pk_bf16_f32 v136, v136, v137
v_mfma_f32_16x16x32_bf16 v[148:151], a[144:147], a[200:203], 0
v_cvt_pk_bf16_f32 v138, v138, v139
v_cvt_pk_bf16_f32 v140, v140, v141
v_mfma_f32_16x16x32_bf16 v[144:147], a[150:153], a[200:203], v[144:147]
v_cvt_pk_bf16_f32 v142, v142, v143
v_accvgpr_write_b32 a196, v136
v_mfma_f32_16x16x32_bf16 v[148:151], a[148:151], a[200:203], v[148:151]
v_accvgpr_write_b32 a197, v138
v_accvgpr_write_b32 a198, v140
s_waitcnt lgkmcnt(0)
v_mfma_f32_16x16x32_bf16 v[152:155], a[146:149], a[204:207], 0
v_accvgpr_write_b32 a199, v142
v_cvt_pk_bf16_f32 v144, v144, v145
v_mfma_f32_16x16x32_bf16 v[156:159], a[144:147], a[204:207], 0
v_cvt_pk_bf16_f32 v146, v146, v147
v_cvt_pk_bf16_f32 v148, v148, v149
v_mfma_f32_16x16x32_bf16 v[152:155], a[150:153], a[204:207], v[152:155]
v_cvt_pk_bf16_f32 v150, v150, v151
v_accvgpr_write_b32 a200, v144
v_mfma_f32_16x16x32_bf16 v[156:159], a[148:151], a[204:207], v[156:159]
v_accvgpr_write_b32 a201, v146
v_accvgpr_write_b32 a202, v148
v_mfma_f32_16x16x32_bf16 v[24:27], a[0:3], a[192:195], v[16:19]
v_accvgpr_write_b32 a203, v150
s_nop 0
v_cvt_pk_bf16_f32 v152, v152, v153
v_mfma_f32_16x16x32_bf16 v[24:27], a[4:7], a[196:199], v[24:27]
v_cvt_pk_bf16_f32 v154, v154, v155
v_cvt_pk_bf16_f32 v156, v156, v157
v_mfma_f32_16x16x32_bf16 v[24:27], a[8:11], a[200:203], v[24:27]
v_cvt_pk_bf16_f32 v158, v158, v159
v_accvgpr_write_b32 a204, v152
v_accvgpr_write_b32 a205, v154
v_accvgpr_write_b32 a206, v156
v_accvgpr_write_b32 a207, v158
s_nop 1
v_mfma_f32_16x16x32_bf16 v[24:27], a[12:15], a[204:207], v[24:27]
v_mfma_f32_16x16x32_bf16 v[96:99], v[44:47], a[96:99], v[96:99]
v_mfma_f32_16x16x32_bf16 v[100:103], v[44:47], a[100:103], v[100:103]
s_nop 5
v_exp_f32 v24, v24
v_mfma_f32_16x16x32_bf16 v[104:107], v[44:47], a[104:107], v[104:107]
v_exp_f32 v25, v25
v_mfma_f32_16x16x32_bf16 v[108:111], v[44:47], a[108:111], v[108:111]
v_exp_f32 v26, v26
v_mfma_f32_16x16x32_bf16 v[112:115], v[44:47], a[112:115], v[112:115]
v_exp_f32 v27, v27
v_mfma_f32_16x16x32_bf16 v[116:119], v[44:47], a[116:119], v[116:119]
v_cvt_pk_bf16_f32 v40, v24, v25
v_cvt_pk_bf16_f32 v41, v26, v27
v_mfma_f32_16x16x32_bf16 v[120:123], v[44:47], a[120:123], v[120:123]
v_mov_b32 v50, v24
v_mov_b32 v51, v25
v_mfma_f32_16x16x32_bf16 v[124:127], v[44:47], a[124:127], v[124:127]
v_add_f32 v50, v50, v26
v_add_f32 v51, v51, v27
v_mfma_f32_16x16x32_bf16 v[32:35], a[32:35], a[192:195], 0
v_mfma_f32_16x16x32_bf16 v[32:35], a[36:39], a[196:199], v[32:35]
v_mfma_f32_16x16x32_bf16 v[32:35], a[40:43], a[200:203], v[32:35]
v_mfma_f32_16x16x32_bf16 v[32:35], a[44:47], a[204:207], v[32:35]
v_mfma_f32_16x16x32_bf16 v[36:39], a[60:63], a[204:207], 0
v_mfma_f32_16x16x32_bf16 v[36:39], a[56:59], a[200:203], v[36:39]
s_nop 5
v_exp_f32 v32, v32
v_mfma_f32_16x16x32_bf16 v[36:39], a[52:55], a[196:199], v[36:39]
v_exp_f32 v33, v33
v_mfma_f32_16x16x32_bf16 v[36:39], a[48:51], a[192:195], v[36:39]
v_exp_f32 v34, v34
v_mfma_f32_16x16x32_bf16 v[128:131], v[40:43], a[64:67], 0
v_exp_f32 v35, v35
v_mfma_f32_16x16x32_bf16 v[132:135], v[40:43], a[68:71], 0
v_cvt_pk_bf16_f32 v44, v32, v33
s_nop 2
v_exp_f32 v36, v36
v_mfma_f32_16x16x32_bf16 v[136:139], v[40:43], a[72:75], 0
s_waitcnt vmcnt(4)
buffer_load_dwordx4 v3, s[4:7], s27 offen lds
v_mfma_f32_16x16x32_bf16 v[140:143], v[40:43], a[76:79], 0
buffer_load_dwordx4 v4, s[4:7], s27 offen offset:1056 lds
v_mfma_f32_16x16x32_bf16 v[144:147], v[40:43], a[80:83], 0
s_mov_b64 s[4:5], s[18:19]
ds_read_b128 a[208:211], v11 offset:0
ds_read_b128 a[212:215], v11 offset:64
v_mfma_f32_16x16x32_bf16 v[148:151], v[40:43], a[84:87], 0
ds_read_b128 a[216:219], v11 offset:128
ds_read_b128 a[220:223], v11 offset:192
v_mfma_f32_16x16x32_bf16 v[152:155], v[40:43], a[88:91], 0
buffer_load_dwordx4 v3, s[8:11], s27 offen offset:2080 lds
v_mfma_f32_16x16x32_bf16 v[156:159], v[40:43], a[92:95], 0
v_add_u32 v11, 16640, v11
v_exp_f32 v37, v37
v_exp_f32 v38, v38
v_exp_f32 v39, v39
v_cvt_pk_bf16_f32 v45, v34, v35
v_cvt_pk_bf16_f32 v46, v36, v37
v_cvt_pk_bf16_f32 v47, v38, v39
v_add_f32 v50, v50, v32
v_add_f32 v51, v51, v33
buffer_load_dwordx4 v4, s[8:11], s27 offen offset:3136 lds
s_add_u32 m0, s28, 0
s_mov_b64 s[8:9], s[20:21]
s_add_u32 s10, s38, 2080
v_add_f32 v50, v50, v34
s_waitcnt lgkmcnt(3)
v_mfma_f32_16x16x32_bf16 v[160:163], a[146:149], a[208:211], 0
s_add_u32 s27, s27, 262144
v_add_f32 v51, v51, v35
v_add_f32 v50, v50, v36
v_mfma_f32_16x16x32_bf16 v[164:167], a[144:147], a[208:211], 0
v_add_f32 v51, v51, v37
v_add_f32 v50, v50, v38
v_mfma_f32_16x16x32_bf16 v[160:163], a[150:153], a[208:211], v[160:163]
v_add_f32 v51, v51, v39
v_mfma_f32_16x16x32_bf16 v[164:167], a[148:151], a[208:211], v[164:167]
s_waitcnt lgkmcnt(2)
v_mfma_f32_16x16x32_bf16 v[168:171], a[146:149], a[212:215], 0
s_nop 3
v_cvt_pk_bf16_f32 v160, v160, v161
v_mfma_f32_16x16x32_bf16 v[172:175], a[144:147], a[212:215], 0
v_cvt_pk_bf16_f32 v162, v162, v163
v_cvt_pk_bf16_f32 v164, v164, v165
v_mfma_f32_16x16x32_bf16 v[168:171], a[150:153], a[212:215], v[168:171]
v_cvt_pk_bf16_f32 v166, v166, v167
v_accvgpr_write_b32 a208, v160
v_mfma_f32_16x16x32_bf16 v[172:175], a[148:151], a[212:215], v[172:175]
v_accvgpr_write_b32 a209, v162
v_accvgpr_write_b32 a210, v164
s_waitcnt lgkmcnt(1)
v_mfma_f32_16x16x32_bf16 v[176:179], a[146:149], a[216:219], 0
v_accvgpr_write_b32 a211, v166
v_cvt_pk_bf16_f32 v168, v168, v169
v_mfma_f32_16x16x32_bf16 v[180:183], a[144:147], a[216:219], 0
v_cvt_pk_bf16_f32 v170, v170, v171
v_cvt_pk_bf16_f32 v172, v172, v173
v_mfma_f32_16x16x32_bf16 v[176:179], a[150:153], a[216:219], v[176:179]
v_cvt_pk_bf16_f32 v174, v174, v175
v_accvgpr_write_b32 a212, v168
v_mfma_f32_16x16x32_bf16 v[180:183], a[148:151], a[216:219], v[180:183]
v_accvgpr_write_b32 a213, v170
v_accvgpr_write_b32 a214, v172
s_waitcnt lgkmcnt(0)
v_mfma_f32_16x16x32_bf16 v[184:187], a[146:149], a[220:223], 0
v_accvgpr_write_b32 a215, v174
v_cvt_pk_bf16_f32 v176, v176, v177
v_mfma_f32_16x16x32_bf16 v[188:191], a[144:147], a[220:223], 0
v_cvt_pk_bf16_f32 v178, v178, v179
v_cvt_pk_bf16_f32 v180, v180, v181
v_mfma_f32_16x16x32_bf16 v[184:187], a[150:153], a[220:223], v[184:187]
v_cvt_pk_bf16_f32 v182, v182, v183
v_accvgpr_write_b32 a216, v176
v_mfma_f32_16x16x32_bf16 v[188:191], a[148:151], a[220:223], v[188:191]
v_accvgpr_write_b32 a217, v178
v_accvgpr_write_b32 a218, v180
v_mfma_f32_16x16x32_bf16 v[24:27], a[0:3], a[208:211], v[16:19]
v_accvgpr_write_b32 a219, v182
s_nop 0
v_cvt_pk_bf16_f32 v184, v184, v185
v_mfma_f32_16x16x32_bf16 v[24:27], a[4:7], a[212:215], v[24:27]
v_cvt_pk_bf16_f32 v186, v186, v187
v_cvt_pk_bf16_f32 v188, v188, v189
v_mfma_f32_16x16x32_bf16 v[24:27], a[8:11], a[216:219], v[24:27]
v_cvt_pk_bf16_f32 v190, v190, v191
v_accvgpr_write_b32 a220, v184
v_accvgpr_write_b32 a221, v186
v_accvgpr_write_b32 a222, v188
v_accvgpr_write_b32 a223, v190
s_nop 1
v_mfma_f32_16x16x32_bf16 v[24:27], a[12:15], a[220:223], v[24:27]
v_mfma_f32_16x16x32_bf16 v[128:131], v[44:47], a[96:99], v[128:131]
v_mfma_f32_16x16x32_bf16 v[132:135], v[44:47], a[100:103], v[132:135]
s_nop 5
v_exp_f32 v24, v24
v_mfma_f32_16x16x32_bf16 v[136:139], v[44:47], a[104:107], v[136:139]
v_exp_f32 v25, v25
v_mfma_f32_16x16x32_bf16 v[140:143], v[44:47], a[108:111], v[140:143]
v_exp_f32 v26, v26
v_mfma_f32_16x16x32_bf16 v[144:147], v[44:47], a[112:115], v[144:147]
v_exp_f32 v27, v27
v_mfma_f32_16x16x32_bf16 v[148:151], v[44:47], a[116:119], v[148:151]
v_cvt_pk_bf16_f32 v40, v24, v25
v_cvt_pk_bf16_f32 v41, v26, v27
v_mfma_f32_16x16x32_bf16 v[152:155], v[44:47], a[120:123], v[152:155]
v_mfma_f32_16x16x32_bf16 v[156:159], v[44:47], a[124:127], v[156:159]
v_mfma_f32_16x16x32_bf16 v[32:35], a[32:35], a[208:211], 0
v_mfma_f32_16x16x32_bf16 v[32:35], a[36:39], a[212:215], v[32:35]
v_mfma_f32_16x16x32_bf16 v[32:35], a[40:43], a[216:219], v[32:35]
v_mfma_f32_16x16x32_bf16 v[32:35], a[44:47], a[220:223], v[32:35]
v_mfma_f32_16x16x32_bf16 v[36:39], a[60:63], a[220:223], 0
v_mfma_f32_16x16x32_bf16 v[36:39], a[56:59], a[216:219], v[36:39]
s_nop 5
v_exp_f32 v32, v32
v_mfma_f32_16x16x32_bf16 v[36:39], a[52:55], a[212:215], v[36:39]
v_exp_f32 v33, v33
v_mfma_f32_16x16x32_bf16 v[36:39], a[48:51], a[208:211], v[36:39]
v_exp_f32 v34, v34
v_mfma_f32_16x16x32_bf16 v[160:163], v[40:43], a[64:67], 0
v_exp_f32 v35, v35
v_mfma_f32_16x16x32_bf16 v[164:167], v[40:43], a[68:71], 0
v_cvt_pk_bf16_f32 v44, v32, v33
s_nop 2
v_exp_f32 v36, v36
v_mfma_f32_16x16x32_bf16 v[168:171], v[40:43], a[72:75], 0
s_waitcnt vmcnt(4)
buffer_load_dwordx4 v3, s[4:7], s24 offen lds
v_mfma_f32_16x16x32_bf16 v[172:175], v[40:43], a[76:79], 0
buffer_load_dwordx4 v4, s[4:7], s24 offen offset:1056 lds
v_mfma_f32_16x16x32_bf16 v[176:179], v[40:43], a[80:83], 0
ds_read_b128 a[224:227], v11 offset:0
ds_read_b128 a[228:231], v11 offset:64
v_mfma_f32_16x16x32_bf16 v[180:183], v[40:43], a[84:87], 0
ds_read_b128 a[232:235], v11 offset:128
ds_read_b128 a[236:239], v11 offset:192
v_mfma_f32_16x16x32_bf16 v[184:187], v[40:43], a[88:91], 0
buffer_load_dwordx4 v3, s[8:11], s24 offen offset:2080 lds
v_mfma_f32_16x16x32_bf16 v[188:191], v[40:43], a[92:95], 0
v_add_u32 v11, 16640, v11
v_exp_f32 v37, v37
v_mfma_f32_16x16x32_bf16 a[136:139], a[128:131], v[40:43], 0
v_exp_f32 v38, v38
v_exp_f32 v39, v39
v_cvt_pk_bf16_f32 v45, v34, v35
v_cvt_pk_bf16_f32 v46, v36, v37
v_cvt_pk_bf16_f32 v47, v38, v39
buffer_load_dwordx4 v4, s[8:11], s24 offen offset:3136 lds
s_add_u32 m0, s28, 16640
s_add_u32 s24, s24, -131072
s_waitcnt lgkmcnt(3)
v_mfma_f32_16x16x32_bf16 v[192:195], a[146:149], a[224:227], 0
v_mfma_f32_16x16x32_bf16 v[196:199], a[144:147], a[224:227], 0
v_mfma_f32_16x16x32_bf16 v[192:195], a[150:153], a[224:227], v[192:195]
v_mfma_f32_16x16x32_bf16 v[196:199], a[148:151], a[224:227], v[196:199]
s_waitcnt lgkmcnt(2)
v_mfma_f32_16x16x32_bf16 v[200:203], a[146:149], a[228:231], 0
s_nop 4
v_cvt_pk_bf16_f32 v192, v192, v193
v_mfma_f32_16x16x32_bf16 v[204:207], a[144:147], a[228:231], 0
v_cvt_pk_bf16_f32 v194, v194, v195
v_cvt_pk_bf16_f32 v196, v196, v197
v_mfma_f32_16x16x32_bf16 v[200:203], a[150:153], a[228:231], v[200:203]
v_cvt_pk_bf16_f32 v198, v198, v199
v_accvgpr_write_b32 a224, v192
v_mfma_f32_16x16x32_bf16 v[204:207], a[148:151], a[228:231], v[204:207]
v_accvgpr_write_b32 a225, v194
v_accvgpr_write_b32 a226, v196
s_waitcnt lgkmcnt(1)
v_mfma_f32_16x16x32_bf16 v[208:211], a[146:149], a[232:235], 0
v_accvgpr_write_b32 a227, v198
v_cvt_pk_bf16_f32 v200, v200, v201
v_mfma_f32_16x16x32_bf16 v[212:215], a[144:147], a[232:235], 0
v_cvt_pk_bf16_f32 v202, v202, v203
v_cvt_pk_bf16_f32 v204, v204, v205
v_mfma_f32_16x16x32_bf16 v[208:211], a[150:153], a[232:235], v[208:211]
v_cvt_pk_bf16_f32 v206, v206, v207
v_accvgpr_write_b32 a228, v200
v_mfma_f32_16x16x32_bf16 v[212:215], a[148:151], a[232:235], v[212:215]
v_accvgpr_write_b32 a229, v202
v_accvgpr_write_b32 a230, v204
s_waitcnt lgkmcnt(0)
v_mfma_f32_16x16x32_bf16 v[216:219], a[146:149], a[236:239], 0
v_accvgpr_write_b32 a231, v206
v_cvt_pk_bf16_f32 v208, v208, v209
v_mfma_f32_16x16x32_bf16 v[220:223], a[144:147], a[236:239], 0
v_cvt_pk_bf16_f32 v210, v210, v211
v_cvt_pk_bf16_f32 v212, v212, v213
v_mfma_f32_16x16x32_bf16 v[216:219], a[150:153], a[236:239], v[216:219]
v_cvt_pk_bf16_f32 v214, v214, v215
v_accvgpr_write_b32 a232, v208
v_mfma_f32_16x16x32_bf16 v[220:223], a[148:151], a[236:239], v[220:223]
v_accvgpr_write_b32 a233, v210
v_accvgpr_write_b32 a234, v212
v_mfma_f32_16x16x32_bf16 v[24:27], a[0:3], a[224:227], v[16:19]
v_accvgpr_write_b32 a235, v214
s_nop 0
v_cvt_pk_bf16_f32 v216, v216, v217
v_mfma_f32_16x16x32_bf16 v[24:27], a[4:7], a[228:231], v[24:27]
v_cvt_pk_bf16_f32 v218, v218, v219
v_cvt_pk_bf16_f32 v220, v220, v221
v_mfma_f32_16x16x32_bf16 v[24:27], a[8:11], a[232:235], v[24:27]
v_cvt_pk_bf16_f32 v222, v222, v223
v_accvgpr_write_b32 a236, v216
v_accvgpr_write_b32 a237, v218
v_accvgpr_write_b32 a238, v220
v_accvgpr_write_b32 a239, v222
s_nop 1
v_mfma_f32_16x16x32_bf16 v[24:27], a[12:15], a[236:239], v[24:27]
v_mfma_f32_16x16x32_bf16 v[160:163], v[44:47], a[96:99], v[160:163]
v_mfma_f32_16x16x32_bf16 v[164:167], v[44:47], a[100:103], v[164:167]
s_nop 5
v_exp_f32 v24, v24
v_mfma_f32_16x16x32_bf16 v[168:171], v[44:47], a[104:107], v[168:171]
v_exp_f32 v25, v25
v_mfma_f32_16x16x32_bf16 v[172:175], v[44:47], a[108:111], v[172:175]
v_exp_f32 v26, v26
v_mfma_f32_16x16x32_bf16 v[176:179], v[44:47], a[112:115], v[176:179]
v_exp_f32 v27, v27
v_mfma_f32_16x16x32_bf16 v[180:183], v[44:47], a[116:119], v[180:183]
v_cvt_pk_bf16_f32 v40, v24, v25
v_cvt_pk_bf16_f32 v41, v26, v27
v_mfma_f32_16x16x32_bf16 v[184:187], v[44:47], a[120:123], v[184:187]
v_mov_b32 v52, v24
v_mov_b32 v53, v25
v_mfma_f32_16x16x32_bf16 v[188:191], v[44:47], a[124:127], v[188:191]
v_add_f32 v52, v52, v26
v_add_f32 v53, v53, v27
v_mfma_f32_16x16x32_bf16 a[136:139], a[128:131], v[44:47], a[136:139]
v_mfma_f32_16x16x32_bf16 v[32:35], a[32:35], a[224:227], 0
v_mfma_f32_16x16x32_bf16 v[32:35], a[36:39], a[228:231], v[32:35]
v_mfma_f32_16x16x32_bf16 v[32:35], a[40:43], a[232:235], v[32:35]
v_mfma_f32_16x16x32_bf16 v[32:35], a[44:47], a[236:239], v[32:35]
v_mfma_f32_16x16x32_bf16 v[36:39], a[60:63], a[236:239], 0
v_mfma_f32_16x16x32_bf16 v[36:39], a[56:59], a[232:235], v[36:39]
s_nop 5
v_exp_f32 v32, v32
v_mfma_f32_16x16x32_bf16 v[36:39], a[52:55], a[228:231], v[36:39]
v_exp_f32 v33, v33
v_mfma_f32_16x16x32_bf16 v[36:39], a[48:51], a[224:227], v[36:39]
v_exp_f32 v34, v34
v_mfma_f32_16x16x32_bf16 v[192:195], v[40:43], a[64:67], 0
v_exp_f32 v35, v35
v_mfma_f32_16x16x32_bf16 v[196:199], v[40:43], a[68:71], 0
s_waitcnt vmcnt(4)
buffer_load_dwordx4 v3, s[4:7], s24 offen lds
v_mfma_f32_16x16x32_bf16 v[200:203], v[40:43], a[72:75], 0
buffer_load_dwordx4 v4, s[4:7], s24 offen offset:1056 lds
v_mfma_f32_16x16x32_bf16 v[204:207], v[40:43], a[76:79], 0
ds_read_b128 a[240:243], v11 offset:0
ds_read_b128 a[244:247], v11 offset:64
v_mfma_f32_16x16x32_bf16 v[208:211], v[40:43], a[80:83], 0
ds_read_b128 a[248:251], v11 offset:128
ds_read_b128 a[252:255], v11 offset:192
v_mfma_f32_16x16x32_bf16 v[212:215], v[40:43], a[84:87], 0
buffer_load_dwordx4 v3, s[8:11], s24 offen offset:2080 lds
v_mfma_f32_16x16x32_bf16 v[216:219], v[40:43], a[88:91], 0
v_exp_f32 v36, v36
v_mfma_f32_16x16x32_bf16 v[220:223], v[40:43], a[92:95], 0
v_exp_f32 v37, v37
v_exp_f32 v38, v38
v_exp_f32 v39, v39
v_cvt_pk_bf16_f32 v44, v32, v33
v_cvt_pk_bf16_f32 v45, v34, v35
buffer_load_dwordx4 v4, s[8:11], s24 offen offset:3136 lds
s_add_u32 m0, s28, 33280
s_add_u32 s24, s24, -131072
v_cvt_pk_bf16_f32 v46, v36, v37
v_cvt_pk_bf16_f32 v47, v38, v39
s_waitcnt lgkmcnt(3)
v_mfma_f32_16x16x32_bf16 v[224:227], a[146:149], a[240:243], 0
v_add_f32 v52, v52, v32
v_add_f32 v53, v53, v33
v_mfma_f32_16x16x32_bf16 v[228:231], a[144:147], a[240:243], 0
v_add_f32 v52, v52, v34
v_add_f32 v53, v53, v35
v_mfma_f32_16x16x32_bf16 v[224:227], a[150:153], a[240:243], v[224:227]
v_add_f32 v52, v52, v36
v_add_f32 v53, v53, v37
v_mfma_f32_16x16x32_bf16 v[228:231], a[148:151], a[240:243], v[228:231]
v_add_f32 v52, v52, v38
v_add_f32 v53, v53, v39
s_waitcnt lgkmcnt(2)
v_mfma_f32_16x16x32_bf16 v[232:235], a[146:149], a[244:247], 0
s_nop 0
v_cvt_pk_bf16_f32 v224, v224, v225
v_mfma_f32_16x16x32_bf16 v[236:239], a[144:147], a[244:247], 0
v_cvt_pk_bf16_f32 v226, v226, v227
v_cvt_pk_bf16_f32 v228, v228, v229
v_mfma_f32_16x16x32_bf16 v[232:235], a[150:153], a[244:247], v[232:235]
v_cvt_pk_bf16_f32 v230, v230, v231
v_accvgpr_write_b32 a240, v224
v_mfma_f32_16x16x32_bf16 v[236:239], a[148:151], a[244:247], v[236:239]
v_accvgpr_write_b32 a241, v226
v_accvgpr_write_b32 a242, v228
s_waitcnt lgkmcnt(1)
v_mfma_f32_16x16x32_bf16 v[240:243], a[146:149], a[248:251], 0
v_accvgpr_write_b32 a243, v230
v_cvt_pk_bf16_f32 v232, v232, v233
v_mfma_f32_16x16x32_bf16 v[244:247], a[144:147], a[248:251], 0
s_waitcnt lgkmcnt(0)
s_waitcnt vmcnt(4)
s_barrier
v_mfma_f32_16x16x32_bf16 v[240:243], a[150:153], a[248:251], v[240:243]
buffer_load_dwordx4 v3, s[4:7], s24 offen lds
v_mfma_f32_16x16x32_bf16 v[244:247], a[148:151], a[248:251], v[244:247]
buffer_load_dwordx4 v4, s[4:7], s24 offen offset:1056 lds
v_mfma_f32_16x16x32_bf16 v[248:251], a[146:149], a[252:255], 0
v_cvt_pk_bf16_f32 v234, v234, v235
v_cvt_pk_bf16_f32 v236, v236, v237
v_mfma_f32_16x16x32_bf16 v[252:255], a[144:147], a[252:255], 0
v_cvt_pk_bf16_f32 v238, v238, v239
v_accvgpr_write_b32 a244, v232
v_mfma_f32_16x16x32_bf16 v[248:251], a[150:153], a[252:255], v[248:251]
buffer_load_dwordx4 v3, s[8:11], s24 offen offset:2080 lds
v_mfma_f32_16x16x32_bf16 v[252:255], a[148:151], a[252:255], v[252:255]
v_accvgpr_write_b32 a245, v234
v_accvgpr_write_b32 a246, v236
v_mfma_f32_16x16x32_bf16 v[24:27], a[0:3], a[240:243], v[16:19]
v_accvgpr_write_b32 a247, v238
v_cvt_pk_bf16_f32 v240, v240, v241
v_cvt_pk_bf16_f32 v242, v242, v243
v_mfma_f32_16x16x32_bf16 v[24:27], a[4:7], a[244:247], v[24:27]
v_cvt_pk_bf16_f32 v244, v244, v245
v_cvt_pk_bf16_f32 v246, v246, v247
v_accvgpr_write_b32 a248, v240
buffer_load_dwordx4 v4, s[8:11], s24 offen offset:3136 lds
v_accvgpr_write_b32 a249, v242
v_accvgpr_write_b32 a250, v244
v_accvgpr_write_b32 a251, v246
v_cvt_pk_bf16_f32 v248, v248, v249
v_cvt_pk_bf16_f32 v250, v250, v251
v_mfma_f32_16x16x32_bf16 v[24:27], a[8:11], a[248:251], v[24:27]
s_add_u32 m0, s28, 49920
v_cvt_pk_bf16_f32 v252, v252, v253
v_cvt_pk_bf16_f32 v254, v254, v255
v_accvgpr_write_b32 a252, v248
v_accvgpr_write_b32 a253, v250
v_accvgpr_write_b32 a254, v252
v_accvgpr_write_b32 a255, v254
ds_read_b128 a[0:3], v1 offset:0
ds_read_b128 a[4:7], v1 offset:64
v_mfma_f32_16x16x32_bf16 v[24:27], a[12:15], a[252:255], v[24:27]
s_add_u32 s24, s24, -131072
ds_read_b128 a[8:11], v1 offset:128
ds_read_b128 a[12:15], v1 offset:192
v_mfma_f32_16x16x32_bf16 v[192:195], v[44:47], a[96:99], v[192:195]
ds_read_b128 a[16:19], v1 offset:512
v_mfma_f32_16x16x32_bf16 v[196:199], v[44:47], a[100:103], v[196:199]
ds_read_b128 a[20:23], v1 offset:576
s_nop 0
v_exp_f32 v24, v24
v_mfma_f32_16x16x32_bf16 v[200:203], v[44:47], a[104:107], v[200:203]
ds_read_b128 a[24:27], v1 offset:640
v_exp_f32 v25, v25
v_mfma_f32_16x16x32_bf16 v[204:207], v[44:47], a[108:111], v[204:207]
ds_read_b128 a[28:31], v1 offset:704
v_exp_f32 v26, v26
v_mfma_f32_16x16x32_bf16 v[208:211], v[44:47], a[112:115], v[208:211]
v_exp_f32 v27, v27
v_mfma_f32_16x16x32_bf16 v[212:215], v[44:47], a[116:119], v[212:215]
v_cvt_pk_bf16_f32 v40, v24, v25
v_cvt_pk_bf16_f32 v41, v26, v27
v_mfma_f32_16x16x32_bf16 v[216:219], v[44:47], a[120:123], v[216:219]
v_mov_b32 v54, v24
v_mov_b32 v55, v25
v_mfma_f32_16x16x32_bf16 v[220:223], v[44:47], a[124:127], v[220:223]
v_add_f32 v54, v54, v26
v_add_f32 v55, v55, v27
v_mfma_f32_16x16x32_bf16 v[32:35], a[32:35], a[240:243], 0
v_add_u32 v1, 16640, v1
v_mfma_f32_16x16x32_bf16 v[32:35], a[36:39], a[244:247], v[32:35]
v_mfma_f32_16x16x32_bf16 v[32:35], a[40:43], a[248:251], v[32:35]
v_mfma_f32_16x16x32_bf16 v[32:35], a[44:47], a[252:255], v[32:35]
v_mfma_f32_16x16x32_bf16 v[36:39], a[60:63], a[252:255], 0
v_mfma_f32_16x16x32_bf16 v[36:39], a[56:59], a[248:251], v[36:39]
s_nop 5
v_exp_f32 v32, v32
v_mfma_f32_16x16x32_bf16 v[36:39], a[52:55], a[244:247], v[36:39]
v_exp_f32 v33, v33
v_mfma_f32_16x16x32_bf16 v[36:39], a[48:51], a[240:243], v[36:39]
v_exp_f32 v34, v34
v_mfma_f32_16x16x32_bf16 v[224:227], v[40:43], a[64:67], 0
ds_read_b64_tr_b16 a[64:65], v2 offset:0
ds_read_b64_tr_b16 a[66:67], v2 offset:512
v_mfma_f32_16x16x32_bf16 v[228:231], v[40:43], a[68:71], 0
ds_read_b64_tr_b16 a[68:69], v2 offset:32
ds_read_b64_tr_b16 a[70:71], v2 offset:544
v_mfma_f32_16x16x32_bf16 v[232:235], v[40:43], a[72:75], 0
ds_read_b64_tr_b16 a[72:73], v2 offset:64
ds_read_b64_tr_b16 a[74:75], v2 offset:576
v_mfma_f32_16x16x32_bf16 v[236:239], v[40:43], a[76:79], 0
ds_read_b64_tr_b16 a[76:77], v2 offset:96
ds_read_b64_tr_b16 a[78:79], v2 offset:608
v_mfma_f32_16x16x32_bf16 v[240:243], v[40:43], a[80:83], 0
ds_read_b64_tr_b16 a[80:81], v2 offset:128
ds_read_b64_tr_b16 a[82:83], v2 offset:640
v_mfma_f32_16x16x32_bf16 v[244:247], v[40:43], a[84:87], 0
ds_read_b64_tr_b16 a[84:85], v2 offset:160
ds_read_b64_tr_b16 a[86:87], v2 offset:672
v_mfma_f32_16x16x32_bf16 v[248:251], v[40:43], a[88:91], 0
ds_read_b64_tr_b16 a[88:89], v2 offset:192
ds_read_b64_tr_b16 a[90:91], v2 offset:704
v_mfma_f32_16x16x32_bf16 v[252:255], v[40:43], a[92:95], 0
ds_read_b64_tr_b16 a[92:93], v2 offset:224
ds_read_b64_tr_b16 a[94:95], v2 offset:736
s_waitcnt lgkmcnt(15)
v_mfma_f32_16x16x32_bf16 v[24:27], a[0:3], a[160:163], 0
v_exp_f32 v35, v35
v_mfma_f32_16x16x32_bf16 v[24:27], a[4:7], a[164:167], v[24:27]
v_exp_f32 v36, v36
v_mfma_f32_16x16x32_bf16 v[24:27], a[8:11], a[168:171], v[24:27]
v_exp_f32 v37, v37
v_mfma_f32_16x16x32_bf16 v[24:27], a[12:15], a[172:175], v[24:27]
v_exp_f32 v38, v38
v_mfma_f32_16x16x32_bf16 v[28:31], a[28:31], a[172:175], 0
v_exp_f32 v39, v39
v_mfma_f32_16x16x32_bf16 v[28:31], a[24:27], a[168:171], v[28:31]
v_cvt_pk_bf16_f32 v44, v32, v33
v_cvt_pk_bf16_f32 v45, v34, v35
v_mfma_f32_16x16x32_bf16 v[28:31], a[20:23], a[164:167], v[28:31]
v_cvt_pk_bf16_f32 v46, v36, v37
v_cvt_pk_bf16_f32 v47, v38, v39
v_mfma_f32_16x16x32_bf16 v[28:31], a[16:19], a[160:163], v[28:31]
s_waitcnt lgkmcnt(0)
s_waitcnt vmcnt(4)
s_barrier
v_mfma_f32_16x16x32_bf16 v[224:227], v[44:47], a[96:99], v[224:227]
buffer_load_dwordx4 v3, s[4:7], s24 offen lds
v_mfma_f32_16x16x32_bf16 v[228:231], v[44:47], a[100:103], v[228:231]
buffer_load_dwordx4 v4, s[4:7], s24 offen offset:1056 lds
v_mfma_f32_16x16x32_bf16 v[232:235], v[44:47], a[104:107], v[232:235]
v_add_f32 v54, v54, v32
v_add_f32 v55, v55, v33
v_mfma_f32_16x16x32_bf16 v[236:239], v[44:47], a[108:111], v[236:239]
v_exp_f32 v24, v24
v_mfma_f32_16x16x32_bf16 v[240:243], v[44:47], a[112:115], v[240:243]
buffer_load_dwordx4 v3, s[8:11], s24 offen offset:2080 lds
v_mfma_f32_16x16x32_bf16 v[244:247], v[44:47], a[116:119], v[244:247]
v_exp_f32 v25, v25
v_mfma_f32_16x16x32_bf16 v[248:251], v[44:47], a[120:123], v[248:251]
v_exp_f32 v26, v26
v_mfma_f32_16x16x32_bf16 v[252:255], v[44:47], a[124:127], v[252:255]
v_exp_f32 v27, v27
v_add_f32 v54, v54, v34
v_add_f32 v55, v55, v35
buffer_load_dwordx4 v4, s[8:11], s24 offen offset:3136 lds
s_add_u32 m0, s28, 66560
s_add_u32 s24, s24, -131072
v_add_f32 v54, v54, v36
v_add_f32 v55, v55, v37
v_exp_f32 v28, v28
v_add_f32 v54, v54, v38
v_add_f32 v55, v55, v39
v_cvt_pk_bf16_f32 v40, v24, v25
v_cvt_pk_bf16_f32 v41, v26, v27
v_add_u32 v2, 16640, v2
buffer_load_dwordx4 v3, s[4:7], s24 offen lds
buffer_load_dwordx4 v4, s[4:7], s24 offen offset:1056 lds
buffer_load_dwordx4 v3, s[8:11], s24 offen offset:2080 lds
buffer_load_dwordx4 v4, s[8:11], s24 offen offset:3136 lds
s_add_u32 m0, s28, 83200
s_add_u32 s24, s24, -131072
L_step2_6:
v_mfma_f32_16x16x32_bf16 v[32:35], a[0:3], a[176:179], 0
buffer_load_dwordx4 v3, s[4:7], s24 offen lds
v_mfma_f32_16x16x32_bf16 v[32:35], a[4:7], a[180:183], v[32:35]
s_sub_u32 s30, s30, 1
v_exp_f32 v29, v29
v_mfma_f32_16x16x32_bf16 v[32:35], a[8:11], a[184:187], v[32:35]
s_cselect_b32 s31, s35, s34
ds_read_b128 a[32:35], v1 offset:0
v_cvt_pk_bf16_f32 v42, v28, v29
v_mfma_f32_16x16x32_bf16 v[32:35], a[12:15], a[188:191], v[32:35]
s_cselect_b32 s30, 7, s30
v_exp_f32 v30, v30
v_mfma_f32_16x16x32_bf16 v[36:39], a[28:31], a[188:191], 0
buffer_load_dwordx4 v4, s[4:7], s24 offen offset:1056 lds
v_mfma_f32_16x16x32_bf16 v[36:39], a[24:27], a[184:187], v[36:39]
s_add_u32 s33, s33, 1
v_exp_f32 v31, v31
v_mfma_f32_16x16x32_bf16 v[36:39], a[20:23], a[180:183], v[36:39]
ds_read_b128 a[36:39], v1 offset:64
v_cvt_pk_bf16_f32 v43, v30, v31
v_mfma_f32_16x16x32_bf16 v[36:39], a[16:19], a[176:179], v[36:39]
v_exp_f32 v32, v32
v_mfma_f32_16x16x32_bf16 v[64:67], v[40:43], a[64:67], v[64:67]
buffer_load_dwordx4 v3, s[8:11], s24 offen offset:2080 lds
v_mfma_f32_16x16x32_bf16 v[68:71], v[40:43], a[68:71], v[68:71]
v_exp_f32 v33, v33
v_mfma_f32_16x16x32_bf16 v[72:75], v[40:43], a[72:75], v[72:75]
v_cvt_pk_bf16_f32 v44, v32, v33
v_add_f32 v48, v48, v32
v_mfma_f32_16x16x32_bf16 v[76:79], v[40:43], a[76:79], v[76:79]
v_exp_f32 v34, v34
v_mfma_f32_16x16x32_bf16 v[80:83], v[40:43], a[80:83], v[80:83]
buffer_load_dwordx4 v4, s[8:11], s24 offen offset:3136 lds
v_mfma_f32_16x16x32_bf16 v[84:87], v[40:43], a[84:87], v[84:87]
s_add_u32 m0, m0, s34
v_exp_f32 v35, v35
v_mfma_f32_16x16x32_bf16 v[88:91], v[40:43], a[88:91], v[88:91]
s_cmp_eq_u32 m0, s29
v_cvt_pk_bf16_f32 v45, v34, v35
v_add_f32 v49, v49, v33
v_mfma_f32_16x16x32_bf16 v[92:95], v[40:43], a[92:95], v[92:95]
s_cselect_b32 m0, s28, m0
v_exp_f32 v36, v36
v_mfma_f32_16x16x32_bf16 a[132:135], a[128:131], v[40:43], a[132:135]
s_add_u32 s24, s24, s25
v_add_f32 v48, v48, v34
v_add_f32 v49, v49, v35
v_mfma_f32_16x16x32_bf16 v[24:27], a[0:3], a[192:195], 0
s_sub_u32 s26, s26, 1
ds_read_b128 a[40:43], v1 offset:128
v_add_f32 v48, v48, v36
v_mfma_f32_16x16x32_bf16 v[24:27], a[4:7], a[196:199], v[24:27]
v_exp_f32 v37, v37
v_mfma_f32_16x16x32_bf16 v[24:27], a[8:11], a[200:203], v[24:27]
v_cvt_pk_bf16_f32 v46, v36, v37
v_add_f32 v49, v49, v37
v_mfma_f32_16x16x32_bf16 v[24:27], a[12:15], a[204:207], v[24:27]
v_exp_f32 v38, v38
v_mfma_f32_16x16x32_bf16 v[28:31], a[28:31], a[204:207], 0
ds_read_b128 a[44:47], v1 offset:192
v_add_f32 v48, v48, v38
v_mfma_f32_16x16x32_bf16 v[28:31], a[24:27], a[200:203], v[28:31]
v_exp_f32 v39, v39
v_mfma_f32_16x16x32_bf16 v[28:31], a[20:23], a[196:199], v[28:31]
v_cvt_pk_bf16_f32 v47, v38, v39
v_add_f32 v49, v49, v39
v_mfma_f32_16x16x32_bf16 v[28:31], a[16:19], a[192:195], v[28:31]
v_exp_f32 v24, v24
v_mfma_f32_16x16x32_bf16 v[96:99], v[44:47], a[64:67], v[96:99]
ds_read_b128 a[48:51], v1 offset:512
v_add_f32 v50, v50, v24
v_mfma_f32_16x16x32_bf16 v[100:103], v[44:47], a[68:71], v[100:103]
v_exp_f32 v25, v25
v_mfma_f32_16x16x32_bf16 v[104:107], v[44:47], a[72:75], v[104:107]
v_cvt_pk_bf16_f32 v40, v24, v25
v_add_f32 v51, v51, v25
v_mfma_f32_16x16x32_bf16 v[108:111], v[44:47], a[76:79], v[108:111]
v_exp_f32 v26, v26
v_mfma_f32_16x16x32_bf16 v[112:115], v[44:47], a[80:83], v[112:115]
ds_read_b128 a[52:55], v1 offset:576
v_add_f32 v50, v50, v26
v_mfma_f32_16x16x32_bf16 v[116:119], v[44:47], a[84:87], v[116:119]
v_exp_f32 v27, v27
v_mfma_f32_16x16x32_bf16 v[120:123], v[44:47], a[88:91], v[120:123]
v_cvt_pk_bf16_f32 v41, v26, v27
v_add_f32 v51, v51, v27
v_mfma_f32_16x16x32_bf16 v[124:127], v[44:47], a[92:95], v[124:127]
v_exp_f32 v28, v28
v_mfma_f32_16x16x32_bf16 v[32:35], a[0:3], a[208:211], 0
ds_read_b128 a[56:59], v1 offset:640
v_add_f32 v50, v50, v28
v_mfma_f32_16x16x32_bf16 v[32:35], a[4:7], a[212:215], v[32:35]
v_exp_f32 v29, v29
v_mfma_f32_16x16x32_bf16 v[32:35], a[8:11], a[216:219], v[32:35]
v_cvt_pk_bf16_f32 v42, v28, v29
v_add_f32 v51, v51, v29
v_mfma_f32_16x16x32_bf16 v[32:35], a[12:15], a[220:223], v[32:35]
v_exp_f32 v30, v30
v_mfma_f32_16x16x32_bf16 v[36:39], a[28:31], a[220:223], 0
ds_read_b128 a[60:63], v1 offset:704
v_add_f32 v50, v50, v30
v_mfma_f32_16x16x32_bf16 v[36:39], a[24:27], a[216:219], v[36:39]
v_exp_f32 v31, v31
v_mfma_f32_16x16x32_bf16 v[36:39], a[20:23], a[212:215], v[36:39]
v_cvt_pk_bf16_f32 v43, v30, v31
v_add_f32 v51, v51, v31
v_mfma_f32_16x16x32_bf16 v[36:39], a[16:19], a[208:211], v[36:39]
s_waitcnt vmcnt(12)
v_exp_f32 v32, v32
v_mfma_f32_16x16x32_bf16 v[128:131], v[40:43], a[64:67], v[128:131]
ds_add_u32 v8, v10
ds_read_b64_tr_b16 a[96:97], v2 offset:0
v_mfma_f32_16x16x32_bf16 v[132:135], v[40:43], a[68:71], v[132:135]
v_exp_f32 v33, v33
v_mfma_f32_16x16x32_bf16 v[136:139], v[40:43], a[72:75], v[136:139]
ds_read_b64_tr_b16 a[98:99], v2 offset:512
v_cvt_pk_bf16_f32 v44, v32, v33
v_mfma_f32_16x16x32_bf16 v[140:143], v[40:43], a[76:79], v[140:143]
v_exp_f32 v34, v34
v_mfma_f32_16x16x32_bf16 v[144:147], v[40:43], a[80:83], v[144:147]
ds_read_b64_tr_b16 a[100:101], v2 offset:32
ds_read_b64_tr_b16 a[102:103], v2 offset:544
v_mfma_f32_16x16x32_bf16 v[148:151], v[40:43], a[84:87], v[148:151]
v_exp_f32 v35, v35
v_mfma_f32_16x16x32_bf16 v[152:155], v[40:43], a[88:91], v[152:155]
ds_read_b64_tr_b16 a[104:105], v2 offset:64
v_cvt_pk_bf16_f32 v45, v34, v35
v_mfma_f32_16x16x32_bf16 v[156:159], v[40:43], a[92:95], v[156:159]
v_exp_f32 v36, v36
v_mfma_f32_16x16x32_bf16 v[24:27], a[0:3], a[224:227], 0
ds_read_b64_tr_b16 a[106:107], v2 offset:576
ds_read_b64_tr_b16 a[108:109], v2 offset:96
v_mfma_f32_16x16x32_bf16 v[24:27], a[4:7], a[228:231], v[24:27]
v_exp_f32 v37, v37
v_mfma_f32_16x16x32_bf16 v[24:27], a[8:11], a[232:235], v[24:27]
ds_read_b64_tr_b16 a[110:111], v2 offset:608
v_cvt_pk_bf16_f32 v46, v36, v37
v_mfma_f32_16x16x32_bf16 v[24:27], a[12:15], a[236:239], v[24:27]
v_exp_f32 v38, v38
v_mfma_f32_16x16x32_bf16 v[28:31], a[28:31], a[236:239], 0
ds_read_b64_tr_b16 a[112:113], v2 offset:128
ds_read_b64_tr_b16 a[114:115], v2 offset:640
v_mfma_f32_16x16x32_bf16 v[28:31], a[24:27], a[232:235], v[28:31]
v_exp_f32 v39, v39
v_mfma_f32_16x16x32_bf16 v[28:31], a[20:23], a[228:231], v[28:31]
ds_read_b64_tr_b16 a[116:117], v2 offset:160
v_cvt_pk_bf16_f32 v47, v38, v39
v_mfma_f32_16x16x32_bf16 v[28:31], a[16:19], a[224:227], v[28:31]
v_exp_f32 v24, v24
v_mfma_f32_16x16x32_bf16 v[160:163], v[44:47], a[64:67], v[160:163]
ds_read_b64_tr_b16 a[118:119], v2 offset:672
v_add_f32 v52, v52, v24
v_mfma_f32_16x16x32_bf16 v[164:167], v[44:47], a[68:71], v[164:167]
v_exp_f32 v25, v25
v_mfma_f32_16x16x32_bf16 v[168:171], v[44:47], a[72:75], v[168:171]
v_cvt_pk_bf16_f32 v40, v24, v25
v_add_f32 v53, v53, v25
v_mfma_f32_16x16x32_bf16 v[172:175], v[44:47], a[76:79], v[172:175]
v_exp_f32 v26, v26
v_mfma_f32_16x16x32_bf16 v[176:179], v[44:47], a[80:83], v[176:179]
ds_read_b64_tr_b16 a[120:121], v2 offset:192
v_add_f32 v52, v52, v26
v_mfma_f32_16x16x32_bf16 v[180:183], v[44:47], a[84:87], v[180:183]
v_exp_f32 v27, v27
v_mfma_f32_16x16x32_bf16 v[184:187], v[44:47], a[88:91], v[184:187]
v_cvt_pk_bf16_f32 v41, v26, v27
v_add_f32 v53, v53, v27
v_mfma_f32_16x16x32_bf16 v[188:191], v[44:47], a[92:95], v[188:191]
v_exp_f32 v28, v28
v_mfma_f32_16x16x32_bf16 a[136:139], a[128:131], v[44:47], a[136:139]
ds_read_b64_tr_b16 a[122:123], v2 offset:704
v_add_f32 v52, v52, v28
v_mfma_f32_16x16x32_bf16 v[32:35], a[0:3], a[240:243], 0
ds_read_b64_tr_b16 a[124:125], v2 offset:224
ds_read_b64_tr_b16 a[126:127], v2 offset:736
v_mfma_f32_16x16x32_bf16 v[32:35], a[4:7], a[244:247], v[32:35]
v_exp_f32 v29, v29
v_mfma_f32_16x16x32_bf16 v[32:35], a[8:11], a[248:251], v[32:35]
v_cvt_pk_bf16_f32 v42, v28, v29
v_add_f32 v53, v53, v29
v_mfma_f32_16x16x32_bf16 v[32:35], a[12:15], a[252:255], v[32:35]
v_exp_f32 v30, v30
v_mfma_f32_16x16x32_bf16 v[36:39], a[28:31], a[252:255], 0
v_add_f32 v52, v52, v30
v_add_u32 v1, s31, v1
v_mfma_f32_16x16x32_bf16 v[36:39], a[24:27], a[248:251], v[36:39]
v_exp_f32 v31, v31
v_mfma_f32_16x16x32_bf16 v[36:39], a[20:23], a[244:247], v[36:39]
v_cvt_pk_bf16_f32 v43, v30, v31
v_add_f32 v53, v53, v31
v_mfma_f32_16x16x32_bf16 v[36:39], a[16:19], a[240:243], v[36:39]
v_exp_f32 v32, v32
v_mfma_f32_16x16x32_bf16 v[192:195], v[40:43], a[64:67], v[192:195]
v_add_f32 v54, v54, v32
v_add_u32 v2, s31, v2
v_mfma_f32_16x16x32_bf16 v[196:199], v[40:43], a[68:71], v[196:199]
v_exp_f32 v33, v33
v_mfma_f32_16x16x32_bf16 v[200:203], v[40:43], a[72:75], v[200:203]
v_cvt_pk_bf16_f32 v44, v32, v33
v_add_f32 v55, v55, v33
v_mfma_f32_16x16x32_bf16 v[204:207], v[40:43], a[76:79], v[204:207]
v_exp_f32 v34, v34
v_mfma_f32_16x16x32_bf16 v[208:211], v[40:43], a[80:83], v[208:211]
v_add_f32 v54, v54, v34
v_mfma_f32_16x16x32_bf16 v[212:215], v[40:43], a[84:87], v[212:215]
v_exp_f32 v35, v35
v_mfma_f32_16x16x32_bf16 v[216:219], v[40:43], a[88:91], v[216:219]
v_cvt_pk_bf16_f32 v45, v34, v35
v_add_f32 v55, v55, v35
v_mfma_f32_16x16x32_bf16 v[220:223], v[40:43], a[92:95], v[220:223]
s_waitcnt lgkmcnt(15)
v_exp_f32 v36, v36
v_mfma_f32_16x16x32_bf16 v[24:27], a[32:35], a[160:163], 0
v_add_f32 v54, v54, v36
v_mfma_f32_16x16x32_bf16 v[24:27], a[36:39], a[164:167], v[24:27]
v_exp_f32 v37, v37
v_mfma_f32_16x16x32_bf16 v[24:27], a[40:43], a[168:171], v[24:27]
v_cvt_pk_bf16_f32 v46, v36, v37
v_add_f32 v55, v55, v37
v_mfma_f32_16x16x32_bf16 v[24:27], a[44:47], a[172:175], v[24:27]
v_exp_f32 v38, v38
v_mfma_f32_16x16x32_bf16 v[28:31], a[60:63], a[172:175], 0
ds_read_b32 v11, v9
v_add_f32 v54, v54, v38
v_mfma_f32_16x16x32_bf16 v[28:31], a[56:59], a[168:171], v[28:31]
v_exp_f32 v39, v39
v_mfma_f32_16x16x32_bf16 v[28:31], a[52:55], a[164:167], v[28:31]
v_cvt_pk_bf16_f32 v47, v38, v39
v_add_f32 v55, v55, v39
v_mfma_f32_16x16x32_bf16 v[28:31], a[48:51], a[160:163], v[28:31]
v_exp_f32 v24, v24
v_mfma_f32_16x16x32_bf16 v[224:227], v[44:47], a[64:67], v[224:227]
v_mfma_f32_16x16x32_bf16 v[228:231], v[44:47], a[68:71], v[228:231]
s_waitcnt lgkmcnt(0)
v_exp_f32 v25, v25
v_mfma_f32_16x16x32_bf16 v[232:235], v[44:47], a[72:75], v[232:235]
v_cvt_pk_bf16_f32 v40, v24, v25
v_cmp_gt_u32 vcc, s33, v11
v_mfma_f32_16x16x32_bf16 v[236:239], v[44:47], a[76:79], v[236:239]
v_exp_f32 v26, v26
v_mfma_f32_16x16x32_bf16 v[240:243], v[44:47], a[80:83], v[240:243]
v_mfma_f32_16x16x32_bf16 v[244:247], v[44:47], a[84:87], v[244:247]
s_waitcnt lgkmcnt(0)
v_exp_f32 v27, v27
v_mfma_f32_16x16x32_bf16 v[248:251], v[44:47], a[88:91], v[248:251]
v_cvt_pk_bf16_f32 v41, v26, v27
v_mfma_f32_16x16x32_bf16 v[252:255], v[44:47], a[92:95], v[252:255]
s_cbranch_vccnz L_spin_57
L_spinret_58:
v_exp_f32 v28, v28
buffer_load_dwordx4 v3, s[4:7], s24 offen lds
buffer_load_dwordx4 v4, s[4:7], s24 offen offset:1056 lds
buffer_load_dwordx4 v3, s[8:11], s24 offen offset:2080 lds
buffer_load_dwordx4 v4, s[8:11], s24 offen offset:3136 lds
s_add_u32 m0, m0, s34
s_cmp_eq_u32 m0, s29
s_cselect_b32 m0, s28, m0
s_add_u32 s24, s24, s25
s_sub_u32 s26, s26, 1
.p2align 6
L_loop6:
v_mfma_f32_16x16x32_bf16 v[32:35], a[32:35], a[176:179], 0
buffer_load_dwordx4 v3, s[4:7], s24 offen lds
v_mfma_f32_16x16x32_bf16 v[32:35], a[36:39], a[180:183], v[32:35]
s_sub_u32 s30, s30, 1
v_exp_f32 v29, v29
v_mfma_f32_16x16x32_bf16 v[32:35], a[40:43], a[184:187], v[32:35]
s_cselect_b32 s31, s35, s34
ds_read_b128 a[0:3], v1 offset:0
v_cvt_pk_bf16_f32 v42, v28, v29
v_mfma_f32_16x16x32_bf16 v[32:35], a[44:47], a[188:191], v[32:35]
s_cselect_b32 s30, 7, s30
v_exp_f32 v30, v30
v_mfma_f32_16x16x32_bf16 v[36:39], a[60:63], a[188:191], 0
buffer_load_dwordx4 v4, s[4:7], s24 offen offset:1056 lds
v_mfma_f32_16x16x32_bf16 v[36:39], a[56:59], a[184:187], v[36:39]
s_add_u32 s33, s33, 1
v_exp_f32 v31, v31
v_mfma_f32_16x16x32_bf16 v[36:39], a[52:55], a[180:183], v[36:39]
ds_read_b128 a[4:7], v1 offset:64
v_cvt_pk_bf16_f32 v43, v30, v31
v_mfma_f32_16x16x32_bf16 v[36:39], a[48:51], a[176:179], v[36:39]
v_exp_f32 v32, v32
v_mfma_f32_16x16x32_bf16 v[64:67], v[40:43], a[96:99], v[64:67]
buffer_load_dwordx4 v3, s[8:11], s24 offen offset:2080 lds
v_mfma_f32_16x16x32_bf16 v[68:71], v[40:43], a[100:103], v[68:71]
v_exp_f32 v33, v33
v_mfma_f32_16x16x32_bf16 v[72:75], v[40:43], a[104:107], v[72:75]
v_cvt_pk_bf16_f32 v44, v32, v33
v_add_f32 v48, v48, v32
v_mfma_f32_16x16x32_bf16 v[76:79], v[40:43], a[108:111], v[76:79]
v_exp_f32 v34, v34
v_mfma_f32_16x16x32_bf16 v[80:83], v[40:43], a[112:115], v[80:83]
buffer_load_dwordx4 v4, s[8:11], s24 offen offset:3136 lds
v_mfma_f32_16x16x32_bf16 v[84:87], v[40:43], a[116:119], v[84:87]
s_add_u32 m0, m0, s34
v_exp_f32 v35, v35
v_mfma_f32_16x16x32_bf16 v[88:91], v[40:43], a[120:123], v[88:91]
s_cmp_eq_u32 m0, s29
v_cvt_pk_bf16_f32 v45, v34, v35
v_add_f32 v49, v49, v33
v_mfma_f32_16x16x32_bf16 v[92:95], v[40:43], a[124:127], v[92:95]
s_cselect_b32 m0, s28, m0
v_exp_f32 v36, v36
v_mfma_f32_16x16x32_bf16 a[132:135], a[128:131], v[40:43], a[132:135]
s_add_u32 s24, s24, s25
v_add_f32 v48, v48, v34
v_add_f32 v49, v49, v35
v_mfma_f32_16x16x32_bf16 v[24:27], a[32:35], a[192:195], 0
s_sub_u32 s26, s26, 1
ds_read_b128 a[8:11], v1 offset:128
v_add_f32 v48, v48, v36
v_mfma_f32_16x16x32_bf16 v[24:27], a[36:39], a[196:199], v[24:27]
s_cmov_b64 s[4:5], s[52:53]
v_exp_f32 v37, v37
v_mfma_f32_16x16x32_bf16 v[24:27], a[40:43], a[200:203], v[24:27]
s_cmov_b64 s[8:9], s[54:55]
v_cvt_pk_bf16_f32 v46, v36, v37
v_add_f32 v49, v49, v37
v_mfma_f32_16x16x32_bf16 v[24:27], a[44:47], a[204:207], v[24:27]
s_cmov_b64 s[24:25], s[56:57]
v_exp_f32 v38, v38
v_mfma_f32_16x16x32_bf16 v[28:31], a[60:63], a[204:207], 0
s_cmov_b32 s6, s58
ds_read_b128 a[12:15], v1 offset:192
v_add_f32 v48, v48, v38
v_mfma_f32_16x16x32_bf16 v[28:31], a[56:59], a[200:203], v[28:31]
s_cmov_b32 s10, s59
v_exp_f32 v39, v39
v_mfma_f32_16x16x32_bf16 v[28:31], a[52:55], a[196:199], v[28:31]
s_cmov_b32 s26, s60
v_cvt_pk_bf16_f32 v47, v38, v39
v_add_f32 v49, v49, v39
v_mfma_f32_16x16x32_bf16 v[28:31], a[48:51], a[192:195], v[28:31]
s_cmov_b64 s[52:53], s[62:63]
v_exp_f32 v24, v24
v_mfma_f32_16x16x32_bf16 v[96:99], v[44:47], a[96:99], v[96:99]
s_cmov_b64 s[54:55], s[64:65]
ds_read_b128 a[16:19], v1 offset:512
v_add_f32 v50, v50, v24
v_mfma_f32_16x16x32_bf16 v[100:103], v[44:47], a[100:103], v[100:103]
s_cmov_b64 s[56:57], s[66:67]
v_exp_f32 v25, v25
v_mfma_f32_16x16x32_bf16 v[104:107], v[44:47], a[104:107], v[104:107]
s_cmov_b64 s[58:59], s[68:69]
v_cvt_pk_bf16_f32 v40, v24, v25
v_add_f32 v51, v51, v25
v_mfma_f32_16x16x32_bf16 v[108:111], v[44:47], a[108:111], v[108:111]
s_cmov_b32 s60, s70
v_exp_f32 v26, v26
v_mfma_f32_16x16x32_bf16 v[112:115], v[44:47], a[112:115], v[112:115]
s_cmov_b64 s[68:69], 0
ds_read_b128 a[20:23], v1 offset:576
v_add_f32 v50, v50, v26
v_mfma_f32_16x16x32_bf16 v[116:119], v[44:47], a[116:119], v[116:119]
s_cmov_b32 s70, 0x7fffffff
v_exp_f32 v27, v27
v_mfma_f32_16x16x32_bf16 v[120:123], v[44:47], a[120:123], v[120:123]
s_sub_u32 s32, s32, 1
v_cvt_pk_bf16_f32 v41, v26, v27
v_add_f32 v51, v51, v27
v_mfma_f32_16x16x32_bf16 v[124:127], v[44:47], a[124:127], v[124:127]
v_exp_f32 v28, v28
v_mfma_f32_16x16x32_bf16 v[32:35], a[32:35], a[208:211], 0
ds_read_b128 a[24:27], v1 offset:640
v_add_f32 v50, v50, v28
v_mfma_f32_16x16x32_bf16 v[32:35], a[36:39], a[212:215], v[32:35]
v_exp_f32 v29, v29
v_mfma_f32_16x16x32_bf16 v[32:35], a[40:43], a[216:219], v[32:35]
v_cvt_pk_bf16_f32 v42, v28, v29
v_add_f32 v51, v51, v29
v_mfma_f32_16x16x32_bf16 v[32:35], a[44:47], a[220:223], v[32:35]
v_exp_f32 v30, v30
v_mfma_f32_16x16x32_bf16 v[36:39], a[60:63], a[220:223], 0
ds_read_b128 a[28:31], v1 offset:704
v_add_f32 v50, v50, v30
v_mfma_f32_16x16x32_bf16 v[36:39], a[56:59], a[216:219], v[36:39]
v_exp_f32 v31, v31
v_mfma_f32_16x16x32_bf16 v[36:39], a[52:55], a[212:215], v[36:39]
v_cvt_pk_bf16_f32 v43, v30, v31
v_add_f32 v51, v51, v31
v_mfma_f32_16x16x32_bf16 v[36:39], a[48:51], a[208:211], v[36:39]
s_waitcnt vmcnt(12)
v_exp_f32 v32, v32
v_mfma_f32_16x16x32_bf16 v[128:131], v[40:43], a[96:99], v[128:131]
ds_add_u32 v8, v10
ds_read_b64_tr_b16 a[64:65], v2 offset:0
v_mfma_f32_16x16x32_bf16 v[132:135], v[40:43], a[100:103], v[132:135]
v_exp_f32 v33, v33
v_mfma_f32_16x16x32_bf16 v[136:139], v[40:43], a[104:107], v[136:139]
ds_read_b64_tr_b16 a[66:67], v2 offset:512
v_cvt_pk_bf16_f32 v44, v32, v33
v_mfma_f32_16x16x32_bf16 v[140:143], v[40:43], a[108:111], v[140:143]
v_exp_f32 v34, v34
v_mfma_f32_16x16x32_bf16 v[144:147], v[40:43], a[112:115], v[144:147]
ds_read_b64_tr_b16 a[68:69], v2 offset:32
ds_read_b64_tr_b16 a[70:71], v2 offset:544
v_mfma_f32_16x16x32_bf16 v[148:151], v[40:43], a[116:119], v[148:151]
v_exp_f32 v35, v35
v_mfma_f32_16x16x32_bf16 v[152:155], v[40:43], a[120:123], v[152:155]
ds_read_b64_tr_b16 a[72:73], v2 offset:64
v_cvt_pk_bf16_f32 v45, v34, v35
v_mfma_f32_16x16x32_bf16 v[156:159], v[40:43], a[124:127], v[156:159]
v_exp_f32 v36, v36
v_mfma_f32_16x16x32_bf16 v[24:27], a[32:35], a[224:227], 0
ds_read_b64_tr_b16 a[74:75], v2 offset:576
ds_read_b64_tr_b16 a[76:77], v2 offset:96
v_mfma_f32_16x16x32_bf16 v[24:27], a[36:39], a[228:231], v[24:27]
v_exp_f32 v37, v37
v_mfma_f32_16x16x32_bf16 v[24:27], a[40:43], a[232:235], v[24:27]
ds_read_b64_tr_b16 a[78:79], v2 offset:608
v_cvt_pk_bf16_f32 v46, v36, v37
v_mfma_f32_16x16x32_bf16 v[24:27], a[44:47], a[236:239], v[24:27]
v_exp_f32 v38, v38
v_mfma_f32_16x16x32_bf16 v[28:31], a[60:63], a[236:239], 0
ds_read_b64_tr_b16 a[80:81], v2 offset:128
ds_read_b64_tr_b16 a[82:83], v2 offset:640
v_mfma_f32_16x16x32_bf16 v[28:31], a[56:59], a[232:235], v[28:31]
v_exp_f32 v39, v39
v_mfma_f32_16x16x32_bf16 v[28:31], a[52:55], a[228:231], v[28:31]
ds_read_b64_tr_b16 a[84:85], v2 offset:160
v_cvt_pk_bf16_f32 v47, v38, v39
v_mfma_f32_16x16x32_bf16 v[28:31], a[48:51], a[224:227], v[28:31]
v_exp_f32 v24, v24
v_mfma_f32_16x16x32_bf16 v[160:163], v[44:47], a[96:99], v[160:163]
ds_read_b64_tr_b16 a[86:87], v2 offset:672
v_add_f32 v52, v52, v24
v_mfma_f32_16x16x32_bf16 v[164:167], v[44:47], a[100:103], v[164:167]
v_exp_f32 v25, v25
v_mfma_f32_16x16x32_bf16 v[168:171], v[44:47], a[104:107], v[168:171]
v_cvt_pk_bf16_f32 v40, v24, v25
v_add_f32 v53, v53, v25
v_mfma_f32_16x16x32_bf16 v[172:175], v[44:47], a[108:111], v[172:175]
v_exp_f32 v26, v26
v_mfma_f32_16x16x32_bf16 v[176:179], v[44:47], a[112:115], v[176:179]
ds_read_b64_tr_b16 a[88:89], v2 offset:192
v_add_f32 v52, v52, v26
v_mfma_f32_16x16x32_bf16 v[180:183], v[44:47], a[116:119], v[180:183]
v_exp_f32 v27, v27
v_mfma_f32_16x16x32_bf16 v[184:187], v[44:47], a[120:123], v[184:187]
v_cvt_pk_bf16_f32 v41, v26, v27
v_add_f32 v53, v53, v27
v_mfma_f32_16x16x32_bf16 v[188:191], v[44:47], a[124:127], v[188:191]
v_exp_f32 v28, v28
v_mfma_f32_16x16x32_bf16 a[136:139], a[128:131], v[44:47], a[136:139]
ds_read_b64_tr_b16 a[90:91], v2 offset:704
v_add_f32 v52, v52, v28
v_mfma_f32_16x16x32_bf16 v[32:35], a[32:35], a[240:243], 0
ds_read_b64_tr_b16 a[92:93], v2 offset:224
ds_read_b64_tr_b16 a[94:95], v2 offset:736
v_mfma_f32_16x16x32_bf16 v[32:35], a[36:39], a[244:247], v[32:35]
v_exp_f32 v29, v29
v_mfma_f32_16x16x32_bf16 v[32:35], a[40:43], a[248:251], v[32:35]
v_cvt_pk_bf16_f32 v42, v28, v29
v_add_f32 v53, v53, v29
v_mfma_f32_16x16x32_bf16 v[32:35], a[44:47], a[252:255], v[32:35]
v_exp_f32 v30, v30
v_mfma_f32_16x16x32_bf16 v[36:39], a[60:63], a[252:255], 0
v_add_f32 v52, v52, v30
v_add_u32 v1, s31, v1
v_mfma_f32_16x16x32_bf16 v[36:39], a[56:59], a[248:251], v[36:39]
v_exp_f32 v31, v31
v_mfma_f32_16x16x32_bf16 v[36:39], a[52:55], a[244:247], v[36:39]
v_cvt_pk_bf16_f32 v43, v30, v31
v_add_f32 v53, v53, v31
v_mfma_f32_16x16x32_bf16 v[36:39], a[48:51], a[240:243], v[36:39]
v_exp_f32 v32, v32
v_mfma_f32_16x16x32_bf16 v[192:195], v[40:43], a[96:99], v[192:195]
v_add_f32 v54, v54, v32
v_add_u32 v2, s31, v2
v_mfma_f32_16x16x32_bf16 v[196:199], v[40:43], a[100:103], v[196:199]
v_exp_f32 v33, v33
v_mfma_f32_16x16x32_bf16 v[200:203], v[40:43], a[104:107], v[200:203]
v_cvt_pk_bf16_f32 v44, v32, v33
v_add_f32 v55, v55, v33
v_mfma_f32_16x16x32_bf16 v[204:207], v[40:43], a[108:111], v[204:207]
v_exp_f32 v34, v34
v_mfma_f32_16x16x32_bf16 v[208:211], v[40:43], a[112:115], v[208:211]
v_add_f32 v54, v54, v34
v_mfma_f32_16x16x32_bf16 v[212:215], v[40:43], a[116:119], v[212:215]
v_exp_f32 v35, v35
v_mfma_f32_16x16x32_bf16 v[216:219], v[40:43], a[120:123], v[216:219]
v_cvt_pk_bf16_f32 v45, v34, v35
v_add_f32 v55, v55, v35
v_mfma_f32_16x16x32_bf16 v[220:223], v[40:43], a[124:127], v[220:223]
s_waitcnt lgkmcnt(15)
v_exp_f32 v36, v36
v_mfma_f32_16x16x32_bf16 v[24:27], a[0:3], a[160:163], 0
v_add_f32 v54, v54, v36
v_mfma_f32_16x16x32_bf16 v[24:27], a[4:7], a[164:167], v[24:27]
v_exp_f32 v37, v37
v_mfma_f32_16x16x32_bf16 v[24:27], a[8:11], a[168:171], v[24:27]
v_cvt_pk_bf16_f32 v46, v36, v37
v_add_f32 v55, v55, v37
v_mfma_f32_16x16x32_bf16 v[24:27], a[12:15], a[172:175], v[24:27]
v_exp_f32 v38, v38
v_mfma_f32_16x16x32_bf16 v[28:31], a[28:31], a[172:175], 0
ds_read_b32 v11, v9
v_add_f32 v54, v54, v38
v_mfma_f32_16x16x32_bf16 v[28:31], a[24:27], a[168:171], v[28:31]
v_exp_f32 v39, v39
v_mfma_f32_16x16x32_bf16 v[28:31], a[20:23], a[164:167], v[28:31]
v_cvt_pk_bf16_f32 v47, v38, v39
v_add_f32 v55, v55, v39
v_mfma_f32_16x16x32_bf16 v[28:31], a[16:19], a[160:163], v[28:31]
v_exp_f32 v24, v24
v_mfma_f32_16x16x32_bf16 v[224:227], v[44:47], a[96:99], v[224:227]
v_mfma_f32_16x16x32_bf16 v[228:231], v[44:47], a[100:103], v[228:231]
s_waitcnt lgkmcnt(0)
v_exp_f32 v25, v25
v_mfma_f32_16x16x32_bf16 v[232:235], v[44:47], a[104:107], v[232:235]
v_cvt_pk_bf16_f32 v40, v24, v25
v_cmp_gt_u32 vcc, s33, v11
v_mfma_f32_16x16x32_bf16 v[236:239], v[44:47], a[108:111], v[236:239]
v_exp_f32 v26, v26
v_mfma_f32_16x16x32_bf16 v[240:243], v[44:47], a[112:115], v[240:243]
v_mfma_f32_16x16x32_bf16 v[244:247], v[44:47], a[116:119], v[244:247]
s_waitcnt lgkmcnt(0)
v_exp_f32 v27, v27
v_mfma_f32_16x16x32_bf16 v[248:251], v[44:47], a[120:123], v[248:251]
v_cvt_pk_bf16_f32 v41, v26, v27
v_mfma_f32_16x16x32_bf16 v[252:255], v[44:47], a[124:127], v[252:255]
s_cbranch_vccnz L_spin_7
L_spinret_8:
v_exp_f32 v28, v28
s_cbranch_scc1 L_last0_6
v_mfma_f32_16x16x32_bf16 v[32:35], a[0:3], a[176:179], 0
buffer_load_dwordx4 v3, s[4:7], s24 offen lds
v_mfma_f32_16x16x32_bf16 v[32:35], a[4:7], a[180:183], v[32:35]
s_sub_u32 s30, s30, 1
v_exp_f32 v29, v29
v_mfma_f32_16x16x32_bf16 v[32:35], a[8:11], a[184:187], v[32:35]
s_cselect_b32 s31, s35, s34
ds_read_b128 a[32:35], v1 offset:0
v_cvt_pk_bf16_f32 v42, v28, v29
v_mfma_f32_16x16x32_bf16 v[32:35], a[12:15], a[188:191], v[32:35]
s_cselect_b32 s30, 7, s30
v_exp_f32 v30, v30
v_mfma_f32_16x16x32_bf16 v[36:39], a[28:31], a[188:191], 0
buffer_load_dwordx4 v4, s[4:7], s24 offen offset:1056 lds
v_mfma_f32_16x16x32_bf16 v[36:39], a[24:27], a[184:187], v[36:39]
v_exp_f32 v31, v31
v_mfma_f32_16x16x32_bf16 v[36:39], a[20:23], a[180:183], v[36:39]
ds_read_b128 a[36:39], v1 offset:64
v_cvt_pk_bf16_f32 v43, v30, v31
v_mfma_f32_16x16x32_bf16 v[36:39], a[16:19], a[176:179], v[36:39]
v_exp_f32 v32, v32
v_mfma_f32_16x16x32_bf16 v[64:67], v[40:43], a[64:67], v[64:67]
buffer_load_dwordx4 v3, s[8:11], s24 offen offset:2080 lds
v_mfma_f32_16x16x32_bf16 v[68:71], v[40:43], a[68:71], v[68:71]
v_exp_f32 v33, v33
v_mfma_f32_16x16x32_bf16 v[72:75], v[40:43], a[72:75], v[72:75]
v_cvt_pk_bf16_f32 v44, v32, v33
v_add_f32 v48, v48, v32
v_mfma_f32_16x16x32_bf16 v[76:79], v[40:43], a[76:79], v[76:79]
v_exp_f32 v34, v34
v_mfma_f32_16x16x32_bf16 v[80:83], v[40:43], a[80:83], v[80:83]
buffer_load_dwordx4 v4, s[8:11], s24 offen offset:3136 lds
v_mfma_f32_16x16x32_bf16 v[84:87], v[40:43], a[84:87], v[84:87]
s_add_u32 m0, m0, s34
v_exp_f32 v35, v35
v_mfma_f32_16x16x32_bf16 v[88:91], v[40:43], a[88:91], v[88:91]
s_cmp_eq_u32 m0, s29
v_cvt_pk_bf16_f32 v45, v34, v35
v_add_f32 v49, v49, v33
v_mfma_f32_16x16x32_bf16 v[92:95], v[40:43], a[92:95], v[92:95]
s_cselect_b32 m0, s28, m0
v_exp_f32 v36, v36
v_mfma_f32_16x16x32_bf16 a[132:135], a[128:131], v[40:43], a[132:135]
s_add_u32 s24, s24, s25
v_add_f32 v48, v48, v34
v_add_f32 v49, v49, v35
v_mfma_f32_16x16x32_bf16 v[24:27], a[0:3], a[192:195], 0
s_sub_u32 s26, s26, 1
ds_read_b128 a[40:43], v1 offset:128
v_add_f32 v48, v48, v36
v_mfma_f32_16x16x32_bf16 v[24:27], a[4:7], a[196:199], v[24:27]
s_cmov_b64 s[4:5], s[52:53]
v_exp_f32 v37, v37
v_mfma_f32_16x16x32_bf16 v[24:27], a[8:11], a[200:203], v[24:27]
s_cmov_b64 s[8:9], s[54:55]
v_cvt_pk_bf16_f32 v46, v36, v37
v_add_f32 v49, v49, v37
v_mfma_f32_16x16x32_bf16 v[24:27], a[12:15], a[204:207], v[24:27]
s_cmov_b64 s[24:25], s[56:57]
v_exp_f32 v38, v38
v_mfma_f32_16x16x32_bf16 v[28:31], a[28:31], a[204:207], 0
s_cmov_b32 s6, s58
ds_read_b128 a[44:47], v1 offset:192
v_add_f32 v48, v48, v38
v_mfma_f32_16x16x32_bf16 v[28:31], a[24:27], a[200:203], v[28:31]
s_cmov_b32 s10, s59
v_exp_f32 v39, v39
v_mfma_f32_16x16x32_bf16 v[28:31], a[20:23], a[196:199], v[28:31]
s_cmov_b32 s26, s60
v_cvt_pk_bf16_f32 v47, v38, v39
v_add_f32 v49, v49, v39
v_mfma_f32_16x16x32_bf16 v[28:31], a[16:19], a[192:195], v[28:31]
s_cmov_b64 s[52:53], s[62:63]
v_exp_f32 v24, v24
v_mfma_f32_16x16x32_bf16 v[96:99], v[44:47], a[64:67], v[96:99]
s_cmov_b64 s[54:55], s[64:65]
ds_read_b128 a[48:51], v1 offset:512
v_add_f32 v50, v50, v24
v_mfma_f32_16x16x32_bf16 v[100:103], v[44:47], a[68:71], v[100:103]
s_cmov_b64 s[56:57], s[66:67]
v_exp_f32 v25, v25
v_mfma_f32_16x16x32_bf16 v[104:107], v[44:47], a[72:75], v[104:107]
s_cmov_b64 s[58:59], s[68:69]
v_cvt_pk_bf16_f32 v40, v24, v25
v_add_f32 v51, v51, v25
v_mfma_f32_16x16x32_bf16 v[108:111], v[44:47], a[76:79], v[108:111]
s_cmov_b32 s60, s70
v_exp_f32 v26, v26
v_mfma_f32_16x16x32_bf16 v[112:115], v[44:47], a[80:83], v[112:115]
s_cmov_b64 s[68:69], 0
ds_read_b128 a[52:55], v1 offset:576
v_add_f32 v50, v50, v26
v_mfma_f32_16x16x32_bf16 v[116:119], v[44:47], a[84:87], v[116:119]
s_cmov_b32 s70, 0x7fffffff
v_exp_f32 v27, v27
v_mfma_f32_16x16x32_bf16 v[120:123], v[44:47], a[88:91], v[120:123]
s_sub_u32 s32, s32, 1
v_cvt_pk_bf16_f32 v41, v26, v27
v_add_f32 v51, v51, v27
v_mfma_f32_16x16x32_bf16 v[124:127], v[44:47], a[92:95], v[124:127]
v_exp_f32 v28, v28
v_mfma_f32_16x16x32_bf16 v[32:35], a[0:3], a[208:211], 0
ds_read_b128 a[56:59], v1 offset:640
v_add_f32 v50, v50, v28
v_mfma_f32_16x16x32_bf16 v[32:35], a[4:7], a[212:215], v[32:35]
v_exp_f32 v29, v29
v_mfma_f32_16x16x32_bf16 v[32:35], a[8:11], a[216:219], v[32:35]
v_cvt_pk_bf16_f32 v42, v28, v29
v_add_f32 v51, v51, v29
v_mfma_f32_16x16x32_bf16 v[32:35], a[12:15], a[220:223], v[32:35]
v_exp_f32 v30, v30
v_mfma_f32_16x16x32_bf16 v[36:39], a[28:31], a[220:223], 0
ds_read_b128 a[60:63], v1 offset:704
v_add_f32 v50, v50, v30
v_mfma_f32_16x16x32_bf16 v[36:39], a[24:27], a[216:219], v[36:39]
v_exp_f32 v31, v31
v_mfma_f32_16x16x32_bf16 v[36:39], a[20:23], a[212:215], v[36:39]
v_cvt_pk_bf16_f32 v43, v30, v31
v_add_f32 v51, v51, v31
v_mfma_f32_16x16x32_bf16 v[36:39], a[16:19], a[208:211], v[36:39]
v_exp_f32 v32, v32
v_mfma_f32_16x16x32_bf16 v[128:131], v[40:43], a[64:67], v[128:131]
ds_read_b64_tr_b16 a[96:97], v2 offset:0
ds_read_b64_tr_b16 a[98:99], v2 offset:512
v_mfma_f32_16x16x32_bf16 v[132:135], v[40:43], a[68:71], v[132:135]
v_exp_f32 v33, v33
v_mfma_f32_16x16x32_bf16 v[136:139], v[40:43], a[72:75], v[136:139]
ds_read_b64_tr_b16 a[100:101], v2 offset:32
v_cvt_pk_bf16_f32 v44, v32, v33
v_mfma_f32_16x16x32_bf16 v[140:143], v[40:43], a[76:79], v[140:143]
v_exp_f32 v34, v34
v_mfma_f32_16x16x32_bf16 v[144:147], v[40:43], a[80:83], v[144:147]
ds_read_b64_tr_b16 a[102:103], v2 offset:544
ds_read_b64_tr_b16 a[104:105], v2 offset:64
v_mfma_f32_16x16x32_bf16 v[148:151], v[40:43], a[84:87], v[148:151]
v_exp_f32 v35, v35
v_mfma_f32_16x16x32_bf16 v[152:155], v[40:43], a[88:91], v[152:155]
ds_read_b64_tr_b16 a[106:107], v2 offset:576
v_cvt_pk_bf16_f32 v45, v34, v35
v_mfma_f32_16x16x32_bf16 v[156:159], v[40:43], a[92:95], v[156:159]
v_exp_f32 v36, v36
v_mfma_f32_16x16x32_bf16 v[24:27], a[0:3], a[224:227], 0
ds_read_b64_tr_b16 a[108:109], v2 offset:96
ds_read_b64_tr_b16 a[110:111], v2 offset:608
v_mfma_f32_16x16x32_bf16 v[24:27], a[4:7], a[228:231], v[24:27]
v_exp_f32 v37, v37
v_mfma_f32_16x16x32_bf16 v[24:27], a[8:11], a[232:235], v[24:27]
ds_read_b64_tr_b16 a[112:113], v2 offset:128
v_cvt_pk_bf16_f32 v46, v36, v37
v_mfma_f32_16x16x32_bf16 v[24:27], a[12:15], a[236:239], v[24:27]
v_exp_f32 v38, v38
v_mfma_f32_16x16x32_bf16 v[28:31], a[28:31], a[236:239], 0
ds_read_b64_tr_b16 a[114:115], v2 offset:640
ds_read_b64_tr_b16 a[116:117], v2 offset:160
v_mfma_f32_16x16x32_bf16 v[28:31], a[24:27], a[232:235], v[28:31]
v_exp_f32 v39, v39
v_mfma_f32_16x16x32_bf16 v[28:31], a[20:23], a[228:231], v[28:31]
ds_read_b64_tr_b16 a[118:119], v2 offset:672
v_cvt_pk_bf16_f32 v47, v38, v39
v_mfma_f32_16x16x32_bf16 v[28:31], a[16:19], a[224:227], v[28:31]
v_exp_f32 v24, v24
v_mfma_f32_16x16x32_bf16 v[160:163], v[44:47], a[64:67], v[160:163]
ds_read_b64_tr_b16 a[120:121], v2 offset:192
v_add_f32 v52, v52, v24
v_mfma_f32_16x16x32_bf16 v[164:167], v[44:47], a[68:71], v[164:167]
v_exp_f32 v25, v25
v_mfma_f32_16x16x32_bf16 v[168:171], v[44:47], a[72:75], v[168:171]
v_cvt_pk_bf16_f32 v40, v24, v25
v_add_f32 v53, v53, v25
v_mfma_f32_16x16x32_bf16 v[172:175], v[44:47], a[76:79], v[172:175]
v_exp_f32 v26, v26
v_mfma_f32_16x16x32_bf16 v[176:179], v[44:47], a[80:83], v[176:179]
ds_read_b64_tr_b16 a[122:123], v2 offset:704
v_add_f32 v52, v52, v26
v_mfma_f32_16x16x32_bf16 v[180:183], v[44:47], a[84:87], v[180:183]
v_exp_f32 v27, v27
v_mfma_f32_16x16x32_bf16 v[184:187], v[44:47], a[88:91], v[184:187]
v_cvt_pk_bf16_f32 v41, v26, v27
v_add_f32 v53, v53, v27
v_mfma_f32_16x16x32_bf16 v[188:191], v[44:47], a[92:95], v[188:191]
v_exp_f32 v28, v28
v_mfma_f32_16x16x32_bf16 a[136:139], a[128:131], v[44:47], a[136:139]
ds_read_b64_tr_b16 a[124:125], v2 offset:224
v_add_f32 v52, v52, v28
v_mfma_f32_16x16x32_bf16 v[32:35], a[0:3], a[240:243], 0
ds_read_b64_tr_b16 a[126:127], v2 offset:736
v_add_u32 v1, s31, v1
v_mfma_f32_16x16x32_bf16 v[32:35], a[4:7], a[244:247], v[32:35]
v_exp_f32 v29, v29
v_mfma_f32_16x16x32_bf16 v[32:35], a[8:11], a[248:251], v[32:35]
v_cvt_pk_bf16_f32 v42, v28, v29
v_add_f32 v53, v53, v29
v_mfma_f32_16x16x32_bf16 v[32:35], a[12:15], a[252:255], v[32:35]
v_exp_f32 v30, v30
v_mfma_f32_16x16x32_bf16 v[36:39], a[28:31], a[252:255], 0
v_add_f32 v52, v52, v30
v_add_u32 v2, s31, v2
v_mfma_f32_16x16x32_bf16 v[36:39], a[24:27], a[248:251], v[36:39]
v_exp_f32 v31, v31
v_mfma_f32_16x16x32_bf16 v[36:39], a[20:23], a[244:247], v[36:39]
v_cvt_pk_bf16_f32 v43, v30, v31
v_add_f32 v53, v53, v31
v_mfma_f32_16x16x32_bf16 v[36:39], a[16:19], a[240:243], v[36:39]
v_exp_f32 v32, v32
v_mfma_f32_16x16x32_bf16 v[192:195], v[40:43], a[64:67], v[192:195]
v_add_f32 v54, v54, v32
v_mfma_f32_16x16x32_bf16 v[196:199], v[40:43], a[68:71], v[196:199]
v_exp_f32 v33, v33
v_mfma_f32_16x16x32_bf16 v[200:203], v[40:43], a[72:75], v[200:203]
v_cvt_pk_bf16_f32 v44, v32, v33
v_add_f32 v55, v55, v33
v_mfma_f32_16x16x32_bf16 v[204:207], v[40:43], a[76:79], v[204:207]
v_exp_f32 v34, v34
v_mfma_f32_16x16x32_bf16 v[208:211], v[40:43], a[80:83], v[208:211]
v_add_f32 v54, v54, v34
v_mfma_f32_16x16x32_bf16 v[212:215], v[40:43], a[84:87], v[212:215]
v_exp_f32 v35, v35
v_mfma_f32_16x16x32_bf16 v[216:219], v[40:43], a[88:91], v[216:219]
v_cvt_pk_bf16_f32 v45, v34, v35
v_add_f32 v55, v55, v35
v_mfma_f32_16x16x32_bf16 v[220:223], v[40:43], a[92:95], v[220:223]
s_waitcnt lgkmcnt(15)
v_exp_f32 v36, v36
v_mfma_f32_16x16x32_bf16 v[24:27], a[32:35], a[160:163], 0
v_add_f32 v54, v54, v36
v_mfma_f32_16x16x32_bf16 v[24:27], a[36:39], a[164:167], v[24:27]
v_exp_f32 v37, v37
v_mfma_f32_16x16x32_bf16 v[24:27], a[40:43], a[168:171], v[24:27]
v_cvt_pk_bf16_f32 v46, v36, v37
v_add_f32 v55, v55, v37
v_mfma_f32_16x16x32_bf16 v[24:27], a[44:47], a[172:175], v[24:27]
v_exp_f32 v38, v38
v_mfma_f32_16x16x32_bf16 v[28:31], a[60:63], a[172:175], 0
v_add_f32 v54, v54, v38
v_mfma_f32_16x16x32_bf16 v[28:31], a[56:59], a[168:171], v[28:31]
v_exp_f32 v39, v39
v_mfma_f32_16x16x32_bf16 v[28:31], a[52:55], a[164:167], v[28:31]
v_cvt_pk_bf16_f32 v47, v38, v39
v_add_f32 v55, v55, v39
v_mfma_f32_16x16x32_bf16 v[28:31], a[48:51], a[160:163], v[28:31]
v_exp_f32 v24, v24
v_mfma_f32_16x16x32_bf16 v[224:227], v[44:47], a[64:67], v[224:227]
v_mfma_f32_16x16x32_bf16 v[228:231], v[44:47], a[68:71], v[228:231]
v_exp_f32 v25, v25
v_mfma_f32_16x16x32_bf16 v[232:235], v[44:47], a[72:75], v[232:235]
v_cvt_pk_bf16_f32 v40, v24, v25
v_mfma_f32_16x16x32_bf16 v[236:239], v[44:47], a[76:79], v[236:239]
v_exp_f32 v26, v26
v_mfma_f32_16x16x32_bf16 v[240:243], v[44:47], a[80:83], v[240:243]
v_mfma_f32_16x16x32_bf16 v[244:247], v[44:47], a[84:87], v[244:247]
s_waitcnt lgkmcnt(0)
v_exp_f32 v27, v27
v_mfma_f32_16x16x32_bf16 v[248:251], v[44:47], a[88:91], v[248:251]
v_cvt_pk_bf16_f32 v41, v26, v27
v_mfma_f32_16x16x32_bf16 v[252:255], v[44:47], a[92:95], v[252:255]
v_exp_f32 v28, v28
s_cbranch_scc0 L_loop6
L_last1_6:
s_branch L_fin
L_last0_6:
L_t6_0_0:
v_mfma_f32_16x16x32_bf16 v[32:35], a[0:3], a[176:179], 0
s_mov_b32 s14, s47
v_exp_f32 v29, v29
v_mfma_f32_16x16x32_bf16 v[32:35], a[4:7], a[180:183], v[32:35]
s_add_u32 s80, s46, 0
v_exp_f32 v30, v30
v_mfma_f32_16x16x32_bf16 v[32:35], a[8:11], a[184:187], v[32:35]
s_add_u32 s81, s46, 131072
v_exp_f32 v31, v31
v_mfma_f32_16x16x32_bf16 v[32:35], a[12:15], a[188:191], v[32:35]
s_add_u32 s82, s46, 262144
v_cvt_pk_bf16_f32 v42, v28, v29
v_cvt_pk_bf16_f32 v43, v30, v31
v_mfma_f32_16x16x32_bf16 v[36:39], a[28:31], a[188:191], 0
s_add_u32 s83, s46, 393216
s_add_u32 s84, s46, 524288
s_add_u32 s85, s46, 655360
v_mfma_f32_16x16x32_bf16 v[36:39], a[24:27], a[184:187], v[36:39]
s_add_u32 s86, s46, 786432
s_add_u32 s87, s46, 917504
v_exp_f32 v32, v32
v_mfma_f32_16x16x32_bf16 v[36:39], a[20:23], a[180:183], v[36:39]
s_add_u32 s88, s46, 1048576
v_exp_f32 v33, v33
v_mfma_f32_16x16x32_bf16 v[36:39], a[16:19], a[176:179], v[36:39]
s_add_u32 s89, s46, 1179648
v_exp_f32 v34, v34
v_mfma_f32_16x16x32_bf16 a[132:135], a[128:131], v[40:43], a[132:135]
s_add_u32 s90, s46, 1310720
v_exp_f32 v35, v35
v_mfma_f32_16x16x32_bf16 v[64:67], v[40:43], a[64:67], v[64:67]
s_add_u32 s91, s46, 1441792
v_add_f32 v48, v48, v32
v_exp_f32 v36, v36
v_mfma_f32_16x16x32_bf16 v[68:71], v[40:43], a[68:71], v[68:71]
s_nop 0
v_accvgpr_read_b32 v16, a132
v_rcp_f32 v13, v16
v_mfma_f32_16x16x32_bf16 v[72:75], v[40:43], a[72:75], v[72:75]
ds_write_b32 v60, v13
v_mfma_f32_16x16x32_bf16 v[76:79], v[40:43], a[76:79], v[76:79]
ds_read_b128 v[20:23], v61
v_exp_f32 v37, v37
v_mfma_f32_16x16x32_bf16 v[80:83], v[40:43], a[80:83], v[80:83]
v_exp_f32 v38, v38
v_mfma_f32_16x16x32_bf16 v[84:87], v[40:43], a[84:87], v[84:87]
v_exp_f32 v39, v39
v_mfma_f32_16x16x32_bf16 v[88:91], v[40:43], a[88:91], v[88:91]
v_add_f32 v49, v49, v33
v_add_f32 v48, v48, v34
v_mfma_f32_16x16x32_bf16 v[92:95], v[40:43], a[92:95], v[92:95]
v_add_f32 v49, v49, v35
v_cvt_pk_bf16_f32 v44, v32, v33
v_mfma_f32_16x16x32_bf16 v[24:27], a[0:3], a[192:195], 0
v_cvt_pk_bf16_f32 v45, v34, v35
v_add_f32 v48, v48, v36
v_mfma_f32_16x16x32_bf16 v[24:27], a[4:7], a[196:199], v[24:27]
v_add_f32 v49, v49, v37
v_cvt_pk_bf16_f32 v46, v36, v37
v_mfma_f32_16x16x32_bf16 v[24:27], a[8:11], a[200:203], v[24:27]
s_waitcnt lgkmcnt(0)
v_pk_mul_f32 v[64:65], v[64:65], v[20:21]
v_pk_mul_f32 v[68:69], v[68:69], v[20:21]
v_pk_mul_f32 v[80:81], v[80:81], v[20:21]
v_pk_mul_f32 v[84:85], v[84:85], v[20:21]
v_pk_mul_f32 v[66:67], v[66:67], v[22:23]
v_pk_mul_f32 v[70:71], v[70:71], v[22:23]
v_pk_mul_f32 v[82:83], v[82:83], v[22:23]
v_pk_mul_f32 v[86:87], v[86:87], v[22:23]
v_pk_mul_f32 v[72:73], v[72:73], v[20:21]
v_pk_mul_f32 v[76:77], v[76:77], v[20:21]
v_pk_mul_f32 v[88:89], v[88:89], v[20:21]
v_pk_mul_f32 v[92:93], v[92:93], v[20:21]
v_pk_mul_f32 v[74:75], v[74:75], v[22:23]
v_pk_mul_f32 v[78:79], v[78:79], v[22:23]
v_pk_mul_f32 v[90:91], v[90:91], v[22:23]
v_pk_mul_f32 v[94:95], v[94:95], v[22:23]
v_mfma_f32_16x16x32_bf16 v[24:27], a[12:15], a[204:207], v[24:27]
v_cvt_pk_bf16_f32 v64, v64, v68
v_cvt_pk_bf16_f32 v80, v80, v84
v_mfma_f32_16x16x32_bf16 v[28:31], a[28:31], a[204:207], 0
v_cvt_pk_bf16_f32 v66, v66, v70
v_cvt_pk_bf16_f32 v82, v82, v86
v_mfma_f32_16x16x32_bf16 v[28:31], a[24:27], a[200:203], v[28:31]
v_cvt_pk_bf16_f32 v68, v65, v69
v_cvt_pk_bf16_f32 v84, v81, v85
v_mfma_f32_16x16x32_bf16 v[28:31], a[20:23], a[196:199], v[28:31]
v_cvt_pk_bf16_f32 v70, v67, v71
v_cvt_pk_bf16_f32 v86, v83, v87
v_mfma_f32_16x16x32_bf16 v[28:31], a[16:19], a[192:195], v[28:31]
v_cvt_pk_bf16_f32 v65, v72, v76
v_cvt_pk_bf16_f32 v69, v73, v77
v_cvt_pk_bf16_f32 v81, v88, v92
v_cvt_pk_bf16_f32 v85, v89, v93
v_cvt_pk_bf16_f32 v67, v74, v78
v_cvt_pk_bf16_f32 v71, v75, v79
v_cvt_pk_bf16_f32 v83, v90, v94
v_cvt_pk_bf16_f32 v87, v91, v95
ds_write2_b64 v5, v[64:65], v[80:81] offset0:0 offset1:16
ds_write2_b64 v0, v[68:69], v[84:85] offset0:32 offset1:48
v_cvt_pk_bf16_f32 v47, v38, v39
v_add_f32 v48, v48, v38
v_add_f32 v49, v49, v39
v_mfma_f32_16x16x32_bf16 v[96:99], v[44:47], a[64:67], v[96:99]
ds_write2_b64 v5, v[66:67], v[82:83] offset0:80 offset1:64
v_mfma_f32_16x16x32_bf16 v[100:103], v[44:47], a[68:71], v[100:103]
v_add_f32 v48, v48, v49
v_mov_b32 v49, v48
v_mfma_f32_16x16x32_bf16 v[104:107], v[44:47], a[72:75], v[104:107]
ds_write2_b64 v0, v[70:71], v[86:87] offset0:112 offset1:96
v_mfma_f32_16x16x32_bf16 v[108:111], v[44:47], a[76:79], v[108:111]
v_permlane16_swap_b32 v48, v49
v_mfma_f32_16x16x32_bf16 v[112:115], v[44:47], a[80:83], v[112:115]
v_add_f32 v48, v48, v49
ds_read_b64_tr_b16 v[64:65], v56 offset:0
v_mfma_f32_16x16x32_bf16 v[116:119], v[44:47], a[84:87], v[116:119]
ds_read_b64_tr_b16 v[66:67], v57 offset:0
v_mov_b32 v49, v48
v_mfma_f32_16x16x32_bf16 v[120:123], v[44:47], a[88:91], v[120:123]
ds_read_b64_tr_b16 v[72:73], v56 offset:2048
v_permlane32_swap_b32 v48, v49
v_mfma_f32_16x16x32_bf16 v[124:127], v[44:47], a[92:95], v[124:127]
ds_read_b64_tr_b16 v[74:75], v57 offset:2048
v_max3_u32 v12, v12, v16, v13
v_mfma_f32_16x16x32_bf16 v[32:35], a[0:3], a[208:211], 0
ds_read_b64_tr_b16 v[80:81], v58 offset:0
v_add_f32 v48, v48, v49
v_mfma_f32_16x16x32_bf16 v[32:35], a[4:7], a[212:215], v[32:35]
ds_read_b64_tr_b16 v[82:83], v59 offset:0
v_rcp_f32 v13, v48
v_mfma_f32_16x16x32_bf16 v[32:35], a[8:11], a[216:219], v[32:35]
ds_write_b32 v60, v13
v_mfma_f32_16x16x32_bf16 v[32:35], a[12:15], a[220:223], v[32:35]
ds_read_b128 v[20:23], v61
ds_read_b64_tr_b16 v[88:89], v58 offset:2048
v_mfma_f32_16x16x32_bf16 v[36:39], a[28:31], a[220:223], 0
s_waitcnt lgkmcnt(7)
buffer_store_dwordx4 v[64:67], v6, s[12:15], s80 offen offset:0 sc1
v_mfma_f32_16x16x32_bf16 v[36:39], a[24:27], a[216:219], v[36:39]
ds_read_b64_tr_b16 v[90:91], v59 offset:2048
s_waitcnt lgkmcnt(6)
buffer_store_dwordx4 v[72:75], v6, s[12:15], s81 offen offset:0 sc1
v_mfma_f32_16x16x32_bf16 v[36:39], a[20:23], a[212:215], v[36:39]
s_waitcnt lgkmcnt(4)
buffer_store_dwordx4 v[80:83], v6, s[12:15], s80 offen offset:128 sc1
v_mfma_f32_16x16x32_bf16 v[36:39], a[16:19], a[208:211], v[36:39]
v_exp_f32 v24, v24
s_waitcnt lgkmcnt(2)
v_pk_mul_f32 v[96:97], v[96:97], v[20:21]
v_pk_mul_f32 v[100:101], v[100:101], v[20:21]
v_pk_mul_f32 v[112:113], v[112:113], v[20:21]
v_pk_mul_f32 v[116:117], v[116:117], v[20:21]
v_pk_mul_f32 v[98:99], v[98:99], v[22:23]
v_pk_mul_f32 v[102:103], v[102:103], v[22:23]
v_pk_mul_f32 v[114:115], v[114:115], v[22:23]
v_pk_mul_f32 v[118:119], v[118:119], v[22:23]
v_cvt_pk_bf16_f32 v96, v96, v100
v_cvt_pk_bf16_f32 v112, v112, v116
v_cvt_pk_bf16_f32 v98, v98, v102
v_cvt_pk_bf16_f32 v114, v114, v118
v_pk_mul_f32 v[104:105], v[104:105], v[20:21]
v_pk_mul_f32 v[108:109], v[108:109], v[20:21]
v_cvt_pk_bf16_f32 v100, v97, v101
v_pk_mul_f32 v[120:121], v[120:121], v[20:21]
v_pk_mul_f32 v[124:125], v[124:125], v[20:21]
v_cvt_pk_bf16_f32 v116, v113, v117
v_pk_mul_f32 v[106:107], v[106:107], v[22:23]
v_pk_mul_f32 v[110:111], v[110:111], v[22:23]
v_cvt_pk_bf16_f32 v102, v99, v103
v_pk_mul_f32 v[122:123], v[122:123], v[22:23]
v_pk_mul_f32 v[126:127], v[126:127], v[22:23]
v_cvt_pk_bf16_f32 v118, v115, v119
v_cvt_pk_bf16_f32 v97, v104, v108
v_cvt_pk_bf16_f32 v101, v105, v109
v_cvt_pk_bf16_f32 v113, v120, v124
v_cvt_pk_bf16_f32 v117, v121, v125
v_cvt_pk_bf16_f32 v99, v106, v110
v_cvt_pk_bf16_f32 v103, v107, v111
v_cvt_pk_bf16_f32 v115, v122, v126
v_cvt_pk_bf16_f32 v119, v123, v127
ds_write2_b64 v5, v[96:97], v[112:113] offset0:0 offset1:16
ds_write2_b64 v0, v[100:101], v[116:117] offset0:32 offset1:48
v_exp_f32 v25, v25
v_exp_f32 v26, v26
ds_write2_b64 v5, v[98:99], v[114:115] offset0:80 offset1:64
v_exp_f32 v27, v27
v_exp_f32 v28, v28
v_exp_f32 v29, v29
v_exp_f32 v30, v30
ds_write2_b64 v0, v[102:103], v[118:119] offset0:112 offset1:96
v_exp_f32 v31, v31
v_add_f32 v50, v50, v24
v_add_f32 v51, v51, v25
v_add_f32 v50, v50, v26
v_add_f32 v51, v51, v27
ds_read_b64_tr_b16 v[96:97], v56 offset:0
v_cvt_pk_bf16_f32 v40, v24, v25
ds_read_b64_tr_b16 v[98:99], v57 offset:0
v_cvt_pk_bf16_f32 v41, v26, v27
v_add_f32 v50, v50, v28
v_add_f32 v51, v51, v29
v_cvt_pk_bf16_f32 v42, v28, v29
v_cvt_pk_bf16_f32 v43, v30, v31
v_add_f32 v50, v50, v30
v_add_f32 v51, v51, v31
v_mfma_f32_16x16x32_bf16 v[128:131], v[40:43], a[64:67], v[128:131]
ds_read_b64_tr_b16 v[104:105], v56 offset:2048
v_add_f32 v50, v50, v51
v_mfma_f32_16x16x32_bf16 v[132:135], v[40:43], a[68:71], v[132:135]
ds_read_b64_tr_b16 v[106:107], v57 offset:2048
v_mov_b32 v51, v50
v_mfma_f32_16x16x32_bf16 v[136:139], v[40:43], a[72:75], v[136:139]
s_waitcnt lgkmcnt(8)
buffer_store_dwordx4 v[88:91], v6, s[12:15], s81 offen offset:128 sc1
v_mfma_f32_16x16x32_bf16 v[140:143], v[40:43], a[76:79], v[140:143]
ds_read_b64_tr_b16 v[112:113], v58 offset:0
v_permlane16_swap_b32 v50, v51
v_mfma_f32_16x16x32_bf16 v[144:147], v[40:43], a[80:83], v[144:147]
ds_read_b64_tr_b16 v[114:115], v59 offset:0
v_add_f32 v50, v50, v51
v_mfma_f32_16x16x32_bf16 v[148:151], v[40:43], a[84:87], v[148:151]
s_waitcnt lgkmcnt(4)
buffer_store_dwordx4 v[96:99], v6, s[12:15], s82 offen offset:0 sc1
v_mfma_f32_16x16x32_bf16 v[152:155], v[40:43], a[88:91], v[152:155]
ds_read_b64_tr_b16 v[120:121], v58 offset:2048
v_mov_b32 v51, v50
v_mfma_f32_16x16x32_bf16 v[156:159], v[40:43], a[92:95], v[156:159]
ds_read_b64_tr_b16 v[122:123], v59 offset:2048
v_permlane32_swap_b32 v50, v51
v_mfma_f32_16x16x32_bf16 v[24:27], a[0:3], a[224:227], 0
s_waitcnt lgkmcnt(4)
buffer_store_dwordx4 v[104:107], v6, s[12:15], s83 offen offset:0 sc1
v_mfma_f32_16x16x32_bf16 v[24:27], a[4:7], a[228:231], v[24:27]
s_waitcnt lgkmcnt(2)
buffer_store_dwordx4 v[112:115], v6, s[12:15], s82 offen offset:128 sc1
v_mfma_f32_16x16x32_bf16 v[24:27], a[8:11], a[232:235], v[24:27]
v_max3_u32 v12, v12, v48, v13
v_add_f32 v50, v50, v51
v_mfma_f32_16x16x32_bf16 v[24:27], a[12:15], a[236:239], v[24:27]
v_rcp_f32 v13, v50
v_mfma_f32_16x16x32_bf16 v[28:31], a[28:31], a[236:239], 0
ds_write_b32 v60, v13
v_mfma_f32_16x16x32_bf16 v[28:31], a[24:27], a[232:235], v[28:31]
ds_read_b128 v[20:23], v61
v_exp_f32 v32, v32
v_mfma_f32_16x16x32_bf16 v[28:31], a[20:23], a[228:231], v[28:31]
s_waitcnt lgkmcnt(2)
buffer_store_dwordx4 v[120:123], v6, s[12:15], s83 offen offset:128 sc1
v_mfma_f32_16x16x32_bf16 v[28:31], a[16:19], a[224:227], v[28:31]
v_exp_f32 v33, v33
v_exp_f32 v34, v34
v_exp_f32 v35, v35
v_exp_f32 v36, v36
v_exp_f32 v37, v37
v_exp_f32 v38, v38
v_exp_f32 v39, v39
v_cvt_pk_bf16_f32 v44, v32, v33
v_cvt_pk_bf16_f32 v45, v34, v35
v_cvt_pk_bf16_f32 v46, v36, v37
s_waitcnt lgkmcnt(0)
v_pk_mul_f32 v[128:129], v[128:129], v[20:21]
v_pk_mul_f32 v[132:133], v[132:133], v[20:21]
v_pk_mul_f32 v[144:145], v[144:145], v[20:21]
v_pk_mul_f32 v[148:149], v[148:149], v[20:21]
v_pk_mul_f32 v[130:131], v[130:131], v[22:23]
v_pk_mul_f32 v[134:135], v[134:135], v[22:23]
v_pk_mul_f32 v[146:147], v[146:147], v[22:23]
v_pk_mul_f32 v[150:151], v[150:151], v[22:23]
v_cvt_pk_bf16_f32 v128, v128, v132
v_cvt_pk_bf16_f32 v144, v144, v148
v_cvt_pk_bf16_f32 v130, v130, v134
v_cvt_pk_bf16_f32 v146, v146, v150
v_pk_mul_f32 v[136:137], v[136:137], v[20:21]
v_pk_mul_f32 v[140:141], v[140:141], v[20:21]
v_cvt_pk_bf16_f32 v132, v129, v133
v_pk_mul_f32 v[152:153], v[152:153], v[20:21]
v_pk_mul_f32 v[156:157], v[156:157], v[20:21]
v_cvt_pk_bf16_f32 v148, v145, v149
v_pk_mul_f32 v[138:139], v[138:139], v[22:23]
v_pk_mul_f32 v[142:143], v[142:143], v[22:23]
v_cvt_pk_bf16_f32 v134, v131, v135
v_pk_mul_f32 v[154:155], v[154:155], v[22:23]
v_pk_mul_f32 v[158:159], v[158:159], v[22:23]
v_cvt_pk_bf16_f32 v150, v147, v151
v_cvt_pk_bf16_f32 v129, v136, v140
v_cvt_pk_bf16_f32 v133, v137, v141
v_cvt_pk_bf16_f32 v145, v152, v156
v_cvt_pk_bf16_f32 v149, v153, v157
v_cvt_pk_bf16_f32 v131, v138, v142
v_cvt_pk_bf16_f32 v135, v139, v143
v_cvt_pk_bf16_f32 v147, v154, v158
v_cvt_pk_bf16_f32 v151, v155, v159
ds_write2_b64 v5, v[128:129], v[144:145] offset0:0 offset1:16
ds_write2_b64 v0, v[132:133], v[148:149] offset0:32 offset1:48
v_cvt_pk_bf16_f32 v47, v38, v39
v_max3_u32 v12, v12, v50, v13
v_exp_f32 v24, v24
v_mfma_f32_16x16x32_bf16 a[136:139], a[128:131], v[44:47], a[136:139]
ds_write2_b64 v5, v[130:131], v[146:147] offset0:80 offset1:64
v_mfma_f32_16x16x32_bf16 v[160:163], v[44:47], a[64:67], v[160:163]
v_exp_f32 v25, v25
v_mfma_f32_16x16x32_bf16 v[164:167], v[44:47], a[68:71], v[164:167]
ds_write2_b64 v0, v[134:135], v[150:151] offset0:112 offset1:96
v_mfma_f32_16x16x32_bf16 v[168:171], v[44:47], a[72:75], v[168:171]
s_nop 1
v_accvgpr_read_b32 v18, a136
v_rcp_f32 v13, v18
v_mfma_f32_16x16x32_bf16 v[172:175], v[44:47], a[76:79], v[172:175]
ds_read_b64_tr_b16 v[128:129], v56 offset:0
ds_read_b64_tr_b16 v[130:131], v57 offset:0
v_mfma_f32_16x16x32_bf16 v[176:179], v[44:47], a[80:83], v[176:179]
ds_read_b64_tr_b16 v[136:137], v56 offset:2048
ds_read_b64_tr_b16 v[138:139], v57 offset:2048
v_mfma_f32_16x16x32_bf16 v[180:183], v[44:47], a[84:87], v[180:183]
ds_write_b32 v60, v13
v_mfma_f32_16x16x32_bf16 v[184:187], v[44:47], a[88:91], v[184:187]
ds_read_b128 v[20:23], v61
v_exp_f32 v26, v26
v_mfma_f32_16x16x32_bf16 v[188:191], v[44:47], a[92:95], v[188:191]
ds_read_b64_tr_b16 v[144:145], v58 offset:0
ds_read_b64_tr_b16 v[146:147], v59 offset:0
v_mfma_f32_16x16x32_bf16 v[32:35], a[0:3], a[240:243], 0
ds_read_b64_tr_b16 v[152:153], v58 offset:2048
ds_read_b64_tr_b16 v[154:155], v59 offset:2048
v_mfma_f32_16x16x32_bf16 v[32:35], a[4:7], a[244:247], v[32:35]
v_exp_f32 v27, v27
v_mfma_f32_16x16x32_bf16 v[32:35], a[8:11], a[248:251], v[32:35]
v_exp_f32 v28, v28
v_mfma_f32_16x16x32_bf16 v[32:35], a[12:15], a[252:255], v[32:35]
s_waitcnt lgkmcnt(8)
buffer_store_dwordx4 v[128:131], v6, s[12:15], s84 offen offset:0 sc1
v_mfma_f32_16x16x32_bf16 v[36:39], a[28:31], a[252:255], 0
s_waitcnt lgkmcnt(6)
buffer_store_dwordx4 v[136:139], v6, s[12:15], s85 offen offset:0 sc1
s_waitcnt lgkmcnt(4)
v_pk_mul_f32 v[160:161], v[160:161], v[20:21]
v_pk_mul_f32 v[164:165], v[164:165], v[20:21]
v_pk_mul_f32 v[176:177], v[176:177], v[20:21]
v_pk_mul_f32 v[180:181], v[180:181], v[20:21]
v_pk_mul_f32 v[162:163], v[162:163], v[22:23]
v_pk_mul_f32 v[166:167], v[166:167], v[22:23]
v_pk_mul_f32 v[178:179], v[178:179], v[22:23]
v_pk_mul_f32 v[182:183], v[182:183], v[22:23]
v_pk_mul_f32 v[168:169], v[168:169], v[20:21]
v_pk_mul_f32 v[172:173], v[172:173], v[20:21]
v_pk_mul_f32 v[184:185], v[184:185], v[20:21]
v_pk_mul_f32 v[188:189], v[188:189], v[20:21]
v_pk_mul_f32 v[170:171], v[170:171], v[22:23]
v_pk_mul_f32 v[174:175], v[174:175], v[22:23]
v_pk_mul_f32 v[186:187], v[186:187], v[22:23]
v_pk_mul_f32 v[190:191], v[190:191], v[22:23]
v_mfma_f32_16x16x32_bf16 v[36:39], a[24:27], a[248:251], v[36:39]
s_waitcnt lgkmcnt(2)
buffer_store_dwordx4 v[144:147], v6, s[12:15], s84 offen offset:128 sc1
v_mfma_f32_16x16x32_bf16 v[36:39], a[20:23], a[244:247], v[36:39]
s_waitcnt lgkmcnt(0)
buffer_store_dwordx4 v[152:155], v6, s[12:15], s85 offen offset:128 sc1
v_mfma_f32_16x16x32_bf16 v[36:39], a[16:19], a[240:243], v[36:39]
v_cvt_pk_bf16_f32 v160, v160, v164
v_cvt_pk_bf16_f32 v176, v176, v180
v_cvt_pk_bf16_f32 v162, v162, v166
v_cvt_pk_bf16_f32 v178, v178, v182
v_cvt_pk_bf16_f32 v164, v161, v165
v_cvt_pk_bf16_f32 v180, v177, v181
v_cvt_pk_bf16_f32 v166, v163, v167
v_cvt_pk_bf16_f32 v182, v179, v183
v_cvt_pk_bf16_f32 v161, v168, v172
v_cvt_pk_bf16_f32 v165, v169, v173
v_cvt_pk_bf16_f32 v177, v184, v188
v_cvt_pk_bf16_f32 v181, v185, v189
v_cvt_pk_bf16_f32 v163, v170, v174
v_cvt_pk_bf16_f32 v167, v171, v175
v_cvt_pk_bf16_f32 v179, v186, v190
v_cvt_pk_bf16_f32 v183, v187, v191
ds_write2_b64 v5, v[160:161], v[176:177] offset0:0 offset1:16
ds_write2_b64 v0, v[164:165], v[180:181] offset0:32 offset1:48
v_exp_f32 v29, v29
v_add_f32 v52, v52, v24
v_add_f32 v53, v53, v25
ds_write2_b64 v5, v[162:163], v[178:179] offset0:80 offset1:64
v_exp_f32 v30, v30
v_exp_f32 v31, v31
v_add_f32 v52, v52, v26
v_add_f32 v53, v53, v27
v_add_f32 v52, v52, v28
ds_write2_b64 v0, v[166:167], v[182:183] offset0:112 offset1:96
v_add_f32 v53, v53, v29
v_add_f32 v52, v52, v30
v_add_f32 v53, v53, v31
v_add_f32 v52, v52, v53
v_mov_b32 v53, v52
v_cvt_pk_bf16_f32 v40, v24, v25
v_cvt_pk_bf16_f32 v41, v26, v27
ds_read_b64_tr_b16 v[160:161], v56 offset:0
v_permlane16_swap_b32 v52, v53
ds_read_b64_tr_b16 v[162:163], v57 offset:0
v_add_f32 v52, v52, v53
v_mov_b32 v53, v52
v_cvt_pk_bf16_f32 v42, v28, v29
v_cvt_pk_bf16_f32 v43, v30, v31
v_permlane32_swap_b32 v52, v53
s_nop 0
v_mfma_f32_16x16x32_bf16 v[192:195], v[40:43], a[64:67], v[192:195]
ds_read_b64_tr_b16 v[168:169], v56 offset:2048
v_max3_u32 v12, v12, v18, v13
v_mfma_f32_16x16x32_bf16 v[196:199], v[40:43], a[68:71], v[196:199]
ds_read_b64_tr_b16 v[170:171], v57 offset:2048
v_add_f32 v52, v52, v53
v_mfma_f32_16x16x32_bf16 v[200:203], v[40:43], a[72:75], v[200:203]
ds_read_b64_tr_b16 v[176:177], v58 offset:0
v_rcp_f32 v13, v52
v_mfma_f32_16x16x32_bf16 v[204:207], v[40:43], a[76:79], v[204:207]
ds_write_b32 v60, v13
v_mfma_f32_16x16x32_bf16 v[208:211], v[40:43], a[80:83], v[208:211]
ds_read_b128 v[20:23], v61
ds_read_b64_tr_b16 v[178:179], v59 offset:0
v_mfma_f32_16x16x32_bf16 v[212:215], v[40:43], a[84:87], v[212:215]
s_waitcnt lgkmcnt(6)
buffer_store_dwordx4 v[160:163], v6, s[12:15], s86 offen offset:0 sc1
v_mfma_f32_16x16x32_bf16 v[216:219], v[40:43], a[88:91], v[216:219]
ds_read_b64_tr_b16 v[184:185], v58 offset:2048
ds_read_b64_tr_b16 v[186:187], v59 offset:2048
v_mfma_f32_16x16x32_bf16 v[220:223], v[40:43], a[92:95], v[220:223]
s_waitcnt lgkmcnt(6)
buffer_store_dwordx4 v[168:171], v6, s[12:15], s87 offen offset:0 sc1
v_exp_f32 v32, v32
v_exp_f32 v33, v33
v_exp_f32 v34, v34
v_exp_f32 v35, v35
s_waitcnt lgkmcnt(3)
v_pk_mul_f32 v[192:193], v[192:193], v[20:21]
v_pk_mul_f32 v[196:197], v[196:197], v[20:21]
v_pk_mul_f32 v[208:209], v[208:209], v[20:21]
v_pk_mul_f32 v[212:213], v[212:213], v[20:21]
v_pk_mul_f32 v[194:195], v[194:195], v[22:23]
v_pk_mul_f32 v[198:199], v[198:199], v[22:23]
v_pk_mul_f32 v[210:211], v[210:211], v[22:23]
v_pk_mul_f32 v[214:215], v[214:215], v[22:23]
v_cvt_pk_bf16_f32 v192, v192, v196
v_cvt_pk_bf16_f32 v208, v208, v212
v_cvt_pk_bf16_f32 v194, v194, v198
v_cvt_pk_bf16_f32 v210, v210, v214
v_pk_mul_f32 v[200:201], v[200:201], v[20:21]
v_pk_mul_f32 v[204:205], v[204:205], v[20:21]
v_cvt_pk_bf16_f32 v196, v193, v197
v_pk_mul_f32 v[216:217], v[216:217], v[20:21]
v_pk_mul_f32 v[220:221], v[220:221], v[20:21]
v_cvt_pk_bf16_f32 v212, v209, v213
v_pk_mul_f32 v[202:203], v[202:203], v[22:23]
v_pk_mul_f32 v[206:207], v[206:207], v[22:23]
v_cvt_pk_bf16_f32 v198, v195, v199
v_pk_mul_f32 v[218:219], v[218:219], v[22:23]
v_pk_mul_f32 v[222:223], v[222:223], v[22:23]
v_cvt_pk_bf16_f32 v214, v211, v215
v_cvt_pk_bf16_f32 v193, v200, v204
v_cvt_pk_bf16_f32 v197, v201, v205
v_cvt_pk_bf16_f32 v209, v216, v220
v_cvt_pk_bf16_f32 v213, v217, v221
v_cvt_pk_bf16_f32 v195, v202, v206
v_cvt_pk_bf16_f32 v199, v203, v207
v_cvt_pk_bf16_f32 v211, v218, v222
v_cvt_pk_bf16_f32 v215, v219, v223
ds_write2_b64 v5, v[192:193], v[208:209] offset0:0 offset1:16
ds_write2_b64 v0, v[196:197], v[212:213] offset0:32 offset1:48
v_exp_f32 v36, v36
v_exp_f32 v37, v37
ds_write2_b64 v5, v[194:195], v[210:211] offset0:80 offset1:64
v_add_f32 v54, v54, v32
v_add_f32 v55, v55, v33
v_exp_f32 v38, v38
v_exp_f32 v39, v39
v_add_f32 v54, v54, v34
ds_write2_b64 v0, v[198:199], v[214:215] offset0:112 offset1:96
v_add_f32 v55, v55, v35
s_waitcnt lgkmcnt(6)
buffer_store_dwordx4 v[176:179], v6, s[12:15], s86 offen offset:128 sc1
ds_read_b64_tr_b16 v[192:193], v56 offset:0
v_add_f32 v54, v54, v36
ds_read_b64_tr_b16 v[194:195], v57 offset:0
v_add_f32 v55, v55, v37
v_add_f32 v54, v54, v38
v_add_f32 v55, v55, v39
v_add_f32 v54, v54, v55
v_mov_b32 v55, v54
v_cvt_pk_bf16_f32 v44, v32, v33
v_cvt_pk_bf16_f32 v45, v34, v35
v_permlane16_swap_b32 v54, v55
v_add_f32 v54, v54, v55
v_mov_b32 v55, v54
v_cvt_pk_bf16_f32 v46, v36, v37
v_cvt_pk_bf16_f32 v47, v38, v39
v_permlane32_swap_b32 v54, v55
s_nop 0
v_mfma_f32_16x16x32_bf16 v[224:227], v[44:47], a[64:67], v[224:227]
ds_read_b64_tr_b16 v[200:201], v56 offset:2048
v_max3_u32 v12, v12, v52, v13
v_mfma_f32_16x16x32_bf16 v[228:231], v[44:47], a[68:71], v[228:231]
ds_read_b64_tr_b16 v[202:203], v57 offset:2048
v_add_f32 v54, v54, v55
v_mfma_f32_16x16x32_bf16 v[232:235], v[44:47], a[72:75], v[232:235]
s_waitcnt lgkmcnt(8)
buffer_store_dwordx4 v[184:187], v6, s[12:15], s87 offen offset:128 sc1
v_mfma_f32_16x16x32_bf16 v[236:239], v[44:47], a[76:79], v[236:239]
ds_read_b64_tr_b16 v[208:209], v58 offset:0
v_rcp_f32 v13, v54
v_mfma_f32_16x16x32_bf16 v[240:243], v[44:47], a[80:83], v[240:243]
ds_write_b32 v60, v13
v_mfma_f32_16x16x32_bf16 v[244:247], v[44:47], a[84:87], v[244:247]
ds_read_b128 v[20:23], v61
ds_read_b64_tr_b16 v[210:211], v59 offset:0
v_mfma_f32_16x16x32_bf16 v[248:251], v[44:47], a[88:91], v[248:251]
s_waitcnt lgkmcnt(6)
buffer_store_dwordx4 v[192:195], v6, s[12:15], s88 offen offset:0 sc1
v_mfma_f32_16x16x32_bf16 v[252:255], v[44:47], a[92:95], v[252:255]
ds_read_b64_tr_b16 v[216:217], v58 offset:2048
ds_read_b64_tr_b16 v[218:219], v59 offset:2048
s_waitcnt lgkmcnt(6)
buffer_store_dwordx4 v[200:203], v6, s[12:15], s89 offen offset:0 sc1
v_max3_u32 v12, v12, v54, v13
s_waitcnt lgkmcnt(3)
v_pk_mul_f32 v[224:225], v[224:225], v[20:21]
v_pk_mul_f32 v[228:229], v[228:229], v[20:21]
v_pk_mul_f32 v[240:241], v[240:241], v[20:21]
v_pk_mul_f32 v[244:245], v[244:245], v[20:21]
v_pk_mul_f32 v[226:227], v[226:227], v[22:23]
v_pk_mul_f32 v[230:231], v[230:231], v[22:23]
v_pk_mul_f32 v[242:243], v[242:243], v[22:23]
v_pk_mul_f32 v[246:247], v[246:247], v[22:23]
v_cvt_pk_bf16_f32 v224, v224, v228
v_cvt_pk_bf16_f32 v240, v240, v244
v_cvt_pk_bf16_f32 v226, v226, v230
v_cvt_pk_bf16_f32 v242, v242, v246
v_pk_mul_f32 v[232:233], v[232:233], v[20:21]
v_pk_mul_f32 v[236:237], v[236:237], v[20:21]
v_cvt_pk_bf16_f32 v228, v225, v229
v_pk_mul_f32 v[248:249], v[248:249], v[20:21]
v_pk_mul_f32 v[252:253], v[252:253], v[20:21]
v_cvt_pk_bf16_f32 v244, v241, v245
v_pk_mul_f32 v[234:235], v[234:235], v[22:23]
v_pk_mul_f32 v[238:239], v[238:239], v[22:23]
v_cvt_pk_bf16_f32 v230, v227, v231
v_pk_mul_f32 v[250:251], v[250:251], v[22:23]
v_pk_mul_f32 v[254:255], v[254:255], v[22:23]
v_cvt_pk_bf16_f32 v246, v243, v247
v_cvt_pk_bf16_f32 v225, v232, v236
v_cvt_pk_bf16_f32 v229, v233, v237
v_cvt_pk_bf16_f32 v241, v248, v252
v_cvt_pk_bf16_f32 v245, v249, v253
v_cvt_pk_bf16_f32 v227, v234, v238
v_cvt_pk_bf16_f32 v231, v235, v239
v_cvt_pk_bf16_f32 v243, v250, v254
v_cvt_pk_bf16_f32 v247, v251, v255
ds_write2_b64 v5, v[224:225], v[240:241] offset0:0 offset1:16
ds_write2_b64 v0, v[228:229], v[244:245] offset0:32 offset1:48
s_waitcnt lgkmcnt(4)
buffer_store_dwordx4 v[208:211], v6, s[12:15], s88 offen offset:128 sc1
ds_write2_b64 v5, v[226:227], v[242:243] offset0:80 offset1:64
s_waitcnt lgkmcnt(3)
buffer_store_dwordx4 v[216:219], v6, s[12:15], s89 offen offset:128 sc1
ds_write2_b64 v0, v[230:231], v[246:247] offset0:112 offset1:96
ds_read_b64_tr_b16 v[224:225], v56 offset:0
ds_read_b64_tr_b16 v[226:227], v57 offset:0
ds_read_b64_tr_b16 v[232:233], v56 offset:2048
ds_read_b64_tr_b16 v[234:235], v57 offset:2048
ds_read_b64_tr_b16 v[240:241], v58 offset:0
ds_read_b64_tr_b16 v[242:243], v59 offset:0
ds_read_b64_tr_b16 v[248:249], v58 offset:2048
ds_read_b64_tr_b16 v[250:251], v59 offset:2048
s_waitcnt lgkmcnt(6)
buffer_store_dwordx4 v[224:227], v6, s[12:15], s90 offen offset:0 sc1
s_waitcnt lgkmcnt(4)
buffer_store_dwordx4 v[232:235], v6, s[12:15], s91 offen offset:0 sc1
s_waitcnt lgkmcnt(2)
buffer_store_dwordx4 v[240:243], v6, s[12:15], s90 offen offset:128 sc1
s_waitcnt lgkmcnt(0)
buffer_store_dwordx4 v[248:251], v6, s[12:15], s91 offen offset:128 sc1
s_waitcnt vmcnt(24)
s_branch L_fin
L_fin:
s_barrier
v_cmp_lt_u32 vcc, 0x53800000, v12
s_nop 4
s_cbranch_vccnz L_slow
L_end:
s_endpgm
L_spin_1:
ds_read_b32 v11, v9
s_waitcnt lgkmcnt(0)
v_cmp_gt_u32 vcc, s33, v11
s_nop 4
s_cbranch_vccnz L_spin_1
s_branch L_spinret_2
L_spin_3:
ds_read_b32 v11, v9
s_waitcnt lgkmcnt(0)
v_cmp_gt_u32 vcc, s33, v11
s_nop 4
s_cbranch_vccnz L_spin_3
s_branch L_spinret_4
L_spin_5:
ds_read_b32 v11, v9
s_waitcnt lgkmcnt(0)
v_cmp_gt_u32 vcc, s33, v11
s_nop 4
s_cbranch_vccnz L_spin_5
s_branch L_spinret_6
L_spin_7:
ds_read_b32 v11, v9
s_waitcnt lgkmcnt(0)
v_cmp_gt_u32 vcc, s33, v11
s_nop 4
s_cbranch_vccnz L_spin_7
s_branch L_spinret_8
L_spin_9:
ds_read_b32 v11, v9
s_waitcnt lgkmcnt(0)
v_cmp_gt_u32 vcc, s33, v11
s_nop 4
s_cbranch_vccnz L_spin_9
s_branch L_spinret_10
L_spin_11:
ds_read_b32 v11, v9
s_waitcnt lgkmcnt(0)
v_cmp_gt_u32 vcc, s33, v11
s_nop 4
s_cbranch_vccnz L_spin_11
s_branch L_spinret_12
L_spin_13:
ds_read_b32 v11, v9
s_waitcnt lgkmcnt(0)
v_cmp_gt_u32 vcc, s33, v11
s_nop 4
s_cbranch_vccnz L_spin_13
s_branch L_spinret_14
L_spin_15:
ds_read_b32 v11, v9
s_waitcnt lgkmcnt(0)
v_cmp_gt_u32 vcc, s33, v11
s_nop 4
s_cbranch_vccnz L_spin_15
s_branch L_spinret_16
L_spin_17:
ds_read_b32 v11, v9
s_waitcnt lgkmcnt(0)
v_cmp_gt_u32 vcc, s33, v11
s_nop 4
s_cbranch_vccnz L_spin_17
s_branch L_spinret_18
L_spin_19:
ds_read_b32 v11, v9
s_waitcnt lgkmcnt(0)
v_cmp_gt_u32 vcc, s33, v11
s_nop 4
s_cbranch_vccnz L_spin_19
s_branch L_spinret_20
L_spin_21:
ds_read_b32 v11, v9
s_waitcnt lgkmcnt(0)
v_cmp_gt_u32 vcc, s33, v11
s_nop 4
s_cbranch_vccnz L_spin_21
s_branch L_spinret_22
L_spin_23:
ds_read_b32 v11, v9
s_waitcnt lgkmcnt(0)
v_cmp_gt_u32 vcc, s33, v11
s_nop 4
s_cbranch_vccnz L_spin_23
s_branch L_spinret_24
L_spin_25:
ds_read_b32 v11, v9
s_waitcnt lgkmcnt(0)
v_cmp_gt_u32 vcc, s33, v11
s_nop 4
s_cbranch_vccnz L_spin_25
s_branch L_spinret_26
L_spin_27:
ds_read_b32 v11, v9
s_waitcnt lgkmcnt(0)
v_cmp_gt_u32 vcc, s33, v11
s_nop 4
s_cbranch_vccnz L_spin_27
s_branch L_spinret_28
L_spin_29:
ds_read_b32 v11, v9
s_waitcnt lgkmcnt(0)
v_cmp_gt_u32 vcc, s33, v11
s_nop 4
s_cbranch_vccnz L_spin_29
s_branch L_spinret_30
L_spin_31:
ds_read_b32 v11, v9
s_waitcnt lgkmcnt(0)
v_cmp_gt_u32 vcc, s33, v11
s_nop 4
s_cbranch_vccnz L_spin_31
s_branch L_spinret_32
L_spin_33:
ds_read_b32 v11, v9
s_waitcnt lgkmcnt(0)
v_cmp_gt_u32 vcc, s33, v11
s_nop 4
s_cbranch_vccnz L_spin_33
s_branch L_spinret_34
L_spin_35:
ds_read_b32 v11, v9
s_waitcnt lgkmcnt(0)
v_cmp_gt_u32 vcc, s33, v11
s_nop 4
s_cbranch_vccnz L_spin_35
s_branch L_spinret_36
L_spin_37:
ds_read_b32 v11, v9
s_waitcnt lgkmcnt(0)
v_cmp_gt_u32 vcc, s33, v11
s_nop 4
s_cbranch_vccnz L_spin_37
s_branch L_spinret_38
L_spin_39:
ds_read_b32 v11, v9
s_waitcnt lgkmcnt(0)
v_cmp_gt_u32 vcc, s33, v11
s_nop 4
s_cbranch_vccnz L_spin_39
s_branch L_spinret_40
L_spin_41:
ds_read_b32 v11, v9
s_waitcnt lgkmcnt(0)
v_cmp_gt_u32 vcc, s33, v11
s_nop 4
s_cbranch_vccnz L_spin_41
s_branch L_spinret_42
L_spin_43:
ds_read_b32 v11, v9
s_waitcnt lgkmcnt(0)
v_cmp_gt_u32 vcc, s33, v11
s_nop 4
s_cbranch_vccnz L_spin_43
s_branch L_spinret_44
L_spin_45:
ds_read_b32 v11, v9
s_waitcnt lgkmcnt(0)
v_cmp_gt_u32 vcc, s33, v11
s_nop 4
s_cbranch_vccnz L_spin_45
s_branch L_spinret_46
L_spin_47:
ds_read_b32 v11, v9
s_waitcnt lgkmcnt(0)
v_cmp_gt_u32 vcc, s33, v11
s_nop 4
s_cbranch_vccnz L_spin_47
s_branch L_spinret_48
L_spin_49:
ds_read_b32 v11, v9
s_waitcnt lgkmcnt(0)
v_cmp_gt_u32 vcc, s33, v11
s_nop 4
s_cbranch_vccnz L_spin_49
s_branch L_spinret_50
L_spin_51:
ds_read_b32 v11, v9
s_waitcnt lgkmcnt(0)
v_cmp_gt_u32 vcc, s33, v11
s_nop 4
s_cbranch_vccnz L_spin_51
s_branch L_spinret_52
L_spin_53:
ds_read_b32 v11, v9
s_waitcnt lgkmcnt(0)
v_cmp_gt_u32 vcc, s33, v11
s_nop 4
s_cbranch_vccnz L_spin_53
s_branch L_spinret_54
L_spin_55:
ds_read_b32 v11, v9
s_waitcnt lgkmcnt(0)
v_cmp_gt_u32 vcc, s33, v11
s_nop 4
s_cbranch_vccnz L_spin_55
s_branch L_spinret_56
L_spin_57:
ds_read_b32 v11, v9
s_waitcnt lgkmcnt(0)
v_cmp_gt_u32 vcc, s33, v11
s_nop 4
s_cbranch_vccnz L_spin_57
s_branch L_spinret_58
L_slow:
s_waitcnt vmcnt(0)
v_mbcnt_lo_u32_b32 v0, -1, 0
v_mbcnt_hi_u32_b32 v0, -1, v0
v_lshrrev_b32 v54, 4, v0
v_and_b32 v51, 15, v0
v_lshlrev_b32 v53, 15, v54
v_lshl_add_u32 v53, v51, 4, v53
v_lshlrev_b32 v54, 2, v54
s_lshl_b32 s77, s72, 6
v_add_u32 v0, s77, v0
v_lshrrev_b32 v13, 6, v0
v_bfe_u32 v14, v0, 4, 2
v_readfirstlane_b32 s72, v13
v_and_b32 v15, 15, v0
v_lshlrev_b32 v3, 13, v13
v_lshl_add_u32 v3, v14, 15, v3
v_lshl_add_u32 v3, v15, 4, v3
v_add_u32 v4, 3040, v3
s_mov_b32 s78, 2080
v_and_b32 v128, 63, v0
v_and_b32 v11, 1, v128
v_mul_u32_u24 v11, 1056, v11
v_bfe_u32 v129, v128, 3, 1
v_mad_u32_u24 v11, v129, s78, v11
v_bfe_u32 v129, v128, 1, 2
v_lshl_add_u32 v11, v129, 8, v11
v_lshl_add_u32 v11, v14, 4, v11
v_mul_u32_u24 v129, 4160, v13
v_add_u32 v11, v11, v129
v_lshrrev_b32 v5, 3, v128
v_bfe_u32 v6, v128, 3, 1
v_lshl_add_u32 v6, v13, 1, v6
v_lshl_add_u32 v6, v14, 3, v6
v_lshlrev_b32 v6, 12, v6
v_and_b32 v129, 3, v128
v_lshl_add_u32 v6, v129, 5, v6
v_bfe_u32 v129, v128, 2, 1
v_lshl_add_u32 v6, v129, 4, v6
v_lshlrev_b32 v130, 12, v13
v_add_u32 v130, 134400, v130
v_lshl_add_u32 v5, v14, 10, v130
v_lshl_add_u32 v5, v15, 3, v5
v_xor_b32 v137, 32, v5
v_bfe_u32 v129, v128, 1, 1
v_lshl_add_u32 v56, v14, 9, v130
v_mul_u32_u24 v129, 0x120, v129
v_add_u32 v56, v56, v129
v_and_b32 v129, 1, v128
v_lshl_add_u32 v56, v129, 6, v56
v_bfe_u32 v129, v128, 2, 2
v_lshl_add_u32 v56, v129, 3, v56
v_and_b32 v129, 1, v14
v_lshl_add_u32 v56, v129, 7, v56
v_xor_b32 v57, 32, v56
v_xor_b32 v58, 0x80, v56
v_xor_b32 v59, 0xa0, v56
v_lshlrev_b32 v130, 6, v13
v_add_u32 v130, 150784, v130
v_lshl_add_u32 v60, v15, 2, v130
v_lshl_add_u32 v61, v14, 4, v130
v_bfe_u32 v1, v128, 1, 2
v_mul_u32_u24 v1, 4160, v1
v_and_b32 v129, 1, v128
v_mul_u32_u24 v130, 1056, v129
v_add_u32 v1, v1, v130
v_bfe_u32 v130, v128, 3, 1
v_lshl_add_u32 v1, v130, 8, v1
v_lshl_add_u32 v1, v14, 4, v1
v_sub_u32 v7, v11, v1
v_bfe_u32 v2, v128, 3, 2
v_mul_u32_u24 v2, 4160, v2
v_bfe_u32 v130, v128, 2, 1
v_mul_u32_u24 v130, 1056, v130
v_add_u32 v2, v2, v130
v_lshrrev_b32 v130, 5, v128
v_lshl_add_u32 v2, v130, 8, v2
v_and_b32 v130, 3, v128
v_lshl_add_u32 v2, v130, 3, v2
v_add_u32 v2, 2080, v2
v_mul_u32_u24 v9, 260, v130
v_add_u32 v9, 133120, v9
v_lshlrev_b32 v8, 2, v0
v_add_u32 v8, 133120, v8
v_mov_b32 v10, 1
v_mov_b32 v0, v137
v_and_b32 v6, 1, v15
v_lshl_add_u32 v6, v13, 1, v6
v_bfe_u32 v55, v15, 1, 3
v_lshl_add_u32 v6, v55, 3, v6
v_lshlrev_b32 v6, 12, v6
v_lshl_add_u32 v55, v14, 3, v6
v_lshl_add_u32 v6, v14, 4, v6
s_mul_i32 s57, s72, 16640
v_add_u32 v1, s57, v1
v_add_u32 v2, s57, v2
s_mov_b32 s52, 0
s_mov_b32 s62, s36
s_mov_b32 s63, s37
s_mov_b32 s64, s38
s_mov_b32 s65, s39
s_mov_b32 s66, s40
L_slow_job:
s_mov_b32 s53, 0
L_slow_blk:
s_mov_b64 s[4:5], s[16:17]
s_mov_b32 s6, s64
s_lshl_b32 s58, s53, 18
s_add_u32 s58, s58, s62
buffer_load_dwordx4 v[192:195], v6, s[4:7], s58 offen offset:0
buffer_load_dwordx4 v[196:199], v6, s[4:7], s58 offen offset:64
buffer_load_dwordx4 v[200:203], v6, s[4:7], s58 offen offset:128
buffer_load_dwordx4 v[204:207], v6, s[4:7], s58 offen offset:192
v_mov_b32 v64, 0
v_mov_b32 v65, 0
v_mov_b32 v66, 0
v_mov_b32 v67, 0
v_mov_b32 v68, 0
v_mov_b32 v69, 0
v_mov_b32 v70, 0
v_mov_b32 v71, 0
v_mov_b32 v72, 0
v_mov_b32 v73, 0
v_mov_b32 v74, 0
v_mov_b32 v75, 0
v_mov_b32 v76, 0
v_mov_b32 v77, 0
v_mov_b32 v78, 0
v_mov_b32 v79, 0
v_mov_b32 v80, 0
v_mov_b32 v81, 0
v_mov_b32 v82, 0
v_mov_b32 v83, 0
v_mov_b32 v84, 0
v_mov_b32 v85, 0
v_mov_b32 v86, 0
v_mov_b32 v87, 0
v_mov_b32 v88, 0
v_mov_b32 v89, 0
v_mov_b32 v90, 0
v_mov_b32 v91, 0
v_mov_b32 v92, 0
v_mov_b32 v93, 0
v_mov_b32 v94, 0
v_mov_b32 v95, 0
v_mov_b32 v48, 0xff800000
v_mov_b32 v49, 0
s_mov_b64 s[4:5], s[18:19]
s_mov_b64 s[8:9], s[20:21]
s_add_u32 s10, s64, 2080
s_mov_b32 s55, s63
s_lshr_b32 s56, s64, 12
s_lshr_b32 s77, s63, 12
s_sub_u32 s56, s56, s77
s_mov_b32 s54, s66
L_slow_tile:
s_add_u32 s77, s55, 0
s_add_u32 m0, s57, 0
s_nop 0
buffer_load_dwordx4 v53, s[4:7], s77 offen lds
buffer_load_dwordx4 v53, s[8:11], s77 offen offset:2080 lds
s_add_u32 s77, s55, 4096
s_add_u32 m0, s57, 1056
s_nop 0
buffer_load_dwordx4 v53, s[4:7], s77 offen lds
buffer_load_dwordx4 v53, s[8:11], s77 offen offset:2080 lds
s_add_u32 s77, s55, 8192
s_add_u32 m0, s57, 4160
s_nop 0
buffer_load_dwordx4 v53, s[4:7], s77 offen lds
buffer_load_dwordx4 v53, s[8:11], s77 offen offset:2080 lds
s_add_u32 s77, s55, 12288
s_add_u32 m0, s57, 5216
s_nop 0
buffer_load_dwordx4 v53, s[4:7], s77 offen lds
buffer_load_dwordx4 v53, s[8:11], s77 offen offset:2080 lds
s_add_u32 s77, s55, 16384
s_add_u32 m0, s57, 8320
s_nop 0
buffer_load_dwordx4 v53, s[4:7], s77 offen lds
buffer_load_dwordx4 v53, s[8:11], s77 offen offset:2080 lds
s_add_u32 s77, s55, 20480
s_add_u32 m0, s57, 9376
s_nop 0
buffer_load_dwordx4 v53, s[4:7], s77 offen lds
buffer_load_dwordx4 v53, s[8:11], s77 offen offset:2080 lds
s_add_u32 s77, s55, 24576
s_add_u32 m0, s57, 12480
s_nop 0
buffer_load_dwordx4 v53, s[4:7], s77 offen lds
buffer_load_dwordx4 v53, s[8:11], s77 offen offset:2080 lds
s_add_u32 s77, s55, 28672
s_add_u32 m0, s57, 13536
s_nop 0
buffer_load_dwordx4 v53, s[4:7], s77 offen lds
buffer_load_dwordx4 v53, s[8:11], s77 offen offset:2080 lds
s_waitcnt vmcnt(0)
ds_read_b128 v[128:131], v1 offset:0
ds_read_b128 v[132:135], v1 offset:64
ds_read_b128 v[136:139], v1 offset:128
ds_read_b128 v[140:143], v1 offset:192
ds_read_b128 v[144:147], v1 offset:512
ds_read_b128 v[148:151], v1 offset:576
ds_read_b128 v[152:155], v1 offset:640
ds_read_b128 v[156:159], v1 offset:704
s_waitcnt lgkmcnt(0)
ds_read_b64_tr_b16 v[160:161], v2 offset:0
ds_read_b64_tr_b16 v[162:163], v2 offset:512
ds_read_b64_tr_b16 v[164:165], v2 offset:32
ds_read_b64_tr_b16 v[166:167], v2 offset:544
ds_read_b64_tr_b16 v[168:169], v2 offset:64
ds_read_b64_tr_b16 v[170:171], v2 offset:576
ds_read_b64_tr_b16 v[172:173], v2 offset:96
ds_read_b64_tr_b16 v[174:175], v2 offset:608
ds_read_b64_tr_b16 v[176:177], v2 offset:128
ds_read_b64_tr_b16 v[178:179], v2 offset:640
ds_read_b64_tr_b16 v[180:181], v2 offset:160
ds_read_b64_tr_b16 v[182:183], v2 offset:672
ds_read_b64_tr_b16 v[184:185], v2 offset:192
ds_read_b64_tr_b16 v[186:187], v2 offset:704
ds_read_b64_tr_b16 v[188:189], v2 offset:224
ds_read_b64_tr_b16 v[190:191], v2 offset:736
v_mfma_f32_16x16x32_bf16 v[24:27], v[128:131], v[192:195], 0
v_mfma_f32_16x16x32_bf16 v[24:27], v[132:135], v[196:199], v[24:27]
v_mfma_f32_16x16x32_bf16 v[24:27], v[136:139], v[200:203], v[24:27]
v_mfma_f32_16x16x32_bf16 v[24:27], v[140:143], v[204:207], v[24:27]
v_mfma_f32_16x16x32_bf16 v[28:31], v[144:147], v[192:195], 0
v_mfma_f32_16x16x32_bf16 v[28:31], v[148:151], v[196:199], v[28:31]
v_mfma_f32_16x16x32_bf16 v[28:31], v[152:155], v[200:203], v[28:31]
v_mfma_f32_16x16x32_bf16 v[28:31], v[156:159], v[204:207], v[28:31]
v_mov_b32 v52, 0xff800000
s_nop 2
v_mul_f32 v24, s74, v24
v_mul_f32 v25, s74, v25
v_mul_f32 v26, s74, v26
v_mul_f32 v27, s74, v27
v_mul_f32 v28, s74, v28
v_mul_f32 v29, s74, v29
v_mul_f32 v30, s74, v30
v_mul_f32 v31, s74, v31
v_add_u32 v51, 0, v54
v_cmp_gt_u32 vcc, s56, v51
s_nop 1
v_cndmask_b32 v24, v52, v24, vcc
v_add_u32 v51, 1, v54
v_cmp_gt_u32 vcc, s56, v51
s_nop 1
v_cndmask_b32 v25, v52, v25, vcc
v_add_u32 v51, 2, v54
v_cmp_gt_u32 vcc, s56, v51
s_nop 1
v_cndmask_b32 v26, v52, v26, vcc
v_add_u32 v51, 3, v54
v_cmp_gt_u32 vcc, s56, v51
s_nop 1
v_cndmask_b32 v27, v52, v27, vcc
v_add_u32 v51, 16, v54
v_cmp_gt_u32 vcc, s56, v51
s_nop 1
v_cndmask_b32 v28, v52, v28, vcc
v_add_u32 v51, 17, v54
v_cmp_gt_u32 vcc, s56, v51
s_nop 1
v_cndmask_b32 v29, v52, v29, vcc
v_add_u32 v51, 18, v54
v_cmp_gt_u32 vcc, s56, v51
s_nop 1
v_cndmask_b32 v30, v52, v30, vcc
v_add_u32 v51, 19, v54
v_cmp_gt_u32 vcc, s56, v51
s_nop 1
v_cndmask_b32 v31, v52, v31, vcc
v_max3_f32 v51, v24, v25, v26
v_max3_f32 v51, v51, v27, v28
v_max3_f32 v51, v51, v29, v30
v_max3_f32 v51, v51, v31, v48
v_mov_b32 v52, v51
s_nop 1
v_permlane16_swap_b32 v51, v52
v_max_f32 v51, v51, v52
v_mov_b32 v52, v51
s_nop 1
v_permlane32_swap_b32 v51, v52
v_max_f32 v51, v51, v52
v_sub_f32 v50, v48, v51
v_exp_f32 v50, v50
v_mov_b32 v48, v51
v_sub_f32 v24, v24, v48
v_sub_f32 v25, v25, v48
v_sub_f32 v26, v26, v48
v_sub_f32 v27, v27, v48
v_sub_f32 v28, v28, v48
v_sub_f32 v29, v29, v48
v_sub_f32 v30, v30, v48
v_sub_f32 v31, v31, v48
v_exp_f32 v24, v24
v_exp_f32 v25, v25
v_exp_f32 v26, v26
v_exp_f32 v27, v27
v_exp_f32 v28, v28
v_exp_f32 v29, v29
v_exp_f32 v30, v30
v_exp_f32 v31, v31
v_mul_f32 v49, v49, v50
v_add_f32 v49, v49, v24
v_add_f32 v49, v49, v25
v_add_f32 v49, v49, v26
v_add_f32 v49, v49, v27
v_add_f32 v49, v49, v28
v_add_f32 v49, v49, v29
v_add_f32 v49, v49, v30
v_add_f32 v49, v49, v31
v_cvt_pk_bf16_f32 v40, v24, v25
v_cvt_pk_bf16_f32 v41, v26, v27
v_cvt_pk_bf16_f32 v42, v28, v29
v_cvt_pk_bf16_f32 v43, v30, v31
v_mul_f32 v64, v64, v50
v_mul_f32 v65, v65, v50
v_mul_f32 v66, v66, v50
v_mul_f32 v67, v67, v50
v_mul_f32 v68, v68, v50
v_mul_f32 v69, v69, v50
v_mul_f32 v70, v70, v50
v_mul_f32 v71, v71, v50
v_mul_f32 v72, v72, v50
v_mul_f32 v73, v73, v50
v_mul_f32 v74, v74, v50
v_mul_f32 v75, v75, v50
v_mul_f32 v76, v76, v50
v_mul_f32 v77, v77, v50
v_mul_f32 v78, v78, v50
v_mul_f32 v79, v79, v50
v_mul_f32 v80, v80, v50
v_mul_f32 v81, v81, v50
v_mul_f32 v82, v82, v50
v_mul_f32 v83, v83, v50
v_mul_f32 v84, v84, v50
v_mul_f32 v85, v85, v50
v_mul_f32 v86, v86, v50
v_mul_f32 v87, v87, v50
v_mul_f32 v88, v88, v50
v_mul_f32 v89, v89, v50
v_mul_f32 v90, v90, v50
v_mul_f32 v91, v91, v50
v_mul_f32 v92, v92, v50
v_mul_f32 v93, v93, v50
v_mul_f32 v94, v94, v50
v_mul_f32 v95, v95, v50
s_waitcnt lgkmcnt(0)
v_mfma_f32_16x16x32_bf16 v[64:67], v[160:163], v[40:43], v[64:67]
v_mfma_f32_16x16x32_bf16 v[68:71], v[164:167], v[40:43], v[68:71]
v_mfma_f32_16x16x32_bf16 v[72:75], v[168:171], v[40:43], v[72:75]
v_mfma_f32_16x16x32_bf16 v[76:79], v[172:175], v[40:43], v[76:79]
v_mfma_f32_16x16x32_bf16 v[80:83], v[176:179], v[40:43], v[80:83]
v_mfma_f32_16x16x32_bf16 v[84:87], v[180:183], v[40:43], v[84:87]
v_mfma_f32_16x16x32_bf16 v[88:91], v[184:187], v[40:43], v[88:91]
v_mfma_f32_16x16x32_bf16 v[92:95], v[188:191], v[40:43], v[92:95]
s_add_u32 s55, s55, 131072
s_sub_u32 s56, s56, 32
s_nop 7
s_sub_u32 s54, s54, 1
s_cmp_lg_u32 s54, 0
s_cbranch_scc1 L_slow_tile
v_mov_b32 v52, v49
s_nop 1
v_permlane16_swap_b32 v49, v52
v_add_f32 v49, v49, v52
v_mov_b32 v52, v49
s_nop 1
v_permlane32_swap_b32 v49, v52
v_add_f32 v49, v49, v52
v_rcp_f32 v49, v49
s_mov_b32 s14, s64
v_mul_f32 v64, v64, v49
v_mul_f32 v65, v65, v49
v_mul_f32 v66, v66, v49
v_mul_f32 v67, v67, v49
v_mul_f32 v68, v68, v49
v_mul_f32 v69, v69, v49
v_mul_f32 v70, v70, v49
v_mul_f32 v71, v71, v49
v_mul_f32 v72, v72, v49
v_mul_f32 v73, v73, v49
v_mul_f32 v74, v74, v49
v_mul_f32 v75, v75, v49
v_mul_f32 v76, v76, v49
v_mul_f32 v77, v77, v49
v_mul_f32 v78, v78, v49
v_mul_f32 v79, v79, v49
v_mul_f32 v80, v80, v49
v_mul_f32 v81, v81, v49
v_mul_f32 v82, v82, v49
v_mul_f32 v83, v83, v49
v_mul_f32 v84, v84, v49
v_mul_f32 v85, v85, v49
v_mul_f32 v86, v86, v49
v_mul_f32 v87, v87, v49
v_mul_f32 v88, v88, v49
v_mul_f32 v89, v89, v49
v_mul_f32 v90, v90, v49
v_mul_f32 v91, v91, v49
v_mul_f32 v92, v92, v49
v_mul_f32 v93, v93, v49
v_mul_f32 v94, v94, v49
v_mul_f32 v95, v95, v49
v_cvt_pk_bf16_f32 v64, v64, v65
v_cvt_pk_bf16_f32 v65, v66, v67
buffer_store_dwordx2 v[64:65], v55, s[12:15], s58 offen offset:0
v_cvt_pk_bf16_f32 v68, v68, v69
v_cvt_pk_bf16_f32 v69, v70, v71
buffer_store_dwordx2 v[68:69], v55, s[12:15], s58 offen offset:32
v_cvt_pk_bf16_f32 v72, v72, v73
v_cvt_pk_bf16_f32 v73, v74, v75
buffer_store_dwordx2 v[72:73], v55, s[12:15], s58 offen offset:64
v_cvt_pk_bf16_f32 v76, v76, v77
v_cvt_pk_bf16_f32 v77, v78, v79
buffer_store_dwordx2 v[76:77], v55, s[12:15], s58 offen offset:96
v_cvt_pk_bf16_f32 v80, v80, v81
v_cvt_pk_bf16_f32 v81, v82, v83
buffer_store_dwordx2 v[80:81], v55, s[12:15], s58 offen offset:128
v_cvt_pk_bf16_f32 v84, v84, v85
v_cvt_pk_bf16_f32 v85, v86, v87
buffer_store_dwordx2 v[84:85], v55, s[12:15], s58 offen offset:160
v_cvt_pk_bf16_f32 v88, v88, v89
v_cvt_pk_bf16_f32 v89, v90, v91
buffer_store_dwordx2 v[88:89], v55, s[12:15], s58 offen offset:192
v_cvt_pk_bf16_f32 v92, v92, v93
v_cvt_pk_bf16_f32 v93, v94, v95
buffer_store_dwordx2 v[92:93], v55, s[12:15], s58 offen offset:224
s_waitcnt vmcnt(0)
s_add_u32 s53, s53, 1
s_cmp_lt_u32 s53, s65
s_cbranch_scc1 L_slow_blk
s_cmp_lg_u32 s52, 0
s_cbranch_scc1 L_end
s_mov_b32 s52, 1
s_mov_b32 s62, s41
s_mov_b32 s63, s42
s_mov_b32 s64, s43
s_mov_b32 s65, s44
s_mov_b32 s66, s45
s_cmp_lg_u32 s65, 0
s_cbranch_scc1 L_slow_job
s_branch L_end
.p2align 4
L_table:
.long 0x1b3cdaa, 0x21eadaa, 0x0, 0x0
.long 0x1b1cdaa, 0x21eadaa, 0x0, 0x0
.long 0x203a43d, 0x104443d, 0x0, 0x0
.long 0x203a57d, 0x104443d, 0x0, 0x0
.long 0x201a43d, 0x104443d, 0x0, 0x0
.long 0x201a57d, 0x104443d, 0x0, 0x0
.long 0x1f3b3d7, 0x2f353d7, 0x0, 0x0
.long 0x1f3b517, 0x2f353d7, 0x0, 0x0
.long 0x1f1b3d7, 0x2f353d7, 0x0, 0x0
.long 0x1f1b517, 0x2f353d7, 0x0, 0x0
.long 0x1b3af2a, 0x21eadaa, 0x0, 0x0
.long 0x1b1af2a, 0x21eadaa, 0x0, 0x0
.long 0x18390f5, 0x27af0f5, 0x1336000, 0x488000
.long 0x18391f5, 0x27af0f5, 0x13360c0, 0x488000
.long 0x18392f5, 0x27af0f5, 0x1316000, 0x488000
.long 0x20366bd, 0x104443d, 0x13160c0, 0x488000
.long 0x203677d, 0x104443d, 0x1028244, 0x87a244
.long 0x20166bd, 0x104443d, 0x1028344, 0x87a244
.long 0x201677d, 0x104443d, 0x1008244, 0x87a244
.long 0x1f37657, 0x2f353d7, 0x1008344, 0x87a244
.long 0x1f37717, 0x2f353d7, 0x1626aed, 0x1b54aed
.long 0x1f17657, 0x2f353d7, 0x1606aed, 0x1b54aed
.long 0x1f17717, 0x2f353d7, 0x1736822, 0x15da822
.long 0x17368e2, 0x15da822, 0x1718822, 0x15da822
.long 0x17369a2, 0x15da822, 0x1718922, 0x15da822
.long 0x1736a62, 0x15da822, 0x1718a22, 0x15da822
.long 0x18170f5, 0x27af0f5, 0x1628bad, 0x1b54aed
.long 0x18171b5, 0x27af0f5, 0x1628cad, 0x1b54aed
.long 0x1817275, 0x27af0f5, 0x1608bad, 0x1b54aed
.long 0x1817335, 0x27af0f5, 0x1608cad, 0x1b54aed
.long 0x1b3706a, 0x21eadaa, 0x1338180, 0x488000
.long 0x1b1706a, 0x21eadaa, 0x1318180, 0x488000
.section .rodata,"a"
.p2align 6
.amdhsa_kernel standalone__varlen_attn_packed__ragged_kernel
  .amdhsa_next_free_vgpr 512
  .amdhsa_next_free_sgpr 102
  .amdhsa_accum_offset 256
  .amdhsa_group_segment_fixed_size 0
  .amdhsa_kernarg_size 56
  .amdhsa_user_sgpr_count 2
  .amdhsa_user_sgpr_kernarg_segment_ptr 1
  .amdhsa_system_sgpr_workgroup_id_x 1
.end_amdhsa_kernel
```
